```python
import torch

def _softmax(x, axis=-1):
    return torch.softmax(x, dim=axis)
def _gelu(x):
    return torch.nn.functional.gelu(x, approximate="tanh")
def _silu(x):
    return torch.nn.functional.silu(x)
def _sigmoid(x):
    return torch.sigmoid(x)
def _layernorm(x, axis=-1, eps=1e-5):
    m = x.mean(dim=axis, keepdim=True)
    v = x.var(dim=axis, keepdim=True, unbiased=False)
    return (x - m) / torch.sqrt(v + eps)
def _scatter_add(tgt, idx, src, axis=0):
    return tgt.clone().index_add_(axis, idx, src)
def _segment_sum(src, seg, n):
    out = torch.zeros((n,) + src.shape[1:], dtype=src.dtype)
    return out.index_add_(0, seg, src)
def _pad(x, pw):
    flat = tuple(v for pair in reversed(pw) for v in pair)
    return torch.nn.functional.pad(x, flat)

kernel_name = 'recurrent_scan__sliding_local_dilated__glu_gated_reglu__prompt'

def setup_inputs():

    _w = (lambda a: (lambda t: t.to(torch.bfloat16) if t.is_floating_point() else t)(torch.as_tensor(a)))
    def _A_setup():
        B, S, D = 1, 2048, 576
        return {
            "x": _w((lambda *s: torch.randn(*s, dtype=torch.bfloat16) * 0.05)(B, S, D)),
            "wqkv": _w((lambda *s: torch.randn(*s, dtype=torch.bfloat16) * 0.2)(D, 3 * D)),
            "wo": _w((lambda *s: torch.randn(*s, dtype=torch.bfloat16) * 0.2)(D, D)),
        }
    _A_in = _A_setup()

    def _B_setup():
        B, S, D, F = 1, 2048, 576, 4608
        return {
            "x": _w((lambda *s: torch.randn(*s, dtype=torch.bfloat16) * 0.05)(B, S, D)),
            "W_gate": _w((lambda *s: torch.randn(*s, dtype=torch.bfloat16) * 0.1)(D, F) * (2.0 / D) ** 0.5),
            "W_up": _w((lambda *s: torch.randn(*s, dtype=torch.bfloat16) * 0.1)(D, F) * (2.0 / D) ** 0.5),
            "W_down": _w((lambda *s: torch.randn(*s, dtype=torch.bfloat16) * 0.1)(F, D) * (1.0 / F) ** 0.5),
        }
    _B_in = _B_setup()

    return {
        "A_x": _A_in["x"],
        "A_wqkv": _A_in["wqkv"],
        "A_wo": _A_in["wo"],
        "B_x": _B_in["x"],
        "B_W_gate": _B_in["W_gate"],
        "B_W_up": _B_in["W_up"],
        "B_W_down": _B_in["W_down"],
    }

def reference(A_x, A_wqkv, A_wo, B_x, B_W_gate, B_W_up, B_W_down):
    def _A_ref(x, wqkv, wo):
        B, S, D = x.shape
        H = 32; Dh = D // H
        W, dil = 8, 2
        qkv = (lambda x, *d: x.permute(*d))((x @ wqkv).reshape(B, S, 3, H, Dh), 2, 0, 3, 1, 4)
        q, k, v = qkv[0], qkv[1], qkv[2]
        scale = Dh ** -0.5
        pos = torch.arange(S)
        off = torch.arange(W) * dil
        idx = pos[:, None] - off[None, :]
        mask = idx >= 0
        idx_c = torch.where(mask, idx, 0).reshape(-1)
        kg = k[:, :, idx_c, :].reshape(B, H, S, W, Dh)
        vg = v[:, :, idx_c, :].reshape(B, H, S, W, Dh)
        logits = torch.einsum("bhsd,bhswd->bhsw", q, kg) * scale
        logits = torch.where(mask[None, None, :, :], logits, -1e9)
        attn = _softmax(logits, axis=-1)
        o = torch.einsum("bhsw,bhswd->bhsd", attn, vg)
        return (lambda x, *d: x.permute(*d))(o, 0, 2, 1, 3).reshape(B, S, D) @ wo

    def _B_ref(x, W_gate, W_up, W_down):
        gate = torch.einsum("bsd,df->bsf", x, W_gate)
        up = torch.einsum("bsd,df->bsf", x, W_up)
        gate = gate * (lambda x, dt: x.to(dt))(gate > 0, gate.dtype)
        h = gate * up
        return torch.einsum("bsf,fd->bsd", h, W_down)

    x = A_x
    xn = _layernorm(x, axis=-1)
    s = _A_ref(xn, A_wqkv, A_wo)
    g = _silu(_B_ref(xn, B_W_gate, B_W_up, B_W_down))
    return x + s * g
```

```asm
; @launch grid=(256,1,1) block=(512,1,1) lds=163840
.amdgcn_target "amdgcn-amd-amdhsa--gfx950"
.text
.globl recurrent_scan__sliding_local_dilated__glu_gated_reglu__prompt_kernel
.p2align 8
.type recurrent_scan__sliding_local_dilated__glu_gated_reglu__prompt_kernel,@function
recurrent_scan__sliding_local_dilated__glu_gated_reglu__prompt_kernel:
    s_cmp_ge_u32 s2, 256
    s_cbranch_scc1 L_exit
    s_load_dwordx4 s[64:67], s[0:1], 0
    s_load_dwordx2 s[68:69], s[0:1], 16
    s_load_dwordx4 s[72:75], s[0:1], 32
    s_load_dwordx4 s[76:79], s[0:1], 48
    s_load_dwordx4 s[80:83], s[0:1], 64
    s_getpc_b64 s[52:53]
L_pc:
    v_and_b32 v1, 63, v0
    v_lshrrev_b32 v2, 6, v0
    v_lshlrev_b32 v2, 2, v2
    v_min_u32 v1, 3, v1
    v_add_u32 v1, v1, v2
    s_lshr_b32 s54, s2, 3
    s_lshl_b32 s54, s54, 5
    v_add_u32 v1, s54, v1
    v_lshlrev_b32 v1, 7, v1
    v_min_u32 v1, (L_code_end-L_pc-4), v1
    global_load_dword v255, v1, s[52:53]
    v_lshrrev_b32 v1, 6, v0
    v_and_b32 v0, 63, v0
    s_nop 0
    v_readfirstlane_b32 s36, v1
    s_and_b32 s51, s2, 7
    s_lshr_b32 s43, s51, 1
    s_and_b32 s51, s51, 1
    s_lshr_b32 s54, s2, 3
    s_lshr_b32 s39, s54, 2
    s_lshl_b32 s51, s51, 3
    s_add_u32 s39, s39, s51
    s_and_b32 s42, s54, 3
    s_lshl_b32 s40, s43, 2
    s_add_u32 s40, s40, s42
    s_and_b32 s41, s40, 1
    s_and_b32 s37, s36, 3
    s_lshr_b32 s38, s36, 2
    s_mov_b32 s48, 0x3f80
    s_mov_b32 s49, 0x3f800000
    s_mov_b32 s50, 0x3f803f80
    s_waitcnt lgkmcnt(0)
    s_mul_i32 s51, s39, 147456
    s_add_u32 s4, s64, s51
    s_addc_u32 s5, s65, 0
    s_mov_b32 s6, 147456
    s_mov_b32 s7, 0x20000
    s_lshl_b32 s51, s37, 5
    s_mul_i32 s59, s38, 16
    s_add_u32 s51, s51, s59
    v_lshrrev_b32 v1, 3, v0
    v_add_u32 v1, s51, v1
    v_mul_u32_u24 v1, 1152, v1
    v_lshrrev_b32 v2, 4, v0
    v_and_b32 v3, 7, v0
    v_xor_b32 v4, v3, v2
    v_lshl_add_u32 v5, v4, 4, v1
    v_xor_b32 v4, 4, v4
    v_lshl_add_u32 v6, v4, 4, v1
    v_add_u32 v6, 9216, v6
    s_mul_i32 s54, s37, 36864
    s_mul_i32 s59, s38, 18432
    s_add_u32 s54, s54, s59
    s_mov_b32 m0, s54
    s_movk_i32 s46, 0
    buffer_load_dwordx4 v5, s[4:7], s46 offen lds
    s_add_u32 m0, m0, 1024
    s_nop 0
    buffer_load_dwordx4 v6, s[4:7], s46 offen lds
    s_add_u32 m0, m0, 1024
    s_movk_i32 s46, 128
    buffer_load_dwordx4 v5, s[4:7], s46 offen lds
    s_add_u32 m0, m0, 1024
    s_nop 0
    buffer_load_dwordx4 v6, s[4:7], s46 offen lds
    s_add_u32 m0, m0, 1024
    s_movk_i32 s46, 256
    buffer_load_dwordx4 v5, s[4:7], s46 offen lds
    s_add_u32 m0, m0, 1024
    s_nop 0
    buffer_load_dwordx4 v6, s[4:7], s46 offen lds
    s_add_u32 m0, m0, 1024
    s_movk_i32 s46, 384
    buffer_load_dwordx4 v5, s[4:7], s46 offen lds
    s_add_u32 m0, m0, 1024
    s_nop 0
    buffer_load_dwordx4 v6, s[4:7], s46 offen lds
    s_add_u32 m0, m0, 1024
    s_movk_i32 s46, 512
    buffer_load_dwordx4 v5, s[4:7], s46 offen lds
    s_add_u32 m0, m0, 1024
    s_nop 0
    buffer_load_dwordx4 v6, s[4:7], s46 offen lds
    s_add_u32 m0, m0, 1024
    s_movk_i32 s46, 640
    buffer_load_dwordx4 v5, s[4:7], s46 offen lds
    s_add_u32 m0, m0, 1024
    s_nop 0
    buffer_load_dwordx4 v6, s[4:7], s46 offen lds
    s_add_u32 m0, m0, 1024
    s_movk_i32 s46, 768
    buffer_load_dwordx4 v5, s[4:7], s46 offen lds
    s_add_u32 m0, m0, 1024
    s_nop 0
    buffer_load_dwordx4 v6, s[4:7], s46 offen lds
    s_add_u32 m0, m0, 1024
    s_movk_i32 s46, 896
    buffer_load_dwordx4 v5, s[4:7], s46 offen lds
    s_add_u32 m0, m0, 1024
    s_nop 0
    buffer_load_dwordx4 v6, s[4:7], s46 offen lds
    s_add_u32 m0, m0, 1024
    s_movk_i32 s46, 1024
    buffer_load_dwordx4 v5, s[4:7], s46 offen lds
    s_add_u32 m0, m0, 1024
    s_nop 0
    buffer_load_dwordx4 v6, s[4:7], s46 offen lds
    s_add_u32 m0, m0, 1024
    s_lshr_b32 s51, s40, 1
    s_mul_i32 s51, s51, 1152
    s_add_u32 s8, s72, s51
    s_addc_u32 s9, s73, 0
    s_sub_u32 s10, 5308416, s51
    s_mov_b32 s11, 0x20000
    s_add_u32 s28, s74, s51
    s_addc_u32 s29, s75, 0
    s_sub_u32 s30, 5308416, s51
    s_mov_b32 s31, 0x20000
    s_mul_i32 s51, s40, 72
    s_andn2_b32 s51, s51, 63
    s_add_u32 s12, s66, s51
    s_addc_u32 s13, s67, 0
    s_sub_u32 s14, 1990656, s51
    s_mov_b32 s15, 0x20000
    s_mul_i32 s51, s39, 1179648
    s_mul_i32 s59, s37, 294912
    s_add_u32 s51, s51, s59
    s_mul_i32 s59, s40, 18432
    s_add_u32 s51, s51, s59
    s_add_u32 s16, s82, s51
    s_addc_u32 s17, s83, 0
    s_mov_b32 s18, 18432
    s_mov_b32 s19, 0x20000
    s_mov_b32 s24, s82
    s_mov_b32 s25, s83
    s_mov_b32 s26, 268435456
    s_mov_b32 s27, 0x20000
    s_getpc_b64 s[72:73]
L_pc2:
    s_add_u32 s72, s72, (L_tab-L_pc2)
    s_addc_u32 s73, s73, 0
    s_mov_b32 s74, (L_tab_end-L_tab)
    s_mov_b32 s75, 0x20000
    s_mul_i32 s44, s37, 3072
    s_and_b32 s51, s37, 1
    s_lshr_b32 s52, s37, 1
    s_lshl_b32 s52, s52, 2
    s_add_u32 s51, s51, s52
    s_mul_i32 s45, s51, 3072
    s_lshl_b32 s51, s38, 11
    s_mul_i32 s59, s41, 2048
    s_add_u32 s51, s51, s59
    s_lshl_b32 s52, s38, 10
    s_add_u32 s53, s51, s52
    v_lshlrev_b32 v1, 4, v0
    v_add_u32 v12, s53, v1
    s_sub_u32 s53, s51, s52
    s_add_u32 s53, s53, 1024
    v_add_u32 v13, s53, v1
    v_lshrrev_b32 v176, 4, v0
    v_bfe_u32 v177, v0, 2, 2
    v_lshl_add_u32 v1, v176, 2, v177
    v_lshlrev_b32 v1, 7, v1
    v_and_b32 v2, 3, v0
    v_lshl_add_u32 v1, v2, 3, v1
    v_lshrrev_b32 v177, 1, v177
    v_and_b32 v176, 1, v176
    v_lshl_or_b32 v176, v176, 1, v177
    s_lshl_b32 s51, s38, 1
    v_xor_b32 v2, s51, v176
    v_lshl_add_u32 v3, v2, 5, v1
    v_add_u32 v4, 49152, v3
    v_add_u32 v5, 98304, v3
    s_lshl_b32 s51, s38, 1
    s_add_u32 s51, s51, 1
    v_xor_b32 v2, s51, v176
    v_lshl_add_u32 v6, v2, 5, v1
    v_add_u32 v7, 49152, v6
    v_add_u32 v8, 98304, v6
    s_mul_i32 s54, s41, 640
    v_lshrrev_b32 v1, 4, v0
    v_lshlrev_b32 v1, 1, v1
    v_and_b32 v2, 7, v0
    v_xor_b32 v1, v1, v2
    v_lshlrev_b32 v1, 4, v1
    s_mul_i32 s51, s37, 24
    v_lshrrev_b32 v2, 3, v0
    v_add_u32 v2, s51, v2
    v_mul_u32_u24 v2, 9216, v2
    v_add3_u32 v1, v1, v2, s54
    v_subrev_u32 v9, 0, v1
    v_lshrrev_b32 v1, 4, v0
    v_lshlrev_b32 v1, 1, v1
    v_and_b32 v2, 7, v0
    v_xor_b32 v1, v1, v2
    v_lshlrev_b32 v1, 4, v1
    s_mul_i32 s51, s37, 24
    s_add_u32 s51, s51, 8
    v_lshrrev_b32 v2, 3, v0
    v_add_u32 v2, s51, v2
    v_mul_u32_u24 v2, 9216, v2
    v_add3_u32 v1, v1, v2, s54
    v_subrev_u32 v10, 1024, v1
    v_lshrrev_b32 v1, 4, v0
    v_lshlrev_b32 v1, 1, v1
    v_and_b32 v2, 7, v0
    v_xor_b32 v1, v1, v2
    v_lshlrev_b32 v1, 4, v1
    s_mul_i32 s51, s37, 24
    s_add_u32 s51, s51, 16
    v_lshrrev_b32 v2, 3, v0
    v_add_u32 v2, s51, v2
    v_mul_u32_u24 v2, 9216, v2
    v_add3_u32 v1, v1, v2, s54
    v_subrev_u32 v11, 2048, v1
    s_cmp_eq_u32 s38, 0
    s_cselect_b64 vcc, -1, 0
    s_cbranch_vccnz Lr_1
    s_lshl_b32 s51, s41, 11
    v_lshlrev_b32 v1, 4, v0
    v_add_u32 v9, s51, v1
    s_lshl_b32 s51, s37, 11
    s_add_u32 s51, s51, 147456
    v_add_u32 v10, s51, v1
Lr_1:
    v_and_b32 v1, 15, v0
    v_lshrrev_b32 v2, 3, v1
    v_lshlrev_b32 v2, 10, v2
    v_and_b32 v228, 7, v1
    v_lshl_add_u32 v2, v228, 7, v2
    v_bfe_u32 v228, v1, 1, 3
    v_lshrrev_b32 v229, 4, v0
    v_xor_b32 v228, v228, v229
    v_lshl_add_u32 v2, v228, 4, v2
    s_mul_i32 s51, s37, 36864
    s_mul_i32 s52, s38, 18432
    s_add_u32 s53, s51, s52
    v_add_u32 v224, s53, v2
    v_xor_b32 v225, 64, v224
    s_sub_u32 s53, s51, s52
    s_add_u32 s53, s53, 18432
    v_add_u32 v226, s53, v2
    v_xor_b32 v227, 64, v226
    s_lshl_b32 s51, s37, 5
    s_lshl_b32 s52, s38, 4
    s_add_u32 s53, s51, s52
    v_add_u32 v230, s53, v1
    v_lshlrev_b32 v230, 3, v230
    s_sub_u32 s53, s51, s52
    s_add_u32 s53, s53, 16
    v_add_u32 v231, s53, v1
    v_lshlrev_b32 v231, 3, v231
    v_add_u32 v230, 161792, v230
    v_add_u32 v231, 161792, v231
    v_lshlrev_b32 v1, 4, v0
    s_mov_b32 s59, 28672
    buffer_load_dwordx4 v[172:175], v1, s[72:75], s59 offen offset:3840
    s_mov_b32 s59, 32768
    buffer_load_dwordx4 v[176:179], v1, s[72:75], s59 offen offset:768
    v_mov_b32 v232, s50
    v_mov_b32 v233, s50
    v_mov_b32 v234, s50
    v_mov_b32 v235, s50
    v_mov_b32 v164, 0
    v_mov_b32 v165, 0
    s_waitcnt vmcnt(18)
    ds_read_b128 v[16:19], v224 offset:0
    ds_read_b128 v[20:23], v225 offset:0
    s_waitcnt vmcnt(16)
    ds_read_b128 v[24:27], v224 offset:2048
    ds_read_b128 v[28:31], v225 offset:2048
    s_waitcnt lgkmcnt(3)
    v_mfma_f32_16x16x32_bf16 v[160:163], v[232:235], v[16:19], 0
    v_dot2c_f32_bf16 v164, v16, v16
    v_dot2c_f32_bf16 v165, v17, v17
    v_dot2c_f32_bf16 v164, v18, v18
    v_dot2c_f32_bf16 v165, v19, v19
    s_waitcnt lgkmcnt(2)
    v_mfma_f32_16x16x32_bf16 v[160:163], v[232:235], v[20:23], v[160:163]
    v_dot2c_f32_bf16 v164, v20, v20
    v_dot2c_f32_bf16 v165, v21, v21
    v_dot2c_f32_bf16 v164, v22, v22
    v_dot2c_f32_bf16 v165, v23, v23
    s_waitcnt vmcnt(14)
    ds_read_b128 v[32:35], v224 offset:4096
    ds_read_b128 v[36:39], v225 offset:4096
    s_waitcnt lgkmcnt(3)
    v_mfma_f32_16x16x32_bf16 v[160:163], v[232:235], v[24:27], v[160:163]
    v_dot2c_f32_bf16 v164, v24, v24
    v_dot2c_f32_bf16 v165, v25, v25
    v_dot2c_f32_bf16 v164, v26, v26
    v_dot2c_f32_bf16 v165, v27, v27
    s_waitcnt lgkmcnt(2)
    v_mfma_f32_16x16x32_bf16 v[160:163], v[232:235], v[28:31], v[160:163]
    v_dot2c_f32_bf16 v164, v28, v28
    v_dot2c_f32_bf16 v165, v29, v29
    v_dot2c_f32_bf16 v164, v30, v30
    v_dot2c_f32_bf16 v165, v31, v31
    s_waitcnt vmcnt(12)
    ds_read_b128 v[40:43], v224 offset:6144
    ds_read_b128 v[44:47], v225 offset:6144
    s_waitcnt lgkmcnt(3)
    v_mfma_f32_16x16x32_bf16 v[160:163], v[232:235], v[32:35], v[160:163]
    v_dot2c_f32_bf16 v164, v32, v32
    v_dot2c_f32_bf16 v165, v33, v33
    v_dot2c_f32_bf16 v164, v34, v34
    v_dot2c_f32_bf16 v165, v35, v35
    s_waitcnt lgkmcnt(2)
    v_mfma_f32_16x16x32_bf16 v[160:163], v[232:235], v[36:39], v[160:163]
    v_dot2c_f32_bf16 v164, v36, v36
    v_dot2c_f32_bf16 v165, v37, v37
    v_dot2c_f32_bf16 v164, v38, v38
    v_dot2c_f32_bf16 v165, v39, v39
    s_waitcnt vmcnt(10)
    ds_read_b128 v[48:51], v224 offset:8192
    ds_read_b128 v[52:55], v225 offset:8192
    s_waitcnt lgkmcnt(3)
    v_mfma_f32_16x16x32_bf16 v[160:163], v[232:235], v[40:43], v[160:163]
    v_dot2c_f32_bf16 v164, v40, v40
    v_dot2c_f32_bf16 v165, v41, v41
    v_dot2c_f32_bf16 v164, v42, v42
    v_dot2c_f32_bf16 v165, v43, v43
    s_waitcnt lgkmcnt(2)
    v_mfma_f32_16x16x32_bf16 v[160:163], v[232:235], v[44:47], v[160:163]
    v_dot2c_f32_bf16 v164, v44, v44
    v_dot2c_f32_bf16 v165, v45, v45
    v_dot2c_f32_bf16 v164, v46, v46
    v_dot2c_f32_bf16 v165, v47, v47
    s_waitcnt vmcnt(8)
    ds_read_b128 v[56:59], v224 offset:10240
    ds_read_b128 v[60:63], v225 offset:10240
    s_waitcnt lgkmcnt(3)
    v_mfma_f32_16x16x32_bf16 v[160:163], v[232:235], v[48:51], v[160:163]
    v_dot2c_f32_bf16 v164, v48, v48
    v_dot2c_f32_bf16 v165, v49, v49
    v_dot2c_f32_bf16 v164, v50, v50
    v_dot2c_f32_bf16 v165, v51, v51
    s_waitcnt lgkmcnt(2)
    v_mfma_f32_16x16x32_bf16 v[160:163], v[232:235], v[52:55], v[160:163]
    v_dot2c_f32_bf16 v164, v52, v52
    v_dot2c_f32_bf16 v165, v53, v53
    v_dot2c_f32_bf16 v164, v54, v54
    v_dot2c_f32_bf16 v165, v55, v55
    s_waitcnt vmcnt(6)
    ds_read_b128 v[64:67], v224 offset:12288
    ds_read_b128 v[68:71], v225 offset:12288
    s_waitcnt lgkmcnt(3)
    v_mfma_f32_16x16x32_bf16 v[160:163], v[232:235], v[56:59], v[160:163]
    v_dot2c_f32_bf16 v164, v56, v56
    v_dot2c_f32_bf16 v165, v57, v57
    v_dot2c_f32_bf16 v164, v58, v58
    v_dot2c_f32_bf16 v165, v59, v59
    s_waitcnt lgkmcnt(2)
    v_mfma_f32_16x16x32_bf16 v[160:163], v[232:235], v[60:63], v[160:163]
    v_dot2c_f32_bf16 v164, v60, v60
    v_dot2c_f32_bf16 v165, v61, v61
    v_dot2c_f32_bf16 v164, v62, v62
    v_dot2c_f32_bf16 v165, v63, v63
    s_waitcnt vmcnt(4)
    ds_read_b128 v[72:75], v224 offset:14336
    ds_read_b128 v[76:79], v225 offset:14336
    s_waitcnt lgkmcnt(3)
    v_mfma_f32_16x16x32_bf16 v[160:163], v[232:235], v[64:67], v[160:163]
    v_dot2c_f32_bf16 v164, v64, v64
    v_dot2c_f32_bf16 v165, v65, v65
    v_dot2c_f32_bf16 v164, v66, v66
    v_dot2c_f32_bf16 v165, v67, v67
    s_waitcnt lgkmcnt(2)
    v_mfma_f32_16x16x32_bf16 v[160:163], v[232:235], v[68:71], v[160:163]
    v_dot2c_f32_bf16 v164, v68, v68
    v_dot2c_f32_bf16 v165, v69, v69
    v_dot2c_f32_bf16 v164, v70, v70
    v_dot2c_f32_bf16 v165, v71, v71
    s_waitcnt vmcnt(2)
    ds_read_b128 v[80:83], v224 offset:16384
    ds_read_b128 v[84:87], v225 offset:16384
    s_waitcnt vmcnt(0)
    s_mov_b32 s57, 50593792
    s_or_b32 s51, s2, s36
    s_cmp_eq_u32 s51, 0
    s_cbranch_scc0 Lns_2
    buffer_load_dword v222, off, s[24:27], s57 sc1
Lns_2:
    s_waitcnt lgkmcnt(3)
    v_mfma_f32_16x16x32_bf16 v[160:163], v[232:235], v[72:75], v[160:163]
    v_dot2c_f32_bf16 v164, v72, v72
    v_dot2c_f32_bf16 v165, v73, v73
    v_dot2c_f32_bf16 v164, v74, v74
    v_dot2c_f32_bf16 v165, v75, v75
    s_waitcnt lgkmcnt(2)
    v_mfma_f32_16x16x32_bf16 v[160:163], v[232:235], v[76:79], v[160:163]
    v_dot2c_f32_bf16 v164, v76, v76
    v_dot2c_f32_bf16 v165, v77, v77
    v_dot2c_f32_bf16 v164, v78, v78
    v_dot2c_f32_bf16 v165, v79, v79
    s_waitcnt lgkmcnt(1)
    v_mfma_f32_16x16x32_bf16 v[160:163], v[232:235], v[80:83], v[160:163]
    v_dot2c_f32_bf16 v164, v80, v80
    v_dot2c_f32_bf16 v165, v81, v81
    v_dot2c_f32_bf16 v164, v82, v82
    v_dot2c_f32_bf16 v165, v83, v83
    s_waitcnt lgkmcnt(0)
    v_mfma_f32_16x16x32_bf16 v[160:163], v[232:235], v[84:87], v[160:163]
    v_dot2c_f32_bf16 v164, v84, v84
    v_dot2c_f32_bf16 v165, v85, v85
    v_dot2c_f32_bf16 v164, v86, v86
    v_dot2c_f32_bf16 v165, v87, v87
    s_nop 2
    v_add_f32 v164, v164, v165
    v_mov_b32 v165, v164
    s_nop 1
    v_permlane32_swap_b32 v164, v165
    s_nop 1
    v_add_f32 v164, v164, v165
    v_mov_b32 v165, v164
    s_nop 1
    v_permlane16_swap_b32 v164, v165
    s_nop 1
    v_add_f32 v164, v164, v165
    s_mov_b32 s51, 0x3ae38e39
    v_mul_f32 v160, s51, v160
    v_mul_f32 v164, s51, v164
    v_fma_f32 v164, -v160, v160, v164
    v_max_f32 v164, 0, v164
    v_add_f32 v164, 0x3727c5ac, v164
    v_rsq_f32 v14, v164
    v_sub_f32 v166, 0, v160
    v_mov_b32 v167, v14
    s_mov_b64 s[60:61], exec
    s_mov_b64 exec, 0xffff
    ds_write_b64 v230, v[166:167]
    s_mov_b64 exec, s[60:61]
    s_waitcnt lgkmcnt(0)
    s_barrier
    s_cmp_eq_u32 s36, 4
    s_cbranch_scc0 Lpf_3
    s_and_b32 s55, s39, 15
    s_mul_i32 s55, s55, 12
    v_min_u32 v1, 11, v0
    v_add_u32 v1, s55, v1
    v_mul_u32_u24 v1, 9216, v1
    s_mul_i32 s55, s41, 640
    s_add_u32 s55, s55, 0
    buffer_load_dword v11, v1, s[8:11], s55 offen
Lpf_3:
    s_cmp_eq_u32 s36, 5
    s_cbranch_scc0 Lpf_4
    s_and_b32 s55, s39, 15
    s_mul_i32 s55, s55, 12
    v_min_u32 v1, 11, v0
    v_add_u32 v1, s55, v1
    v_mul_u32_u24 v1, 9216, v1
    s_mul_i32 s55, s41, 640
    s_add_u32 s55, s55, 0
    buffer_load_dword v11, v1, s[28:31], s55 offen
Lpf_4:
    s_cmp_eq_u32 s36, 6
    s_cbranch_scc0 Lpf_5
    s_and_b32 s55, s39, 15
    s_mul_i32 s55, s55, 12
    v_min_u32 v1, 11, v0
    v_add_u32 v1, s55, v1
    v_mul_u32_u24 v1, 9216, v1
    s_mul_i32 s55, s41, 640
    s_add_u32 s55, s55, 1769472
    buffer_load_dword v11, v1, s[8:11], s55 offen
Lpf_5:
    s_cmp_eq_u32 s36, 7
    s_cbranch_scc0 Lpf_6
    s_and_b32 s55, s39, 15
    s_mul_i32 s55, s55, 12
    v_min_u32 v1, 11, v0
    v_add_u32 v1, s55, v1
    v_mul_u32_u24 v1, 9216, v1
    s_mul_i32 s55, s41, 640
    s_add_u32 s55, s55, 1769472
    buffer_load_dword v11, v1, s[28:31], s55 offen
Lpf_6:
    s_cmp_eq_u32 s36, 4
    s_cbranch_scc0 Lpf_7
    s_and_b32 s55, s39, 15
    s_mul_i32 s55, s55, 12
    v_min_u32 v1, 11, v0
    v_add_u32 v1, s55, v1
    v_mul_u32_u24 v1, 9216, v1
    s_mul_i32 s55, s41, 640
    s_add_u32 s55, s55, 3538944
    buffer_load_dword v11, v1, s[8:11], s55 offen
Lpf_7:
    s_cmp_eq_u32 s36, 5
    s_cbranch_scc0 Lpf_8
    s_and_b32 s55, s39, 15
    s_mul_i32 s55, s55, 12
    v_min_u32 v1, 11, v0
    v_add_u32 v1, s55, v1
    v_mul_u32_u24 v1, 9216, v1
    s_mul_i32 s55, s41, 640
    s_add_u32 s55, s55, 3538944
    buffer_load_dword v11, v1, s[28:31], s55 offen
Lpf_8:
    s_cmp_eq_u32 s36, 6
    s_cbranch_scc0 Lpf_9
    s_and_b32 s55, s39, 15
    s_mul_i32 s55, s55, 12
    v_min_u32 v1, 11, v0
    v_add_u32 v1, s55, v1
    v_mul_u32_u24 v1, 9216, v1
    s_mul_i32 s55, s41, 640
    s_add_u32 s55, s55, 128
    buffer_load_dword v11, v1, s[8:11], s55 offen
Lpf_9:
    s_cmp_eq_u32 s36, 7
    s_cbranch_scc0 Lpf_10
    s_and_b32 s55, s39, 15
    s_mul_i32 s55, s55, 12
    v_min_u32 v1, 11, v0
    v_add_u32 v1, s55, v1
    v_mul_u32_u24 v1, 9216, v1
    s_mul_i32 s55, s41, 640
    s_add_u32 s55, s55, 128
    buffer_load_dword v11, v1, s[28:31], s55 offen
Lpf_10:
    s_cmp_eq_u32 s36, 4
    s_cbranch_scc0 Lpf_11
    s_and_b32 s55, s39, 15
    s_mul_i32 s55, s55, 12
    v_min_u32 v1, 11, v0
    v_add_u32 v1, s55, v1
    v_mul_u32_u24 v1, 9216, v1
    s_mul_i32 s55, s41, 640
    s_add_u32 s55, s55, 1769600
    buffer_load_dword v11, v1, s[8:11], s55 offen
Lpf_11:
    s_cmp_eq_u32 s36, 5
    s_cbranch_scc0 Lpf_12
    s_and_b32 s55, s39, 15
    s_mul_i32 s55, s55, 12
    v_min_u32 v1, 11, v0
    v_add_u32 v1, s55, v1
    v_mul_u32_u24 v1, 9216, v1
    s_mul_i32 s55, s41, 640
    s_add_u32 s55, s55, 1769600
    buffer_load_dword v11, v1, s[28:31], s55 offen
Lpf_12:
    s_cmp_eq_u32 s36, 6
    s_cbranch_scc0 Lpf_13
    s_and_b32 s55, s39, 15
    s_mul_i32 s55, s55, 12
    v_min_u32 v1, 11, v0
    v_add_u32 v1, s55, v1
    v_mul_u32_u24 v1, 9216, v1
    s_mul_i32 s55, s41, 640
    s_add_u32 s55, s55, 3539072
    buffer_load_dword v11, v1, s[8:11], s55 offen
Lpf_13:
    s_cmp_eq_u32 s36, 7
    s_cbranch_scc0 Lpf_14
    s_and_b32 s55, s39, 15
    s_mul_i32 s55, s55, 12
    v_min_u32 v1, 11, v0
    v_add_u32 v1, s55, v1
    v_mul_u32_u24 v1, 9216, v1
    s_mul_i32 s55, s41, 640
    s_add_u32 s55, s55, 3539072
    buffer_load_dword v11, v1, s[28:31], s55 offen
Lpf_14:
    s_cmp_eq_u32 s36, 4
    s_cbranch_scc0 Lpf_15
    s_and_b32 s55, s39, 15
    s_mul_i32 s55, s55, 12
    v_min_u32 v1, 11, v0
    v_add_u32 v1, s55, v1
    v_mul_u32_u24 v1, 9216, v1
    s_mul_i32 s55, s41, 640
    s_add_u32 s55, s55, 256
    buffer_load_dword v11, v1, s[8:11], s55 offen
Lpf_15:
    s_cmp_eq_u32 s36, 5
    s_cbranch_scc0 Lpf_16
    s_and_b32 s55, s39, 15
    s_mul_i32 s55, s55, 12
    v_min_u32 v1, 11, v0
    v_add_u32 v1, s55, v1
    v_mul_u32_u24 v1, 9216, v1
    s_mul_i32 s55, s41, 640
    s_add_u32 s55, s55, 256
    buffer_load_dword v11, v1, s[28:31], s55 offen
Lpf_16:
    s_cmp_eq_u32 s36, 6
    s_cbranch_scc0 Lpf_17
    s_and_b32 s55, s39, 15
    s_mul_i32 s55, s55, 12
    v_min_u32 v1, 11, v0
    v_add_u32 v1, s55, v1
    v_mul_u32_u24 v1, 9216, v1
    s_mul_i32 s55, s41, 640
    s_add_u32 s55, s55, 1769728
    buffer_load_dword v11, v1, s[8:11], s55 offen
Lpf_17:
    s_cmp_eq_u32 s36, 7
    s_cbranch_scc0 Lpf_18
    s_and_b32 s55, s39, 15
    s_mul_i32 s55, s55, 12
    v_min_u32 v1, 11, v0
    v_add_u32 v1, s55, v1
    v_mul_u32_u24 v1, 9216, v1
    s_mul_i32 s55, s41, 640
    s_add_u32 s55, s55, 1769728
    buffer_load_dword v11, v1, s[28:31], s55 offen
Lpf_18:
    s_cmp_eq_u32 s36, 4
    s_cbranch_scc0 Lpf_19
    s_and_b32 s55, s39, 15
    s_mul_i32 s55, s55, 12
    v_min_u32 v1, 11, v0
    v_add_u32 v1, s55, v1
    v_mul_u32_u24 v1, 9216, v1
    s_mul_i32 s55, s41, 640
    s_add_u32 s55, s55, 3539200
    buffer_load_dword v11, v1, s[8:11], s55 offen
Lpf_19:
    s_cmp_eq_u32 s36, 5
    s_cbranch_scc0 Lpf_20
    s_and_b32 s55, s39, 15
    s_mul_i32 s55, s55, 12
    v_min_u32 v1, 11, v0
    v_add_u32 v1, s55, v1
    v_mul_u32_u24 v1, 9216, v1
    s_mul_i32 s55, s41, 640
    s_add_u32 s55, s55, 3539200
    buffer_load_dword v11, v1, s[28:31], s55 offen
Lpf_20:
    s_or_b32 s51, s2, s36
    s_cmp_eq_u32 s51, 0
    s_cbranch_scc0 Lnp_21
    s_waitcnt vmcnt(0)
    v_readfirstlane_b32 s51, v222
    s_nop 3
    s_add_u32 s51, s51, 1
    s_mul_i32 s52, s51, 0x9E3779B1
    s_not_b32 s53, s52
    v_mov_b32 v254, s51
    v_mov_b32 v252, s52
    v_mov_b32 v253, s53
    v_mov_b32 v1, 0
    s_mov_b64 s[60:61], exec
    s_mov_b64 exec, 1
    buffer_store_dword v254, off, s[24:27], s57 sc1
    global_store_dwordx2 v1, v[252:253], s[80:81] sc1
    s_mov_b64 exec, s[60:61]
    s_waitcnt vmcnt(0)
Lnp_21:
    ds_read_b64 v[168:169], v231
    ds_read_b128 v[88:91], v226 offset:0
    ds_read_b128 v[92:95], v227 offset:0
    ds_read_b128 v[96:99], v226 offset:2048
    ds_read_b128 v[100:103], v227 offset:2048
    ds_read_b128 v[104:107], v226 offset:4096
    ds_read_b128 v[108:111], v227 offset:4096
    ds_read_b128 v[112:115], v226 offset:6144
    ds_read_b128 v[116:119], v227 offset:6144
    ds_read_b128 v[120:123], v226 offset:8192
    ds_read_b128 v[124:127], v227 offset:8192
    ds_read_b128 v[128:131], v226 offset:10240
    ds_read_b128 v[132:135], v227 offset:10240
    ds_read_b128 v[136:139], v226 offset:12288
    ds_read_b128 v[140:143], v227 offset:12288
    ds_read_b128 v[144:147], v226 offset:14336
    ds_read_b128 v[148:151], v227 offset:14336
    ds_read_b128 v[152:155], v226 offset:16384
    ds_read_b128 v[156:159], v227 offset:16384
    v_mov_b32 v180, v166
    v_mov_b32 v181, v166
    v_mov_b32 v182, v166
    v_mov_b32 v183, v166
    s_nop 1
    v_mfma_f32_16x16x32_bf16 v[184:187], v[172:175], v[16:19], v[180:183]
    v_mfma_f32_16x16x32_bf16 v[188:191], v[176:179], v[16:19], v[180:183]
    v_mfma_f32_16x16x32_bf16 v[192:195], v[172:175], v[20:23], v[180:183]
    v_mfma_f32_16x16x32_bf16 v[196:199], v[176:179], v[20:23], v[180:183]
    v_mfma_f32_16x16x32_bf16 v[200:203], v[172:175], v[24:27], v[180:183]
    v_mfma_f32_16x16x32_bf16 v[204:207], v[176:179], v[24:27], v[180:183]
    v_mfma_f32_16x16x32_bf16 v[208:211], v[172:175], v[28:31], v[180:183]
    v_mfma_f32_16x16x32_bf16 v[212:215], v[176:179], v[28:31], v[180:183]
    v_cvt_pk_bf16_f32 v16, v184, v185
    v_cvt_pk_bf16_f32 v17, v186, v187
    v_cvt_pk_bf16_f32 v18, v188, v189
    v_cvt_pk_bf16_f32 v19, v190, v191
    v_mfma_f32_16x16x32_bf16 v[184:187], v[172:175], v[32:35], v[180:183]
    v_mfma_f32_16x16x32_bf16 v[188:191], v[176:179], v[32:35], v[180:183]
    v_cvt_pk_bf16_f32 v20, v192, v193
    v_cvt_pk_bf16_f32 v21, v194, v195
    v_cvt_pk_bf16_f32 v22, v196, v197
    v_cvt_pk_bf16_f32 v23, v198, v199
    v_mfma_f32_16x16x32_bf16 v[192:195], v[172:175], v[36:39], v[180:183]
    v_mfma_f32_16x16x32_bf16 v[196:199], v[176:179], v[36:39], v[180:183]
    v_cvt_pk_bf16_f32 v24, v200, v201
    v_cvt_pk_bf16_f32 v25, v202, v203
    v_cvt_pk_bf16_f32 v26, v204, v205
    v_cvt_pk_bf16_f32 v27, v206, v207
    v_mfma_f32_16x16x32_bf16 v[200:203], v[172:175], v[40:43], v[180:183]
    v_mfma_f32_16x16x32_bf16 v[204:207], v[176:179], v[40:43], v[180:183]
    v_cvt_pk_bf16_f32 v28, v208, v209
    v_cvt_pk_bf16_f32 v29, v210, v211
    v_cvt_pk_bf16_f32 v30, v212, v213
    v_cvt_pk_bf16_f32 v31, v214, v215
    v_mfma_f32_16x16x32_bf16 v[208:211], v[172:175], v[44:47], v[180:183]
    v_mfma_f32_16x16x32_bf16 v[212:215], v[176:179], v[44:47], v[180:183]
    v_cvt_pk_bf16_f32 v32, v184, v185
    v_cvt_pk_bf16_f32 v33, v186, v187
    v_cvt_pk_bf16_f32 v34, v188, v189
    v_cvt_pk_bf16_f32 v35, v190, v191
    v_mfma_f32_16x16x32_bf16 v[184:187], v[172:175], v[48:51], v[180:183]
    v_mfma_f32_16x16x32_bf16 v[188:191], v[176:179], v[48:51], v[180:183]
    v_cvt_pk_bf16_f32 v36, v192, v193
    v_cvt_pk_bf16_f32 v37, v194, v195
    v_cvt_pk_bf16_f32 v38, v196, v197
    v_cvt_pk_bf16_f32 v39, v198, v199
    v_mfma_f32_16x16x32_bf16 v[192:195], v[172:175], v[52:55], v[180:183]
    v_mfma_f32_16x16x32_bf16 v[196:199], v[176:179], v[52:55], v[180:183]
    v_cvt_pk_bf16_f32 v40, v200, v201
    v_cvt_pk_bf16_f32 v41, v202, v203
    v_cvt_pk_bf16_f32 v42, v204, v205
    v_cvt_pk_bf16_f32 v43, v206, v207
    v_mfma_f32_16x16x32_bf16 v[200:203], v[172:175], v[56:59], v[180:183]
    v_mfma_f32_16x16x32_bf16 v[204:207], v[176:179], v[56:59], v[180:183]
    v_cvt_pk_bf16_f32 v44, v208, v209
    v_cvt_pk_bf16_f32 v45, v210, v211
    v_cvt_pk_bf16_f32 v46, v212, v213
    v_cvt_pk_bf16_f32 v47, v214, v215
    v_mfma_f32_16x16x32_bf16 v[208:211], v[172:175], v[60:63], v[180:183]
    v_mfma_f32_16x16x32_bf16 v[212:215], v[176:179], v[60:63], v[180:183]
    v_cvt_pk_bf16_f32 v48, v184, v185
    v_cvt_pk_bf16_f32 v49, v186, v187
    v_cvt_pk_bf16_f32 v50, v188, v189
    v_cvt_pk_bf16_f32 v51, v190, v191
    v_mfma_f32_16x16x32_bf16 v[184:187], v[172:175], v[64:67], v[180:183]
    v_mfma_f32_16x16x32_bf16 v[188:191], v[176:179], v[64:67], v[180:183]
    v_cvt_pk_bf16_f32 v52, v192, v193
    v_cvt_pk_bf16_f32 v53, v194, v195
    v_cvt_pk_bf16_f32 v54, v196, v197
    v_cvt_pk_bf16_f32 v55, v198, v199
    v_mfma_f32_16x16x32_bf16 v[192:195], v[172:175], v[68:71], v[180:183]
    v_mfma_f32_16x16x32_bf16 v[196:199], v[176:179], v[68:71], v[180:183]
    v_cvt_pk_bf16_f32 v56, v200, v201
    v_cvt_pk_bf16_f32 v57, v202, v203
    v_cvt_pk_bf16_f32 v58, v204, v205
    v_cvt_pk_bf16_f32 v59, v206, v207
    v_mfma_f32_16x16x32_bf16 v[200:203], v[172:175], v[72:75], v[180:183]
    v_mfma_f32_16x16x32_bf16 v[204:207], v[176:179], v[72:75], v[180:183]
    v_cvt_pk_bf16_f32 v60, v208, v209
    v_cvt_pk_bf16_f32 v61, v210, v211
    v_cvt_pk_bf16_f32 v62, v212, v213
    v_cvt_pk_bf16_f32 v63, v214, v215
    v_mfma_f32_16x16x32_bf16 v[208:211], v[172:175], v[76:79], v[180:183]
    v_mfma_f32_16x16x32_bf16 v[212:215], v[176:179], v[76:79], v[180:183]
    v_cvt_pk_bf16_f32 v64, v184, v185
    v_cvt_pk_bf16_f32 v65, v186, v187
    v_cvt_pk_bf16_f32 v66, v188, v189
    v_cvt_pk_bf16_f32 v67, v190, v191
    v_mfma_f32_16x16x32_bf16 v[184:187], v[172:175], v[80:83], v[180:183]
    v_mfma_f32_16x16x32_bf16 v[188:191], v[176:179], v[80:83], v[180:183]
    v_cvt_pk_bf16_f32 v68, v192, v193
    v_cvt_pk_bf16_f32 v69, v194, v195
    v_cvt_pk_bf16_f32 v70, v196, v197
    v_cvt_pk_bf16_f32 v71, v198, v199
    v_mfma_f32_16x16x32_bf16 v[192:195], v[172:175], v[84:87], v[180:183]
    v_mfma_f32_16x16x32_bf16 v[196:199], v[176:179], v[84:87], v[180:183]
    v_cvt_pk_bf16_f32 v72, v200, v201
    v_cvt_pk_bf16_f32 v73, v202, v203
    v_cvt_pk_bf16_f32 v74, v204, v205
    v_cvt_pk_bf16_f32 v75, v206, v207
    s_nop 7
    v_cvt_pk_bf16_f32 v76, v208, v209
    v_cvt_pk_bf16_f32 v77, v210, v211
    v_cvt_pk_bf16_f32 v78, v212, v213
    v_cvt_pk_bf16_f32 v79, v214, v215
    v_cvt_pk_bf16_f32 v80, v184, v185
    v_cvt_pk_bf16_f32 v81, v186, v187
    v_cvt_pk_bf16_f32 v82, v188, v189
    v_cvt_pk_bf16_f32 v83, v190, v191
    v_cvt_pk_bf16_f32 v84, v192, v193
    v_cvt_pk_bf16_f32 v85, v194, v195
    v_cvt_pk_bf16_f32 v86, v196, v197
    v_cvt_pk_bf16_f32 v87, v198, v199
    s_waitcnt lgkmcnt(0)
    v_mov_b32 v15, v169
    s_barrier
    s_cbranch_vccz Lr_22
    s_add_u32 m0, s44, 73728
    s_mov_b32 s46, 0
    buffer_load_dwordx4 v9, s[8:11], s46 offen offset:0 lds
    buffer_load_dwordx4 v10, s[8:11], s46 offen offset:1024 lds
    buffer_load_dwordx4 v11, s[8:11], s46 offen offset:2048 lds
Lr_22:
    s_cbranch_vccz Lr_23
    s_add_u32 m0, s44, 86016
    s_mov_b32 s46, 0
    buffer_load_dwordx4 v9, s[28:31], s46 offen offset:0 lds
    buffer_load_dwordx4 v10, s[28:31], s46 offen offset:1024 lds
    buffer_load_dwordx4 v11, s[28:31], s46 offen offset:2048 lds
Lr_23:
    s_cbranch_vccz Lr_24
    s_add_u32 m0, s44, 98304
    s_mov_b32 s46, 884736
    buffer_load_dwordx4 v9, s[8:11], s46 offen offset:0 lds
    buffer_load_dwordx4 v10, s[8:11], s46 offen offset:1024 lds
    buffer_load_dwordx4 v11, s[8:11], s46 offen offset:2048 lds
Lr_24:
    s_cbranch_vccz Lr_25
    s_add_u32 m0, s44, 110592
    s_mov_b32 s46, 884736
    buffer_load_dwordx4 v9, s[28:31], s46 offen offset:0 lds
    buffer_load_dwordx4 v10, s[28:31], s46 offen offset:1024 lds
    buffer_load_dwordx4 v11, s[28:31], s46 offen offset:2048 lds
Lr_25:
    v_mov_b32 v180, v168
    v_mov_b32 v181, v168
    v_mov_b32 v182, v168
    v_mov_b32 v183, v168
    s_nop 1
    v_mfma_f32_16x16x32_bf16 v[184:187], v[172:175], v[88:91], v[180:183]
    v_mfma_f32_16x16x32_bf16 v[188:191], v[176:179], v[88:91], v[180:183]
    v_mfma_f32_16x16x32_bf16 v[192:195], v[172:175], v[92:95], v[180:183]
    v_mfma_f32_16x16x32_bf16 v[196:199], v[176:179], v[92:95], v[180:183]
    v_mfma_f32_16x16x32_bf16 v[200:203], v[172:175], v[96:99], v[180:183]
    v_mfma_f32_16x16x32_bf16 v[204:207], v[176:179], v[96:99], v[180:183]
    v_mfma_f32_16x16x32_bf16 v[208:211], v[172:175], v[100:103], v[180:183]
    v_mfma_f32_16x16x32_bf16 v[212:215], v[176:179], v[100:103], v[180:183]
    v_cvt_pk_bf16_f32 v88, v184, v185
    v_cvt_pk_bf16_f32 v89, v186, v187
    v_cvt_pk_bf16_f32 v90, v188, v189
    v_cvt_pk_bf16_f32 v91, v190, v191
    s_cbranch_vccz Lr_26
    s_add_u32 m0, s44, 122880
    s_mov_b32 s46, 1769472
    buffer_load_dwordx4 v9, s[8:11], s46 offen offset:0 lds
    buffer_load_dwordx4 v10, s[8:11], s46 offen offset:1024 lds
    buffer_load_dwordx4 v11, s[8:11], s46 offen offset:2048 lds
Lr_26:
    v_mfma_f32_16x16x32_bf16 v[184:187], v[172:175], v[104:107], v[180:183]
    v_mfma_f32_16x16x32_bf16 v[188:191], v[176:179], v[104:107], v[180:183]
    v_cvt_pk_bf16_f32 v92, v192, v193
    v_cvt_pk_bf16_f32 v93, v194, v195
    v_cvt_pk_bf16_f32 v94, v196, v197
    v_cvt_pk_bf16_f32 v95, v198, v199
    v_mfma_f32_16x16x32_bf16 v[192:195], v[172:175], v[108:111], v[180:183]
    v_mfma_f32_16x16x32_bf16 v[196:199], v[176:179], v[108:111], v[180:183]
    v_cvt_pk_bf16_f32 v96, v200, v201
    v_cvt_pk_bf16_f32 v97, v202, v203
    v_cvt_pk_bf16_f32 v98, v204, v205
    v_cvt_pk_bf16_f32 v99, v206, v207
    v_mfma_f32_16x16x32_bf16 v[200:203], v[172:175], v[112:115], v[180:183]
    v_mfma_f32_16x16x32_bf16 v[204:207], v[176:179], v[112:115], v[180:183]
    v_cvt_pk_bf16_f32 v100, v208, v209
    v_cvt_pk_bf16_f32 v101, v210, v211
    v_cvt_pk_bf16_f32 v102, v212, v213
    v_cvt_pk_bf16_f32 v103, v214, v215
    v_mfma_f32_16x16x32_bf16 v[208:211], v[172:175], v[116:119], v[180:183]
    v_mfma_f32_16x16x32_bf16 v[212:215], v[176:179], v[116:119], v[180:183]
    v_cvt_pk_bf16_f32 v104, v184, v185
    v_cvt_pk_bf16_f32 v105, v186, v187
    v_cvt_pk_bf16_f32 v106, v188, v189
    v_cvt_pk_bf16_f32 v107, v190, v191
    s_cbranch_vccz Lr_27
    s_add_u32 m0, s44, 135168
    s_mov_b32 s46, 1769472
    buffer_load_dwordx4 v9, s[28:31], s46 offen offset:0 lds
    buffer_load_dwordx4 v10, s[28:31], s46 offen offset:1024 lds
    buffer_load_dwordx4 v11, s[28:31], s46 offen offset:2048 lds
Lr_27:
    v_mfma_f32_16x16x32_bf16 v[184:187], v[172:175], v[120:123], v[180:183]
    v_mfma_f32_16x16x32_bf16 v[188:191], v[176:179], v[120:123], v[180:183]
    v_cvt_pk_bf16_f32 v108, v192, v193
    v_cvt_pk_bf16_f32 v109, v194, v195
    v_cvt_pk_bf16_f32 v110, v196, v197
    v_cvt_pk_bf16_f32 v111, v198, v199
    v_mfma_f32_16x16x32_bf16 v[192:195], v[172:175], v[124:127], v[180:183]
    v_mfma_f32_16x16x32_bf16 v[196:199], v[176:179], v[124:127], v[180:183]
    v_cvt_pk_bf16_f32 v112, v200, v201
    v_cvt_pk_bf16_f32 v113, v202, v203
    v_cvt_pk_bf16_f32 v114, v204, v205
    v_cvt_pk_bf16_f32 v115, v206, v207
    v_mfma_f32_16x16x32_bf16 v[200:203], v[172:175], v[128:131], v[180:183]
    v_mfma_f32_16x16x32_bf16 v[204:207], v[176:179], v[128:131], v[180:183]
    v_cvt_pk_bf16_f32 v116, v208, v209
    v_cvt_pk_bf16_f32 v117, v210, v211
    v_cvt_pk_bf16_f32 v118, v212, v213
    v_cvt_pk_bf16_f32 v119, v214, v215
    v_mfma_f32_16x16x32_bf16 v[208:211], v[172:175], v[132:135], v[180:183]
    v_mfma_f32_16x16x32_bf16 v[212:215], v[176:179], v[132:135], v[180:183]
    v_cvt_pk_bf16_f32 v120, v184, v185
    v_cvt_pk_bf16_f32 v121, v186, v187
    v_cvt_pk_bf16_f32 v122, v188, v189
    v_cvt_pk_bf16_f32 v123, v190, v191
    s_cbranch_vccz Lr_28
    s_add_u32 m0, s44, 0
    s_mov_b32 s46, 2654208
    buffer_load_dwordx4 v9, s[8:11], s46 offen offset:0 lds
    buffer_load_dwordx4 v10, s[8:11], s46 offen offset:1024 lds
    buffer_load_dwordx4 v11, s[8:11], s46 offen offset:2048 lds
Lr_28:
    v_mfma_f32_16x16x32_bf16 v[184:187], v[172:175], v[136:139], v[180:183]
    v_mfma_f32_16x16x32_bf16 v[188:191], v[176:179], v[136:139], v[180:183]
    v_cvt_pk_bf16_f32 v124, v192, v193
    v_cvt_pk_bf16_f32 v125, v194, v195
    v_cvt_pk_bf16_f32 v126, v196, v197
    v_cvt_pk_bf16_f32 v127, v198, v199
    v_mfma_f32_16x16x32_bf16 v[192:195], v[172:175], v[140:143], v[180:183]
    v_mfma_f32_16x16x32_bf16 v[196:199], v[176:179], v[140:143], v[180:183]
    v_cvt_pk_bf16_f32 v128, v200, v201
    v_cvt_pk_bf16_f32 v129, v202, v203
    v_cvt_pk_bf16_f32 v130, v204, v205
    v_cvt_pk_bf16_f32 v131, v206, v207
    v_mfma_f32_16x16x32_bf16 v[200:203], v[172:175], v[144:147], v[180:183]
    v_mfma_f32_16x16x32_bf16 v[204:207], v[176:179], v[144:147], v[180:183]
    v_cvt_pk_bf16_f32 v132, v208, v209
    v_cvt_pk_bf16_f32 v133, v210, v211
    v_cvt_pk_bf16_f32 v134, v212, v213
    v_cvt_pk_bf16_f32 v135, v214, v215
    v_mfma_f32_16x16x32_bf16 v[208:211], v[172:175], v[148:151], v[180:183]
    v_mfma_f32_16x16x32_bf16 v[212:215], v[176:179], v[148:151], v[180:183]
    v_cvt_pk_bf16_f32 v136, v184, v185
    v_cvt_pk_bf16_f32 v137, v186, v187
    v_cvt_pk_bf16_f32 v138, v188, v189
    v_cvt_pk_bf16_f32 v139, v190, v191
    s_cbranch_vccz Lr_29
    s_add_u32 m0, s44, 12288
    s_mov_b32 s46, 2654208
    buffer_load_dwordx4 v9, s[28:31], s46 offen offset:0 lds
    buffer_load_dwordx4 v10, s[28:31], s46 offen offset:1024 lds
    buffer_load_dwordx4 v11, s[28:31], s46 offen offset:2048 lds
Lr_29:
    v_mfma_f32_16x16x32_bf16 v[184:187], v[172:175], v[152:155], v[180:183]
    v_mfma_f32_16x16x32_bf16 v[188:191], v[176:179], v[152:155], v[180:183]
    v_cvt_pk_bf16_f32 v140, v192, v193
    v_cvt_pk_bf16_f32 v141, v194, v195
    v_cvt_pk_bf16_f32 v142, v196, v197
    v_cvt_pk_bf16_f32 v143, v198, v199
    v_mfma_f32_16x16x32_bf16 v[192:195], v[172:175], v[156:159], v[180:183]
    v_mfma_f32_16x16x32_bf16 v[196:199], v[176:179], v[156:159], v[180:183]
    v_cvt_pk_bf16_f32 v144, v200, v201
    v_cvt_pk_bf16_f32 v145, v202, v203
    v_cvt_pk_bf16_f32 v146, v204, v205
    v_cvt_pk_bf16_f32 v147, v206, v207
    s_nop 7
    v_cvt_pk_bf16_f32 v148, v208, v209
    v_cvt_pk_bf16_f32 v149, v210, v211
    v_cvt_pk_bf16_f32 v150, v212, v213
    v_cvt_pk_bf16_f32 v151, v214, v215
    v_cvt_pk_bf16_f32 v152, v184, v185
    v_cvt_pk_bf16_f32 v153, v186, v187
    v_cvt_pk_bf16_f32 v154, v188, v189
    v_cvt_pk_bf16_f32 v155, v190, v191
    v_cvt_pk_bf16_f32 v156, v192, v193
    v_cvt_pk_bf16_f32 v157, v194, v195
    v_cvt_pk_bf16_f32 v158, v196, v197
    v_cvt_pk_bf16_f32 v159, v198, v199
    .p2align 3
    s_cbranch_vccz L_helper
    .p2align 3
    s_waitcnt vmcnt(18)
    s_barrier
    ds_read_b64_tr_b16 v[224:225], v4 offset:24576
    s_add_u32 m0, s44, 24576
    s_mov_b32 s46, 3538944
    buffer_load_dwordx4 v9, s[8:11], s46 offen offset:0 lds
    ds_read_b64_tr_b16 v[226:227], v4 offset:26624
    ds_read_b64_tr_b16 v[228:229], v4 offset:28672
    ds_read_b64_tr_b16 v[230:231], v4 offset:30720
    ds_read_b64_tr_b16 v[232:233], v4 offset:32768
    buffer_load_dwordx4 v10, s[8:11], s46 offen offset:1024 lds
    ds_read_b64_tr_b16 v[234:235], v4 offset:34816
    ds_read_b64_tr_b16 v[236:237], v4 offset:36864
    ds_read_b64_tr_b16 v[238:239], v4 offset:38912
    s_waitcnt lgkmcnt(4)
    v_mfma_f32_16x16x32_bf16 v[160:163], v[224:227], v[16:19], 0
    ds_read_b64_tr_b16 v[240:241], v4 offset:40960
    buffer_load_dwordx4 v11, s[8:11], s46 offen offset:2048 lds
    v_mfma_f32_16x16x32_bf16 v[164:167], v[224:227], v[88:91], 0
    ds_read_b64_tr_b16 v[242:243], v4 offset:43008
    v_mfma_f32_16x16x32_bf16 v[164:167], v[228:231], v[92:95], v[164:167]
    ds_read_b64_tr_b16 v[244:245], v4 offset:45056
    v_mfma_f32_16x16x32_bf16 v[160:163], v[228:231], v[20:23], v[160:163]
    ds_read_b64_tr_b16 v[246:247], v4 offset:47104
    s_waitcnt lgkmcnt(4)
    v_mfma_f32_16x16x32_bf16 v[160:163], v[232:235], v[24:27], v[160:163]
    ds_read_b64_tr_b16 v[224:225], v7 offset:24576
    s_add_u32 m0, s44, 36864
    s_mov_b32 s46, 3538944
    buffer_load_dwordx4 v9, s[28:31], s46 offen offset:0 lds
    v_mfma_f32_16x16x32_bf16 v[164:167], v[232:235], v[96:99], v[164:167]
    ds_read_b64_tr_b16 v[226:227], v7 offset:26624
    v_mfma_f32_16x16x32_bf16 v[172:175], v[236:239], v[88:91], 0
    ds_read_b64_tr_b16 v[228:229], v7 offset:28672
    v_mfma_f32_16x16x32_bf16 v[168:171], v[236:239], v[16:19], 0
    ds_read_b64_tr_b16 v[230:231], v7 offset:30720
    s_waitcnt lgkmcnt(4)
    v_mfma_f32_16x16x32_bf16 v[168:171], v[240:243], v[20:23], v[168:171]
    ds_read_b64_tr_b16 v[232:233], v7 offset:32768
    buffer_load_dwordx4 v10, s[28:31], s46 offen offset:1024 lds
    v_mfma_f32_16x16x32_bf16 v[172:175], v[240:243], v[92:95], v[172:175]
    ds_read_b64_tr_b16 v[234:235], v7 offset:34816
    v_mfma_f32_16x16x32_bf16 v[172:175], v[244:247], v[96:99], v[172:175]
    ds_read_b64_tr_b16 v[236:237], v7 offset:36864
    v_mfma_f32_16x16x32_bf16 v[168:171], v[244:247], v[24:27], v[168:171]
    ds_read_b64_tr_b16 v[238:239], v7 offset:38912
    s_waitcnt lgkmcnt(4)
    v_mfma_f32_16x16x32_bf16 v[176:179], v[224:227], v[16:19], 0
    ds_read_b64_tr_b16 v[240:241], v7 offset:40960
    buffer_load_dwordx4 v11, s[28:31], s46 offen offset:2048 lds
    v_mfma_f32_16x16x32_bf16 v[180:183], v[224:227], v[88:91], 0
    ds_read_b64_tr_b16 v[242:243], v7 offset:43008
    v_mfma_f32_16x16x32_bf16 v[180:183], v[228:231], v[92:95], v[180:183]
    ds_read_b64_tr_b16 v[244:245], v7 offset:45056
    v_mfma_f32_16x16x32_bf16 v[176:179], v[228:231], v[20:23], v[176:179]
    ds_read_b64_tr_b16 v[246:247], v7 offset:47104
    s_waitcnt vmcnt(18)
    s_barrier
    v_mov_b32 v1, 0
    global_load_dwordx2 v[194:195], v1, s[80:81] sc1
    s_waitcnt lgkmcnt(4)
    v_mfma_f32_16x16x32_bf16 v[176:179], v[232:235], v[24:27], v[176:179]
    ds_read_b64_tr_b16 v[224:225], v5 offset:0
    s_add_u32 m0, s44, 49152
    s_mov_b32 s46, 4423680
    buffer_load_dwordx4 v9, s[8:11], s46 offen offset:0 lds
    v_mfma_f32_16x16x32_bf16 v[180:183], v[232:235], v[96:99], v[180:183]
    ds_read_b64_tr_b16 v[226:227], v5 offset:2048
    v_mfma_f32_16x16x32_bf16 v[188:191], v[236:239], v[88:91], 0
    ds_read_b64_tr_b16 v[228:229], v5 offset:4096
    v_mfma_f32_16x16x32_bf16 v[184:187], v[236:239], v[16:19], 0
    ds_read_b64_tr_b16 v[230:231], v5 offset:6144
    s_waitcnt lgkmcnt(4)
    v_mfma_f32_16x16x32_bf16 v[184:187], v[240:243], v[20:23], v[184:187]
    ds_read_b64_tr_b16 v[232:233], v5 offset:8192
    buffer_load_dwordx4 v10, s[8:11], s46 offen offset:1024 lds
    v_mfma_f32_16x16x32_bf16 v[188:191], v[240:243], v[92:95], v[188:191]
    ds_read_b64_tr_b16 v[234:235], v5 offset:10240
    v_mfma_f32_16x16x32_bf16 v[188:191], v[244:247], v[96:99], v[188:191]
    ds_read_b64_tr_b16 v[236:237], v5 offset:12288
    v_mfma_f32_16x16x32_bf16 v[184:187], v[244:247], v[24:27], v[184:187]
    ds_read_b64_tr_b16 v[238:239], v5 offset:14336
    s_waitcnt lgkmcnt(4)
    v_mfma_f32_16x16x32_bf16 v[160:163], v[224:227], v[28:31], v[160:163]
    ds_read_b64_tr_b16 v[240:241], v5 offset:16384
    buffer_load_dwordx4 v11, s[8:11], s46 offen offset:2048 lds
    v_mfma_f32_16x16x32_bf16 v[164:167], v[224:227], v[100:103], v[164:167]
    ds_read_b64_tr_b16 v[242:243], v5 offset:18432
    v_mfma_f32_16x16x32_bf16 v[164:167], v[228:231], v[104:107], v[164:167]
    ds_read_b64_tr_b16 v[244:245], v5 offset:20480
    v_mfma_f32_16x16x32_bf16 v[160:163], v[228:231], v[32:35], v[160:163]
    ds_read_b64_tr_b16 v[246:247], v5 offset:22528
    s_waitcnt lgkmcnt(4)
    v_mfma_f32_16x16x32_bf16 v[160:163], v[232:235], v[36:39], v[160:163]
    ds_read_b64_tr_b16 v[224:225], v8 offset:0
    s_add_u32 m0, s44, 61440
    s_mov_b32 s46, 4423680
    buffer_load_dwordx4 v9, s[28:31], s46 offen offset:0 lds
    v_mfma_f32_16x16x32_bf16 v[164:167], v[232:235], v[108:111], v[164:167]
    ds_read_b64_tr_b16 v[226:227], v8 offset:2048
    v_mfma_f32_16x16x32_bf16 v[172:175], v[236:239], v[100:103], v[172:175]
    ds_read_b64_tr_b16 v[228:229], v8 offset:4096
    v_mfma_f32_16x16x32_bf16 v[168:171], v[236:239], v[28:31], v[168:171]
    ds_read_b64_tr_b16 v[230:231], v8 offset:6144
    s_waitcnt lgkmcnt(4)
    v_mfma_f32_16x16x32_bf16 v[168:171], v[240:243], v[32:35], v[168:171]
    ds_read_b64_tr_b16 v[232:233], v8 offset:8192
    buffer_load_dwordx4 v10, s[28:31], s46 offen offset:1024 lds
    v_mfma_f32_16x16x32_bf16 v[172:175], v[240:243], v[104:107], v[172:175]
    ds_read_b64_tr_b16 v[234:235], v8 offset:10240
    v_mfma_f32_16x16x32_bf16 v[172:175], v[244:247], v[108:111], v[172:175]
    ds_read_b64_tr_b16 v[236:237], v8 offset:12288
    v_mfma_f32_16x16x32_bf16 v[168:171], v[244:247], v[36:39], v[168:171]
    ds_read_b64_tr_b16 v[238:239], v8 offset:14336
    s_waitcnt lgkmcnt(4)
    v_mfma_f32_16x16x32_bf16 v[176:179], v[224:227], v[28:31], v[176:179]
    ds_read_b64_tr_b16 v[240:241], v8 offset:16384
    buffer_load_dwordx4 v11, s[28:31], s46 offen offset:2048 lds
    v_mfma_f32_16x16x32_bf16 v[180:183], v[224:227], v[100:103], v[180:183]
    ds_read_b64_tr_b16 v[242:243], v8 offset:18432
    v_mfma_f32_16x16x32_bf16 v[180:183], v[228:231], v[104:107], v[180:183]
    ds_read_b64_tr_b16 v[244:245], v8 offset:20480
    v_mfma_f32_16x16x32_bf16 v[176:179], v[228:231], v[32:35], v[176:179]
    ds_read_b64_tr_b16 v[246:247], v8 offset:22528
    s_waitcnt vmcnt(19)
    s_barrier
    s_waitcnt lgkmcnt(4)
    v_mfma_f32_16x16x32_bf16 v[176:179], v[232:235], v[36:39], v[176:179]
    ds_read_b64_tr_b16 v[224:225], v5 offset:24576
    s_add_u32 m0, s44, 73728
    s_mov_b32 s46, 128
    buffer_load_dwordx4 v9, s[8:11], s46 offen offset:0 lds
    v_mfma_f32_16x16x32_bf16 v[180:183], v[232:235], v[108:111], v[180:183]
    ds_read_b64_tr_b16 v[226:227], v5 offset:26624
    v_mfma_f32_16x16x32_bf16 v[188:191], v[236:239], v[100:103], v[188:191]
    ds_read_b64_tr_b16 v[228:229], v5 offset:28672
    v_mfma_f32_16x16x32_bf16 v[184:187], v[236:239], v[28:31], v[184:187]
    ds_read_b64_tr_b16 v[230:231], v5 offset:30720
    s_waitcnt lgkmcnt(4)
    v_mfma_f32_16x16x32_bf16 v[184:187], v[240:243], v[32:35], v[184:187]
    ds_read_b64_tr_b16 v[232:233], v5 offset:32768
    buffer_load_dwordx4 v10, s[8:11], s46 offen offset:1024 lds
    v_mfma_f32_16x16x32_bf16 v[188:191], v[240:243], v[104:107], v[188:191]
    ds_read_b64_tr_b16 v[234:235], v5 offset:34816
    v_mfma_f32_16x16x32_bf16 v[188:191], v[244:247], v[108:111], v[188:191]
    ds_read_b64_tr_b16 v[236:237], v5 offset:36864
    v_mfma_f32_16x16x32_bf16 v[184:187], v[244:247], v[36:39], v[184:187]
    ds_read_b64_tr_b16 v[238:239], v5 offset:38912
    s_waitcnt lgkmcnt(4)
    v_mfma_f32_16x16x32_bf16 v[160:163], v[224:227], v[40:43], v[160:163]
    ds_read_b64_tr_b16 v[240:241], v5 offset:40960
    buffer_load_dwordx4 v11, s[8:11], s46 offen offset:2048 lds
    v_mfma_f32_16x16x32_bf16 v[164:167], v[224:227], v[112:115], v[164:167]
    ds_read_b64_tr_b16 v[242:243], v5 offset:43008
    v_mfma_f32_16x16x32_bf16 v[164:167], v[228:231], v[116:119], v[164:167]
    ds_read_b64_tr_b16 v[244:245], v5 offset:45056
    v_mfma_f32_16x16x32_bf16 v[160:163], v[228:231], v[44:47], v[160:163]
    ds_read_b64_tr_b16 v[246:247], v5 offset:47104
    s_waitcnt lgkmcnt(4)
    v_mfma_f32_16x16x32_bf16 v[160:163], v[232:235], v[48:51], v[160:163]
    ds_read_b64_tr_b16 v[224:225], v8 offset:24576
    s_add_u32 m0, s44, 86016
    s_mov_b32 s46, 128
    buffer_load_dwordx4 v9, s[28:31], s46 offen offset:0 lds
    v_mfma_f32_16x16x32_bf16 v[164:167], v[232:235], v[120:123], v[164:167]
    ds_read_b64_tr_b16 v[226:227], v8 offset:26624
    v_mfma_f32_16x16x32_bf16 v[172:175], v[236:239], v[112:115], v[172:175]
    ds_read_b64_tr_b16 v[228:229], v8 offset:28672
    v_mfma_f32_16x16x32_bf16 v[168:171], v[236:239], v[40:43], v[168:171]
    ds_read_b64_tr_b16 v[230:231], v8 offset:30720
    s_waitcnt lgkmcnt(4)
    v_mfma_f32_16x16x32_bf16 v[168:171], v[240:243], v[44:47], v[168:171]
    ds_read_b64_tr_b16 v[232:233], v8 offset:32768
    buffer_load_dwordx4 v10, s[28:31], s46 offen offset:1024 lds
    v_mfma_f32_16x16x32_bf16 v[172:175], v[240:243], v[116:119], v[172:175]
    ds_read_b64_tr_b16 v[234:235], v8 offset:34816
    v_mfma_f32_16x16x32_bf16 v[172:175], v[244:247], v[120:123], v[172:175]
    ds_read_b64_tr_b16 v[236:237], v8 offset:36864
    v_mfma_f32_16x16x32_bf16 v[168:171], v[244:247], v[48:51], v[168:171]
    ds_read_b64_tr_b16 v[238:239], v8 offset:38912
    s_waitcnt lgkmcnt(4)
    v_mfma_f32_16x16x32_bf16 v[176:179], v[224:227], v[40:43], v[176:179]
    ds_read_b64_tr_b16 v[240:241], v8 offset:40960
    buffer_load_dwordx4 v11, s[28:31], s46 offen offset:2048 lds
    v_mfma_f32_16x16x32_bf16 v[180:183], v[224:227], v[112:115], v[180:183]
    ds_read_b64_tr_b16 v[242:243], v8 offset:43008
    v_mfma_f32_16x16x32_bf16 v[180:183], v[228:231], v[116:119], v[180:183]
    ds_read_b64_tr_b16 v[244:245], v8 offset:45056
    v_mfma_f32_16x16x32_bf16 v[176:179], v[228:231], v[44:47], v[176:179]
    ds_read_b64_tr_b16 v[246:247], v8 offset:47104
    s_waitcnt vmcnt(19)
    s_barrier
    s_waitcnt lgkmcnt(4)
    v_mfma_f32_16x16x32_bf16 v[176:179], v[232:235], v[48:51], v[176:179]
    ds_read_b64_tr_b16 v[224:225], v3 offset:0
    s_add_u32 m0, s44, 98304
    s_mov_b32 s46, 884864
    buffer_load_dwordx4 v9, s[8:11], s46 offen offset:0 lds
    v_mfma_f32_16x16x32_bf16 v[180:183], v[232:235], v[120:123], v[180:183]
    ds_read_b64_tr_b16 v[226:227], v3 offset:2048
    v_mfma_f32_16x16x32_bf16 v[188:191], v[236:239], v[112:115], v[188:191]
    ds_read_b64_tr_b16 v[228:229], v3 offset:4096
    v_mfma_f32_16x16x32_bf16 v[184:187], v[236:239], v[40:43], v[184:187]
    ds_read_b64_tr_b16 v[230:231], v3 offset:6144
    s_waitcnt lgkmcnt(4)
    v_mfma_f32_16x16x32_bf16 v[184:187], v[240:243], v[44:47], v[184:187]
    ds_read_b64_tr_b16 v[232:233], v3 offset:8192
    buffer_load_dwordx4 v10, s[8:11], s46 offen offset:1024 lds
    v_mfma_f32_16x16x32_bf16 v[188:191], v[240:243], v[116:119], v[188:191]
    ds_read_b64_tr_b16 v[234:235], v3 offset:10240
    v_mfma_f32_16x16x32_bf16 v[188:191], v[244:247], v[120:123], v[188:191]
    ds_read_b64_tr_b16 v[236:237], v3 offset:12288
    v_mfma_f32_16x16x32_bf16 v[184:187], v[244:247], v[48:51], v[184:187]
    ds_read_b64_tr_b16 v[238:239], v3 offset:14336
    s_waitcnt lgkmcnt(4)
    v_mfma_f32_16x16x32_bf16 v[160:163], v[224:227], v[52:55], v[160:163]
    ds_read_b64_tr_b16 v[240:241], v3 offset:16384
    buffer_load_dwordx4 v11, s[8:11], s46 offen offset:2048 lds
    v_mfma_f32_16x16x32_bf16 v[164:167], v[224:227], v[124:127], v[164:167]
    ds_read_b64_tr_b16 v[242:243], v3 offset:18432
    v_mfma_f32_16x16x32_bf16 v[164:167], v[228:231], v[128:131], v[164:167]
    ds_read_b64_tr_b16 v[244:245], v3 offset:20480
    v_mfma_f32_16x16x32_bf16 v[160:163], v[228:231], v[56:59], v[160:163]
    ds_read_b64_tr_b16 v[246:247], v3 offset:22528
    s_waitcnt lgkmcnt(4)
    v_mfma_f32_16x16x32_bf16 v[160:163], v[232:235], v[60:63], v[160:163]
    ds_read_b64_tr_b16 v[224:225], v6 offset:0
    s_add_u32 m0, s44, 110592
    s_mov_b32 s46, 884864
    buffer_load_dwordx4 v9, s[28:31], s46 offen offset:0 lds
    v_mfma_f32_16x16x32_bf16 v[164:167], v[232:235], v[132:135], v[164:167]
    ds_read_b64_tr_b16 v[226:227], v6 offset:2048
    v_mfma_f32_16x16x32_bf16 v[172:175], v[236:239], v[124:127], v[172:175]
    ds_read_b64_tr_b16 v[228:229], v6 offset:4096
    v_mfma_f32_16x16x32_bf16 v[168:171], v[236:239], v[52:55], v[168:171]
    ds_read_b64_tr_b16 v[230:231], v6 offset:6144
    s_waitcnt lgkmcnt(4)
    v_mfma_f32_16x16x32_bf16 v[168:171], v[240:243], v[56:59], v[168:171]
    ds_read_b64_tr_b16 v[232:233], v6 offset:8192
    buffer_load_dwordx4 v10, s[28:31], s46 offen offset:1024 lds
    v_mfma_f32_16x16x32_bf16 v[172:175], v[240:243], v[128:131], v[172:175]
    ds_read_b64_tr_b16 v[234:235], v6 offset:10240
    v_mfma_f32_16x16x32_bf16 v[172:175], v[244:247], v[132:135], v[172:175]
    ds_read_b64_tr_b16 v[236:237], v6 offset:12288
    v_mfma_f32_16x16x32_bf16 v[168:171], v[244:247], v[60:63], v[168:171]
    ds_read_b64_tr_b16 v[238:239], v6 offset:14336
    s_waitcnt lgkmcnt(4)
    v_mfma_f32_16x16x32_bf16 v[176:179], v[224:227], v[52:55], v[176:179]
    ds_read_b64_tr_b16 v[240:241], v6 offset:16384
    buffer_load_dwordx4 v11, s[28:31], s46 offen offset:2048 lds
    v_mfma_f32_16x16x32_bf16 v[180:183], v[224:227], v[124:127], v[180:183]
    ds_read_b64_tr_b16 v[242:243], v6 offset:18432
    v_mfma_f32_16x16x32_bf16 v[180:183], v[228:231], v[128:131], v[180:183]
    ds_read_b64_tr_b16 v[244:245], v6 offset:20480
    v_mfma_f32_16x16x32_bf16 v[176:179], v[228:231], v[56:59], v[176:179]
    ds_read_b64_tr_b16 v[246:247], v6 offset:22528
    s_waitcnt vmcnt(19)
    s_barrier
    s_waitcnt lgkmcnt(4)
    v_mfma_f32_16x16x32_bf16 v[176:179], v[232:235], v[60:63], v[176:179]
    ds_read_b64_tr_b16 v[224:225], v3 offset:24576
    s_add_u32 m0, s44, 122880
    s_mov_b32 s46, 1769600
    buffer_load_dwordx4 v9, s[8:11], s46 offen offset:0 lds
    v_mfma_f32_16x16x32_bf16 v[180:183], v[232:235], v[132:135], v[180:183]
    ds_read_b64_tr_b16 v[226:227], v3 offset:26624
    v_mfma_f32_16x16x32_bf16 v[188:191], v[236:239], v[124:127], v[188:191]
    ds_read_b64_tr_b16 v[228:229], v3 offset:28672
    v_mfma_f32_16x16x32_bf16 v[184:187], v[236:239], v[52:55], v[184:187]
    ds_read_b64_tr_b16 v[230:231], v3 offset:30720
    s_waitcnt lgkmcnt(4)
    v_mfma_f32_16x16x32_bf16 v[184:187], v[240:243], v[56:59], v[184:187]
    ds_read_b64_tr_b16 v[232:233], v3 offset:32768
    buffer_load_dwordx4 v10, s[8:11], s46 offen offset:1024 lds
    v_mfma_f32_16x16x32_bf16 v[188:191], v[240:243], v[128:131], v[188:191]
    ds_read_b64_tr_b16 v[234:235], v3 offset:34816
    v_mfma_f32_16x16x32_bf16 v[188:191], v[244:247], v[132:135], v[188:191]
    ds_read_b64_tr_b16 v[236:237], v3 offset:36864
    v_mfma_f32_16x16x32_bf16 v[184:187], v[244:247], v[60:63], v[184:187]
    ds_read_b64_tr_b16 v[238:239], v3 offset:38912
    s_waitcnt lgkmcnt(4)
    v_mfma_f32_16x16x32_bf16 v[160:163], v[224:227], v[64:67], v[160:163]
    ds_read_b64_tr_b16 v[240:241], v3 offset:40960
    buffer_load_dwordx4 v11, s[8:11], s46 offen offset:2048 lds
    v_mfma_f32_16x16x32_bf16 v[164:167], v[224:227], v[136:139], v[164:167]
    ds_read_b64_tr_b16 v[242:243], v3 offset:43008
    v_mfma_f32_16x16x32_bf16 v[164:167], v[228:231], v[140:143], v[164:167]
    ds_read_b64_tr_b16 v[244:245], v3 offset:45056
    v_mfma_f32_16x16x32_bf16 v[160:163], v[228:231], v[68:71], v[160:163]
    ds_read_b64_tr_b16 v[246:247], v3 offset:47104
    s_waitcnt lgkmcnt(4)
    v_mfma_f32_16x16x32_bf16 v[160:163], v[232:235], v[72:75], v[160:163]
    ds_read_b64_tr_b16 v[224:225], v6 offset:24576
    s_add_u32 m0, s44, 135168
    s_mov_b32 s46, 1769600
    buffer_load_dwordx4 v9, s[28:31], s46 offen offset:0 lds
    v_mfma_f32_16x16x32_bf16 v[164:167], v[232:235], v[144:147], v[164:167]
    ds_read_b64_tr_b16 v[226:227], v6 offset:26624
    v_mfma_f32_16x16x32_bf16 v[172:175], v[236:239], v[136:139], v[172:175]
    ds_read_b64_tr_b16 v[228:229], v6 offset:28672
    v_mfma_f32_16x16x32_bf16 v[168:171], v[236:239], v[64:67], v[168:171]
    ds_read_b64_tr_b16 v[230:231], v6 offset:30720
    s_waitcnt lgkmcnt(4)
    v_mfma_f32_16x16x32_bf16 v[168:171], v[240:243], v[68:71], v[168:171]
    ds_read_b64_tr_b16 v[232:233], v6 offset:32768
    buffer_load_dwordx4 v10, s[28:31], s46 offen offset:1024 lds
    v_mfma_f32_16x16x32_bf16 v[172:175], v[240:243], v[140:143], v[172:175]
    ds_read_b64_tr_b16 v[234:235], v6 offset:34816
    v_mfma_f32_16x16x32_bf16 v[172:175], v[244:247], v[144:147], v[172:175]
    ds_read_b64_tr_b16 v[236:237], v6 offset:36864
    v_mfma_f32_16x16x32_bf16 v[168:171], v[244:247], v[72:75], v[168:171]
    ds_read_b64_tr_b16 v[238:239], v6 offset:38912
    s_waitcnt lgkmcnt(4)
    v_mfma_f32_16x16x32_bf16 v[176:179], v[224:227], v[64:67], v[176:179]
    ds_read_b64_tr_b16 v[240:241], v6 offset:40960
    buffer_load_dwordx4 v11, s[28:31], s46 offen offset:2048 lds
    v_mfma_f32_16x16x32_bf16 v[180:183], v[224:227], v[136:139], v[180:183]
    ds_read_b64_tr_b16 v[242:243], v6 offset:43008
    v_mfma_f32_16x16x32_bf16 v[180:183], v[228:231], v[140:143], v[180:183]
    ds_read_b64_tr_b16 v[244:245], v6 offset:45056
    v_mfma_f32_16x16x32_bf16 v[176:179], v[228:231], v[68:71], v[176:179]
    ds_read_b64_tr_b16 v[246:247], v6 offset:47104
    s_waitcnt vmcnt(24)
    s_mov_b32 s58, 400000
Lnsp_31:
    v_readfirstlane_b32 s84, v194
    v_readfirstlane_b32 s85, v195
    s_nop 3
    s_not_b32 s57, s84
    s_cmp_eq_u32 s57, s85
    s_cbranch_scc1 Lnok_30
    s_sub_u32 s58, s58, 1
    s_cmp_eq_u32 s58, 0
    s_cbranch_scc1 Lnok_30
    v_mov_b32 v1, 0
    global_load_dwordx2 v[194:195], v1, s[80:81] sc1
    s_waitcnt vmcnt(0)
    s_branch Lnsp_31
Lnok_30:
    s_waitcnt vmcnt(18)
    s_barrier
    s_waitcnt lgkmcnt(4)
    v_mfma_f32_16x16x32_bf16 v[176:179], v[232:235], v[72:75], v[176:179]
    ds_read_b64_tr_b16 v[224:225], v4 offset:0
    s_add_u32 m0, s44, 0
    s_mov_b32 s46, 2654336
    buffer_load_dwordx4 v9, s[8:11], s46 offen offset:0 lds
    v_mfma_f32_16x16x32_bf16 v[180:183], v[232:235], v[144:147], v[180:183]
    ds_read_b64_tr_b16 v[226:227], v4 offset:2048
    v_mfma_f32_16x16x32_bf16 v[188:191], v[236:239], v[136:139], v[188:191]
    ds_read_b64_tr_b16 v[228:229], v4 offset:4096
    v_mfma_f32_16x16x32_bf16 v[184:187], v[236:239], v[64:67], v[184:187]
    ds_read_b64_tr_b16 v[230:231], v4 offset:6144
    s_waitcnt lgkmcnt(4)
    v_mfma_f32_16x16x32_bf16 v[184:187], v[240:243], v[68:71], v[184:187]
    ds_read_b64_tr_b16 v[232:233], v4 offset:8192
    buffer_load_dwordx4 v10, s[8:11], s46 offen offset:1024 lds
    v_mfma_f32_16x16x32_bf16 v[188:191], v[240:243], v[140:143], v[188:191]
    ds_read_b64_tr_b16 v[234:235], v4 offset:10240
    v_mfma_f32_16x16x32_bf16 v[188:191], v[244:247], v[144:147], v[188:191]
    ds_read_b64_tr_b16 v[236:237], v4 offset:12288
    v_mfma_f32_16x16x32_bf16 v[184:187], v[244:247], v[72:75], v[184:187]
    ds_read_b64_tr_b16 v[238:239], v4 offset:14336
    s_waitcnt lgkmcnt(4)
    v_mfma_f32_16x16x32_bf16 v[160:163], v[224:227], v[76:79], v[160:163]
    ds_read_b64_tr_b16 v[240:241], v4 offset:16384
    buffer_load_dwordx4 v11, s[8:11], s46 offen offset:2048 lds
    v_mfma_f32_16x16x32_bf16 v[164:167], v[224:227], v[148:151], v[164:167]
    ds_read_b64_tr_b16 v[242:243], v4 offset:18432
    v_mfma_f32_16x16x32_bf16 v[164:167], v[228:231], v[152:155], v[164:167]
    ds_read_b64_tr_b16 v[244:245], v4 offset:20480
    v_mfma_f32_16x16x32_bf16 v[160:163], v[228:231], v[80:83], v[160:163]
    ds_read_b64_tr_b16 v[246:247], v4 offset:22528
    s_waitcnt lgkmcnt(4)
    v_mfma_f32_16x16x32_bf16 v[160:163], v[232:235], v[84:87], v[160:163]
    ds_read_b64_tr_b16 v[224:225], v7 offset:0
    s_add_u32 m0, s44, 12288
    s_mov_b32 s46, 2654336
    buffer_load_dwordx4 v9, s[28:31], s46 offen offset:0 lds
    v_mfma_f32_16x16x32_bf16 v[164:167], v[232:235], v[156:159], v[164:167]
    ds_read_b64_tr_b16 v[226:227], v7 offset:2048
    v_mfma_f32_16x16x32_bf16 v[172:175], v[236:239], v[148:151], v[172:175]
    ds_read_b64_tr_b16 v[228:229], v7 offset:4096
    v_mfma_f32_16x16x32_bf16 v[168:171], v[236:239], v[76:79], v[168:171]
    ds_read_b64_tr_b16 v[230:231], v7 offset:6144
    s_waitcnt lgkmcnt(4)
    v_mfma_f32_16x16x32_bf16 v[168:171], v[240:243], v[80:83], v[168:171]
    ds_read_b64_tr_b16 v[232:233], v7 offset:8192
    buffer_load_dwordx4 v10, s[28:31], s46 offen offset:1024 lds
    v_mfma_f32_16x16x32_bf16 v[172:175], v[240:243], v[152:155], v[172:175]
    ds_read_b64_tr_b16 v[234:235], v7 offset:10240
    v_mfma_f32_16x16x32_bf16 v[172:175], v[244:247], v[156:159], v[172:175]
    ds_read_b64_tr_b16 v[236:237], v7 offset:12288
    v_mfma_f32_16x16x32_bf16 v[168:171], v[244:247], v[84:87], v[168:171]
    ds_read_b64_tr_b16 v[238:239], v7 offset:14336
    s_waitcnt lgkmcnt(4)
    v_mfma_f32_16x16x32_bf16 v[176:179], v[224:227], v[76:79], v[176:179]
    ds_read_b64_tr_b16 v[240:241], v7 offset:16384
    buffer_load_dwordx4 v11, s[28:31], s46 offen offset:2048 lds
    v_mfma_f32_16x16x32_bf16 v[180:183], v[224:227], v[148:151], v[180:183]
    ds_read_b64_tr_b16 v[242:243], v7 offset:18432
    v_mfma_f32_16x16x32_bf16 v[180:183], v[228:231], v[152:155], v[180:183]
    ds_read_b64_tr_b16 v[244:245], v7 offset:20480
    v_mfma_f32_16x16x32_bf16 v[176:179], v[228:231], v[80:83], v[176:179]
    ds_read_b64_tr_b16 v[246:247], v7 offset:22528
    s_waitcnt vmcnt(18)
    s_barrier
    s_waitcnt lgkmcnt(4)
    v_mfma_f32_16x16x32_bf16 v[176:179], v[232:235], v[84:87], v[176:179]
    ds_read_b64_tr_b16 v[224:225], v4 offset:24576
    s_add_u32 m0, s44, 24576
    s_mov_b32 s46, 3539072
    buffer_load_dwordx4 v9, s[8:11], s46 offen offset:0 lds
    v_mfma_f32_16x16x32_bf16 v[180:183], v[232:235], v[156:159], v[180:183]
    ds_read_b64_tr_b16 v[226:227], v4 offset:26624
    v_mfma_f32_16x16x32_bf16 v[188:191], v[236:239], v[148:151], v[188:191]
    ds_read_b64_tr_b16 v[228:229], v4 offset:28672
    v_mfma_f32_16x16x32_bf16 v[184:187], v[236:239], v[76:79], v[184:187]
    ds_read_b64_tr_b16 v[230:231], v4 offset:30720
    s_waitcnt lgkmcnt(4)
    v_mfma_f32_16x16x32_bf16 v[184:187], v[240:243], v[80:83], v[184:187]
    ds_read_b64_tr_b16 v[232:233], v4 offset:32768
    buffer_load_dwordx4 v10, s[8:11], s46 offen offset:1024 lds
    v_mfma_f32_16x16x32_bf16 v[188:191], v[240:243], v[152:155], v[188:191]
    ds_read_b64_tr_b16 v[234:235], v4 offset:34816
    v_mfma_f32_16x16x32_bf16 v[188:191], v[244:247], v[156:159], v[188:191]
    ds_read_b64_tr_b16 v[236:237], v4 offset:36864
    v_mfma_f32_16x16x32_bf16 v[184:187], v[244:247], v[84:87], v[184:187]
    ds_read_b64_tr_b16 v[238:239], v4 offset:38912
    s_waitcnt lgkmcnt(4)
    v_mfma_f32_16x16x32_bf16 v[192:195], v[224:227], v[16:19], 0
    ds_read_b64_tr_b16 v[240:241], v4 offset:40960
    buffer_load_dwordx4 v11, s[8:11], s46 offen offset:2048 lds
    v_mfma_f32_16x16x32_bf16 v[196:199], v[224:227], v[88:91], 0
    ds_read_b64_tr_b16 v[242:243], v4 offset:43008
    v_mfma_f32_16x16x32_bf16 v[196:199], v[228:231], v[92:95], v[196:199]
    ds_read_b64_tr_b16 v[244:245], v4 offset:45056
    v_mfma_f32_16x16x32_bf16 v[192:195], v[228:231], v[20:23], v[192:195]
    ds_read_b64_tr_b16 v[246:247], v4 offset:47104
    s_waitcnt lgkmcnt(4)
    v_mfma_f32_16x16x32_bf16 v[192:195], v[232:235], v[24:27], v[192:195]
    ds_read_b64_tr_b16 v[224:225], v7 offset:24576
    s_add_u32 m0, s44, 36864
    s_mov_b32 s46, 3539072
    buffer_load_dwordx4 v9, s[28:31], s46 offen offset:0 lds
    v_mfma_f32_16x16x32_bf16 v[196:199], v[232:235], v[96:99], v[196:199]
    ds_read_b64_tr_b16 v[226:227], v7 offset:26624
    v_mfma_f32_16x16x32_bf16 v[204:207], v[236:239], v[88:91], 0
    ds_read_b64_tr_b16 v[228:229], v7 offset:28672
    v_max_f32 v160, 0, v160
    v_mfma_f32_16x16x32_bf16 v[200:203], v[236:239], v[16:19], 0
    ds_read_b64_tr_b16 v[230:231], v7 offset:30720
    v_max_f32 v161, 0, v161
    s_waitcnt lgkmcnt(4)
    v_mfma_f32_16x16x32_bf16 v[200:203], v[240:243], v[20:23], v[200:203]
    ds_read_b64_tr_b16 v[232:233], v7 offset:32768
    buffer_load_dwordx4 v10, s[28:31], s46 offen offset:1024 lds
    v_mfma_f32_16x16x32_bf16 v[204:207], v[240:243], v[92:95], v[204:207]
    ds_read_b64_tr_b16 v[234:235], v7 offset:34816
    v_max_f32 v162, 0, v162
    v_mfma_f32_16x16x32_bf16 v[204:207], v[244:247], v[96:99], v[204:207]
    ds_read_b64_tr_b16 v[236:237], v7 offset:36864
    v_max_f32 v163, 0, v163
    v_mfma_f32_16x16x32_bf16 v[200:203], v[244:247], v[24:27], v[200:203]
    ds_read_b64_tr_b16 v[238:239], v7 offset:38912
    v_mul_f32 v160, v160, v168
    s_waitcnt lgkmcnt(4)
    v_mfma_f32_16x16x32_bf16 v[208:211], v[224:227], v[16:19], 0
    ds_read_b64_tr_b16 v[240:241], v7 offset:40960
    buffer_load_dwordx4 v11, s[28:31], s46 offen offset:2048 lds
    v_mfma_f32_16x16x32_bf16 v[212:215], v[224:227], v[88:91], 0
    ds_read_b64_tr_b16 v[242:243], v7 offset:43008
    v_mul_f32 v161, v161, v169
    v_mfma_f32_16x16x32_bf16 v[212:215], v[228:231], v[92:95], v[212:215]
    ds_read_b64_tr_b16 v[244:245], v7 offset:45056
    v_mul_f32 v162, v162, v170
    v_mfma_f32_16x16x32_bf16 v[208:211], v[228:231], v[20:23], v[208:211]
    ds_read_b64_tr_b16 v[246:247], v7 offset:47104
    v_mul_f32 v163, v163, v171
    s_waitcnt vmcnt(18)
    s_barrier
    s_waitcnt lgkmcnt(4)
    v_mfma_f32_16x16x32_bf16 v[208:211], v[232:235], v[24:27], v[208:211]
    ds_read_b64_tr_b16 v[224:225], v5 offset:0
    s_add_u32 m0, s44, 49152
    s_mov_b32 s46, 4423808
    buffer_load_dwordx4 v9, s[8:11], s46 offen offset:0 lds
    v_mfma_f32_16x16x32_bf16 v[212:215], v[232:235], v[96:99], v[212:215]
    ds_read_b64_tr_b16 v[226:227], v5 offset:2048
    v_cvt_pk_bf16_f32 v248, v160, v161
    v_mfma_f32_16x16x32_bf16 v[220:223], v[236:239], v[88:91], 0
    ds_read_b64_tr_b16 v[228:229], v5 offset:4096
    v_cvt_pk_bf16_f32 v249, v162, v163
    v_mfma_f32_16x16x32_bf16 v[216:219], v[236:239], v[16:19], 0
    ds_read_b64_tr_b16 v[230:231], v5 offset:6144
    v_max_f32 v176, 0, v176
    s_waitcnt lgkmcnt(4)
    v_mfma_f32_16x16x32_bf16 v[216:219], v[240:243], v[20:23], v[216:219]
    ds_read_b64_tr_b16 v[232:233], v5 offset:8192
    buffer_load_dwordx4 v10, s[8:11], s46 offen offset:1024 lds
    v_mfma_f32_16x16x32_bf16 v[220:223], v[240:243], v[92:95], v[220:223]
    ds_read_b64_tr_b16 v[234:235], v5 offset:10240
    v_max_f32 v177, 0, v177
    v_mfma_f32_16x16x32_bf16 v[220:223], v[244:247], v[96:99], v[220:223]
    ds_read_b64_tr_b16 v[236:237], v5 offset:12288
    v_max_f32 v178, 0, v178
    v_mfma_f32_16x16x32_bf16 v[216:219], v[244:247], v[24:27], v[216:219]
    ds_read_b64_tr_b16 v[238:239], v5 offset:14336
    v_max_f32 v179, 0, v179
    s_waitcnt lgkmcnt(4)
    v_mfma_f32_16x16x32_bf16 v[192:195], v[224:227], v[28:31], v[192:195]
    ds_read_b64_tr_b16 v[240:241], v5 offset:16384
    buffer_load_dwordx4 v11, s[8:11], s46 offen offset:2048 lds
    v_mfma_f32_16x16x32_bf16 v[196:199], v[224:227], v[100:103], v[196:199]
    ds_read_b64_tr_b16 v[242:243], v5 offset:18432
    v_mul_f32 v176, v176, v184
    v_mfma_f32_16x16x32_bf16 v[196:199], v[228:231], v[104:107], v[196:199]
    ds_read_b64_tr_b16 v[244:245], v5 offset:20480
    v_mul_f32 v177, v177, v185
    v_mfma_f32_16x16x32_bf16 v[192:195], v[228:231], v[32:35], v[192:195]
    ds_read_b64_tr_b16 v[246:247], v5 offset:22528
    v_mul_f32 v178, v178, v186
    s_waitcnt lgkmcnt(4)
    v_mfma_f32_16x16x32_bf16 v[192:195], v[232:235], v[36:39], v[192:195]
    ds_read_b64_tr_b16 v[224:225], v8 offset:0
    s_add_u32 m0, s44, 61440
    s_mov_b32 s46, 4423808
    buffer_load_dwordx4 v9, s[28:31], s46 offen offset:0 lds
    v_mfma_f32_16x16x32_bf16 v[196:199], v[232:235], v[108:111], v[196:199]
    ds_read_b64_tr_b16 v[226:227], v8 offset:2048
    v_mul_f32 v179, v179, v187
    v_mfma_f32_16x16x32_bf16 v[204:207], v[236:239], v[100:103], v[204:207]
    ds_read_b64_tr_b16 v[228:229], v8 offset:4096
    v_cvt_pk_bf16_f32 v250, v176, v177
    v_mfma_f32_16x16x32_bf16 v[200:203], v[236:239], v[28:31], v[200:203]
    ds_read_b64_tr_b16 v[230:231], v8 offset:6144
    v_cvt_pk_bf16_f32 v251, v178, v179
    s_waitcnt lgkmcnt(4)
    v_mfma_f32_16x16x32_bf16 v[200:203], v[240:243], v[32:35], v[200:203]
    ds_read_b64_tr_b16 v[232:233], v8 offset:8192
    buffer_load_dwordx4 v10, s[28:31], s46 offen offset:1024 lds
    v_mfma_f32_16x16x32_bf16 v[204:207], v[240:243], v[104:107], v[204:207]
    ds_read_b64_tr_b16 v[234:235], v8 offset:10240
    v_max_f32 v164, 0, v164
    v_mfma_f32_16x16x32_bf16 v[204:207], v[244:247], v[108:111], v[204:207]
    ds_read_b64_tr_b16 v[236:237], v8 offset:12288
    v_max_f32 v165, 0, v165
    v_mfma_f32_16x16x32_bf16 v[200:203], v[244:247], v[36:39], v[200:203]
    ds_read_b64_tr_b16 v[238:239], v8 offset:14336
    v_max_f32 v166, 0, v166
    s_waitcnt lgkmcnt(4)
    v_mfma_f32_16x16x32_bf16 v[208:211], v[224:227], v[28:31], v[208:211]
    ds_read_b64_tr_b16 v[240:241], v8 offset:16384
    buffer_load_dwordx4 v11, s[28:31], s46 offen offset:2048 lds
    v_mfma_f32_16x16x32_bf16 v[212:215], v[224:227], v[100:103], v[212:215]
    ds_read_b64_tr_b16 v[242:243], v8 offset:18432
    v_max_f32 v167, 0, v167
    v_mfma_f32_16x16x32_bf16 v[212:215], v[228:231], v[104:107], v[212:215]
    ds_read_b64_tr_b16 v[244:245], v8 offset:20480
    v_mul_f32 v164, v164, v172
    v_mfma_f32_16x16x32_bf16 v[208:211], v[228:231], v[32:35], v[208:211]
    ds_read_b64_tr_b16 v[246:247], v8 offset:22528
    v_mul_f32 v165, v165, v173
    s_waitcnt vmcnt(18)
    s_barrier
    s_waitcnt lgkmcnt(4)
    v_mfma_f32_16x16x32_bf16 v[208:211], v[232:235], v[36:39], v[208:211]
    ds_read_b64_tr_b16 v[224:225], v5 offset:24576
    s_add_u32 m0, s44, 73728
    s_mov_b32 s46, 256
    buffer_load_dwordx4 v9, s[8:11], s46 offen offset:0 lds
    v_mfma_f32_16x16x32_bf16 v[212:215], v[232:235], v[108:111], v[212:215]
    ds_read_b64_tr_b16 v[226:227], v5 offset:26624
    v_mul_f32 v166, v166, v174
    v_mfma_f32_16x16x32_bf16 v[220:223], v[236:239], v[100:103], v[220:223]
    ds_read_b64_tr_b16 v[228:229], v5 offset:28672
    v_mul_f32 v167, v167, v175
    v_mfma_f32_16x16x32_bf16 v[216:219], v[236:239], v[28:31], v[216:219]
    ds_read_b64_tr_b16 v[230:231], v5 offset:30720
    v_cvt_pk_bf16_f32 v252, v164, v165
    s_waitcnt lgkmcnt(4)
    v_mfma_f32_16x16x32_bf16 v[216:219], v[240:243], v[32:35], v[216:219]
    ds_read_b64_tr_b16 v[232:233], v5 offset:32768
    buffer_load_dwordx4 v10, s[8:11], s46 offen offset:1024 lds
    v_mfma_f32_16x16x32_bf16 v[220:223], v[240:243], v[104:107], v[220:223]
    ds_read_b64_tr_b16 v[234:235], v5 offset:34816
    v_cvt_pk_bf16_f32 v253, v166, v167
    v_mfma_f32_16x16x32_bf16 v[220:223], v[244:247], v[108:111], v[220:223]
    ds_read_b64_tr_b16 v[236:237], v5 offset:36864
    v_max_f32 v180, 0, v180
    v_mfma_f32_16x16x32_bf16 v[216:219], v[244:247], v[36:39], v[216:219]
    ds_read_b64_tr_b16 v[238:239], v5 offset:38912
    v_max_f32 v181, 0, v181
    s_waitcnt lgkmcnt(4)
    v_mfma_f32_16x16x32_bf16 v[192:195], v[224:227], v[40:43], v[192:195]
    ds_read_b64_tr_b16 v[240:241], v5 offset:40960
    buffer_load_dwordx4 v11, s[8:11], s46 offen offset:2048 lds
    v_mfma_f32_16x16x32_bf16 v[196:199], v[224:227], v[112:115], v[196:199]
    ds_read_b64_tr_b16 v[242:243], v5 offset:43008
    v_max_f32 v182, 0, v182
    v_mfma_f32_16x16x32_bf16 v[196:199], v[228:231], v[116:119], v[196:199]
    ds_read_b64_tr_b16 v[244:245], v5 offset:45056
    v_max_f32 v183, 0, v183
    v_mfma_f32_16x16x32_bf16 v[192:195], v[228:231], v[44:47], v[192:195]
    ds_read_b64_tr_b16 v[246:247], v5 offset:47104
    v_mul_f32 v180, v180, v188
    s_waitcnt lgkmcnt(4)
    v_mfma_f32_16x16x32_bf16 v[192:195], v[232:235], v[48:51], v[192:195]
    ds_read_b64_tr_b16 v[224:225], v8 offset:24576
    s_add_u32 m0, s44, 86016
    s_mov_b32 s46, 256
    buffer_load_dwordx4 v9, s[28:31], s46 offen offset:0 lds
    v_mfma_f32_16x16x32_bf16 v[196:199], v[232:235], v[120:123], v[196:199]
    ds_read_b64_tr_b16 v[226:227], v8 offset:26624
    v_mul_f32 v181, v181, v189
    v_mfma_f32_16x16x32_bf16 v[204:207], v[236:239], v[112:115], v[204:207]
    ds_read_b64_tr_b16 v[228:229], v8 offset:28672
    v_mul_f32 v182, v182, v190
    v_mfma_f32_16x16x32_bf16 v[200:203], v[236:239], v[40:43], v[200:203]
    ds_read_b64_tr_b16 v[230:231], v8 offset:30720
    v_mul_f32 v183, v183, v191
    s_waitcnt lgkmcnt(4)
    v_mfma_f32_16x16x32_bf16 v[200:203], v[240:243], v[44:47], v[200:203]
    ds_read_b64_tr_b16 v[232:233], v8 offset:32768
    buffer_load_dwordx4 v10, s[28:31], s46 offen offset:1024 lds
    v_mfma_f32_16x16x32_bf16 v[204:207], v[240:243], v[116:119], v[204:207]
    ds_read_b64_tr_b16 v[234:235], v8 offset:34816
    v_cvt_pk_bf16_f32 v254, v180, v181
    v_mfma_f32_16x16x32_bf16 v[204:207], v[244:247], v[120:123], v[204:207]
    ds_read_b64_tr_b16 v[236:237], v8 offset:36864
    v_cvt_pk_bf16_f32 v255, v182, v183
    v_mfma_f32_16x16x32_bf16 v[200:203], v[244:247], v[48:51], v[200:203]
    ds_read_b64_tr_b16 v[238:239], v8 offset:38912
    s_lshl_b32 s55, s41, 11
    s_add_u32 s55, s55, 0
    v_lshlrev_b32 v1, 4, v0
    buffer_store_dwordx4 v[248:251], v1, s[16:19], s55 offen offset:0 sc1
    buffer_store_dwordx4 v[252:255], v1, s[16:19], s55 offen offset:1024 sc1
    s_waitcnt lgkmcnt(4)
    v_mfma_f32_16x16x32_bf16 v[208:211], v[224:227], v[40:43], v[208:211]
    ds_read_b64_tr_b16 v[240:241], v8 offset:40960
    buffer_load_dwordx4 v11, s[28:31], s46 offen offset:2048 lds
    v_mfma_f32_16x16x32_bf16 v[212:215], v[224:227], v[112:115], v[212:215]
    ds_read_b64_tr_b16 v[242:243], v8 offset:43008
    v_mfma_f32_16x16x32_bf16 v[212:215], v[228:231], v[116:119], v[212:215]
    ds_read_b64_tr_b16 v[244:245], v8 offset:45056
    v_mfma_f32_16x16x32_bf16 v[208:211], v[228:231], v[44:47], v[208:211]
    ds_read_b64_tr_b16 v[246:247], v8 offset:47104
    s_waitcnt vmcnt(20)
    s_barrier
    s_waitcnt lgkmcnt(4)
    v_mfma_f32_16x16x32_bf16 v[208:211], v[232:235], v[48:51], v[208:211]
    ds_read_b64_tr_b16 v[224:225], v3 offset:0
    s_add_u32 m0, s44, 98304
    s_mov_b32 s46, 884992
    buffer_load_dwordx4 v9, s[8:11], s46 offen offset:0 lds
    v_mfma_f32_16x16x32_bf16 v[212:215], v[232:235], v[120:123], v[212:215]
    ds_read_b64_tr_b16 v[226:227], v3 offset:2048
    v_mfma_f32_16x16x32_bf16 v[220:223], v[236:239], v[112:115], v[220:223]
    ds_read_b64_tr_b16 v[228:229], v3 offset:4096
    v_mfma_f32_16x16x32_bf16 v[216:219], v[236:239], v[40:43], v[216:219]
    ds_read_b64_tr_b16 v[230:231], v3 offset:6144
    s_waitcnt lgkmcnt(4)
    v_mfma_f32_16x16x32_bf16 v[216:219], v[240:243], v[44:47], v[216:219]
    ds_read_b64_tr_b16 v[232:233], v3 offset:8192
    buffer_load_dwordx4 v10, s[8:11], s46 offen offset:1024 lds
    v_mfma_f32_16x16x32_bf16 v[220:223], v[240:243], v[116:119], v[220:223]
    ds_read_b64_tr_b16 v[234:235], v3 offset:10240
    v_mfma_f32_16x16x32_bf16 v[220:223], v[244:247], v[120:123], v[220:223]
    ds_read_b64_tr_b16 v[236:237], v3 offset:12288
    v_mfma_f32_16x16x32_bf16 v[216:219], v[244:247], v[48:51], v[216:219]
    ds_read_b64_tr_b16 v[238:239], v3 offset:14336
    s_waitcnt lgkmcnt(4)
    v_mfma_f32_16x16x32_bf16 v[192:195], v[224:227], v[52:55], v[192:195]
    ds_read_b64_tr_b16 v[240:241], v3 offset:16384
    buffer_load_dwordx4 v11, s[8:11], s46 offen offset:2048 lds
    v_mfma_f32_16x16x32_bf16 v[196:199], v[224:227], v[124:127], v[196:199]
    ds_read_b64_tr_b16 v[242:243], v3 offset:18432
    v_mfma_f32_16x16x32_bf16 v[196:199], v[228:231], v[128:131], v[196:199]
    ds_read_b64_tr_b16 v[244:245], v3 offset:20480
    v_mfma_f32_16x16x32_bf16 v[192:195], v[228:231], v[56:59], v[192:195]
    ds_read_b64_tr_b16 v[246:247], v3 offset:22528
    s_waitcnt lgkmcnt(4)
    v_mfma_f32_16x16x32_bf16 v[192:195], v[232:235], v[60:63], v[192:195]
    ds_read_b64_tr_b16 v[224:225], v6 offset:0
    s_add_u32 m0, s44, 110592
    s_mov_b32 s46, 884992
    buffer_load_dwordx4 v9, s[28:31], s46 offen offset:0 lds
    v_mfma_f32_16x16x32_bf16 v[196:199], v[232:235], v[132:135], v[196:199]
    ds_read_b64_tr_b16 v[226:227], v6 offset:2048
    v_mfma_f32_16x16x32_bf16 v[204:207], v[236:239], v[124:127], v[204:207]
    ds_read_b64_tr_b16 v[228:229], v6 offset:4096
    v_mfma_f32_16x16x32_bf16 v[200:203], v[236:239], v[52:55], v[200:203]
    ds_read_b64_tr_b16 v[230:231], v6 offset:6144
    s_waitcnt lgkmcnt(4)
    v_mfma_f32_16x16x32_bf16 v[200:203], v[240:243], v[56:59], v[200:203]
    ds_read_b64_tr_b16 v[232:233], v6 offset:8192
    buffer_load_dwordx4 v10, s[28:31], s46 offen offset:1024 lds
    v_mfma_f32_16x16x32_bf16 v[204:207], v[240:243], v[128:131], v[204:207]
    ds_read_b64_tr_b16 v[234:235], v6 offset:10240
    v_mfma_f32_16x16x32_bf16 v[204:207], v[244:247], v[132:135], v[204:207]
    ds_read_b64_tr_b16 v[236:237], v6 offset:12288
    v_mfma_f32_16x16x32_bf16 v[200:203], v[244:247], v[60:63], v[200:203]
    ds_read_b64_tr_b16 v[238:239], v6 offset:14336
    s_waitcnt lgkmcnt(4)
    v_mfma_f32_16x16x32_bf16 v[208:211], v[224:227], v[52:55], v[208:211]
    ds_read_b64_tr_b16 v[240:241], v6 offset:16384
    buffer_load_dwordx4 v11, s[28:31], s46 offen offset:2048 lds
    v_mfma_f32_16x16x32_bf16 v[212:215], v[224:227], v[124:127], v[212:215]
    ds_read_b64_tr_b16 v[242:243], v6 offset:18432
    v_mfma_f32_16x16x32_bf16 v[212:215], v[228:231], v[128:131], v[212:215]
    ds_read_b64_tr_b16 v[244:245], v6 offset:20480
    v_mfma_f32_16x16x32_bf16 v[208:211], v[228:231], v[56:59], v[208:211]
    ds_read_b64_tr_b16 v[246:247], v6 offset:22528
    s_waitcnt vmcnt(20)
    s_barrier
    s_waitcnt lgkmcnt(4)
    v_mfma_f32_16x16x32_bf16 v[208:211], v[232:235], v[60:63], v[208:211]
    ds_read_b64_tr_b16 v[224:225], v3 offset:24576
    s_add_u32 m0, s44, 122880
    s_mov_b32 s46, 1769728
    buffer_load_dwordx4 v9, s[8:11], s46 offen offset:0 lds
    v_mfma_f32_16x16x32_bf16 v[212:215], v[232:235], v[132:135], v[212:215]
    ds_read_b64_tr_b16 v[226:227], v3 offset:26624
    v_mfma_f32_16x16x32_bf16 v[220:223], v[236:239], v[124:127], v[220:223]
    ds_read_b64_tr_b16 v[228:229], v3 offset:28672
    v_mfma_f32_16x16x32_bf16 v[216:219], v[236:239], v[52:55], v[216:219]
    ds_read_b64_tr_b16 v[230:231], v3 offset:30720
    s_waitcnt lgkmcnt(4)
    v_mfma_f32_16x16x32_bf16 v[216:219], v[240:243], v[56:59], v[216:219]
    ds_read_b64_tr_b16 v[232:233], v3 offset:32768
    buffer_load_dwordx4 v10, s[8:11], s46 offen offset:1024 lds
    v_mfma_f32_16x16x32_bf16 v[220:223], v[240:243], v[128:131], v[220:223]
    ds_read_b64_tr_b16 v[234:235], v3 offset:34816
    v_mfma_f32_16x16x32_bf16 v[220:223], v[244:247], v[132:135], v[220:223]
    ds_read_b64_tr_b16 v[236:237], v3 offset:36864
    v_mfma_f32_16x16x32_bf16 v[216:219], v[244:247], v[60:63], v[216:219]
    ds_read_b64_tr_b16 v[238:239], v3 offset:38912
    s_waitcnt lgkmcnt(4)
    v_mfma_f32_16x16x32_bf16 v[192:195], v[224:227], v[64:67], v[192:195]
    ds_read_b64_tr_b16 v[240:241], v3 offset:40960
    buffer_load_dwordx4 v11, s[8:11], s46 offen offset:2048 lds
    v_mfma_f32_16x16x32_bf16 v[196:199], v[224:227], v[136:139], v[196:199]
    ds_read_b64_tr_b16 v[242:243], v3 offset:43008
    v_mfma_f32_16x16x32_bf16 v[196:199], v[228:231], v[140:143], v[196:199]
    ds_read_b64_tr_b16 v[244:245], v3 offset:45056
    v_mfma_f32_16x16x32_bf16 v[192:195], v[228:231], v[68:71], v[192:195]
    ds_read_b64_tr_b16 v[246:247], v3 offset:47104
    s_waitcnt lgkmcnt(4)
    v_mfma_f32_16x16x32_bf16 v[192:195], v[232:235], v[72:75], v[192:195]
    ds_read_b64_tr_b16 v[224:225], v6 offset:24576
    s_add_u32 m0, s44, 135168
    s_mov_b32 s46, 1769728
    buffer_load_dwordx4 v9, s[28:31], s46 offen offset:0 lds
    v_mfma_f32_16x16x32_bf16 v[196:199], v[232:235], v[144:147], v[196:199]
    ds_read_b64_tr_b16 v[226:227], v6 offset:26624
    v_mfma_f32_16x16x32_bf16 v[204:207], v[236:239], v[136:139], v[204:207]
    ds_read_b64_tr_b16 v[228:229], v6 offset:28672
    v_mfma_f32_16x16x32_bf16 v[200:203], v[236:239], v[64:67], v[200:203]
    ds_read_b64_tr_b16 v[230:231], v6 offset:30720
    s_waitcnt lgkmcnt(4)
    v_mfma_f32_16x16x32_bf16 v[200:203], v[240:243], v[68:71], v[200:203]
    ds_read_b64_tr_b16 v[232:233], v6 offset:32768
    buffer_load_dwordx4 v10, s[28:31], s46 offen offset:1024 lds
    v_mfma_f32_16x16x32_bf16 v[204:207], v[240:243], v[140:143], v[204:207]
    ds_read_b64_tr_b16 v[234:235], v6 offset:34816
    v_mfma_f32_16x16x32_bf16 v[204:207], v[244:247], v[144:147], v[204:207]
    ds_read_b64_tr_b16 v[236:237], v6 offset:36864
    v_mfma_f32_16x16x32_bf16 v[200:203], v[244:247], v[72:75], v[200:203]
    ds_read_b64_tr_b16 v[238:239], v6 offset:38912
    s_waitcnt lgkmcnt(4)
    v_mfma_f32_16x16x32_bf16 v[208:211], v[224:227], v[64:67], v[208:211]
    ds_read_b64_tr_b16 v[240:241], v6 offset:40960
    buffer_load_dwordx4 v11, s[28:31], s46 offen offset:2048 lds
    v_mfma_f32_16x16x32_bf16 v[212:215], v[224:227], v[136:139], v[212:215]
    ds_read_b64_tr_b16 v[242:243], v6 offset:43008
    v_mfma_f32_16x16x32_bf16 v[212:215], v[228:231], v[140:143], v[212:215]
    ds_read_b64_tr_b16 v[244:245], v6 offset:45056
    v_mfma_f32_16x16x32_bf16 v[208:211], v[228:231], v[68:71], v[208:211]
    ds_read_b64_tr_b16 v[246:247], v6 offset:47104
    s_waitcnt vmcnt(20)
    s_barrier
    s_waitcnt lgkmcnt(4)
    v_mfma_f32_16x16x32_bf16 v[208:211], v[232:235], v[72:75], v[208:211]
    ds_read_b64_tr_b16 v[224:225], v4 offset:0
    s_add_u32 m0, s44, 0
    s_mov_b32 s46, 2654464
    buffer_load_dwordx4 v9, s[8:11], s46 offen offset:0 lds
    v_mfma_f32_16x16x32_bf16 v[212:215], v[232:235], v[144:147], v[212:215]
    ds_read_b64_tr_b16 v[226:227], v4 offset:2048
    v_mfma_f32_16x16x32_bf16 v[220:223], v[236:239], v[136:139], v[220:223]
    ds_read_b64_tr_b16 v[228:229], v4 offset:4096
    v_mfma_f32_16x16x32_bf16 v[216:219], v[236:239], v[64:67], v[216:219]
    ds_read_b64_tr_b16 v[230:231], v4 offset:6144
    s_waitcnt lgkmcnt(4)
    v_mfma_f32_16x16x32_bf16 v[216:219], v[240:243], v[68:71], v[216:219]
    ds_read_b64_tr_b16 v[232:233], v4 offset:8192
    buffer_load_dwordx4 v10, s[8:11], s46 offen offset:1024 lds
    v_mfma_f32_16x16x32_bf16 v[220:223], v[240:243], v[140:143], v[220:223]
    ds_read_b64_tr_b16 v[234:235], v4 offset:10240
    v_mfma_f32_16x16x32_bf16 v[220:223], v[244:247], v[144:147], v[220:223]
    ds_read_b64_tr_b16 v[236:237], v4 offset:12288
    v_mfma_f32_16x16x32_bf16 v[216:219], v[244:247], v[72:75], v[216:219]
    ds_read_b64_tr_b16 v[238:239], v4 offset:14336
    s_waitcnt lgkmcnt(4)
    v_mfma_f32_16x16x32_bf16 v[192:195], v[224:227], v[76:79], v[192:195]
    ds_read_b64_tr_b16 v[240:241], v4 offset:16384
    buffer_load_dwordx4 v11, s[8:11], s46 offen offset:2048 lds
    v_mfma_f32_16x16x32_bf16 v[196:199], v[224:227], v[148:151], v[196:199]
    ds_read_b64_tr_b16 v[242:243], v4 offset:18432
    v_mfma_f32_16x16x32_bf16 v[196:199], v[228:231], v[152:155], v[196:199]
    ds_read_b64_tr_b16 v[244:245], v4 offset:20480
    v_mfma_f32_16x16x32_bf16 v[192:195], v[228:231], v[80:83], v[192:195]
    ds_read_b64_tr_b16 v[246:247], v4 offset:22528
    s_waitcnt lgkmcnt(4)
    v_mfma_f32_16x16x32_bf16 v[192:195], v[232:235], v[84:87], v[192:195]
    ds_read_b64_tr_b16 v[224:225], v7 offset:0
    s_add_u32 m0, s44, 12288
    s_mov_b32 s46, 2654464
    buffer_load_dwordx4 v9, s[28:31], s46 offen offset:0 lds
    v_mfma_f32_16x16x32_bf16 v[196:199], v[232:235], v[156:159], v[196:199]
    ds_read_b64_tr_b16 v[226:227], v7 offset:2048
    v_mfma_f32_16x16x32_bf16 v[204:207], v[236:239], v[148:151], v[204:207]
    ds_read_b64_tr_b16 v[228:229], v7 offset:4096
    v_mfma_f32_16x16x32_bf16 v[200:203], v[236:239], v[76:79], v[200:203]
    ds_read_b64_tr_b16 v[230:231], v7 offset:6144
    s_waitcnt lgkmcnt(4)
    v_mfma_f32_16x16x32_bf16 v[200:203], v[240:243], v[80:83], v[200:203]
    ds_read_b64_tr_b16 v[232:233], v7 offset:8192
    buffer_load_dwordx4 v10, s[28:31], s46 offen offset:1024 lds
    v_mfma_f32_16x16x32_bf16 v[204:207], v[240:243], v[152:155], v[204:207]
    ds_read_b64_tr_b16 v[234:235], v7 offset:10240
    v_mfma_f32_16x16x32_bf16 v[204:207], v[244:247], v[156:159], v[204:207]
    ds_read_b64_tr_b16 v[236:237], v7 offset:12288
    v_mfma_f32_16x16x32_bf16 v[200:203], v[244:247], v[84:87], v[200:203]
    ds_read_b64_tr_b16 v[238:239], v7 offset:14336
    s_waitcnt lgkmcnt(4)
    v_mfma_f32_16x16x32_bf16 v[208:211], v[224:227], v[76:79], v[208:211]
    ds_read_b64_tr_b16 v[240:241], v7 offset:16384
    buffer_load_dwordx4 v11, s[28:31], s46 offen offset:2048 lds
    v_mfma_f32_16x16x32_bf16 v[212:215], v[224:227], v[148:151], v[212:215]
    ds_read_b64_tr_b16 v[242:243], v7 offset:18432
    v_mfma_f32_16x16x32_bf16 v[212:215], v[228:231], v[152:155], v[212:215]
    ds_read_b64_tr_b16 v[244:245], v7 offset:20480
    v_mfma_f32_16x16x32_bf16 v[208:211], v[228:231], v[80:83], v[208:211]
    ds_read_b64_tr_b16 v[246:247], v7 offset:22528
    s_waitcnt vmcnt(18)
    s_barrier
    s_waitcnt lgkmcnt(4)
    v_mfma_f32_16x16x32_bf16 v[208:211], v[232:235], v[84:87], v[208:211]
    ds_read_b64_tr_b16 v[224:225], v4 offset:24576
    s_add_u32 m0, s44, 24576
    s_mov_b32 s46, 3539200
    buffer_load_dwordx4 v9, s[8:11], s46 offen offset:0 lds
    v_mfma_f32_16x16x32_bf16 v[212:215], v[232:235], v[156:159], v[212:215]
    ds_read_b64_tr_b16 v[226:227], v4 offset:26624
    v_mfma_f32_16x16x32_bf16 v[220:223], v[236:239], v[148:151], v[220:223]
    ds_read_b64_tr_b16 v[228:229], v4 offset:28672
    v_mfma_f32_16x16x32_bf16 v[216:219], v[236:239], v[76:79], v[216:219]
    ds_read_b64_tr_b16 v[230:231], v4 offset:30720
    s_waitcnt lgkmcnt(4)
    v_mfma_f32_16x16x32_bf16 v[216:219], v[240:243], v[80:83], v[216:219]
    ds_read_b64_tr_b16 v[232:233], v4 offset:32768
    buffer_load_dwordx4 v10, s[8:11], s46 offen offset:1024 lds
    v_mfma_f32_16x16x32_bf16 v[220:223], v[240:243], v[152:155], v[220:223]
    ds_read_b64_tr_b16 v[234:235], v4 offset:34816
    v_mfma_f32_16x16x32_bf16 v[220:223], v[244:247], v[156:159], v[220:223]
    ds_read_b64_tr_b16 v[236:237], v4 offset:36864
    v_mfma_f32_16x16x32_bf16 v[216:219], v[244:247], v[84:87], v[216:219]
    ds_read_b64_tr_b16 v[238:239], v4 offset:38912
    s_waitcnt lgkmcnt(4)
    v_mfma_f32_16x16x32_bf16 v[160:163], v[224:227], v[16:19], 0
    ds_read_b64_tr_b16 v[240:241], v4 offset:40960
    buffer_load_dwordx4 v11, s[8:11], s46 offen offset:2048 lds
    v_mfma_f32_16x16x32_bf16 v[164:167], v[224:227], v[88:91], 0
    ds_read_b64_tr_b16 v[242:243], v4 offset:43008
    v_mfma_f32_16x16x32_bf16 v[164:167], v[228:231], v[92:95], v[164:167]
    ds_read_b64_tr_b16 v[244:245], v4 offset:45056
    v_mfma_f32_16x16x32_bf16 v[160:163], v[228:231], v[20:23], v[160:163]
    ds_read_b64_tr_b16 v[246:247], v4 offset:47104
    s_waitcnt lgkmcnt(4)
    v_mfma_f32_16x16x32_bf16 v[160:163], v[232:235], v[24:27], v[160:163]
    ds_read_b64_tr_b16 v[224:225], v7 offset:24576
    s_add_u32 m0, s44, 36864
    s_mov_b32 s46, 3539200
    buffer_load_dwordx4 v9, s[28:31], s46 offen offset:0 lds
    v_mfma_f32_16x16x32_bf16 v[164:167], v[232:235], v[96:99], v[164:167]
    ds_read_b64_tr_b16 v[226:227], v7 offset:26624
    v_mfma_f32_16x16x32_bf16 v[172:175], v[236:239], v[88:91], 0
    ds_read_b64_tr_b16 v[228:229], v7 offset:28672
    v_max_f32 v192, 0, v192
    v_mfma_f32_16x16x32_bf16 v[168:171], v[236:239], v[16:19], 0
    ds_read_b64_tr_b16 v[230:231], v7 offset:30720
    v_max_f32 v193, 0, v193
    s_waitcnt lgkmcnt(4)
    v_mfma_f32_16x16x32_bf16 v[168:171], v[240:243], v[20:23], v[168:171]
    ds_read_b64_tr_b16 v[232:233], v7 offset:32768
    buffer_load_dwordx4 v10, s[28:31], s46 offen offset:1024 lds
    v_mfma_f32_16x16x32_bf16 v[172:175], v[240:243], v[92:95], v[172:175]
    ds_read_b64_tr_b16 v[234:235], v7 offset:34816
    v_max_f32 v194, 0, v194
    v_mfma_f32_16x16x32_bf16 v[172:175], v[244:247], v[96:99], v[172:175]
    ds_read_b64_tr_b16 v[236:237], v7 offset:36864
    v_max_f32 v195, 0, v195
    v_mfma_f32_16x16x32_bf16 v[168:171], v[244:247], v[24:27], v[168:171]
    ds_read_b64_tr_b16 v[238:239], v7 offset:38912
    v_mul_f32 v192, v192, v200
    s_waitcnt lgkmcnt(4)
    v_mfma_f32_16x16x32_bf16 v[176:179], v[224:227], v[16:19], 0
    ds_read_b64_tr_b16 v[240:241], v7 offset:40960
    buffer_load_dwordx4 v11, s[28:31], s46 offen offset:2048 lds
    v_mfma_f32_16x16x32_bf16 v[180:183], v[224:227], v[88:91], 0
    ds_read_b64_tr_b16 v[242:243], v7 offset:43008
    v_mul_f32 v193, v193, v201
    v_mfma_f32_16x16x32_bf16 v[180:183], v[228:231], v[92:95], v[180:183]
    ds_read_b64_tr_b16 v[244:245], v7 offset:45056
    v_mul_f32 v194, v194, v202
    v_mfma_f32_16x16x32_bf16 v[176:179], v[228:231], v[20:23], v[176:179]
    ds_read_b64_tr_b16 v[246:247], v7 offset:47104
    v_mul_f32 v195, v195, v203
    s_waitcnt vmcnt(18)
    s_barrier
    s_waitcnt lgkmcnt(4)
    v_mfma_f32_16x16x32_bf16 v[176:179], v[232:235], v[24:27], v[176:179]
    ds_read_b64_tr_b16 v[224:225], v5 offset:0
    s_add_u32 m0, s44, 49152
    s_mov_b32 s46, 4423936
    buffer_load_dwordx4 v9, s[8:11], s46 offen offset:0 lds
    v_mfma_f32_16x16x32_bf16 v[180:183], v[232:235], v[96:99], v[180:183]
    ds_read_b64_tr_b16 v[226:227], v5 offset:2048
    v_cvt_pk_bf16_f32 v248, v192, v193
    v_mfma_f32_16x16x32_bf16 v[188:191], v[236:239], v[88:91], 0
    ds_read_b64_tr_b16 v[228:229], v5 offset:4096
    v_cvt_pk_bf16_f32 v249, v194, v195
    v_mfma_f32_16x16x32_bf16 v[184:187], v[236:239], v[16:19], 0
    ds_read_b64_tr_b16 v[230:231], v5 offset:6144
    v_max_f32 v208, 0, v208
    s_waitcnt lgkmcnt(4)
    v_mfma_f32_16x16x32_bf16 v[184:187], v[240:243], v[20:23], v[184:187]
    ds_read_b64_tr_b16 v[232:233], v5 offset:8192
    buffer_load_dwordx4 v10, s[8:11], s46 offen offset:1024 lds
    v_mfma_f32_16x16x32_bf16 v[188:191], v[240:243], v[92:95], v[188:191]
    ds_read_b64_tr_b16 v[234:235], v5 offset:10240
    v_max_f32 v209, 0, v209
    v_mfma_f32_16x16x32_bf16 v[188:191], v[244:247], v[96:99], v[188:191]
    ds_read_b64_tr_b16 v[236:237], v5 offset:12288
    v_max_f32 v210, 0, v210
    v_mfma_f32_16x16x32_bf16 v[184:187], v[244:247], v[24:27], v[184:187]
    ds_read_b64_tr_b16 v[238:239], v5 offset:14336
    v_max_f32 v211, 0, v211
    s_waitcnt lgkmcnt(4)
    v_mfma_f32_16x16x32_bf16 v[160:163], v[224:227], v[28:31], v[160:163]
    ds_read_b64_tr_b16 v[240:241], v5 offset:16384
    buffer_load_dwordx4 v11, s[8:11], s46 offen offset:2048 lds
    v_mfma_f32_16x16x32_bf16 v[164:167], v[224:227], v[100:103], v[164:167]
    ds_read_b64_tr_b16 v[242:243], v5 offset:18432
    v_mul_f32 v208, v208, v216
    v_mfma_f32_16x16x32_bf16 v[164:167], v[228:231], v[104:107], v[164:167]
    ds_read_b64_tr_b16 v[244:245], v5 offset:20480
    v_mul_f32 v209, v209, v217
    v_mfma_f32_16x16x32_bf16 v[160:163], v[228:231], v[32:35], v[160:163]
    ds_read_b64_tr_b16 v[246:247], v5 offset:22528
    v_mul_f32 v210, v210, v218
    s_waitcnt lgkmcnt(4)
    v_mfma_f32_16x16x32_bf16 v[160:163], v[232:235], v[36:39], v[160:163]
    ds_read_b64_tr_b16 v[224:225], v8 offset:0
    s_add_u32 m0, s44, 61440
    s_mov_b32 s46, 4423936
    buffer_load_dwordx4 v9, s[28:31], s46 offen offset:0 lds
    v_mfma_f32_16x16x32_bf16 v[164:167], v[232:235], v[108:111], v[164:167]
    ds_read_b64_tr_b16 v[226:227], v8 offset:2048
    v_mul_f32 v211, v211, v219
    v_mfma_f32_16x16x32_bf16 v[172:175], v[236:239], v[100:103], v[172:175]
    ds_read_b64_tr_b16 v[228:229], v8 offset:4096
    v_cvt_pk_bf16_f32 v250, v208, v209
    v_mfma_f32_16x16x32_bf16 v[168:171], v[236:239], v[28:31], v[168:171]
    ds_read_b64_tr_b16 v[230:231], v8 offset:6144
    v_cvt_pk_bf16_f32 v251, v210, v211
    s_waitcnt lgkmcnt(4)
    v_mfma_f32_16x16x32_bf16 v[168:171], v[240:243], v[32:35], v[168:171]
    ds_read_b64_tr_b16 v[232:233], v8 offset:8192
    buffer_load_dwordx4 v10, s[28:31], s46 offen offset:1024 lds
    v_mfma_f32_16x16x32_bf16 v[172:175], v[240:243], v[104:107], v[172:175]
    ds_read_b64_tr_b16 v[234:235], v8 offset:10240
    v_max_f32 v196, 0, v196
    v_mfma_f32_16x16x32_bf16 v[172:175], v[244:247], v[108:111], v[172:175]
    ds_read_b64_tr_b16 v[236:237], v8 offset:12288
    v_max_f32 v197, 0, v197
    v_mfma_f32_16x16x32_bf16 v[168:171], v[244:247], v[36:39], v[168:171]
    ds_read_b64_tr_b16 v[238:239], v8 offset:14336
    v_max_f32 v198, 0, v198
    s_waitcnt lgkmcnt(4)
    v_mfma_f32_16x16x32_bf16 v[176:179], v[224:227], v[28:31], v[176:179]
    ds_read_b64_tr_b16 v[240:241], v8 offset:16384
    buffer_load_dwordx4 v11, s[28:31], s46 offen offset:2048 lds
    v_mfma_f32_16x16x32_bf16 v[180:183], v[224:227], v[100:103], v[180:183]
    ds_read_b64_tr_b16 v[242:243], v8 offset:18432
    v_max_f32 v199, 0, v199
    v_mfma_f32_16x16x32_bf16 v[180:183], v[228:231], v[104:107], v[180:183]
    ds_read_b64_tr_b16 v[244:245], v8 offset:20480
    v_mul_f32 v196, v196, v204
    v_mfma_f32_16x16x32_bf16 v[176:179], v[228:231], v[32:35], v[176:179]
    ds_read_b64_tr_b16 v[246:247], v8 offset:22528
    v_mul_f32 v197, v197, v205
    s_waitcnt vmcnt(18)
    s_barrier
    s_waitcnt lgkmcnt(4)
    v_mfma_f32_16x16x32_bf16 v[176:179], v[232:235], v[36:39], v[176:179]
    ds_read_b64_tr_b16 v[224:225], v5 offset:24576
    s_add_u32 m0, s44, 73728
    s_mov_b32 s46, 384
    buffer_load_dwordx4 v9, s[8:11], s46 offen offset:0 lds
    v_mfma_f32_16x16x32_bf16 v[180:183], v[232:235], v[108:111], v[180:183]
    ds_read_b64_tr_b16 v[226:227], v5 offset:26624
    v_mul_f32 v198, v198, v206
    v_mfma_f32_16x16x32_bf16 v[188:191], v[236:239], v[100:103], v[188:191]
    ds_read_b64_tr_b16 v[228:229], v5 offset:28672
    v_mul_f32 v199, v199, v207
    v_mfma_f32_16x16x32_bf16 v[184:187], v[236:239], v[28:31], v[184:187]
    ds_read_b64_tr_b16 v[230:231], v5 offset:30720
    v_cvt_pk_bf16_f32 v252, v196, v197
    s_waitcnt lgkmcnt(4)
    v_mfma_f32_16x16x32_bf16 v[184:187], v[240:243], v[32:35], v[184:187]
    ds_read_b64_tr_b16 v[232:233], v5 offset:32768
    buffer_load_dwordx4 v10, s[8:11], s46 offen offset:1024 lds
    v_mfma_f32_16x16x32_bf16 v[188:191], v[240:243], v[104:107], v[188:191]
    ds_read_b64_tr_b16 v[234:235], v5 offset:34816
    v_cvt_pk_bf16_f32 v253, v198, v199
    v_mfma_f32_16x16x32_bf16 v[188:191], v[244:247], v[108:111], v[188:191]
    ds_read_b64_tr_b16 v[236:237], v5 offset:36864
    v_max_f32 v212, 0, v212
    v_mfma_f32_16x16x32_bf16 v[184:187], v[244:247], v[36:39], v[184:187]
    ds_read_b64_tr_b16 v[238:239], v5 offset:38912
    v_max_f32 v213, 0, v213
    s_waitcnt lgkmcnt(4)
    v_mfma_f32_16x16x32_bf16 v[160:163], v[224:227], v[40:43], v[160:163]
    ds_read_b64_tr_b16 v[240:241], v5 offset:40960
    buffer_load_dwordx4 v11, s[8:11], s46 offen offset:2048 lds
    v_mfma_f32_16x16x32_bf16 v[164:167], v[224:227], v[112:115], v[164:167]
    ds_read_b64_tr_b16 v[242:243], v5 offset:43008
    v_max_f32 v214, 0, v214
    v_mfma_f32_16x16x32_bf16 v[164:167], v[228:231], v[116:119], v[164:167]
    ds_read_b64_tr_b16 v[244:245], v5 offset:45056
    v_max_f32 v215, 0, v215
    v_mfma_f32_16x16x32_bf16 v[160:163], v[228:231], v[44:47], v[160:163]
    ds_read_b64_tr_b16 v[246:247], v5 offset:47104
    v_mul_f32 v212, v212, v220
    s_waitcnt lgkmcnt(4)
    v_mfma_f32_16x16x32_bf16 v[160:163], v[232:235], v[48:51], v[160:163]
    ds_read_b64_tr_b16 v[224:225], v8 offset:24576
    s_add_u32 m0, s44, 86016
    s_mov_b32 s46, 384
    buffer_load_dwordx4 v9, s[28:31], s46 offen offset:0 lds
    v_mfma_f32_16x16x32_bf16 v[164:167], v[232:235], v[120:123], v[164:167]
    ds_read_b64_tr_b16 v[226:227], v8 offset:26624
    v_mul_f32 v213, v213, v221
    v_mfma_f32_16x16x32_bf16 v[172:175], v[236:239], v[112:115], v[172:175]
    ds_read_b64_tr_b16 v[228:229], v8 offset:28672
    v_mul_f32 v214, v214, v222
    v_mfma_f32_16x16x32_bf16 v[168:171], v[236:239], v[40:43], v[168:171]
    ds_read_b64_tr_b16 v[230:231], v8 offset:30720
    v_mul_f32 v215, v215, v223
    s_waitcnt lgkmcnt(4)
    v_mfma_f32_16x16x32_bf16 v[168:171], v[240:243], v[44:47], v[168:171]
    ds_read_b64_tr_b16 v[232:233], v8 offset:32768
    buffer_load_dwordx4 v10, s[28:31], s46 offen offset:1024 lds
    v_mfma_f32_16x16x32_bf16 v[172:175], v[240:243], v[116:119], v[172:175]
    ds_read_b64_tr_b16 v[234:235], v8 offset:34816
    v_cvt_pk_bf16_f32 v254, v212, v213
    v_mfma_f32_16x16x32_bf16 v[172:175], v[244:247], v[120:123], v[172:175]
    ds_read_b64_tr_b16 v[236:237], v8 offset:36864
    v_cvt_pk_bf16_f32 v255, v214, v215
    v_mfma_f32_16x16x32_bf16 v[168:171], v[244:247], v[48:51], v[168:171]
    ds_read_b64_tr_b16 v[238:239], v8 offset:38912
    s_lshl_b32 s55, s41, 11
    s_add_u32 s55, s55, 4096
    v_lshlrev_b32 v1, 4, v0
    buffer_store_dwordx4 v[248:251], v1, s[16:19], s55 offen offset:0 sc1
    buffer_store_dwordx4 v[252:255], v1, s[16:19], s55 offen offset:1024 sc1
    s_waitcnt lgkmcnt(4)
    v_mfma_f32_16x16x32_bf16 v[176:179], v[224:227], v[40:43], v[176:179]
    ds_read_b64_tr_b16 v[240:241], v8 offset:40960
    buffer_load_dwordx4 v11, s[28:31], s46 offen offset:2048 lds
    v_mfma_f32_16x16x32_bf16 v[180:183], v[224:227], v[112:115], v[180:183]
    ds_read_b64_tr_b16 v[242:243], v8 offset:43008
    v_mfma_f32_16x16x32_bf16 v[180:183], v[228:231], v[116:119], v[180:183]
    ds_read_b64_tr_b16 v[244:245], v8 offset:45056
    v_mfma_f32_16x16x32_bf16 v[176:179], v[228:231], v[44:47], v[176:179]
    ds_read_b64_tr_b16 v[246:247], v8 offset:47104
    s_waitcnt vmcnt(20)
    s_barrier
    s_waitcnt lgkmcnt(4)
    v_mfma_f32_16x16x32_bf16 v[176:179], v[232:235], v[48:51], v[176:179]
    ds_read_b64_tr_b16 v[224:225], v3 offset:0
    s_add_u32 m0, s44, 98304
    s_mov_b32 s46, 885120
    buffer_load_dwordx4 v9, s[8:11], s46 offen offset:0 lds
    v_mfma_f32_16x16x32_bf16 v[180:183], v[232:235], v[120:123], v[180:183]
    ds_read_b64_tr_b16 v[226:227], v3 offset:2048
    v_mfma_f32_16x16x32_bf16 v[188:191], v[236:239], v[112:115], v[188:191]
    ds_read_b64_tr_b16 v[228:229], v3 offset:4096
    v_mfma_f32_16x16x32_bf16 v[184:187], v[236:239], v[40:43], v[184:187]
    ds_read_b64_tr_b16 v[230:231], v3 offset:6144
    s_waitcnt lgkmcnt(4)
    v_mfma_f32_16x16x32_bf16 v[184:187], v[240:243], v[44:47], v[184:187]
    ds_read_b64_tr_b16 v[232:233], v3 offset:8192
    buffer_load_dwordx4 v10, s[8:11], s46 offen offset:1024 lds
    v_mfma_f32_16x16x32_bf16 v[188:191], v[240:243], v[116:119], v[188:191]
    ds_read_b64_tr_b16 v[234:235], v3 offset:10240
    v_mfma_f32_16x16x32_bf16 v[188:191], v[244:247], v[120:123], v[188:191]
    ds_read_b64_tr_b16 v[236:237], v3 offset:12288
    v_mfma_f32_16x16x32_bf16 v[184:187], v[244:247], v[48:51], v[184:187]
    ds_read_b64_tr_b16 v[238:239], v3 offset:14336
    s_waitcnt lgkmcnt(4)
    v_mfma_f32_16x16x32_bf16 v[160:163], v[224:227], v[52:55], v[160:163]
    ds_read_b64_tr_b16 v[240:241], v3 offset:16384
    buffer_load_dwordx4 v11, s[8:11], s46 offen offset:2048 lds
    v_mfma_f32_16x16x32_bf16 v[164:167], v[224:227], v[124:127], v[164:167]
    ds_read_b64_tr_b16 v[242:243], v3 offset:18432
    v_mfma_f32_16x16x32_bf16 v[164:167], v[228:231], v[128:131], v[164:167]
    ds_read_b64_tr_b16 v[244:245], v3 offset:20480
    v_mfma_f32_16x16x32_bf16 v[160:163], v[228:231], v[56:59], v[160:163]
    ds_read_b64_tr_b16 v[246:247], v3 offset:22528
    s_waitcnt lgkmcnt(4)
    v_mfma_f32_16x16x32_bf16 v[160:163], v[232:235], v[60:63], v[160:163]
    ds_read_b64_tr_b16 v[224:225], v6 offset:0
    s_add_u32 m0, s44, 110592
    s_mov_b32 s46, 885120
    buffer_load_dwordx4 v9, s[28:31], s46 offen offset:0 lds
    v_mfma_f32_16x16x32_bf16 v[164:167], v[232:235], v[132:135], v[164:167]
    ds_read_b64_tr_b16 v[226:227], v6 offset:2048
    v_mfma_f32_16x16x32_bf16 v[172:175], v[236:239], v[124:127], v[172:175]
    ds_read_b64_tr_b16 v[228:229], v6 offset:4096
    v_mfma_f32_16x16x32_bf16 v[168:171], v[236:239], v[52:55], v[168:171]
    ds_read_b64_tr_b16 v[230:231], v6 offset:6144
    s_waitcnt lgkmcnt(4)
    v_mfma_f32_16x16x32_bf16 v[168:171], v[240:243], v[56:59], v[168:171]
    ds_read_b64_tr_b16 v[232:233], v6 offset:8192
    buffer_load_dwordx4 v10, s[28:31], s46 offen offset:1024 lds
    v_mfma_f32_16x16x32_bf16 v[172:175], v[240:243], v[128:131], v[172:175]
    ds_read_b64_tr_b16 v[234:235], v6 offset:10240
    v_mfma_f32_16x16x32_bf16 v[172:175], v[244:247], v[132:135], v[172:175]
    ds_read_b64_tr_b16 v[236:237], v6 offset:12288
    v_mfma_f32_16x16x32_bf16 v[168:171], v[244:247], v[60:63], v[168:171]
    ds_read_b64_tr_b16 v[238:239], v6 offset:14336
    s_waitcnt lgkmcnt(4)
    v_mfma_f32_16x16x32_bf16 v[176:179], v[224:227], v[52:55], v[176:179]
    ds_read_b64_tr_b16 v[240:241], v6 offset:16384
    buffer_load_dwordx4 v11, s[28:31], s46 offen offset:2048 lds
    v_mfma_f32_16x16x32_bf16 v[180:183], v[224:227], v[124:127], v[180:183]
    ds_read_b64_tr_b16 v[242:243], v6 offset:18432
    v_mfma_f32_16x16x32_bf16 v[180:183], v[228:231], v[128:131], v[180:183]
    ds_read_b64_tr_b16 v[244:245], v6 offset:20480
    v_mfma_f32_16x16x32_bf16 v[176:179], v[228:231], v[56:59], v[176:179]
    ds_read_b64_tr_b16 v[246:247], v6 offset:22528
    s_waitcnt vmcnt(20)
    s_barrier
    s_waitcnt lgkmcnt(4)
    v_mfma_f32_16x16x32_bf16 v[176:179], v[232:235], v[60:63], v[176:179]
    ds_read_b64_tr_b16 v[224:225], v3 offset:24576
    s_add_u32 m0, s44, 122880
    s_mov_b32 s46, 1769856
    buffer_load_dwordx4 v9, s[8:11], s46 offen offset:0 lds
    v_mfma_f32_16x16x32_bf16 v[180:183], v[232:235], v[132:135], v[180:183]
    ds_read_b64_tr_b16 v[226:227], v3 offset:26624
    v_mfma_f32_16x16x32_bf16 v[188:191], v[236:239], v[124:127], v[188:191]
    ds_read_b64_tr_b16 v[228:229], v3 offset:28672
    v_mfma_f32_16x16x32_bf16 v[184:187], v[236:239], v[52:55], v[184:187]
    ds_read_b64_tr_b16 v[230:231], v3 offset:30720
    s_waitcnt lgkmcnt(4)
    v_mfma_f32_16x16x32_bf16 v[184:187], v[240:243], v[56:59], v[184:187]
    ds_read_b64_tr_b16 v[232:233], v3 offset:32768
    buffer_load_dwordx4 v10, s[8:11], s46 offen offset:1024 lds
    v_mfma_f32_16x16x32_bf16 v[188:191], v[240:243], v[128:131], v[188:191]
    ds_read_b64_tr_b16 v[234:235], v3 offset:34816
    v_mfma_f32_16x16x32_bf16 v[188:191], v[244:247], v[132:135], v[188:191]
    ds_read_b64_tr_b16 v[236:237], v3 offset:36864
    v_mfma_f32_16x16x32_bf16 v[184:187], v[244:247], v[60:63], v[184:187]
    ds_read_b64_tr_b16 v[238:239], v3 offset:38912
    s_waitcnt lgkmcnt(4)
    v_mfma_f32_16x16x32_bf16 v[160:163], v[224:227], v[64:67], v[160:163]
    ds_read_b64_tr_b16 v[240:241], v3 offset:40960
    buffer_load_dwordx4 v11, s[8:11], s46 offen offset:2048 lds
    v_mfma_f32_16x16x32_bf16 v[164:167], v[224:227], v[136:139], v[164:167]
    ds_read_b64_tr_b16 v[242:243], v3 offset:43008
    v_mfma_f32_16x16x32_bf16 v[164:167], v[228:231], v[140:143], v[164:167]
    ds_read_b64_tr_b16 v[244:245], v3 offset:45056
    v_mfma_f32_16x16x32_bf16 v[160:163], v[228:231], v[68:71], v[160:163]
    ds_read_b64_tr_b16 v[246:247], v3 offset:47104
    s_waitcnt lgkmcnt(4)
    v_mfma_f32_16x16x32_bf16 v[160:163], v[232:235], v[72:75], v[160:163]
    ds_read_b64_tr_b16 v[224:225], v6 offset:24576
    s_add_u32 m0, s44, 135168
    s_mov_b32 s46, 1769856
    buffer_load_dwordx4 v9, s[28:31], s46 offen offset:0 lds
    v_mfma_f32_16x16x32_bf16 v[164:167], v[232:235], v[144:147], v[164:167]
    ds_read_b64_tr_b16 v[226:227], v6 offset:26624
    v_mfma_f32_16x16x32_bf16 v[172:175], v[236:239], v[136:139], v[172:175]
    ds_read_b64_tr_b16 v[228:229], v6 offset:28672
    v_mfma_f32_16x16x32_bf16 v[168:171], v[236:239], v[64:67], v[168:171]
    ds_read_b64_tr_b16 v[230:231], v6 offset:30720
    s_waitcnt lgkmcnt(4)
    v_mfma_f32_16x16x32_bf16 v[168:171], v[240:243], v[68:71], v[168:171]
    ds_read_b64_tr_b16 v[232:233], v6 offset:32768
    buffer_load_dwordx4 v10, s[28:31], s46 offen offset:1024 lds
    v_mfma_f32_16x16x32_bf16 v[172:175], v[240:243], v[140:143], v[172:175]
    ds_read_b64_tr_b16 v[234:235], v6 offset:34816
    v_mfma_f32_16x16x32_bf16 v[172:175], v[244:247], v[144:147], v[172:175]
    ds_read_b64_tr_b16 v[236:237], v6 offset:36864
    v_mfma_f32_16x16x32_bf16 v[168:171], v[244:247], v[72:75], v[168:171]
    ds_read_b64_tr_b16 v[238:239], v6 offset:38912
    s_waitcnt lgkmcnt(4)
    v_mfma_f32_16x16x32_bf16 v[176:179], v[224:227], v[64:67], v[176:179]
    ds_read_b64_tr_b16 v[240:241], v6 offset:40960
    buffer_load_dwordx4 v11, s[28:31], s46 offen offset:2048 lds
    v_mfma_f32_16x16x32_bf16 v[180:183], v[224:227], v[136:139], v[180:183]
    ds_read_b64_tr_b16 v[242:243], v6 offset:43008
    v_mfma_f32_16x16x32_bf16 v[180:183], v[228:231], v[140:143], v[180:183]
    ds_read_b64_tr_b16 v[244:245], v6 offset:45056
    v_mfma_f32_16x16x32_bf16 v[176:179], v[228:231], v[68:71], v[176:179]
    ds_read_b64_tr_b16 v[246:247], v6 offset:47104
    s_waitcnt vmcnt(20)
    s_barrier
    s_waitcnt lgkmcnt(4)
    v_mfma_f32_16x16x32_bf16 v[176:179], v[232:235], v[72:75], v[176:179]
    ds_read_b64_tr_b16 v[224:225], v4 offset:0
    s_add_u32 m0, s44, 0
    s_mov_b32 s46, 2654592
    buffer_load_dwordx4 v9, s[8:11], s46 offen offset:0 lds
    v_mfma_f32_16x16x32_bf16 v[180:183], v[232:235], v[144:147], v[180:183]
    ds_read_b64_tr_b16 v[226:227], v4 offset:2048
    v_mfma_f32_16x16x32_bf16 v[188:191], v[236:239], v[136:139], v[188:191]
    ds_read_b64_tr_b16 v[228:229], v4 offset:4096
    v_mfma_f32_16x16x32_bf16 v[184:187], v[236:239], v[64:67], v[184:187]
    ds_read_b64_tr_b16 v[230:231], v4 offset:6144
    s_waitcnt lgkmcnt(4)
    v_mfma_f32_16x16x32_bf16 v[184:187], v[240:243], v[68:71], v[184:187]
    ds_read_b64_tr_b16 v[232:233], v4 offset:8192
    buffer_load_dwordx4 v10, s[8:11], s46 offen offset:1024 lds
    v_mfma_f32_16x16x32_bf16 v[188:191], v[240:243], v[140:143], v[188:191]
    ds_read_b64_tr_b16 v[234:235], v4 offset:10240
    v_mfma_f32_16x16x32_bf16 v[188:191], v[244:247], v[144:147], v[188:191]
    ds_read_b64_tr_b16 v[236:237], v4 offset:12288
    v_mfma_f32_16x16x32_bf16 v[184:187], v[244:247], v[72:75], v[184:187]
    ds_read_b64_tr_b16 v[238:239], v4 offset:14336
    s_waitcnt lgkmcnt(4)
    v_mfma_f32_16x16x32_bf16 v[160:163], v[224:227], v[76:79], v[160:163]
    ds_read_b64_tr_b16 v[240:241], v4 offset:16384
    buffer_load_dwordx4 v11, s[8:11], s46 offen offset:2048 lds
    v_mfma_f32_16x16x32_bf16 v[164:167], v[224:227], v[148:151], v[164:167]
    ds_read_b64_tr_b16 v[242:243], v4 offset:18432
    v_mfma_f32_16x16x32_bf16 v[164:167], v[228:231], v[152:155], v[164:167]
    ds_read_b64_tr_b16 v[244:245], v4 offset:20480
    v_mfma_f32_16x16x32_bf16 v[160:163], v[228:231], v[80:83], v[160:163]
    ds_read_b64_tr_b16 v[246:247], v4 offset:22528
    s_waitcnt lgkmcnt(4)
    v_mfma_f32_16x16x32_bf16 v[160:163], v[232:235], v[84:87], v[160:163]
    ds_read_b64_tr_b16 v[224:225], v7 offset:0
    s_add_u32 m0, s44, 12288
    s_mov_b32 s46, 2654592
    buffer_load_dwordx4 v9, s[28:31], s46 offen offset:0 lds
    v_mfma_f32_16x16x32_bf16 v[164:167], v[232:235], v[156:159], v[164:167]
    ds_read_b64_tr_b16 v[226:227], v7 offset:2048
    v_mfma_f32_16x16x32_bf16 v[172:175], v[236:239], v[148:151], v[172:175]
    ds_read_b64_tr_b16 v[228:229], v7 offset:4096
    v_mfma_f32_16x16x32_bf16 v[168:171], v[236:239], v[76:79], v[168:171]
    ds_read_b64_tr_b16 v[230:231], v7 offset:6144
    s_waitcnt lgkmcnt(4)
    v_mfma_f32_16x16x32_bf16 v[168:171], v[240:243], v[80:83], v[168:171]
    ds_read_b64_tr_b16 v[232:233], v7 offset:8192
    buffer_load_dwordx4 v10, s[28:31], s46 offen offset:1024 lds
    v_mfma_f32_16x16x32_bf16 v[172:175], v[240:243], v[152:155], v[172:175]
    ds_read_b64_tr_b16 v[234:235], v7 offset:10240
    v_mfma_f32_16x16x32_bf16 v[172:175], v[244:247], v[156:159], v[172:175]
    ds_read_b64_tr_b16 v[236:237], v7 offset:12288
    v_mfma_f32_16x16x32_bf16 v[168:171], v[244:247], v[84:87], v[168:171]
    ds_read_b64_tr_b16 v[238:239], v7 offset:14336
    s_waitcnt lgkmcnt(4)
    v_mfma_f32_16x16x32_bf16 v[176:179], v[224:227], v[76:79], v[176:179]
    ds_read_b64_tr_b16 v[240:241], v7 offset:16384
    buffer_load_dwordx4 v11, s[28:31], s46 offen offset:2048 lds
    v_mfma_f32_16x16x32_bf16 v[180:183], v[224:227], v[148:151], v[180:183]
    ds_read_b64_tr_b16 v[242:243], v7 offset:18432
    v_mfma_f32_16x16x32_bf16 v[180:183], v[228:231], v[152:155], v[180:183]
    ds_read_b64_tr_b16 v[244:245], v7 offset:20480
    v_mfma_f32_16x16x32_bf16 v[176:179], v[228:231], v[80:83], v[176:179]
    ds_read_b64_tr_b16 v[246:247], v7 offset:22528
    s_waitcnt vmcnt(18)
    s_barrier
    s_waitcnt lgkmcnt(4)
    v_mfma_f32_16x16x32_bf16 v[176:179], v[232:235], v[84:87], v[176:179]
    ds_read_b64_tr_b16 v[224:225], v4 offset:24576
    s_add_u32 m0, s44, 24576
    s_mov_b32 s46, 3539328
    buffer_load_dwordx4 v9, s[8:11], s46 offen offset:0 lds
    v_mfma_f32_16x16x32_bf16 v[180:183], v[232:235], v[156:159], v[180:183]
    ds_read_b64_tr_b16 v[226:227], v4 offset:26624
    v_mfma_f32_16x16x32_bf16 v[188:191], v[236:239], v[148:151], v[188:191]
    ds_read_b64_tr_b16 v[228:229], v4 offset:28672
    v_mfma_f32_16x16x32_bf16 v[184:187], v[236:239], v[76:79], v[184:187]
    ds_read_b64_tr_b16 v[230:231], v4 offset:30720
    s_waitcnt lgkmcnt(4)
    v_mfma_f32_16x16x32_bf16 v[184:187], v[240:243], v[80:83], v[184:187]
    ds_read_b64_tr_b16 v[232:233], v4 offset:32768
    buffer_load_dwordx4 v10, s[8:11], s46 offen offset:1024 lds
    v_mfma_f32_16x16x32_bf16 v[188:191], v[240:243], v[152:155], v[188:191]
    ds_read_b64_tr_b16 v[234:235], v4 offset:34816
    v_mfma_f32_16x16x32_bf16 v[188:191], v[244:247], v[156:159], v[188:191]
    ds_read_b64_tr_b16 v[236:237], v4 offset:36864
    v_mfma_f32_16x16x32_bf16 v[184:187], v[244:247], v[84:87], v[184:187]
    ds_read_b64_tr_b16 v[238:239], v4 offset:38912
    s_waitcnt lgkmcnt(4)
    v_mfma_f32_16x16x32_bf16 v[192:195], v[224:227], v[16:19], 0
    ds_read_b64_tr_b16 v[240:241], v4 offset:40960
    buffer_load_dwordx4 v11, s[8:11], s46 offen offset:2048 lds
    v_mfma_f32_16x16x32_bf16 v[196:199], v[224:227], v[88:91], 0
    ds_read_b64_tr_b16 v[242:243], v4 offset:43008
    v_mfma_f32_16x16x32_bf16 v[196:199], v[228:231], v[92:95], v[196:199]
    ds_read_b64_tr_b16 v[244:245], v4 offset:45056
    v_mfma_f32_16x16x32_bf16 v[192:195], v[228:231], v[20:23], v[192:195]
    ds_read_b64_tr_b16 v[246:247], v4 offset:47104
    s_waitcnt lgkmcnt(4)
    v_mfma_f32_16x16x32_bf16 v[192:195], v[232:235], v[24:27], v[192:195]
    ds_read_b64_tr_b16 v[224:225], v7 offset:24576
    s_add_u32 m0, s44, 36864
    s_mov_b32 s46, 3539328
    buffer_load_dwordx4 v9, s[28:31], s46 offen offset:0 lds
    v_mfma_f32_16x16x32_bf16 v[196:199], v[232:235], v[96:99], v[196:199]
    ds_read_b64_tr_b16 v[226:227], v7 offset:26624
    v_mfma_f32_16x16x32_bf16 v[204:207], v[236:239], v[88:91], 0
    ds_read_b64_tr_b16 v[228:229], v7 offset:28672
    v_max_f32 v160, 0, v160
    v_mfma_f32_16x16x32_bf16 v[200:203], v[236:239], v[16:19], 0
    ds_read_b64_tr_b16 v[230:231], v7 offset:30720
    v_max_f32 v161, 0, v161
    s_waitcnt lgkmcnt(4)
    v_mfma_f32_16x16x32_bf16 v[200:203], v[240:243], v[20:23], v[200:203]
    ds_read_b64_tr_b16 v[232:233], v7 offset:32768
    buffer_load_dwordx4 v10, s[28:31], s46 offen offset:1024 lds
    v_mfma_f32_16x16x32_bf16 v[204:207], v[240:243], v[92:95], v[204:207]
    ds_read_b64_tr_b16 v[234:235], v7 offset:34816
    v_max_f32 v162, 0, v162
    v_mfma_f32_16x16x32_bf16 v[204:207], v[244:247], v[96:99], v[204:207]
    ds_read_b64_tr_b16 v[236:237], v7 offset:36864
    v_max_f32 v163, 0, v163
    v_mfma_f32_16x16x32_bf16 v[200:203], v[244:247], v[24:27], v[200:203]
    ds_read_b64_tr_b16 v[238:239], v7 offset:38912
    v_mul_f32 v160, v160, v168
    s_waitcnt lgkmcnt(4)
    v_mfma_f32_16x16x32_bf16 v[208:211], v[224:227], v[16:19], 0
    ds_read_b64_tr_b16 v[240:241], v7 offset:40960
    buffer_load_dwordx4 v11, s[28:31], s46 offen offset:2048 lds
    v_mfma_f32_16x16x32_bf16 v[212:215], v[224:227], v[88:91], 0
    ds_read_b64_tr_b16 v[242:243], v7 offset:43008
    v_mul_f32 v161, v161, v169
    v_mfma_f32_16x16x32_bf16 v[212:215], v[228:231], v[92:95], v[212:215]
    ds_read_b64_tr_b16 v[244:245], v7 offset:45056
    v_mul_f32 v162, v162, v170
    v_mfma_f32_16x16x32_bf16 v[208:211], v[228:231], v[20:23], v[208:211]
    ds_read_b64_tr_b16 v[246:247], v7 offset:47104
    v_mul_f32 v163, v163, v171
    s_waitcnt vmcnt(18)
    s_barrier
    s_waitcnt lgkmcnt(4)
    v_mfma_f32_16x16x32_bf16 v[208:211], v[232:235], v[24:27], v[208:211]
    ds_read_b64_tr_b16 v[224:225], v5 offset:0
    s_add_u32 m0, s44, 49152
    s_mov_b32 s46, 4424064
    buffer_load_dwordx4 v9, s[8:11], s46 offen offset:0 lds
    v_mfma_f32_16x16x32_bf16 v[212:215], v[232:235], v[96:99], v[212:215]
    ds_read_b64_tr_b16 v[226:227], v5 offset:2048
    v_cvt_pk_bf16_f32 v248, v160, v161
    v_mfma_f32_16x16x32_bf16 v[220:223], v[236:239], v[88:91], 0
    ds_read_b64_tr_b16 v[228:229], v5 offset:4096
    v_cvt_pk_bf16_f32 v249, v162, v163
    v_mfma_f32_16x16x32_bf16 v[216:219], v[236:239], v[16:19], 0
    ds_read_b64_tr_b16 v[230:231], v5 offset:6144
    v_max_f32 v176, 0, v176
    s_waitcnt lgkmcnt(4)
    v_mfma_f32_16x16x32_bf16 v[216:219], v[240:243], v[20:23], v[216:219]
    ds_read_b64_tr_b16 v[232:233], v5 offset:8192
    buffer_load_dwordx4 v10, s[8:11], s46 offen offset:1024 lds
    v_mfma_f32_16x16x32_bf16 v[220:223], v[240:243], v[92:95], v[220:223]
    ds_read_b64_tr_b16 v[234:235], v5 offset:10240
    v_max_f32 v177, 0, v177
    v_mfma_f32_16x16x32_bf16 v[220:223], v[244:247], v[96:99], v[220:223]
    ds_read_b64_tr_b16 v[236:237], v5 offset:12288
    v_max_f32 v178, 0, v178
    v_mfma_f32_16x16x32_bf16 v[216:219], v[244:247], v[24:27], v[216:219]
    ds_read_b64_tr_b16 v[238:239], v5 offset:14336
    v_max_f32 v179, 0, v179
    s_waitcnt lgkmcnt(4)
    v_mfma_f32_16x16x32_bf16 v[192:195], v[224:227], v[28:31], v[192:195]
    ds_read_b64_tr_b16 v[240:241], v5 offset:16384
    buffer_load_dwordx4 v11, s[8:11], s46 offen offset:2048 lds
    v_mfma_f32_16x16x32_bf16 v[196:199], v[224:227], v[100:103], v[196:199]
    ds_read_b64_tr_b16 v[242:243], v5 offset:18432
    v_mul_f32 v176, v176, v184
    v_mfma_f32_16x16x32_bf16 v[196:199], v[228:231], v[104:107], v[196:199]
    ds_read_b64_tr_b16 v[244:245], v5 offset:20480
    v_mul_f32 v177, v177, v185
    v_mfma_f32_16x16x32_bf16 v[192:195], v[228:231], v[32:35], v[192:195]
    ds_read_b64_tr_b16 v[246:247], v5 offset:22528
    v_mul_f32 v178, v178, v186
    s_waitcnt lgkmcnt(4)
    v_mfma_f32_16x16x32_bf16 v[192:195], v[232:235], v[36:39], v[192:195]
    ds_read_b64_tr_b16 v[224:225], v8 offset:0
    s_add_u32 m0, s44, 61440
    s_mov_b32 s46, 4424064
    buffer_load_dwordx4 v9, s[28:31], s46 offen offset:0 lds
    v_mfma_f32_16x16x32_bf16 v[196:199], v[232:235], v[108:111], v[196:199]
    ds_read_b64_tr_b16 v[226:227], v8 offset:2048
    v_mul_f32 v179, v179, v187
    v_mfma_f32_16x16x32_bf16 v[204:207], v[236:239], v[100:103], v[204:207]
    ds_read_b64_tr_b16 v[228:229], v8 offset:4096
    v_cvt_pk_bf16_f32 v250, v176, v177
    v_mfma_f32_16x16x32_bf16 v[200:203], v[236:239], v[28:31], v[200:203]
    ds_read_b64_tr_b16 v[230:231], v8 offset:6144
    v_cvt_pk_bf16_f32 v251, v178, v179
    s_waitcnt lgkmcnt(4)
    v_mfma_f32_16x16x32_bf16 v[200:203], v[240:243], v[32:35], v[200:203]
    ds_read_b64_tr_b16 v[232:233], v8 offset:8192
    buffer_load_dwordx4 v10, s[28:31], s46 offen offset:1024 lds
    v_mfma_f32_16x16x32_bf16 v[204:207], v[240:243], v[104:107], v[204:207]
    ds_read_b64_tr_b16 v[234:235], v8 offset:10240
    v_max_f32 v164, 0, v164
    v_mfma_f32_16x16x32_bf16 v[204:207], v[244:247], v[108:111], v[204:207]
    ds_read_b64_tr_b16 v[236:237], v8 offset:12288
    v_max_f32 v165, 0, v165
    v_mfma_f32_16x16x32_bf16 v[200:203], v[244:247], v[36:39], v[200:203]
    ds_read_b64_tr_b16 v[238:239], v8 offset:14336
    v_max_f32 v166, 0, v166
    s_waitcnt lgkmcnt(4)
    v_mfma_f32_16x16x32_bf16 v[208:211], v[224:227], v[28:31], v[208:211]
    ds_read_b64_tr_b16 v[240:241], v8 offset:16384
    buffer_load_dwordx4 v11, s[28:31], s46 offen offset:2048 lds
    v_mfma_f32_16x16x32_bf16 v[212:215], v[224:227], v[100:103], v[212:215]
    ds_read_b64_tr_b16 v[242:243], v8 offset:18432
    v_max_f32 v167, 0, v167
    v_mfma_f32_16x16x32_bf16 v[212:215], v[228:231], v[104:107], v[212:215]
    ds_read_b64_tr_b16 v[244:245], v8 offset:20480
    v_mul_f32 v164, v164, v172
    v_mfma_f32_16x16x32_bf16 v[208:211], v[228:231], v[32:35], v[208:211]
    ds_read_b64_tr_b16 v[246:247], v8 offset:22528
    v_mul_f32 v165, v165, v173
    s_waitcnt vmcnt(18)
    s_barrier
    s_lshl_b32 s56, s41, 6
    s_add_u32 s56, s56, 512
    s_mul_i32 s55, s37, 48
    v_bfe_u32 v9, v0, 4, 1
    v_lshlrev_b32 v9, 1, v9
    v_and_b32 v10, 3, v0
    v_xor_b32 v9, v9, v10
    v_lshlrev_b32 v9, 4, v9
    v_lshrrev_b32 v10, 2, v0
    v_add_u32 v10, s55, v10
    v_mul_u32_u24 v10, 9216, v10
    v_add3_u32 v9, v9, v10, s56
    v_add_u32 v10, 146432, v9
    v_add_u32 v11, 292864, v9
    s_waitcnt lgkmcnt(4)
    v_mfma_f32_16x16x32_bf16 v[208:211], v[232:235], v[36:39], v[208:211]
    ds_read_b64_tr_b16 v[224:225], v5 offset:24576
    s_add_u32 m0, s44, 73728
    s_mov_b32 s46, 0
    buffer_load_dwordx4 v9, s[8:11], s46 offen offset:0 lds
    v_mfma_f32_16x16x32_bf16 v[212:215], v[232:235], v[108:111], v[212:215]
    ds_read_b64_tr_b16 v[226:227], v5 offset:26624
    v_mul_f32 v166, v166, v174
    v_mfma_f32_16x16x32_bf16 v[220:223], v[236:239], v[100:103], v[220:223]
    ds_read_b64_tr_b16 v[228:229], v5 offset:28672
    v_mul_f32 v167, v167, v175
    v_mfma_f32_16x16x32_bf16 v[216:219], v[236:239], v[28:31], v[216:219]
    ds_read_b64_tr_b16 v[230:231], v5 offset:30720
    v_cvt_pk_bf16_f32 v252, v164, v165
    s_waitcnt lgkmcnt(4)
    v_mfma_f32_16x16x32_bf16 v[216:219], v[240:243], v[32:35], v[216:219]
    ds_read_b64_tr_b16 v[232:233], v5 offset:32768
    buffer_load_dwordx4 v10, s[8:11], s46 offen offset:1024 lds
    v_mfma_f32_16x16x32_bf16 v[220:223], v[240:243], v[104:107], v[220:223]
    ds_read_b64_tr_b16 v[234:235], v5 offset:34816
    v_cvt_pk_bf16_f32 v253, v166, v167
    v_mfma_f32_16x16x32_bf16 v[220:223], v[244:247], v[108:111], v[220:223]
    ds_read_b64_tr_b16 v[236:237], v5 offset:36864
    v_max_f32 v180, 0, v180
    v_mfma_f32_16x16x32_bf16 v[216:219], v[244:247], v[36:39], v[216:219]
    ds_read_b64_tr_b16 v[238:239], v5 offset:38912
    v_max_f32 v181, 0, v181
    s_waitcnt lgkmcnt(4)
    v_mfma_f32_16x16x32_bf16 v[192:195], v[224:227], v[40:43], v[192:195]
    ds_read_b64_tr_b16 v[240:241], v5 offset:40960
    buffer_load_dwordx4 v11, s[8:11], s46 offen offset:2048 lds
    v_mfma_f32_16x16x32_bf16 v[196:199], v[224:227], v[112:115], v[196:199]
    ds_read_b64_tr_b16 v[242:243], v5 offset:43008
    v_max_f32 v182, 0, v182
    v_mfma_f32_16x16x32_bf16 v[196:199], v[228:231], v[116:119], v[196:199]
    ds_read_b64_tr_b16 v[244:245], v5 offset:45056
    v_max_f32 v183, 0, v183
    v_mfma_f32_16x16x32_bf16 v[192:195], v[228:231], v[44:47], v[192:195]
    ds_read_b64_tr_b16 v[246:247], v5 offset:47104
    v_mul_f32 v180, v180, v188
    s_waitcnt lgkmcnt(4)
    v_mfma_f32_16x16x32_bf16 v[192:195], v[232:235], v[48:51], v[192:195]
    ds_read_b64_tr_b16 v[224:225], v8 offset:24576
    s_add_u32 m0, s44, 86016
    s_mov_b32 s46, 0
    buffer_load_dwordx4 v9, s[28:31], s46 offen offset:0 lds
    v_mfma_f32_16x16x32_bf16 v[196:199], v[232:235], v[120:123], v[196:199]
    ds_read_b64_tr_b16 v[226:227], v8 offset:26624
    v_mul_f32 v181, v181, v189
    v_mfma_f32_16x16x32_bf16 v[204:207], v[236:239], v[112:115], v[204:207]
    ds_read_b64_tr_b16 v[228:229], v8 offset:28672
    v_mul_f32 v182, v182, v190
    v_mfma_f32_16x16x32_bf16 v[200:203], v[236:239], v[40:43], v[200:203]
    ds_read_b64_tr_b16 v[230:231], v8 offset:30720
    v_mul_f32 v183, v183, v191
    s_waitcnt lgkmcnt(4)
    v_mfma_f32_16x16x32_bf16 v[200:203], v[240:243], v[44:47], v[200:203]
    ds_read_b64_tr_b16 v[232:233], v8 offset:32768
    buffer_load_dwordx4 v10, s[28:31], s46 offen offset:1024 lds
    v_mfma_f32_16x16x32_bf16 v[204:207], v[240:243], v[116:119], v[204:207]
    ds_read_b64_tr_b16 v[234:235], v8 offset:34816
    v_cvt_pk_bf16_f32 v254, v180, v181
    v_mfma_f32_16x16x32_bf16 v[204:207], v[244:247], v[120:123], v[204:207]
    ds_read_b64_tr_b16 v[236:237], v8 offset:36864
    v_cvt_pk_bf16_f32 v255, v182, v183
    v_mfma_f32_16x16x32_bf16 v[200:203], v[244:247], v[48:51], v[200:203]
    ds_read_b64_tr_b16 v[238:239], v8 offset:38912
    s_lshl_b32 s55, s41, 11
    s_add_u32 s55, s55, 8192
    v_lshlrev_b32 v1, 4, v0
    buffer_store_dwordx4 v[248:251], v1, s[16:19], s55 offen offset:0 sc1
    buffer_store_dwordx4 v[252:255], v1, s[16:19], s55 offen offset:1024 sc1
    s_waitcnt lgkmcnt(4)
    v_mfma_f32_16x16x32_bf16 v[208:211], v[224:227], v[40:43], v[208:211]
    ds_read_b64_tr_b16 v[240:241], v8 offset:40960
    buffer_load_dwordx4 v11, s[28:31], s46 offen offset:2048 lds
    v_mfma_f32_16x16x32_bf16 v[212:215], v[224:227], v[112:115], v[212:215]
    ds_read_b64_tr_b16 v[242:243], v8 offset:43008
    v_lshlrev_b32 v1, 2, v0
    v_mfma_f32_16x16x32_bf16 v[212:215], v[228:231], v[116:119], v[212:215]
    ds_read_b64_tr_b16 v[244:245], v8 offset:45056
    s_mul_i32 s58, s37, 768
    v_mfma_f32_16x16x32_bf16 v[208:211], v[228:231], v[44:47], v[208:211]
    ds_read_b64_tr_b16 v[246:247], v8 offset:47104
    buffer_load_dword v12, v1, s[72:75], s58 offen offset:0
    s_waitcnt vmcnt(21)
    s_barrier
    s_waitcnt lgkmcnt(4)
    v_mfma_f32_16x16x32_bf16 v[208:211], v[232:235], v[48:51], v[208:211]
    ds_read_b64_tr_b16 v[224:225], v3 offset:0
    s_add_u32 m0, s44, 98304
    s_mov_b32 s46, 1769472
    buffer_load_dwordx4 v9, s[8:11], s46 offen offset:0 lds
    v_mfma_f32_16x16x32_bf16 v[212:215], v[232:235], v[120:123], v[212:215]
    ds_read_b64_tr_b16 v[226:227], v3 offset:2048
    buffer_load_dword v13, v1, s[72:75], s58 offen offset:256
    v_mfma_f32_16x16x32_bf16 v[220:223], v[236:239], v[112:115], v[220:223]
    ds_read_b64_tr_b16 v[228:229], v3 offset:4096
    buffer_load_dword v2, v1, s[72:75], s58 offen offset:512
    v_mfma_f32_16x16x32_bf16 v[216:219], v[236:239], v[40:43], v[216:219]
    ds_read_b64_tr_b16 v[230:231], v3 offset:6144
    v_lshlrev_b32 v1, 2, v0
    s_waitcnt lgkmcnt(4)
    v_mfma_f32_16x16x32_bf16 v[216:219], v[240:243], v[44:47], v[216:219]
    ds_read_b64_tr_b16 v[232:233], v3 offset:8192
    buffer_load_dwordx4 v10, s[8:11], s46 offen offset:1024 lds
    v_mfma_f32_16x16x32_bf16 v[220:223], v[240:243], v[116:119], v[220:223]
    ds_read_b64_tr_b16 v[234:235], v3 offset:10240
    s_mul_i32 s58, s40, 72
    v_mfma_f32_16x16x32_bf16 v[220:223], v[244:247], v[120:123], v[220:223]
    ds_read_b64_tr_b16 v[236:237], v3 offset:12288
    s_and_b32 s58, s58, 63
    v_mfma_f32_16x16x32_bf16 v[216:219], v[244:247], v[48:51], v[216:219]
    ds_read_b64_tr_b16 v[238:239], v3 offset:14336
    s_mul_i32 s58, s58, 224
    s_waitcnt lgkmcnt(4)
    v_mfma_f32_16x16x32_bf16 v[192:195], v[224:227], v[52:55], v[192:195]
    ds_read_b64_tr_b16 v[240:241], v3 offset:16384
    buffer_load_dwordx4 v11, s[8:11], s46 offen offset:2048 lds
    v_mfma_f32_16x16x32_bf16 v[196:199], v[224:227], v[124:127], v[196:199]
    ds_read_b64_tr_b16 v[242:243], v3 offset:18432
    s_add_u32 s59, s58, 4096
    buffer_load_dword v176, v1, s[72:75], s59 offen offset:0
    v_mfma_f32_16x16x32_bf16 v[196:199], v[228:231], v[128:131], v[196:199]
    ds_read_b64_tr_b16 v[244:245], v3 offset:20480
    s_add_u32 s59, s58, 4096
    buffer_load_dword v179, v1, s[72:75], s59 offen offset:256
    v_mfma_f32_16x16x32_bf16 v[192:195], v[228:231], v[56:59], v[192:195]
    ds_read_b64_tr_b16 v[246:247], v3 offset:22528
    s_add_u32 s59, s58, 4096
    buffer_load_dword v182, v1, s[72:75], s59 offen offset:512
    s_waitcnt lgkmcnt(4)
    v_mfma_f32_16x16x32_bf16 v[192:195], v[232:235], v[60:63], v[192:195]
    ds_read_b64_tr_b16 v[224:225], v6 offset:0
    s_add_u32 m0, s44, 110592
    s_mov_b32 s46, 1769472
    buffer_load_dwordx4 v9, s[28:31], s46 offen offset:0 lds
    v_mfma_f32_16x16x32_bf16 v[196:199], v[232:235], v[132:135], v[196:199]
    ds_read_b64_tr_b16 v[226:227], v6 offset:2048
    v_mfma_f32_16x16x32_bf16 v[204:207], v[236:239], v[124:127], v[204:207]
    ds_read_b64_tr_b16 v[228:229], v6 offset:4096
    v_mfma_f32_16x16x32_bf16 v[200:203], v[236:239], v[52:55], v[200:203]
    ds_read_b64_tr_b16 v[230:231], v6 offset:6144
    s_waitcnt lgkmcnt(4)
    v_mfma_f32_16x16x32_bf16 v[200:203], v[240:243], v[56:59], v[200:203]
    ds_read_b64_tr_b16 v[232:233], v6 offset:8192
    buffer_load_dwordx4 v10, s[28:31], s46 offen offset:1024 lds
    v_mfma_f32_16x16x32_bf16 v[204:207], v[240:243], v[128:131], v[204:207]
    ds_read_b64_tr_b16 v[234:235], v6 offset:10240
    v_mfma_f32_16x16x32_bf16 v[204:207], v[244:247], v[132:135], v[204:207]
    ds_read_b64_tr_b16 v[236:237], v6 offset:12288
    v_mfma_f32_16x16x32_bf16 v[200:203], v[244:247], v[60:63], v[200:203]
    ds_read_b64_tr_b16 v[238:239], v6 offset:14336
    s_waitcnt lgkmcnt(4)
    v_mfma_f32_16x16x32_bf16 v[208:211], v[224:227], v[52:55], v[208:211]
    ds_read_b64_tr_b16 v[240:241], v6 offset:16384
    buffer_load_dwordx4 v11, s[28:31], s46 offen offset:2048 lds
    v_mfma_f32_16x16x32_bf16 v[212:215], v[224:227], v[124:127], v[212:215]
    ds_read_b64_tr_b16 v[242:243], v6 offset:18432
    v_mfma_f32_16x16x32_bf16 v[212:215], v[228:231], v[128:131], v[212:215]
    ds_read_b64_tr_b16 v[244:245], v6 offset:20480
    v_mfma_f32_16x16x32_bf16 v[208:211], v[228:231], v[56:59], v[208:211]
    ds_read_b64_tr_b16 v[246:247], v6 offset:22528
    s_waitcnt vmcnt(26)
    s_barrier
    s_waitcnt lgkmcnt(4)
    v_mfma_f32_16x16x32_bf16 v[208:211], v[232:235], v[60:63], v[208:211]
    ds_read_b64_tr_b16 v[224:225], v3 offset:24576
    s_add_u32 m0, s44, 122880
    s_mov_b32 s46, 3538944
    buffer_load_dwordx4 v9, s[8:11], s46 offen offset:0 lds
    v_mfma_f32_16x16x32_bf16 v[212:215], v[232:235], v[132:135], v[212:215]
    ds_read_b64_tr_b16 v[226:227], v3 offset:26624
    v_mfma_f32_16x16x32_bf16 v[220:223], v[236:239], v[124:127], v[220:223]
    ds_read_b64_tr_b16 v[228:229], v3 offset:28672
    v_mfma_f32_16x16x32_bf16 v[216:219], v[236:239], v[52:55], v[216:219]
    ds_read_b64_tr_b16 v[230:231], v3 offset:30720
    s_waitcnt lgkmcnt(4)
    v_mfma_f32_16x16x32_bf16 v[216:219], v[240:243], v[56:59], v[216:219]
    ds_read_b64_tr_b16 v[232:233], v3 offset:32768
    buffer_load_dwordx4 v10, s[8:11], s46 offen offset:1024 lds
    v_mfma_f32_16x16x32_bf16 v[220:223], v[240:243], v[128:131], v[220:223]
    ds_read_b64_tr_b16 v[234:235], v3 offset:34816
    v_mfma_f32_16x16x32_bf16 v[220:223], v[244:247], v[132:135], v[220:223]
    ds_read_b64_tr_b16 v[236:237], v3 offset:36864
    v_mfma_f32_16x16x32_bf16 v[216:219], v[244:247], v[60:63], v[216:219]
    ds_read_b64_tr_b16 v[238:239], v3 offset:38912
    s_waitcnt lgkmcnt(4)
    v_mfma_f32_16x16x32_bf16 v[192:195], v[224:227], v[64:67], v[192:195]
    ds_read_b64_tr_b16 v[240:241], v3 offset:40960
    buffer_load_dwordx4 v11, s[8:11], s46 offen offset:2048 lds
    v_mfma_f32_16x16x32_bf16 v[196:199], v[224:227], v[136:139], v[196:199]
    ds_read_b64_tr_b16 v[242:243], v3 offset:43008
    v_mfma_f32_16x16x32_bf16 v[196:199], v[228:231], v[140:143], v[196:199]
    ds_read_b64_tr_b16 v[244:245], v3 offset:45056
    v_mfma_f32_16x16x32_bf16 v[192:195], v[228:231], v[68:71], v[192:195]
    ds_read_b64_tr_b16 v[246:247], v3 offset:47104
    s_waitcnt lgkmcnt(4)
    v_mfma_f32_16x16x32_bf16 v[192:195], v[232:235], v[72:75], v[192:195]
    ds_read_b64_tr_b16 v[224:225], v6 offset:24576
    s_add_u32 m0, s44, 135168
    s_mov_b32 s46, 3538944
    buffer_load_dwordx4 v9, s[28:31], s46 offen offset:0 lds
    v_mfma_f32_16x16x32_bf16 v[196:199], v[232:235], v[144:147], v[196:199]
    ds_read_b64_tr_b16 v[226:227], v6 offset:26624
    v_mfma_f32_16x16x32_bf16 v[204:207], v[236:239], v[136:139], v[204:207]
    ds_read_b64_tr_b16 v[228:229], v6 offset:28672
    v_mfma_f32_16x16x32_bf16 v[200:203], v[236:239], v[64:67], v[200:203]
    ds_read_b64_tr_b16 v[230:231], v6 offset:30720
    s_waitcnt lgkmcnt(4)
    v_mfma_f32_16x16x32_bf16 v[200:203], v[240:243], v[68:71], v[200:203]
    ds_read_b64_tr_b16 v[232:233], v6 offset:32768
    buffer_load_dwordx4 v10, s[28:31], s46 offen offset:1024 lds
    v_mfma_f32_16x16x32_bf16 v[204:207], v[240:243], v[140:143], v[204:207]
    ds_read_b64_tr_b16 v[234:235], v6 offset:34816
    v_mfma_f32_16x16x32_bf16 v[204:207], v[244:247], v[144:147], v[204:207]
    ds_read_b64_tr_b16 v[236:237], v6 offset:36864
    v_mfma_f32_16x16x32_bf16 v[200:203], v[244:247], v[72:75], v[200:203]
    ds_read_b64_tr_b16 v[238:239], v6 offset:38912
    s_waitcnt lgkmcnt(4)
    v_mfma_f32_16x16x32_bf16 v[208:211], v[224:227], v[64:67], v[208:211]
    ds_read_b64_tr_b16 v[240:241], v6 offset:40960
    buffer_load_dwordx4 v11, s[28:31], s46 offen offset:2048 lds
    v_mfma_f32_16x16x32_bf16 v[212:215], v[224:227], v[136:139], v[212:215]
    ds_read_b64_tr_b16 v[242:243], v6 offset:43008
    v_mfma_f32_16x16x32_bf16 v[212:215], v[228:231], v[140:143], v[212:215]
    ds_read_b64_tr_b16 v[244:245], v6 offset:45056
    v_mfma_f32_16x16x32_bf16 v[208:211], v[228:231], v[68:71], v[208:211]
    ds_read_b64_tr_b16 v[246:247], v6 offset:47104
    s_waitcnt vmcnt(26)
    s_barrier
    s_waitcnt vmcnt(14)
    s_waitcnt lgkmcnt(4)
    v_mfma_f32_16x16x32_bf16 v[208:211], v[232:235], v[72:75], v[208:211]
    ds_read_b64_tr_b16 v[224:225], v4 offset:0
    s_add_u32 m0, s45, 0
    s_mov_b32 s46, 0
    buffer_load_dwordx4 v12, s[12:15], s46 offen offset:0 lds
    v_mfma_f32_16x16x32_bf16 v[212:215], v[232:235], v[144:147], v[212:215]
    ds_read_b64_tr_b16 v[226:227], v4 offset:2048
    v_mfma_f32_16x16x32_bf16 v[220:223], v[236:239], v[136:139], v[220:223]
    ds_read_b64_tr_b16 v[228:229], v4 offset:4096
    v_mfma_f32_16x16x32_bf16 v[216:219], v[236:239], v[64:67], v[216:219]
    ds_read_b64_tr_b16 v[230:231], v4 offset:6144
    s_waitcnt lgkmcnt(4)
    v_mfma_f32_16x16x32_bf16 v[216:219], v[240:243], v[68:71], v[216:219]
    ds_read_b64_tr_b16 v[232:233], v4 offset:8192
    buffer_load_dwordx4 v13, s[12:15], s46 offen offset:1024 lds
    v_mfma_f32_16x16x32_bf16 v[220:223], v[240:243], v[140:143], v[220:223]
    ds_read_b64_tr_b16 v[234:235], v4 offset:10240
    v_mfma_f32_16x16x32_bf16 v[220:223], v[244:247], v[144:147], v[220:223]
    ds_read_b64_tr_b16 v[236:237], v4 offset:12288
    v_mfma_f32_16x16x32_bf16 v[216:219], v[244:247], v[72:75], v[216:219]
    ds_read_b64_tr_b16 v[238:239], v4 offset:14336
    s_waitcnt lgkmcnt(4)
    v_mfma_f32_16x16x32_bf16 v[192:195], v[224:227], v[76:79], v[192:195]
    ds_read_b64_tr_b16 v[240:241], v4 offset:16384
    buffer_load_dwordx4 v2, s[12:15], s46 offen offset:2048 lds
    v_mfma_f32_16x16x32_bf16 v[196:199], v[224:227], v[148:151], v[196:199]
    ds_read_b64_tr_b16 v[242:243], v4 offset:18432
    v_mfma_f32_16x16x32_bf16 v[196:199], v[228:231], v[152:155], v[196:199]
    ds_read_b64_tr_b16 v[244:245], v4 offset:20480
    v_mfma_f32_16x16x32_bf16 v[192:195], v[228:231], v[80:83], v[192:195]
    ds_read_b64_tr_b16 v[246:247], v4 offset:22528
    s_waitcnt lgkmcnt(4)
    v_mfma_f32_16x16x32_bf16 v[192:195], v[232:235], v[84:87], v[192:195]
    ds_read_b64_tr_b16 v[224:225], v7 offset:0
    s_add_u32 m0, s45, 6144
    s_mov_b32 s46, 55296
    buffer_load_dwordx4 v12, s[12:15], s46 offen offset:0 lds
    v_mfma_f32_16x16x32_bf16 v[196:199], v[232:235], v[156:159], v[196:199]
    ds_read_b64_tr_b16 v[226:227], v7 offset:2048
    v_mfma_f32_16x16x32_bf16 v[204:207], v[236:239], v[148:151], v[204:207]
    ds_read_b64_tr_b16 v[228:229], v7 offset:4096
    v_mfma_f32_16x16x32_bf16 v[200:203], v[236:239], v[76:79], v[200:203]
    ds_read_b64_tr_b16 v[230:231], v7 offset:6144
    s_waitcnt lgkmcnt(4)
    v_mfma_f32_16x16x32_bf16 v[200:203], v[240:243], v[80:83], v[200:203]
    ds_read_b64_tr_b16 v[232:233], v7 offset:8192
    buffer_load_dwordx4 v13, s[12:15], s46 offen offset:1024 lds
    v_mfma_f32_16x16x32_bf16 v[204:207], v[240:243], v[152:155], v[204:207]
    ds_read_b64_tr_b16 v[234:235], v7 offset:10240
    v_mfma_f32_16x16x32_bf16 v[204:207], v[244:247], v[156:159], v[204:207]
    ds_read_b64_tr_b16 v[236:237], v7 offset:12288
    v_mfma_f32_16x16x32_bf16 v[200:203], v[244:247], v[84:87], v[200:203]
    ds_read_b64_tr_b16 v[238:239], v7 offset:14336
    s_waitcnt lgkmcnt(4)
    v_mfma_f32_16x16x32_bf16 v[208:211], v[224:227], v[76:79], v[208:211]
    ds_read_b64_tr_b16 v[240:241], v7 offset:16384
    buffer_load_dwordx4 v2, s[12:15], s46 offen offset:2048 lds
    v_mfma_f32_16x16x32_bf16 v[212:215], v[224:227], v[148:151], v[212:215]
    ds_read_b64_tr_b16 v[242:243], v7 offset:18432
    v_mfma_f32_16x16x32_bf16 v[212:215], v[228:231], v[152:155], v[212:215]
    ds_read_b64_tr_b16 v[244:245], v7 offset:20480
    v_mfma_f32_16x16x32_bf16 v[208:211], v[228:231], v[80:83], v[208:211]
    ds_read_b64_tr_b16 v[246:247], v7 offset:22528
    s_barrier
    v_lshrrev_b32 v6, 4, v0
    v_bfe_u32 v7, v0, 2, 2
    v_lshl_add_u32 v6, v6, 2, v7
    v_lshlrev_b32 v6, 6, v6
    v_and_b32 v7, 3, v0
    v_lshl_add_u32 v6, v7, 3, v6
    v_bfe_u32 v7, v0, 4, 1
    v_xor_b32 v7, s38, v7
    v_lshl_add_u32 v3, v7, 5, v6
    v_add_u32 v4, 49152, v3
    v_add_u32 v5, 98304, v3
    s_waitcnt lgkmcnt(4)
    v_mfma_f32_16x16x32_bf16 v[208:211], v[232:235], v[84:87], v[208:211]
    ds_read_b64_tr_b16 v[224:225], v4 offset:24576
    s_add_u32 m0, s45, 24576
    s_mov_b32 s46, 221184
    buffer_load_dwordx4 v12, s[12:15], s46 offen offset:0 lds
    v_mfma_f32_16x16x32_bf16 v[212:215], v[232:235], v[156:159], v[212:215]
    ds_read_b64_tr_b16 v[226:227], v4 offset:25600
    v_mfma_f32_16x16x32_bf16 v[220:223], v[236:239], v[148:151], v[220:223]
    ds_read_b64_tr_b16 v[228:229], v4 offset:26624
    v_mfma_f32_16x16x32_bf16 v[216:219], v[236:239], v[76:79], v[216:219]
    ds_read_b64_tr_b16 v[230:231], v4 offset:27648
    s_waitcnt lgkmcnt(4)
    v_mfma_f32_16x16x32_bf16 v[216:219], v[240:243], v[80:83], v[216:219]
    ds_read_b64_tr_b16 v[232:233], v4 offset:28672
    buffer_load_dwordx4 v13, s[12:15], s46 offen offset:1024 lds
    v_mfma_f32_16x16x32_bf16 v[220:223], v[240:243], v[152:155], v[220:223]
    ds_read_b64_tr_b16 v[234:235], v4 offset:29696
    v_mfma_f32_16x16x32_bf16 v[220:223], v[244:247], v[156:159], v[220:223]
    ds_read_b64_tr_b16 v[236:237], v4 offset:30720
    v_mfma_f32_16x16x32_bf16 v[216:219], v[244:247], v[84:87], v[216:219]
    ds_read_b64_tr_b16 v[238:239], v4 offset:31744
    s_waitcnt lgkmcnt(4)
    v_mfma_f32_16x16x32_bf16 v[160:163], v[224:227], v[16:19], 0
    ds_read_b64_tr_b16 v[240:241], v4 offset:32768
    buffer_load_dwordx4 v2, s[12:15], s46 offen offset:2048 lds
    v_mfma_f32_16x16x32_bf16 v[164:167], v[224:227], v[88:91], 0
    ds_read_b64_tr_b16 v[242:243], v4 offset:33792
    v_mfma_f32_16x16x32_bf16 v[164:167], v[228:231], v[92:95], v[164:167]
    ds_read_b64_tr_b16 v[244:245], v4 offset:34816
    v_mfma_f32_16x16x32_bf16 v[160:163], v[228:231], v[20:23], v[160:163]
    ds_read_b64_tr_b16 v[246:247], v4 offset:35840
    s_waitcnt lgkmcnt(4)
    v_mfma_f32_16x16x32_bf16 v[160:163], v[232:235], v[24:27], v[160:163]
    ds_read_b64_tr_b16 v[224:225], v4 offset:36864
    s_add_u32 m0, s45, 30720
    s_mov_b32 s46, 276480
    buffer_load_dwordx4 v12, s[12:15], s46 offen offset:0 lds
    v_mfma_f32_16x16x32_bf16 v[164:167], v[232:235], v[96:99], v[164:167]
    ds_read_b64_tr_b16 v[226:227], v4 offset:37888
    v_mfma_f32_16x16x32_bf16 v[164:167], v[236:239], v[100:103], v[164:167]
    ds_read_b64_tr_b16 v[228:229], v4 offset:38912
    v_max_f32 v192, 0, v192
    v_mfma_f32_16x16x32_bf16 v[160:163], v[236:239], v[28:31], v[160:163]
    ds_read_b64_tr_b16 v[230:231], v4 offset:39936
    v_max_f32 v193, 0, v193
    s_waitcnt lgkmcnt(4)
    v_mfma_f32_16x16x32_bf16 v[160:163], v[240:243], v[32:35], v[160:163]
    ds_read_b64_tr_b16 v[232:233], v4 offset:40960
    buffer_load_dwordx4 v13, s[12:15], s46 offen offset:1024 lds
    v_mfma_f32_16x16x32_bf16 v[164:167], v[240:243], v[104:107], v[164:167]
    ds_read_b64_tr_b16 v[234:235], v4 offset:41984
    v_max_f32 v194, 0, v194
    v_mfma_f32_16x16x32_bf16 v[164:167], v[244:247], v[108:111], v[164:167]
    ds_read_b64_tr_b16 v[236:237], v4 offset:43008
    v_max_f32 v195, 0, v195
    v_mfma_f32_16x16x32_bf16 v[160:163], v[244:247], v[36:39], v[160:163]
    ds_read_b64_tr_b16 v[238:239], v4 offset:44032
    v_mul_f32 v192, v192, v200
    s_waitcnt lgkmcnt(4)
    v_mfma_f32_16x16x32_bf16 v[168:171], v[224:227], v[16:19], 0
    ds_read_b64_tr_b16 v[240:241], v4 offset:45056
    buffer_load_dwordx4 v2, s[12:15], s46 offen offset:2048 lds
    v_mfma_f32_16x16x32_bf16 v[172:175], v[224:227], v[88:91], 0
    ds_read_b64_tr_b16 v[242:243], v4 offset:46080
    v_mul_f32 v193, v193, v201
    v_mfma_f32_16x16x32_bf16 v[172:175], v[228:231], v[92:95], v[172:175]
    ds_read_b64_tr_b16 v[244:245], v4 offset:47104
    v_mul_f32 v194, v194, v202
    v_mfma_f32_16x16x32_bf16 v[168:171], v[228:231], v[20:23], v[168:171]
    ds_read_b64_tr_b16 v[246:247], v4 offset:48128
    v_mul_f32 v195, v195, v203
    s_waitcnt vmcnt(18)
    s_barrier
    s_waitcnt lgkmcnt(4)
    v_mfma_f32_16x16x32_bf16 v[168:171], v[232:235], v[24:27], v[168:171]
    ds_read_b64_tr_b16 v[224:225], v5 offset:0
    s_add_u32 m0, s45, 49152
    s_mov_b32 s46, 442368
    buffer_load_dwordx4 v12, s[12:15], s46 offen offset:0 lds
    v_mfma_f32_16x16x32_bf16 v[172:175], v[232:235], v[96:99], v[172:175]
    ds_read_b64_tr_b16 v[226:227], v5 offset:1024
    v_cvt_pk_bf16_f32 v248, v192, v193
    v_mfma_f32_16x16x32_bf16 v[172:175], v[236:239], v[100:103], v[172:175]
    ds_read_b64_tr_b16 v[228:229], v5 offset:2048
    v_cvt_pk_bf16_f32 v249, v194, v195
    v_mfma_f32_16x16x32_bf16 v[168:171], v[236:239], v[28:31], v[168:171]
    ds_read_b64_tr_b16 v[230:231], v5 offset:3072
    v_max_f32 v208, 0, v208
    s_waitcnt lgkmcnt(4)
    v_mfma_f32_16x16x32_bf16 v[168:171], v[240:243], v[32:35], v[168:171]
    ds_read_b64_tr_b16 v[232:233], v5 offset:4096
    buffer_load_dwordx4 v13, s[12:15], s46 offen offset:1024 lds
    v_mfma_f32_16x16x32_bf16 v[172:175], v[240:243], v[104:107], v[172:175]
    ds_read_b64_tr_b16 v[234:235], v5 offset:5120
    v_max_f32 v209, 0, v209
    v_mfma_f32_16x16x32_bf16 v[172:175], v[244:247], v[108:111], v[172:175]
    ds_read_b64_tr_b16 v[236:237], v5 offset:6144
    v_max_f32 v210, 0, v210
    v_mfma_f32_16x16x32_bf16 v[168:171], v[244:247], v[36:39], v[168:171]
    ds_read_b64_tr_b16 v[238:239], v5 offset:7168
    v_max_f32 v211, 0, v211
    s_waitcnt lgkmcnt(4)
    v_mfma_f32_16x16x32_bf16 v[160:163], v[224:227], v[40:43], v[160:163]
    ds_read_b64_tr_b16 v[240:241], v5 offset:8192
    buffer_load_dwordx4 v2, s[12:15], s46 offen offset:2048 lds
    v_mfma_f32_16x16x32_bf16 v[164:167], v[224:227], v[112:115], v[164:167]
    ds_read_b64_tr_b16 v[242:243], v5 offset:9216
    v_mul_f32 v208, v208, v216
    v_mfma_f32_16x16x32_bf16 v[164:167], v[228:231], v[116:119], v[164:167]
    ds_read_b64_tr_b16 v[244:245], v5 offset:10240
    v_mul_f32 v209, v209, v217
    v_mfma_f32_16x16x32_bf16 v[160:163], v[228:231], v[44:47], v[160:163]
    ds_read_b64_tr_b16 v[246:247], v5 offset:11264
    v_mul_f32 v210, v210, v218
    s_waitcnt lgkmcnt(4)
    v_mfma_f32_16x16x32_bf16 v[160:163], v[232:235], v[48:51], v[160:163]
    ds_read_b64_tr_b16 v[224:225], v5 offset:12288
    s_add_u32 m0, s45, 55296
    s_mov_b32 s46, 497664
    buffer_load_dwordx4 v12, s[12:15], s46 offen offset:0 lds
    v_mfma_f32_16x16x32_bf16 v[164:167], v[232:235], v[120:123], v[164:167]
    ds_read_b64_tr_b16 v[226:227], v5 offset:13312
    v_mul_f32 v211, v211, v219
    v_mfma_f32_16x16x32_bf16 v[164:167], v[236:239], v[124:127], v[164:167]
    ds_read_b64_tr_b16 v[228:229], v5 offset:14336
    v_cvt_pk_bf16_f32 v250, v208, v209
    v_mfma_f32_16x16x32_bf16 v[160:163], v[236:239], v[52:55], v[160:163]
    ds_read_b64_tr_b16 v[230:231], v5 offset:15360
    v_cvt_pk_bf16_f32 v251, v210, v211
    s_waitcnt lgkmcnt(4)
    v_mfma_f32_16x16x32_bf16 v[160:163], v[240:243], v[56:59], v[160:163]
    ds_read_b64_tr_b16 v[232:233], v5 offset:16384
    buffer_load_dwordx4 v13, s[12:15], s46 offen offset:1024 lds
    v_mfma_f32_16x16x32_bf16 v[164:167], v[240:243], v[128:131], v[164:167]
    ds_read_b64_tr_b16 v[234:235], v5 offset:17408
    v_max_f32 v196, 0, v196
    v_mfma_f32_16x16x32_bf16 v[164:167], v[244:247], v[132:135], v[164:167]
    ds_read_b64_tr_b16 v[236:237], v5 offset:18432
    v_max_f32 v197, 0, v197
    v_mfma_f32_16x16x32_bf16 v[160:163], v[244:247], v[60:63], v[160:163]
    ds_read_b64_tr_b16 v[238:239], v5 offset:19456
    v_max_f32 v198, 0, v198
    s_waitcnt lgkmcnt(4)
    v_mfma_f32_16x16x32_bf16 v[168:171], v[224:227], v[40:43], v[168:171]
    ds_read_b64_tr_b16 v[240:241], v5 offset:20480
    buffer_load_dwordx4 v2, s[12:15], s46 offen offset:2048 lds
    v_mfma_f32_16x16x32_bf16 v[172:175], v[224:227], v[112:115], v[172:175]
    ds_read_b64_tr_b16 v[242:243], v5 offset:21504
    v_max_f32 v199, 0, v199
    v_mfma_f32_16x16x32_bf16 v[172:175], v[228:231], v[116:119], v[172:175]
    ds_read_b64_tr_b16 v[244:245], v5 offset:22528
    v_mul_f32 v196, v196, v204
    v_mfma_f32_16x16x32_bf16 v[168:171], v[228:231], v[44:47], v[168:171]
    ds_read_b64_tr_b16 v[246:247], v5 offset:23552
    v_mul_f32 v197, v197, v205
    s_waitcnt vmcnt(18)
    s_barrier
    s_waitcnt lgkmcnt(4)
    v_mfma_f32_16x16x32_bf16 v[168:171], v[232:235], v[48:51], v[168:171]
    ds_read_b64_tr_b16 v[224:225], v5 offset:24576
    s_add_u32 m0, s45, 73728
    s_mov_b32 s46, 663552
    buffer_load_dwordx4 v12, s[12:15], s46 offen offset:0 lds
    v_mfma_f32_16x16x32_bf16 v[172:175], v[232:235], v[120:123], v[172:175]
    ds_read_b64_tr_b16 v[226:227], v5 offset:25600
    v_mul_f32 v198, v198, v206
    v_mfma_f32_16x16x32_bf16 v[172:175], v[236:239], v[124:127], v[172:175]
    ds_read_b64_tr_b16 v[228:229], v5 offset:26624
    v_mul_f32 v199, v199, v207
    v_mfma_f32_16x16x32_bf16 v[168:171], v[236:239], v[52:55], v[168:171]
    ds_read_b64_tr_b16 v[230:231], v5 offset:27648
    v_cvt_pk_bf16_f32 v252, v196, v197
    s_waitcnt lgkmcnt(4)
    v_mfma_f32_16x16x32_bf16 v[168:171], v[240:243], v[56:59], v[168:171]
    ds_read_b64_tr_b16 v[232:233], v5 offset:28672
    buffer_load_dwordx4 v13, s[12:15], s46 offen offset:1024 lds
    v_mfma_f32_16x16x32_bf16 v[172:175], v[240:243], v[128:131], v[172:175]
    ds_read_b64_tr_b16 v[234:235], v5 offset:29696
    v_cvt_pk_bf16_f32 v253, v198, v199
    v_mfma_f32_16x16x32_bf16 v[172:175], v[244:247], v[132:135], v[172:175]
    ds_read_b64_tr_b16 v[236:237], v5 offset:30720
    v_max_f32 v212, 0, v212
    v_mfma_f32_16x16x32_bf16 v[168:171], v[244:247], v[60:63], v[168:171]
    ds_read_b64_tr_b16 v[238:239], v5 offset:31744
    v_max_f32 v213, 0, v213
    s_waitcnt lgkmcnt(4)
    v_mfma_f32_16x16x32_bf16 v[160:163], v[224:227], v[64:67], v[160:163]
    ds_read_b64_tr_b16 v[240:241], v5 offset:32768
    buffer_load_dwordx4 v2, s[12:15], s46 offen offset:2048 lds
    v_mfma_f32_16x16x32_bf16 v[164:167], v[224:227], v[136:139], v[164:167]
    ds_read_b64_tr_b16 v[242:243], v5 offset:33792
    v_max_f32 v214, 0, v214
    v_mfma_f32_16x16x32_bf16 v[164:167], v[228:231], v[140:143], v[164:167]
    ds_read_b64_tr_b16 v[244:245], v5 offset:34816
    v_max_f32 v215, 0, v215
    v_mfma_f32_16x16x32_bf16 v[160:163], v[228:231], v[68:71], v[160:163]
    ds_read_b64_tr_b16 v[246:247], v5 offset:35840
    v_mul_f32 v212, v212, v220
    s_waitcnt lgkmcnt(4)
    v_mfma_f32_16x16x32_bf16 v[160:163], v[232:235], v[72:75], v[160:163]
    ds_read_b64_tr_b16 v[224:225], v5 offset:36864
    s_add_u32 m0, s45, 79872
    s_mov_b32 s46, 718848
    buffer_load_dwordx4 v12, s[12:15], s46 offen offset:0 lds
    v_mfma_f32_16x16x32_bf16 v[164:167], v[232:235], v[144:147], v[164:167]
    ds_read_b64_tr_b16 v[226:227], v5 offset:37888
    v_mul_f32 v213, v213, v221
    v_mfma_f32_16x16x32_bf16 v[164:167], v[236:239], v[148:151], v[164:167]
    ds_read_b64_tr_b16 v[228:229], v5 offset:38912
    v_mul_f32 v214, v214, v222
    v_mfma_f32_16x16x32_bf16 v[160:163], v[236:239], v[76:79], v[160:163]
    ds_read_b64_tr_b16 v[230:231], v5 offset:39936
    v_mul_f32 v215, v215, v223
    s_waitcnt lgkmcnt(4)
    v_mfma_f32_16x16x32_bf16 v[160:163], v[240:243], v[80:83], v[160:163]
    ds_read_b64_tr_b16 v[232:233], v5 offset:40960
    buffer_load_dwordx4 v13, s[12:15], s46 offen offset:1024 lds
    v_mfma_f32_16x16x32_bf16 v[164:167], v[240:243], v[152:155], v[164:167]
    ds_read_b64_tr_b16 v[234:235], v5 offset:41984
    v_cvt_pk_bf16_f32 v254, v212, v213
    v_mfma_f32_16x16x32_bf16 v[164:167], v[244:247], v[156:159], v[164:167]
    ds_read_b64_tr_b16 v[236:237], v5 offset:43008
    v_cvt_pk_bf16_f32 v255, v214, v215
    v_mfma_f32_16x16x32_bf16 v[160:163], v[244:247], v[84:87], v[160:163]
    ds_read_b64_tr_b16 v[238:239], v5 offset:44032
    s_lshl_b32 s55, s41, 11
    s_add_u32 s55, s55, 12288
    v_lshlrev_b32 v1, 4, v0
    buffer_store_dwordx4 v[248:251], v1, s[16:19], s55 offen offset:0 sc1
    buffer_store_dwordx4 v[252:255], v1, s[16:19], s55 offen offset:1024 sc1
    s_waitcnt lgkmcnt(4)
    v_mfma_f32_16x16x32_bf16 v[168:171], v[224:227], v[64:67], v[168:171]
    ds_read_b64_tr_b16 v[240:241], v5 offset:45056
    buffer_load_dwordx4 v2, s[12:15], s46 offen offset:2048 lds
    v_mfma_f32_16x16x32_bf16 v[172:175], v[224:227], v[136:139], v[172:175]
    ds_read_b64_tr_b16 v[242:243], v5 offset:46080
    v_add_u32 v177, 49152, v176
    v_mfma_f32_16x16x32_bf16 v[172:175], v[228:231], v[140:143], v[172:175]
    ds_read_b64_tr_b16 v[244:245], v5 offset:47104
    v_add_u32 v178, 98304, v176
    v_mfma_f32_16x16x32_bf16 v[168:171], v[228:231], v[68:71], v[168:171]
    ds_read_b64_tr_b16 v[246:247], v5 offset:48128
    v_add_u32 v180, 49152, v179
    v_add_u32 v181, 98304, v179
    v_add_u32 v183, 49152, v182
    v_add_u32 v184, 98304, v182
    s_waitcnt vmcnt(20)
    s_barrier
    s_waitcnt lgkmcnt(4)
    v_mfma_f32_16x16x32_bf16 v[168:171], v[232:235], v[72:75], v[168:171]
    ds_read_b64_tr_b16 v[224:225], v176 offset:0
    s_add_u32 m0, s45, 98304
    s_mov_b32 s46, 884736
    buffer_load_dwordx4 v12, s[12:15], s46 offen offset:0 lds
    v_mfma_f32_16x16x32_bf16 v[172:175], v[232:235], v[144:147], v[172:175]
    ds_read_b64_tr_b16 v[226:227], v176 offset:6144
    v_mfma_f32_16x16x32_bf16 v[172:175], v[236:239], v[148:151], v[172:175]
    ds_read_b64_tr_b16 v[228:229], v176 offset:12288
    buffer_load_dwordx4 v13, s[12:15], s46 offen offset:1024 lds
    v_mfma_f32_16x16x32_bf16 v[168:171], v[236:239], v[76:79], v[168:171]
    ds_read_b64_tr_b16 v[230:231], v176 offset:18432
    s_waitcnt lgkmcnt(4)
    v_mfma_f32_16x16x32_bf16 v[168:171], v[240:243], v[80:83], v[168:171]
    ds_read_b64_tr_b16 v[232:233], v179 offset:0
    buffer_load_dwordx4 v2, s[12:15], s46 offen offset:2048 lds
    v_mfma_f32_16x16x32_bf16 v[172:175], v[240:243], v[152:155], v[172:175]
    ds_read_b64_tr_b16 v[234:235], v179 offset:6144
    v_mfma_f32_16x16x32_bf16 v[172:175], v[244:247], v[156:159], v[172:175]
    ds_read_b64_tr_b16 v[236:237], v179 offset:12288
    s_add_u32 m0, s45, 104448
    s_mov_b32 s46, 940032
    buffer_load_dwordx4 v12, s[12:15], s46 offen offset:0 lds
    v_mfma_f32_16x16x32_bf16 v[168:171], v[244:247], v[84:87], v[168:171]
    ds_read_b64_tr_b16 v[238:239], v179 offset:18432
    s_waitcnt lgkmcnt(4)
    v_mfma_f32_16x16x32_bf16 v[192:195], v[224:227], v[16:19], 0
    ds_read_b64_tr_b16 v[240:241], v182 offset:0
    buffer_load_dwordx4 v13, s[12:15], s46 offen offset:1024 lds
    v_mfma_f32_16x16x32_bf16 v[196:199], v[224:227], v[88:91], 0
    ds_read_b64_tr_b16 v[242:243], v182 offset:6144
    v_mfma_f32_16x16x32_bf16 v[196:199], v[228:231], v[92:95], v[196:199]
    ds_read_b64_tr_b16 v[244:245], v182 offset:12288
    buffer_load_dwordx4 v2, s[12:15], s46 offen offset:2048 lds
    v_mfma_f32_16x16x32_bf16 v[192:195], v[228:231], v[20:23], v[192:195]
    ds_read_b64_tr_b16 v[246:247], v182 offset:18432
    s_waitcnt vmcnt(20)
    s_barrier
    s_waitcnt lgkmcnt(4)
    v_mfma_f32_16x16x32_bf16 v[200:203], v[232:235], v[16:19], 0
    ds_read_b64_tr_b16 v[224:225], v176 offset:24576
    s_add_u32 m0, s45, 122880
    s_mov_b32 s46, 1105920
    buffer_load_dwordx4 v12, s[12:15], s46 offen offset:0 lds
    v_mfma_f32_16x16x32_bf16 v[204:207], v[232:235], v[88:91], 0
    ds_read_b64_tr_b16 v[226:227], v176 offset:30720
    v_mfma_f32_16x16x32_bf16 v[204:207], v[236:239], v[92:95], v[204:207]
    ds_read_b64_tr_b16 v[228:229], v176 offset:36864
    buffer_load_dwordx4 v13, s[12:15], s46 offen offset:1024 lds
    v_mfma_f32_16x16x32_bf16 v[200:203], v[236:239], v[20:23], v[200:203]
    ds_read_b64_tr_b16 v[230:231], v176 offset:43008
    v_max_f32 v160, 0, v160
    v_max_f32 v161, 0, v161
    s_waitcnt lgkmcnt(4)
    v_mfma_f32_16x16x32_bf16 v[208:211], v[240:243], v[16:19], 0
    ds_read_b64_tr_b16 v[232:233], v179 offset:24576
    buffer_load_dwordx4 v2, s[12:15], s46 offen offset:2048 lds
    v_mfma_f32_16x16x32_bf16 v[212:215], v[240:243], v[88:91], 0
    ds_read_b64_tr_b16 v[234:235], v179 offset:30720
    v_max_f32 v162, 0, v162
    v_max_f32 v163, 0, v163
    v_mfma_f32_16x16x32_bf16 v[212:215], v[244:247], v[92:95], v[212:215]
    ds_read_b64_tr_b16 v[236:237], v179 offset:36864
    s_add_u32 m0, s45, 129024
    s_mov_b32 s46, 1161216
    buffer_load_dwordx4 v12, s[12:15], s46 offen offset:0 lds
    v_mfma_f32_16x16x32_bf16 v[208:211], v[244:247], v[20:23], v[208:211]
    ds_read_b64_tr_b16 v[238:239], v179 offset:43008
    v_mul_f32 v160, v160, v168
    v_mul_f32 v161, v161, v169
    s_waitcnt lgkmcnt(4)
    v_mfma_f32_16x16x32_bf16 v[192:195], v[224:227], v[24:27], v[192:195]
    ds_read_b64_tr_b16 v[240:241], v182 offset:24576
    buffer_load_dwordx4 v13, s[12:15], s46 offen offset:1024 lds
    v_mfma_f32_16x16x32_bf16 v[196:199], v[224:227], v[96:99], v[196:199]
    ds_read_b64_tr_b16 v[242:243], v182 offset:30720
    v_mul_f32 v162, v162, v170
    v_mul_f32 v163, v163, v171
    v_mfma_f32_16x16x32_bf16 v[196:199], v[228:231], v[100:103], v[196:199]
    ds_read_b64_tr_b16 v[244:245], v182 offset:36864
    buffer_load_dwordx4 v2, s[12:15], s46 offen offset:2048 lds
    v_mfma_f32_16x16x32_bf16 v[192:195], v[228:231], v[28:31], v[192:195]
    ds_read_b64_tr_b16 v[246:247], v182 offset:43008
    v_cvt_pk_bf16_f32 v248, v160, v161
    v_cvt_pk_bf16_f32 v249, v162, v163
    v_max_f32 v164, 0, v164
    v_max_f32 v165, 0, v165
    v_max_f32 v166, 0, v166
    v_max_f32 v167, 0, v167
    v_mul_f32 v164, v164, v172
    v_mul_f32 v165, v165, v173
    v_mul_f32 v166, v166, v174
    v_mul_f32 v167, v167, v175
    v_cvt_pk_bf16_f32 v252, v164, v165
    v_cvt_pk_bf16_f32 v253, v166, v167
    s_lshl_b32 s55, s37, 11
    s_add_u32 s55, s55, 147456
    v_lshlrev_b32 v1, 4, v0
    v_add_u32 v1, s55, v1
    ds_write_b64 v1, v[248:249] offset:0
    ds_write_b64 v1, v[252:253] offset:1024
    s_waitcnt lgkmcnt(0)
    s_waitcnt vmcnt(20)
    s_barrier
    v_mfma_f32_16x16x32_bf16 v[200:203], v[232:235], v[24:27], v[200:203]
    ds_read_b64_tr_b16 v[224:225], v177 offset:0
    s_add_u32 m0, s45, 0
    s_mov_b32 s46, 1327104
    buffer_load_dwordx4 v12, s[12:15], s46 offen offset:0 lds
    v_mfma_f32_16x16x32_bf16 v[204:207], v[232:235], v[96:99], v[204:207]
    ds_read_b64_tr_b16 v[226:227], v177 offset:6144
    v_mfma_f32_16x16x32_bf16 v[204:207], v[236:239], v[100:103], v[204:207]
    ds_read_b64_tr_b16 v[228:229], v177 offset:12288
    buffer_load_dwordx4 v13, s[12:15], s46 offen offset:1024 lds
    v_mfma_f32_16x16x32_bf16 v[200:203], v[236:239], v[28:31], v[200:203]
    ds_read_b64_tr_b16 v[230:231], v177 offset:18432
    v_mfma_f32_16x16x32_bf16 v[208:211], v[240:243], v[24:27], v[208:211]
    ds_read_b64_tr_b16 v[232:233], v180 offset:0
    buffer_load_dwordx4 v2, s[12:15], s46 offen offset:2048 lds
    v_mfma_f32_16x16x32_bf16 v[212:215], v[240:243], v[96:99], v[212:215]
    ds_read_b64_tr_b16 v[234:235], v180 offset:6144
    v_mfma_f32_16x16x32_bf16 v[212:215], v[244:247], v[100:103], v[212:215]
    ds_read_b64_tr_b16 v[236:237], v180 offset:12288
    s_add_u32 m0, s45, 6144
    s_mov_b32 s46, 1382400
    buffer_load_dwordx4 v12, s[12:15], s46 offen offset:0 lds
    v_mfma_f32_16x16x32_bf16 v[208:211], v[244:247], v[28:31], v[208:211]
    ds_read_b64_tr_b16 v[238:239], v180 offset:18432
    s_waitcnt lgkmcnt(4)
    v_mfma_f32_16x16x32_bf16 v[192:195], v[224:227], v[32:35], v[192:195]
    ds_read_b64_tr_b16 v[240:241], v183 offset:0
    buffer_load_dwordx4 v13, s[12:15], s46 offen offset:1024 lds
    v_mfma_f32_16x16x32_bf16 v[196:199], v[224:227], v[104:107], v[196:199]
    ds_read_b64_tr_b16 v[242:243], v183 offset:6144
    v_mfma_f32_16x16x32_bf16 v[196:199], v[228:231], v[108:111], v[196:199]
    ds_read_b64_tr_b16 v[244:245], v183 offset:12288
    buffer_load_dwordx4 v2, s[12:15], s46 offen offset:2048 lds
    v_mfma_f32_16x16x32_bf16 v[192:195], v[228:231], v[36:39], v[192:195]
    ds_read_b64_tr_b16 v[246:247], v183 offset:18432
    s_waitcnt vmcnt(18)
    s_barrier
    s_waitcnt lgkmcnt(4)
    v_mfma_f32_16x16x32_bf16 v[200:203], v[232:235], v[32:35], v[200:203]
    ds_read_b64_tr_b16 v[224:225], v177 offset:24576
    s_add_u32 m0, s45, 24576
    s_mov_b32 s46, 1548288
    buffer_load_dwordx4 v12, s[12:15], s46 offen offset:0 lds
    v_mfma_f32_16x16x32_bf16 v[204:207], v[232:235], v[104:107], v[204:207]
    ds_read_b64_tr_b16 v[226:227], v177 offset:30720
    v_mfma_f32_16x16x32_bf16 v[204:207], v[236:239], v[108:111], v[204:207]
    ds_read_b64_tr_b16 v[228:229], v177 offset:36864
    buffer_load_dwordx4 v13, s[12:15], s46 offen offset:1024 lds
    v_mfma_f32_16x16x32_bf16 v[200:203], v[236:239], v[36:39], v[200:203]
    ds_read_b64_tr_b16 v[230:231], v177 offset:43008
    s_waitcnt lgkmcnt(4)
    v_mfma_f32_16x16x32_bf16 v[208:211], v[240:243], v[32:35], v[208:211]
    ds_read_b64_tr_b16 v[232:233], v180 offset:24576
    buffer_load_dwordx4 v2, s[12:15], s46 offen offset:2048 lds
    v_mfma_f32_16x16x32_bf16 v[212:215], v[240:243], v[104:107], v[212:215]
    ds_read_b64_tr_b16 v[234:235], v180 offset:30720
    v_mfma_f32_16x16x32_bf16 v[212:215], v[244:247], v[108:111], v[212:215]
    ds_read_b64_tr_b16 v[236:237], v180 offset:36864
    s_add_u32 m0, s45, 30720
    s_mov_b32 s46, 1603584
    buffer_load_dwordx4 v12, s[12:15], s46 offen offset:0 lds
    v_mfma_f32_16x16x32_bf16 v[208:211], v[244:247], v[36:39], v[208:211]
    ds_read_b64_tr_b16 v[238:239], v180 offset:43008
    s_waitcnt lgkmcnt(4)
    v_mfma_f32_16x16x32_bf16 v[192:195], v[224:227], v[40:43], v[192:195]
    ds_read_b64_tr_b16 v[240:241], v183 offset:24576
    buffer_load_dwordx4 v13, s[12:15], s46 offen offset:1024 lds
    v_mfma_f32_16x16x32_bf16 v[196:199], v[224:227], v[112:115], v[196:199]
    ds_read_b64_tr_b16 v[242:243], v183 offset:30720
    v_mfma_f32_16x16x32_bf16 v[196:199], v[228:231], v[116:119], v[196:199]
    ds_read_b64_tr_b16 v[244:245], v183 offset:36864
    buffer_load_dwordx4 v2, s[12:15], s46 offen offset:2048 lds
    v_mfma_f32_16x16x32_bf16 v[192:195], v[228:231], v[44:47], v[192:195]
    ds_read_b64_tr_b16 v[246:247], v183 offset:43008
    s_waitcnt vmcnt(18)
    s_barrier
    s_waitcnt lgkmcnt(4)
    v_mfma_f32_16x16x32_bf16 v[200:203], v[232:235], v[40:43], v[200:203]
    ds_read_b64_tr_b16 v[224:225], v178 offset:0
    s_add_u32 m0, s45, 49152
    s_mov_b32 s46, 1769472
    buffer_load_dwordx4 v12, s[12:15], s46 offen offset:0 lds
    v_mfma_f32_16x16x32_bf16 v[204:207], v[232:235], v[112:115], v[204:207]
    ds_read_b64_tr_b16 v[226:227], v178 offset:6144
    v_mfma_f32_16x16x32_bf16 v[204:207], v[236:239], v[116:119], v[204:207]
    ds_read_b64_tr_b16 v[228:229], v178 offset:12288
    buffer_load_dwordx4 v13, s[12:15], s46 offen offset:1024 lds
    v_mfma_f32_16x16x32_bf16 v[200:203], v[236:239], v[44:47], v[200:203]
    ds_read_b64_tr_b16 v[230:231], v178 offset:18432
    s_waitcnt lgkmcnt(4)
    v_mfma_f32_16x16x32_bf16 v[208:211], v[240:243], v[40:43], v[208:211]
    ds_read_b64_tr_b16 v[232:233], v181 offset:0
    buffer_load_dwordx4 v2, s[12:15], s46 offen offset:2048 lds
    v_mfma_f32_16x16x32_bf16 v[212:215], v[240:243], v[112:115], v[212:215]
    ds_read_b64_tr_b16 v[234:235], v181 offset:6144
    v_mfma_f32_16x16x32_bf16 v[212:215], v[244:247], v[116:119], v[212:215]
    ds_read_b64_tr_b16 v[236:237], v181 offset:12288
    s_add_u32 m0, s45, 55296
    s_mov_b32 s46, 1824768
    buffer_load_dwordx4 v12, s[12:15], s46 offen offset:0 lds
    v_mfma_f32_16x16x32_bf16 v[208:211], v[244:247], v[44:47], v[208:211]
    ds_read_b64_tr_b16 v[238:239], v181 offset:18432
    s_waitcnt lgkmcnt(4)
    v_mfma_f32_16x16x32_bf16 v[192:195], v[224:227], v[48:51], v[192:195]
    ds_read_b64_tr_b16 v[240:241], v184 offset:0
    buffer_load_dwordx4 v13, s[12:15], s46 offen offset:1024 lds
    v_mfma_f32_16x16x32_bf16 v[196:199], v[224:227], v[120:123], v[196:199]
    ds_read_b64_tr_b16 v[242:243], v184 offset:6144
    v_mfma_f32_16x16x32_bf16 v[196:199], v[228:231], v[124:127], v[196:199]
    ds_read_b64_tr_b16 v[244:245], v184 offset:12288
    buffer_load_dwordx4 v2, s[12:15], s46 offen offset:2048 lds
    v_mfma_f32_16x16x32_bf16 v[192:195], v[228:231], v[52:55], v[192:195]
    ds_read_b64_tr_b16 v[246:247], v184 offset:18432
    s_waitcnt vmcnt(18)
    s_barrier
    s_waitcnt lgkmcnt(4)
    v_mfma_f32_16x16x32_bf16 v[200:203], v[232:235], v[48:51], v[200:203]
    ds_read_b64_tr_b16 v[224:225], v178 offset:24576
    v_lshlrev_b32 v1, 4, v0
    s_mov_b32 s59, 32768
    buffer_load_dwordx4 v[160:163], v1, s[72:75], s59 offen offset:3840
    v_mfma_f32_16x16x32_bf16 v[204:207], v[232:235], v[120:123], v[204:207]
    ds_read_b64_tr_b16 v[226:227], v178 offset:30720
    s_mov_b32 s59, 36864
    buffer_load_dwordx2 v[164:165], v1, s[72:75], s59 offen offset:768
    s_mul_i32 s58, s37, 2048
    v_mfma_f32_16x16x32_bf16 v[204:207], v[236:239], v[124:127], v[204:207]
    ds_read_b64_tr_b16 v[228:229], v178 offset:36864
    s_add_u32 s59, s58, 36864
    buffer_load_dwordx2 v[168:169], v1, s[72:75], s59 offen offset:1792
    v_mfma_f32_16x16x32_bf16 v[200:203], v[236:239], v[52:55], v[200:203]
    ds_read_b64_tr_b16 v[230:231], v178 offset:43008
    s_waitcnt lgkmcnt(4)
    v_mfma_f32_16x16x32_bf16 v[208:211], v[240:243], v[48:51], v[208:211]
    ds_read_b64_tr_b16 v[232:233], v181 offset:24576
    v_mfma_f32_16x16x32_bf16 v[212:215], v[240:243], v[120:123], v[212:215]
    ds_read_b64_tr_b16 v[234:235], v181 offset:30720
    v_mfma_f32_16x16x32_bf16 v[212:215], v[244:247], v[124:127], v[212:215]
    ds_read_b64_tr_b16 v[236:237], v181 offset:36864
    v_mfma_f32_16x16x32_bf16 v[208:211], v[244:247], v[52:55], v[208:211]
    ds_read_b64_tr_b16 v[238:239], v181 offset:43008
    s_waitcnt lgkmcnt(4)
    v_mfma_f32_16x16x32_bf16 v[192:195], v[224:227], v[56:59], v[192:195]
    ds_read_b64_tr_b16 v[240:241], v184 offset:24576
    v_mfma_f32_16x16x32_bf16 v[196:199], v[224:227], v[128:131], v[196:199]
    ds_read_b64_tr_b16 v[242:243], v184 offset:30720
    v_mfma_f32_16x16x32_bf16 v[196:199], v[228:231], v[132:135], v[196:199]
    ds_read_b64_tr_b16 v[244:245], v184 offset:36864
    v_mfma_f32_16x16x32_bf16 v[192:195], v[228:231], v[60:63], v[192:195]
    ds_read_b64_tr_b16 v[246:247], v184 offset:43008
    s_waitcnt vmcnt(15)
    s_barrier
    s_waitcnt lgkmcnt(4)
    v_mfma_f32_16x16x32_bf16 v[200:203], v[232:235], v[56:59], v[200:203]
    ds_read_b64_tr_b16 v[224:225], v176 offset:0
    v_lshlrev_b32 v1, 2, v0
    s_and_b32 s58, s42, 1
    v_mfma_f32_16x16x32_bf16 v[204:207], v[232:235], v[128:131], v[204:207]
    ds_read_b64_tr_b16 v[226:227], v176 offset:6144
    s_lshl_b32 s58, s58, 8
    s_add_u32 s59, s58, 24576
    buffer_load_dword v3, v1, s[72:75], s59 offen offset:1024
    v_mfma_f32_16x16x32_bf16 v[204:207], v[236:239], v[132:135], v[204:207]
    ds_read_b64_tr_b16 v[228:229], v176 offset:12288
    s_add_u32 s59, s58, 24576
    buffer_load_dword v4, v1, s[72:75], s59 offen offset:1280
    v_mfma_f32_16x16x32_bf16 v[200:203], v[236:239], v[60:63], v[200:203]
    ds_read_b64_tr_b16 v[230:231], v176 offset:18432
    s_waitcnt lgkmcnt(4)
    v_mfma_f32_16x16x32_bf16 v[208:211], v[240:243], v[56:59], v[208:211]
    ds_read_b64_tr_b16 v[232:233], v179 offset:0
    v_mfma_f32_16x16x32_bf16 v[212:215], v[240:243], v[128:131], v[212:215]
    ds_read_b64_tr_b16 v[234:235], v179 offset:6144
    v_mfma_f32_16x16x32_bf16 v[212:215], v[244:247], v[132:135], v[212:215]
    ds_read_b64_tr_b16 v[236:237], v179 offset:12288
    v_mfma_f32_16x16x32_bf16 v[208:211], v[244:247], v[60:63], v[208:211]
    ds_read_b64_tr_b16 v[238:239], v179 offset:18432
    s_waitcnt lgkmcnt(4)
    v_mfma_f32_16x16x32_bf16 v[192:195], v[224:227], v[64:67], v[192:195]
    ds_read_b64_tr_b16 v[240:241], v182 offset:0
    v_mfma_f32_16x16x32_bf16 v[196:199], v[224:227], v[136:139], v[196:199]
    ds_read_b64_tr_b16 v[242:243], v182 offset:6144
    v_mfma_f32_16x16x32_bf16 v[196:199], v[228:231], v[140:143], v[196:199]
    ds_read_b64_tr_b16 v[244:245], v182 offset:12288
    v_mfma_f32_16x16x32_bf16 v[192:195], v[228:231], v[68:71], v[192:195]
    ds_read_b64_tr_b16 v[246:247], v182 offset:18432
    s_waitcnt vmcnt(11)
    s_barrier
    s_waitcnt lgkmcnt(4)
    v_mfma_f32_16x16x32_bf16 v[200:203], v[232:235], v[64:67], v[200:203]
    ds_read_b64_tr_b16 v[224:225], v176 offset:24576
    v_mfma_f32_16x16x32_bf16 v[204:207], v[232:235], v[136:139], v[204:207]
    ds_read_b64_tr_b16 v[226:227], v176 offset:30720
    v_mfma_f32_16x16x32_bf16 v[204:207], v[236:239], v[140:143], v[204:207]
    ds_read_b64_tr_b16 v[228:229], v176 offset:36864
    v_mfma_f32_16x16x32_bf16 v[200:203], v[236:239], v[68:71], v[200:203]
    ds_read_b64_tr_b16 v[230:231], v176 offset:43008
    s_waitcnt lgkmcnt(4)
    v_mfma_f32_16x16x32_bf16 v[208:211], v[240:243], v[64:67], v[208:211]
    ds_read_b64_tr_b16 v[232:233], v179 offset:24576
    v_mfma_f32_16x16x32_bf16 v[212:215], v[240:243], v[136:139], v[212:215]
    ds_read_b64_tr_b16 v[234:235], v179 offset:30720
    v_mfma_f32_16x16x32_bf16 v[212:215], v[244:247], v[140:143], v[212:215]
    ds_read_b64_tr_b16 v[236:237], v179 offset:36864
    v_mfma_f32_16x16x32_bf16 v[208:211], v[244:247], v[68:71], v[208:211]
    ds_read_b64_tr_b16 v[238:239], v179 offset:43008
    s_waitcnt lgkmcnt(4)
    v_mfma_f32_16x16x32_bf16 v[192:195], v[224:227], v[72:75], v[192:195]
    ds_read_b64_tr_b16 v[240:241], v182 offset:24576
    v_mfma_f32_16x16x32_bf16 v[196:199], v[224:227], v[144:147], v[196:199]
    ds_read_b64_tr_b16 v[242:243], v182 offset:30720
    v_mfma_f32_16x16x32_bf16 v[196:199], v[228:231], v[148:151], v[196:199]
    ds_read_b64_tr_b16 v[244:245], v182 offset:36864
    v_mfma_f32_16x16x32_bf16 v[192:195], v[228:231], v[76:79], v[192:195]
    ds_read_b64_tr_b16 v[246:247], v182 offset:43008
    s_waitcnt vmcnt(5)
    s_barrier
    s_waitcnt lgkmcnt(4)
    v_mfma_f32_16x16x32_bf16 v[200:203], v[232:235], v[72:75], v[200:203]
    ds_read_b64_tr_b16 v[224:225], v177 offset:0
    v_mfma_f32_16x16x32_bf16 v[204:207], v[232:235], v[144:147], v[204:207]
    ds_read_b64_tr_b16 v[226:227], v177 offset:6144
    v_mfma_f32_16x16x32_bf16 v[204:207], v[236:239], v[148:151], v[204:207]
    ds_read_b64_tr_b16 v[228:229], v177 offset:12288
    v_mfma_f32_16x16x32_bf16 v[200:203], v[236:239], v[76:79], v[200:203]
    ds_read_b64_tr_b16 v[230:231], v177 offset:18432
    s_waitcnt lgkmcnt(4)
    v_mfma_f32_16x16x32_bf16 v[208:211], v[240:243], v[72:75], v[208:211]
    ds_read_b64_tr_b16 v[232:233], v180 offset:0
    v_mfma_f32_16x16x32_bf16 v[212:215], v[240:243], v[144:147], v[212:215]
    ds_read_b64_tr_b16 v[234:235], v180 offset:6144
    v_mfma_f32_16x16x32_bf16 v[212:215], v[244:247], v[148:151], v[212:215]
    ds_read_b64_tr_b16 v[236:237], v180 offset:12288
    v_mfma_f32_16x16x32_bf16 v[208:211], v[244:247], v[76:79], v[208:211]
    ds_read_b64_tr_b16 v[238:239], v180 offset:18432
    s_waitcnt lgkmcnt(4)
    v_mfma_f32_16x16x32_bf16 v[192:195], v[224:227], v[80:83], v[192:195]
    ds_read_b64_tr_b16 v[240:241], v183 offset:0
    v_mfma_f32_16x16x32_bf16 v[196:199], v[224:227], v[152:155], v[196:199]
    ds_read_b64_tr_b16 v[242:243], v183 offset:6144
    v_mfma_f32_16x16x32_bf16 v[196:199], v[228:231], v[156:159], v[196:199]
    ds_read_b64_tr_b16 v[244:245], v183 offset:12288
    v_mfma_f32_16x16x32_bf16 v[192:195], v[228:231], v[84:87], v[192:195]
    ds_read_b64_tr_b16 v[246:247], v183 offset:18432
    s_waitcnt lgkmcnt(4)
    v_mfma_f32_16x16x32_bf16 v[200:203], v[232:235], v[80:83], v[200:203]
    v_mfma_f32_16x16x32_bf16 v[204:207], v[232:235], v[152:155], v[204:207]
    v_mfma_f32_16x16x32_bf16 v[204:207], v[236:239], v[156:159], v[204:207]
    v_mfma_f32_16x16x32_bf16 v[200:203], v[236:239], v[84:87], v[200:203]
    s_waitcnt lgkmcnt(0)
    v_mfma_f32_16x16x32_bf16 v[208:211], v[240:243], v[80:83], v[208:211]
    v_mfma_f32_16x16x32_bf16 v[212:215], v[240:243], v[152:155], v[212:215]
    v_mfma_f32_16x16x32_bf16 v[212:215], v[244:247], v[156:159], v[212:215]
    v_mfma_f32_16x16x32_bf16 v[208:211], v[244:247], v[84:87], v[208:211]
    s_waitcnt lgkmcnt(0)
    s_barrier
    s_mul_i32 s51, s39, 1179648
    s_mul_i32 s59, s37, 294912
    s_add_u32 s51, s51, s59
    s_mul_i32 s59, s43, 73728
    s_add_u32 s51, s51, s59
    s_add_u32 s28, s82, s51
    s_addc_u32 s29, s83, 0
    s_mov_b32 s30, 73728
    s_mov_b32 s31, 0x20000
    v_lshlrev_b32 v9, 4, v0
    s_mov_b32 s46, 0
    buffer_load_dwordx4 v[88:91], v9, s[28:31], s46 offen offset:0 sc1
    buffer_load_dwordx4 v[92:95], v9, s[28:31], s46 offen offset:1024 sc1
    s_mov_b32 s46, 0
    buffer_load_dwordx4 v[96:99], v9, s[28:31], s46 offen offset:2048 sc1
    buffer_load_dwordx4 v[100:103], v9, s[28:31], s46 offen offset:3072 sc1
    s_mov_b32 s46, 4096
    buffer_load_dwordx4 v[104:107], v9, s[28:31], s46 offen offset:0 sc1
    buffer_load_dwordx4 v[108:111], v9, s[28:31], s46 offen offset:1024 sc1
    s_mov_b32 s46, 4096
    buffer_load_dwordx4 v[112:115], v9, s[28:31], s46 offen offset:2048 sc1
    buffer_load_dwordx4 v[116:119], v9, s[28:31], s46 offen offset:3072 sc1
    s_waitcnt vmcnt(10)
    v_mul_f32 v192, v14, v192
    v_mul_f32 v193, v14, v193
    v_mul_f32 v194, v14, v194
    v_mul_f32 v195, v14, v195
    v_cvt_pk_bf16_f32 v192, v192, v193
    v_add_u32 v193, v160, v168
    v_cvt_pk_bf16_f32 v194, v194, v195
    v_add_u32 v195, v161, v168
    ds_write_b32 v193, v192 offset:0
    ds_write_b32 v195, v194 offset:0
    v_mul_f32 v196, v15, v196
    v_mul_f32 v197, v15, v197
    v_mul_f32 v198, v15, v198
    v_mul_f32 v199, v15, v199
    v_cvt_pk_bf16_f32 v196, v196, v197
    v_add_u32 v197, v160, v169
    v_cvt_pk_bf16_f32 v198, v198, v199
    v_add_u32 v199, v161, v169
    ds_write_b32 v197, v196 offset:0
    ds_write_b32 v199, v198 offset:0
    v_mul_f32 v200, v14, v200
    v_mul_f32 v201, v14, v201
    v_mul_f32 v202, v14, v202
    v_mul_f32 v203, v14, v203
    v_cvt_pk_bf16_f32 v200, v200, v201
    v_add_u32 v201, v162, v168
    v_cvt_pk_bf16_f32 v202, v202, v203
    v_add_u32 v203, v163, v168
    ds_write_b32 v201, v200 offset:0
    ds_write_b32 v203, v202 offset:0
    v_mul_f32 v204, v15, v204
    v_mul_f32 v205, v15, v205
    v_mul_f32 v206, v15, v206
    v_mul_f32 v207, v15, v207
    v_cvt_pk_bf16_f32 v204, v204, v205
    v_add_u32 v205, v162, v169
    v_cvt_pk_bf16_f32 v206, v206, v207
    v_add_u32 v207, v163, v169
    ds_write_b32 v205, v204 offset:0
    ds_write_b32 v207, v206 offset:0
    v_mul_f32 v208, v14, v208
    v_mul_f32 v209, v14, v209
    v_mul_f32 v210, v14, v210
    v_mul_f32 v211, v14, v211
    v_cvt_pk_bf16_f32 v208, v208, v209
    v_add_u32 v209, v164, v168
    v_cvt_pk_bf16_f32 v210, v210, v211
    v_add_u32 v211, v165, v168
    ds_write_b32 v209, v208 offset:0
    ds_write_b32 v211, v210 offset:0
    v_mul_f32 v212, v15, v212
    v_mul_f32 v213, v15, v213
    v_mul_f32 v214, v15, v214
    v_mul_f32 v215, v15, v215
    v_cvt_pk_bf16_f32 v212, v212, v213
    v_add_u32 v213, v164, v169
    v_cvt_pk_bf16_f32 v214, v214, v215
    v_add_u32 v215, v165, v169
    ds_write_b32 v213, v212 offset:0
    ds_write_b32 v215, v214 offset:0
    s_waitcnt vmcnt(8)
    v_add_u32 v7, 40960, v3
    v_add_u32 v8, 40960, v4
    v_add_u32 v5, 122880, v3
    v_add_u32 v6, 122880, v4
    v_add_u32 v3, 81920, v3
    v_add_u32 v4, 81920, v4
    s_mul_i32 s51, s39, 655360
    s_mul_i32 s59, s42, 163840
    s_add_u32 s51, s51, s59
    s_mul_i32 s59, s43, 40960
    s_add_u32 s51, s51, s59
    s_mul_i32 s59, s37, 10240
    s_add_u32 s51, s51, s59
    s_add_u32 s51, s51, 25165824
    s_add_u32 s32, s82, s51
    s_addc_u32 s33, s83, 0
    s_mov_b32 s34, 10240
    s_mov_b32 s35, 0x20000
    s_waitcnt lgkmcnt(0)
    s_barrier
    ds_read_b64_tr_b16 v[168:169], v3 offset:0
    ds_read_b64_tr_b16 v[170:171], v3 offset:5120
    ds_read_b64_tr_b16 v[172:173], v4 offset:0
    ds_read_b64_tr_b16 v[174:175], v4 offset:5120
    ds_read_b64_tr_b16 v[176:177], v3 offset:64
    ds_read_b64_tr_b16 v[178:179], v3 offset:5184
    ds_read_b64_tr_b16 v[180:181], v4 offset:64
    ds_read_b64_tr_b16 v[182:183], v4 offset:5184
    s_waitcnt vmcnt(6)
    s_waitcnt lgkmcnt(4)
    v_mfma_f32_16x16x32_bf16 v[16:19], v[168:171], v[88:91], 0
    ds_read_b64_tr_b16 v[184:185], v3 offset:128
    v_mfma_f32_16x16x32_bf16 v[52:55], v[168:171], v[92:95], 0
    ds_read_b64_tr_b16 v[186:187], v3 offset:5248
    s_mov_b32 s46, 8192
    v_mfma_f32_16x16x32_bf16 v[20:23], v[172:175], v[88:91], 0
    ds_read_b64_tr_b16 v[188:189], v4 offset:128
    v_mfma_f32_16x16x32_bf16 v[56:59], v[172:175], v[92:95], 0
    ds_read_b64_tr_b16 v[190:191], v4 offset:5248
    buffer_load_dwordx4 v[120:123], v9, s[28:31], s46 offen offset:0 sc1
    s_waitcnt lgkmcnt(4)
    v_mfma_f32_16x16x32_bf16 v[24:27], v[176:179], v[88:91], 0
    ds_read_b64_tr_b16 v[168:169], v3 offset:192
    v_mfma_f32_16x16x32_bf16 v[60:63], v[176:179], v[92:95], 0
    ds_read_b64_tr_b16 v[170:171], v3 offset:5312
    buffer_load_dwordx4 v[124:127], v9, s[28:31], s46 offen offset:1024 sc1
    v_mfma_f32_16x16x32_bf16 v[28:31], v[180:183], v[88:91], 0
    ds_read_b64_tr_b16 v[172:173], v4 offset:192
    v_mfma_f32_16x16x32_bf16 v[64:67], v[180:183], v[92:95], 0
    ds_read_b64_tr_b16 v[174:175], v4 offset:5312
    s_mov_b32 s46, 8192
    s_waitcnt lgkmcnt(4)
    v_mfma_f32_16x16x32_bf16 v[32:35], v[184:187], v[88:91], 0
    ds_read_b64_tr_b16 v[176:177], v3 offset:256
    v_mfma_f32_16x16x32_bf16 v[68:71], v[184:187], v[92:95], 0
    ds_read_b64_tr_b16 v[178:179], v3 offset:5376
    buffer_load_dwordx4 v[128:131], v9, s[28:31], s46 offen offset:2048 sc1
    v_mfma_f32_16x16x32_bf16 v[36:39], v[188:191], v[88:91], 0
    ds_read_b64_tr_b16 v[180:181], v3 offset:10240
    v_mfma_f32_16x16x32_bf16 v[72:75], v[188:191], v[92:95], 0
    ds_read_b64_tr_b16 v[182:183], v3 offset:15360
    buffer_load_dwordx4 v[132:135], v9, s[28:31], s46 offen offset:3072 sc1
    s_waitcnt lgkmcnt(4)
    v_mfma_f32_16x16x32_bf16 v[40:43], v[168:171], v[88:91], 0
    ds_read_b64_tr_b16 v[184:185], v4 offset:10240
    v_mfma_f32_16x16x32_bf16 v[76:79], v[168:171], v[92:95], 0
    ds_read_b64_tr_b16 v[186:187], v4 offset:15360
    s_and_b32 s57, s36, 1
    s_mul_i32 s57, s57, 768
    v_mfma_f32_16x16x32_bf16 v[44:47], v[172:175], v[88:91], 0
    ds_read_b64_tr_b16 v[188:189], v3 offset:10304
    v_mfma_f32_16x16x32_bf16 v[80:83], v[172:175], v[92:95], 0
    ds_read_b64_tr_b16 v[190:191], v3 offset:15424
    s_mul_i32 s58, s43, 1536
    s_add_u32 s57, s57, s58
    s_waitcnt lgkmcnt(4)
    v_mfma_f32_16x16x32_bf16 v[48:51], v[176:179], v[88:91], 0
    ds_read_b64_tr_b16 v[168:169], v4 offset:10304
    v_mfma_f32_16x16x32_bf16 v[84:87], v[176:179], v[92:95], 0
    ds_read_b64_tr_b16 v[170:171], v4 offset:15424
    s_add_u32 s57, s57, 672
    v_and_b32 v243, 15, v0
    s_waitcnt vmcnt(8)
    v_mfma_f32_16x16x32_bf16 v[16:19], v[180:183], v[96:99], v[16:19]
    ds_read_b64_tr_b16 v[172:173], v3 offset:10368
    v_mfma_f32_16x16x32_bf16 v[52:55], v[180:183], v[100:103], v[52:55]
    ds_read_b64_tr_b16 v[174:175], v3 offset:15488
    s_mov_b32 s46, 12288
    s_waitcnt lgkmcnt(4)
    v_mfma_f32_16x16x32_bf16 v[20:23], v[184:187], v[96:99], v[20:23]
    ds_read_b64_tr_b16 v[176:177], v4 offset:10368
    v_mfma_f32_16x16x32_bf16 v[56:59], v[184:187], v[100:103], v[56:59]
    ds_read_b64_tr_b16 v[178:179], v4 offset:15488
    buffer_load_dwordx4 v[136:139], v9, s[28:31], s46 offen offset:0 sc1
    v_mfma_f32_16x16x32_bf16 v[24:27], v[188:191], v[96:99], v[24:27]
    ds_read_b64_tr_b16 v[180:181], v3 offset:10432
    v_mfma_f32_16x16x32_bf16 v[60:63], v[188:191], v[100:103], v[60:63]
    ds_read_b64_tr_b16 v[182:183], v3 offset:15552
    buffer_load_dwordx4 v[140:143], v9, s[28:31], s46 offen offset:1024 sc1
    s_waitcnt lgkmcnt(4)
    v_mfma_f32_16x16x32_bf16 v[28:31], v[168:171], v[96:99], v[28:31]
    ds_read_b64_tr_b16 v[184:185], v4 offset:10432
    v_mfma_f32_16x16x32_bf16 v[64:67], v[168:171], v[100:103], v[64:67]
    ds_read_b64_tr_b16 v[186:187], v4 offset:15552
    s_mov_b32 s46, 12288
    v_mfma_f32_16x16x32_bf16 v[32:35], v[172:175], v[96:99], v[32:35]
    ds_read_b64_tr_b16 v[188:189], v3 offset:10496
    v_mfma_f32_16x16x32_bf16 v[68:71], v[172:175], v[100:103], v[68:71]
    ds_read_b64_tr_b16 v[190:191], v3 offset:15616
    buffer_load_dwordx4 v[144:147], v9, s[28:31], s46 offen offset:2048 sc1
    s_waitcnt lgkmcnt(4)
    v_mfma_f32_16x16x32_bf16 v[36:39], v[176:179], v[96:99], v[36:39]
    ds_read_b64_tr_b16 v[168:169], v3 offset:20480
    v_mfma_f32_16x16x32_bf16 v[72:75], v[176:179], v[100:103], v[72:75]
    ds_read_b64_tr_b16 v[170:171], v3 offset:25600
    buffer_load_dwordx4 v[148:151], v9, s[28:31], s46 offen offset:3072 sc1
    v_mfma_f32_16x16x32_bf16 v[40:43], v[180:183], v[96:99], v[40:43]
    ds_read_b64_tr_b16 v[172:173], v4 offset:20480
    v_mfma_f32_16x16x32_bf16 v[76:79], v[180:183], v[100:103], v[76:79]
    ds_read_b64_tr_b16 v[174:175], v4 offset:25600
    v_mul_u32_u24 v243, 48, v243
    v_add_u32 v243, s57, v243
    s_waitcnt lgkmcnt(4)
    v_mfma_f32_16x16x32_bf16 v[44:47], v[184:187], v[96:99], v[44:47]
    ds_read_b64_tr_b16 v[176:177], v3 offset:20544
    v_mfma_f32_16x16x32_bf16 v[80:83], v[184:187], v[100:103], v[80:83]
    ds_read_b64_tr_b16 v[178:179], v3 offset:25664
    ds_read_b32 v243, v243 offset:44
    s_and_b32 s41, s36, 1
    v_mfma_f32_16x16x32_bf16 v[48:51], v[188:191], v[96:99], v[48:51]
    ds_read_b64_tr_b16 v[180:181], v4 offset:20544
    v_mfma_f32_16x16x32_bf16 v[84:87], v[188:191], v[100:103], v[84:87]
    ds_read_b64_tr_b16 v[182:183], v4 offset:25664
    s_lshr_b32 s49, s36, 1
    s_lshl_b32 s53, s49, 1
    s_waitcnt vmcnt(10)
    s_waitcnt lgkmcnt(5)
    v_mfma_f32_16x16x32_bf16 v[16:19], v[168:171], v[104:107], v[16:19]
    ds_read_b64_tr_b16 v[184:185], v3 offset:20608
    v_mfma_f32_16x16x32_bf16 v[52:55], v[168:171], v[108:111], v[52:55]
    ds_read_b64_tr_b16 v[186:187], v3 offset:25728
    s_mov_b32 s46, 16384
    v_mfma_f32_16x16x32_bf16 v[20:23], v[172:175], v[104:107], v[20:23]
    ds_read_b64_tr_b16 v[188:189], v4 offset:20608
    v_mfma_f32_16x16x32_bf16 v[56:59], v[172:175], v[108:111], v[56:59]
    ds_read_b64_tr_b16 v[190:191], v4 offset:25728
    buffer_load_dwordx4 v[152:155], v9, s[28:31], s46 offen offset:0 sc1
    s_waitcnt lgkmcnt(4)
    v_mfma_f32_16x16x32_bf16 v[24:27], v[176:179], v[104:107], v[24:27]
    ds_read_b64_tr_b16 v[168:169], v3 offset:20672
    v_mfma_f32_16x16x32_bf16 v[60:63], v[176:179], v[108:111], v[60:63]
    ds_read_b64_tr_b16 v[170:171], v3 offset:25792
    buffer_load_dwordx4 v[156:159], v9, s[28:31], s46 offen offset:1024 sc1
    v_mfma_f32_16x16x32_bf16 v[28:31], v[180:183], v[104:107], v[28:31]
    ds_read_b64_tr_b16 v[172:173], v4 offset:20672
    v_mfma_f32_16x16x32_bf16 v[64:67], v[180:183], v[108:111], v[64:67]
    ds_read_b64_tr_b16 v[174:175], v4 offset:25792
    s_mov_b32 s46, 16384
    s_waitcnt lgkmcnt(4)
    v_mfma_f32_16x16x32_bf16 v[32:35], v[184:187], v[104:107], v[32:35]
    ds_read_b64_tr_b16 v[176:177], v3 offset:20736
    v_mfma_f32_16x16x32_bf16 v[68:71], v[184:187], v[108:111], v[68:71]
    ds_read_b64_tr_b16 v[178:179], v3 offset:25856
    buffer_load_dwordx4 v[160:163], v9, s[28:31], s46 offen offset:2048 sc1
    v_mfma_f32_16x16x32_bf16 v[36:39], v[188:191], v[104:107], v[36:39]
    ds_read_b64_tr_b16 v[180:181], v3 offset:30720
    v_mfma_f32_16x16x32_bf16 v[72:75], v[188:191], v[108:111], v[72:75]
    ds_read_b64_tr_b16 v[182:183], v3 offset:35840
    buffer_load_dwordx4 v[164:167], v9, s[28:31], s46 offen offset:3072 sc1
    s_waitcnt lgkmcnt(4)
    v_mfma_f32_16x16x32_bf16 v[40:43], v[168:171], v[104:107], v[40:43]
    ds_read_b64_tr_b16 v[184:185], v4 offset:30720
    v_mfma_f32_16x16x32_bf16 v[76:79], v[168:171], v[108:111], v[76:79]
    ds_read_b64_tr_b16 v[186:187], v4 offset:35840
    s_add_u32 s53, s53, 1
    s_cmp_eq_u32 s49, 0
    v_mfma_f32_16x16x32_bf16 v[44:47], v[172:175], v[104:107], v[44:47]
    ds_read_b64_tr_b16 v[188:189], v3 offset:30784
    v_mfma_f32_16x16x32_bf16 v[80:83], v[172:175], v[108:111], v[80:83]
    ds_read_b64_tr_b16 v[190:191], v3 offset:35904
    s_cselect_b32 s44, 0, s53
    s_cselect_b32 s54, 2, 1
    s_waitcnt lgkmcnt(4)
    v_mfma_f32_16x16x32_bf16 v[48:51], v[176:179], v[104:107], v[48:51]
    ds_read_b64_tr_b16 v[168:169], v4 offset:30784
    v_mfma_f32_16x16x32_bf16 v[84:87], v[176:179], v[108:111], v[84:87]
    ds_read_b64_tr_b16 v[170:171], v4 offset:35904
    s_add_u32 s47, s54, s44
    v_lshlrev_b32 v1, 2, v0
    s_waitcnt vmcnt(12)
    v_mfma_f32_16x16x32_bf16 v[16:19], v[180:183], v[112:115], v[16:19]
    ds_read_b64_tr_b16 v[172:173], v3 offset:30848
    v_mfma_f32_16x16x32_bf16 v[52:55], v[180:183], v[116:119], v[52:55]
    ds_read_b64_tr_b16 v[174:175], v3 offset:35968
    s_mov_b32 s46, 20480
    s_waitcnt lgkmcnt(4)
    v_mfma_f32_16x16x32_bf16 v[20:23], v[184:187], v[112:115], v[20:23]
    ds_read_b64_tr_b16 v[176:177], v4 offset:30848
    v_mfma_f32_16x16x32_bf16 v[56:59], v[184:187], v[116:119], v[56:59]
    ds_read_b64_tr_b16 v[178:179], v4 offset:35968
    buffer_load_dwordx4 v[88:91], v9, s[28:31], s46 offen offset:0 sc1
    v_mfma_f32_16x16x32_bf16 v[24:27], v[188:191], v[112:115], v[24:27]
    ds_read_b64_tr_b16 v[180:181], v3 offset:30912
    v_mfma_f32_16x16x32_bf16 v[60:63], v[188:191], v[116:119], v[60:63]
    ds_read_b64_tr_b16 v[182:183], v3 offset:36032
    buffer_load_dwordx4 v[92:95], v9, s[28:31], s46 offen offset:1024 sc1
    s_waitcnt lgkmcnt(4)
    v_mfma_f32_16x16x32_bf16 v[28:31], v[168:171], v[112:115], v[28:31]
    ds_read_b64_tr_b16 v[184:185], v4 offset:30912
    v_mfma_f32_16x16x32_bf16 v[64:67], v[168:171], v[116:119], v[64:67]
    ds_read_b64_tr_b16 v[186:187], v4 offset:36032
    s_mov_b32 s46, 20480
    v_mfma_f32_16x16x32_bf16 v[32:35], v[172:175], v[112:115], v[32:35]
    ds_read_b64_tr_b16 v[188:189], v3 offset:30976
    v_mfma_f32_16x16x32_bf16 v[68:71], v[172:175], v[116:119], v[68:71]
    ds_read_b64_tr_b16 v[190:191], v3 offset:36096
    buffer_load_dwordx4 v[96:99], v9, s[28:31], s46 offen offset:2048 sc1
    s_waitcnt lgkmcnt(0)
    s_barrier
    v_mfma_f32_16x16x32_bf16 v[36:39], v[176:179], v[112:115], v[36:39]
    ds_read_b64_tr_b16 v[168:169], v5 offset:0
    v_mfma_f32_16x16x32_bf16 v[72:75], v[176:179], v[116:119], v[72:75]
    ds_read_b64_tr_b16 v[170:171], v5 offset:5120
    buffer_load_dwordx4 v[100:103], v9, s[28:31], s46 offen offset:3072 sc1
    v_mfma_f32_16x16x32_bf16 v[40:43], v[180:183], v[112:115], v[40:43]
    ds_read_b64_tr_b16 v[172:173], v6 offset:0
    v_mfma_f32_16x16x32_bf16 v[76:79], v[180:183], v[116:119], v[76:79]
    ds_read_b64_tr_b16 v[174:175], v6 offset:5120
    s_and_b32 s53, s42, 1
    s_add_u32 s54, s53, s44
    v_mfma_f32_16x16x32_bf16 v[44:47], v[184:187], v[112:115], v[44:47]
    ds_read_b64_tr_b16 v[176:177], v5 offset:64
    v_mfma_f32_16x16x32_bf16 v[80:83], v[184:187], v[116:119], v[80:83]
    ds_read_b64_tr_b16 v[178:179], v5 offset:5184
    s_lshl_b32 s54, s54, 8
    s_add_u32 s59, s54, 24576
    v_mfma_f32_16x16x32_bf16 v[48:51], v[188:191], v[112:115], v[48:51]
    ds_read_b64_tr_b16 v[180:181], v6 offset:64
    v_mfma_f32_16x16x32_bf16 v[84:87], v[188:191], v[116:119], v[84:87]
    ds_read_b64_tr_b16 v[182:183], v6 offset:5184
    buffer_load_dword v226, v1, s[72:75], s59 offen offset:1024
    s_add_u32 s59, s54, 24576
    s_waitcnt vmcnt(15)
    s_waitcnt lgkmcnt(4)
    v_mfma_f32_16x16x32_bf16 v[16:19], v[168:171], v[120:123], v[16:19]
    ds_read_b64_tr_b16 v[184:185], v5 offset:128
    v_mfma_f32_16x16x32_bf16 v[52:55], v[168:171], v[124:127], v[52:55]
    ds_read_b64_tr_b16 v[186:187], v5 offset:5248
    s_mov_b32 s46, 24576
    v_mfma_f32_16x16x32_bf16 v[20:23], v[172:175], v[120:123], v[20:23]
    ds_read_b64_tr_b16 v[188:189], v6 offset:128
    v_mfma_f32_16x16x32_bf16 v[56:59], v[172:175], v[124:127], v[56:59]
    ds_read_b64_tr_b16 v[190:191], v6 offset:5248
    buffer_load_dwordx4 v[104:107], v9, s[28:31], s46 offen offset:0 sc1
    s_waitcnt lgkmcnt(4)
    v_mfma_f32_16x16x32_bf16 v[24:27], v[176:179], v[120:123], v[24:27]
    ds_read_b64_tr_b16 v[168:169], v5 offset:192
    v_mfma_f32_16x16x32_bf16 v[60:63], v[176:179], v[124:127], v[60:63]
    ds_read_b64_tr_b16 v[170:171], v5 offset:5312
    buffer_load_dwordx4 v[108:111], v9, s[28:31], s46 offen offset:1024 sc1
    v_mfma_f32_16x16x32_bf16 v[28:31], v[180:183], v[120:123], v[28:31]
    ds_read_b64_tr_b16 v[172:173], v6 offset:192
    v_mfma_f32_16x16x32_bf16 v[64:67], v[180:183], v[124:127], v[64:67]
    ds_read_b64_tr_b16 v[174:175], v6 offset:5312
    s_mov_b32 s46, 24576
    s_waitcnt lgkmcnt(4)
    v_mfma_f32_16x16x32_bf16 v[32:35], v[184:187], v[120:123], v[32:35]
    ds_read_b64_tr_b16 v[176:177], v5 offset:256
    v_mfma_f32_16x16x32_bf16 v[68:71], v[184:187], v[124:127], v[68:71]
    ds_read_b64_tr_b16 v[178:179], v5 offset:5376
    buffer_load_dwordx4 v[112:115], v9, s[28:31], s46 offen offset:2048 sc1
    v_mfma_f32_16x16x32_bf16 v[36:39], v[188:191], v[120:123], v[36:39]
    ds_read_b64_tr_b16 v[180:181], v5 offset:10240
    v_mfma_f32_16x16x32_bf16 v[72:75], v[188:191], v[124:127], v[72:75]
    ds_read_b64_tr_b16 v[182:183], v5 offset:15360
    buffer_load_dwordx4 v[116:119], v9, s[28:31], s46 offen offset:3072 sc1
    s_waitcnt lgkmcnt(4)
    v_mfma_f32_16x16x32_bf16 v[40:43], v[168:171], v[120:123], v[40:43]
    ds_read_b64_tr_b16 v[184:185], v6 offset:10240
    v_mfma_f32_16x16x32_bf16 v[76:79], v[168:171], v[124:127], v[76:79]
    ds_read_b64_tr_b16 v[186:187], v6 offset:15360
    buffer_load_dword v229, v1, s[72:75], s59 offen offset:1280
    s_add_u32 s54, s53, s47
    v_mfma_f32_16x16x32_bf16 v[44:47], v[172:175], v[120:123], v[44:47]
    ds_read_b64_tr_b16 v[188:189], v5 offset:10304
    v_mfma_f32_16x16x32_bf16 v[80:83], v[172:175], v[124:127], v[80:83]
    ds_read_b64_tr_b16 v[190:191], v5 offset:15424
    s_lshl_b32 s54, s54, 8
    s_add_u32 s59, s54, 24576
    s_waitcnt lgkmcnt(4)
    v_mfma_f32_16x16x32_bf16 v[48:51], v[176:179], v[120:123], v[48:51]
    ds_read_b64_tr_b16 v[168:169], v6 offset:10304
    v_mfma_f32_16x16x32_bf16 v[84:87], v[176:179], v[124:127], v[84:87]
    ds_read_b64_tr_b16 v[170:171], v6 offset:15424
    buffer_load_dword v217, v1, s[72:75], s59 offen offset:1024
    s_mov_b32 s59, 28672
    s_waitcnt vmcnt(19)
    v_mfma_f32_16x16x32_bf16 v[16:19], v[180:183], v[128:131], v[16:19]
    ds_read_b64_tr_b16 v[172:173], v5 offset:10368
    v_mfma_f32_16x16x32_bf16 v[52:55], v[180:183], v[132:135], v[52:55]
    ds_read_b64_tr_b16 v[174:175], v5 offset:15488
    s_mov_b32 s46, 28672
    s_waitcnt lgkmcnt(4)
    v_mfma_f32_16x16x32_bf16 v[20:23], v[184:187], v[128:131], v[20:23]
    ds_read_b64_tr_b16 v[176:177], v6 offset:10368
    v_mfma_f32_16x16x32_bf16 v[56:59], v[184:187], v[132:135], v[56:59]
    ds_read_b64_tr_b16 v[178:179], v6 offset:15488
    buffer_load_dwordx4 v[120:123], v9, s[28:31], s46 offen offset:0 sc1
    v_mfma_f32_16x16x32_bf16 v[24:27], v[188:191], v[128:131], v[24:27]
    ds_read_b64_tr_b16 v[180:181], v5 offset:10432
    v_mfma_f32_16x16x32_bf16 v[60:63], v[188:191], v[132:135], v[60:63]
    ds_read_b64_tr_b16 v[182:183], v5 offset:15552
    buffer_load_dwordx4 v[124:127], v9, s[28:31], s46 offen offset:1024 sc1
    s_waitcnt lgkmcnt(4)
    v_mfma_f32_16x16x32_bf16 v[28:31], v[168:171], v[128:131], v[28:31]
    ds_read_b64_tr_b16 v[184:185], v6 offset:10432
    v_mfma_f32_16x16x32_bf16 v[64:67], v[168:171], v[132:135], v[64:67]
    ds_read_b64_tr_b16 v[186:187], v6 offset:15552
    buffer_load_dword v238, v1, s[72:75], s59 offen offset:3328
    s_mul_i32 s51, s39, 147456
    v_mfma_f32_16x16x32_bf16 v[32:35], v[172:175], v[128:131], v[32:35]
    ds_read_b64_tr_b16 v[188:189], v5 offset:10496
    v_mfma_f32_16x16x32_bf16 v[68:71], v[172:175], v[132:135], v[68:71]
    ds_read_b64_tr_b16 v[190:191], v5 offset:15616
    s_mul_i32 s59, s43, 36864
    s_add_u32 s51, s51, s59
    s_waitcnt lgkmcnt(4)
    v_mfma_f32_16x16x32_bf16 v[36:39], v[176:179], v[128:131], v[36:39]
    ds_read_b64_tr_b16 v[168:169], v5 offset:20480
    v_mfma_f32_16x16x32_bf16 v[72:75], v[176:179], v[132:135], v[72:75]
    ds_read_b64_tr_b16 v[170:171], v5 offset:25600
    s_mul_i32 s59, s42, 288
    s_add_u32 s51, s51, s59
    v_mfma_f32_16x16x32_bf16 v[40:43], v[180:183], v[128:131], v[40:43]
    ds_read_b64_tr_b16 v[172:173], v6 offset:20480
    v_mfma_f32_16x16x32_bf16 v[76:79], v[180:183], v[132:135], v[76:79]
    ds_read_b64_tr_b16 v[174:175], v6 offset:25600
    s_add_u32 s4, s64, s51
    s_addc_u32 s5, s65, 0
    s_waitcnt lgkmcnt(4)
    v_mfma_f32_16x16x32_bf16 v[44:47], v[184:187], v[128:131], v[44:47]
    ds_read_b64_tr_b16 v[176:177], v5 offset:20544
    v_mfma_f32_16x16x32_bf16 v[80:83], v[184:187], v[132:135], v[80:83]
    ds_read_b64_tr_b16 v[178:179], v5 offset:25664
    s_sub_u32 s6, 2359296, s51
    s_mov_b32 s7, 0x20000
    v_mfma_f32_16x16x32_bf16 v[48:51], v[188:191], v[128:131], v[48:51]
    ds_read_b64_tr_b16 v[180:181], v6 offset:20544
    v_mfma_f32_16x16x32_bf16 v[84:87], v[188:191], v[132:135], v[84:87]
    ds_read_b64_tr_b16 v[182:183], v6 offset:25664
    s_add_u32 s12, s78, s51
    s_addc_u32 s13, s79, 0
    s_waitcnt vmcnt(20)
    s_waitcnt lgkmcnt(4)
    v_mfma_f32_16x16x32_bf16 v[16:19], v[168:171], v[136:139], v[16:19]
    ds_read_b64_tr_b16 v[184:185], v5 offset:20608
    v_mfma_f32_16x16x32_bf16 v[52:55], v[168:171], v[140:143], v[52:55]
    ds_read_b64_tr_b16 v[186:187], v5 offset:25728
    s_mov_b32 s46, 28672
    v_mfma_f32_16x16x32_bf16 v[20:23], v[172:175], v[136:139], v[20:23]
    ds_read_b64_tr_b16 v[188:189], v6 offset:20608
    v_mfma_f32_16x16x32_bf16 v[56:59], v[172:175], v[140:143], v[56:59]
    ds_read_b64_tr_b16 v[190:191], v6 offset:25728
    buffer_load_dwordx4 v[128:131], v9, s[28:31], s46 offen offset:2048 sc1
    s_waitcnt lgkmcnt(4)
    v_mfma_f32_16x16x32_bf16 v[24:27], v[176:179], v[136:139], v[24:27]
    ds_read_b64_tr_b16 v[168:169], v5 offset:20672
    v_mfma_f32_16x16x32_bf16 v[60:63], v[176:179], v[140:143], v[60:63]
    ds_read_b64_tr_b16 v[170:171], v5 offset:25792
    buffer_load_dwordx4 v[132:135], v9, s[28:31], s46 offen offset:3072 sc1
    v_mfma_f32_16x16x32_bf16 v[28:31], v[180:183], v[136:139], v[28:31]
    ds_read_b64_tr_b16 v[172:173], v6 offset:20672
    v_mfma_f32_16x16x32_bf16 v[64:67], v[180:183], v[140:143], v[64:67]
    ds_read_b64_tr_b16 v[174:175], v6 offset:25792
    s_sub_u32 s14, 2359296, s51
    s_mov_b32 s15, 0x20000
    s_waitcnt lgkmcnt(4)
    v_mfma_f32_16x16x32_bf16 v[32:35], v[184:187], v[136:139], v[32:35]
    ds_read_b64_tr_b16 v[176:177], v5 offset:20736
    v_mfma_f32_16x16x32_bf16 v[68:71], v[184:187], v[140:143], v[68:71]
    ds_read_b64_tr_b16 v[178:179], v5 offset:25856
    s_cmp_eq_u32 s49, 0
    s_cselect_b32 s51, 0, 1
    v_mfma_f32_16x16x32_bf16 v[36:39], v[188:191], v[136:139], v[36:39]
    ds_read_b64_tr_b16 v[180:181], v5 offset:30720
    v_mfma_f32_16x16x32_bf16 v[72:75], v[188:191], v[140:143], v[72:75]
    ds_read_b64_tr_b16 v[182:183], v5 offset:35840
    s_add_u32 s51, s51, s49
    s_mul_i32 s52, s41, 5
    s_waitcnt lgkmcnt(4)
    v_mfma_f32_16x16x32_bf16 v[40:43], v[168:171], v[136:139], v[40:43]
    ds_read_b64_tr_b16 v[184:185], v6 offset:30720
    v_mfma_f32_16x16x32_bf16 v[76:79], v[168:171], v[140:143], v[76:79]
    ds_read_b64_tr_b16 v[186:187], v6 offset:35840
    s_add_u32 s51, s51, s52
    s_lshl_b32 s51, s51, 10
    v_mfma_f32_16x16x32_bf16 v[44:47], v[172:175], v[136:139], v[44:47]
    ds_read_b64_tr_b16 v[188:189], v5 offset:30784
    v_mfma_f32_16x16x32_bf16 v[80:83], v[172:175], v[140:143], v[80:83]
    ds_read_b64_tr_b16 v[190:191], v5 offset:35904
    v_lshl_add_u32 v241, v0, 4, s51
    s_cmp_eq_u32 s49, 0
    s_waitcnt lgkmcnt(4)
    v_mfma_f32_16x16x32_bf16 v[48:51], v[176:179], v[136:139], v[48:51]
    ds_read_b64_tr_b16 v[168:169], v6 offset:30784
    v_mfma_f32_16x16x32_bf16 v[84:87], v[176:179], v[140:143], v[84:87]
    ds_read_b64_tr_b16 v[170:171], v6 offset:35904
    s_cselect_b32 s52, 1024, 8
    v_add_u32 v242, s52, v241
    s_waitcnt vmcnt(20)
    v_mfma_f32_16x16x32_bf16 v[16:19], v[180:183], v[144:147], v[16:19]
    ds_read_b64_tr_b16 v[172:173], v5 offset:30848
    v_mfma_f32_16x16x32_bf16 v[52:55], v[180:183], v[148:151], v[52:55]
    ds_read_b64_tr_b16 v[174:175], v5 offset:35968
    s_mov_b32 s46, 32768
    s_waitcnt lgkmcnt(4)
    v_mfma_f32_16x16x32_bf16 v[20:23], v[184:187], v[144:147], v[20:23]
    ds_read_b64_tr_b16 v[176:177], v6 offset:30848
    v_mfma_f32_16x16x32_bf16 v[56:59], v[184:187], v[148:151], v[56:59]
    ds_read_b64_tr_b16 v[178:179], v6 offset:35968
    buffer_load_dwordx4 v[136:139], v9, s[28:31], s46 offen offset:0 sc1
    v_mfma_f32_16x16x32_bf16 v[24:27], v[188:191], v[144:147], v[24:27]
    ds_read_b64_tr_b16 v[180:181], v5 offset:30912
    v_mfma_f32_16x16x32_bf16 v[60:63], v[188:191], v[148:151], v[60:63]
    ds_read_b64_tr_b16 v[182:183], v5 offset:36032
    buffer_load_dwordx4 v[140:143], v9, s[28:31], s46 offen offset:1024 sc1
    s_waitcnt lgkmcnt(4)
    v_mfma_f32_16x16x32_bf16 v[28:31], v[168:171], v[144:147], v[28:31]
    ds_read_b64_tr_b16 v[184:185], v6 offset:30912
    v_mfma_f32_16x16x32_bf16 v[64:67], v[168:171], v[148:151], v[64:67]
    ds_read_b64_tr_b16 v[186:187], v6 offset:36032
    s_mul_i32 s51, s39, 655360
    s_mul_i32 s59, s42, 163840
    v_mfma_f32_16x16x32_bf16 v[32:35], v[172:175], v[144:147], v[32:35]
    ds_read_b64_tr_b16 v[188:189], v5 offset:30976
    v_mfma_f32_16x16x32_bf16 v[68:71], v[172:175], v[148:151], v[68:71]
    ds_read_b64_tr_b16 v[190:191], v5 offset:36096
    s_add_u32 s51, s51, s59
    s_mul_i32 s59, s43, 10240
    s_waitcnt lgkmcnt(0)
    s_barrier
    v_mfma_f32_16x16x32_bf16 v[36:39], v[176:179], v[144:147], v[36:39]
    ds_read_b64_tr_b16 v[168:169], v7 offset:0
    v_mfma_f32_16x16x32_bf16 v[72:75], v[176:179], v[148:151], v[72:75]
    ds_read_b64_tr_b16 v[170:171], v7 offset:5120
    s_add_u32 s51, s51, s59
    s_add_u32 s51, s51, 25165824
    v_mfma_f32_16x16x32_bf16 v[40:43], v[180:183], v[144:147], v[40:43]
    ds_read_b64_tr_b16 v[172:173], v8 offset:0
    v_mfma_f32_16x16x32_bf16 v[76:79], v[180:183], v[148:151], v[76:79]
    ds_read_b64_tr_b16 v[174:175], v8 offset:5120
    s_add_u32 s8, s82, s51
    s_addc_u32 s9, s83, 0
    v_mfma_f32_16x16x32_bf16 v[44:47], v[184:187], v[144:147], v[44:47]
    ds_read_b64_tr_b16 v[176:177], v7 offset:64
    v_mfma_f32_16x16x32_bf16 v[80:83], v[184:187], v[148:151], v[80:83]
    ds_read_b64_tr_b16 v[178:179], v7 offset:5184
    s_mov_b32 s10, 133120
    s_mov_b32 s11, 0x20000
    v_mfma_f32_16x16x32_bf16 v[48:51], v[188:191], v[144:147], v[48:51]
    ds_read_b64_tr_b16 v[180:181], v8 offset:64
    v_mfma_f32_16x16x32_bf16 v[84:87], v[188:191], v[148:151], v[84:87]
    ds_read_b64_tr_b16 v[182:183], v8 offset:5184
    s_waitcnt vmcnt(20)
    s_waitcnt lgkmcnt(4)
    v_mfma_f32_16x16x32_bf16 v[16:19], v[168:171], v[152:155], v[16:19]
    ds_read_b64_tr_b16 v[184:185], v7 offset:128
    v_mfma_f32_16x16x32_bf16 v[52:55], v[168:171], v[156:159], v[52:55]
    ds_read_b64_tr_b16 v[186:187], v7 offset:5248
    s_mov_b32 s46, 32768
    v_mfma_f32_16x16x32_bf16 v[20:23], v[172:175], v[152:155], v[20:23]
    ds_read_b64_tr_b16 v[188:189], v8 offset:128
    v_mfma_f32_16x16x32_bf16 v[56:59], v[172:175], v[156:159], v[56:59]
    ds_read_b64_tr_b16 v[190:191], v8 offset:5248
    buffer_load_dwordx4 v[144:147], v9, s[28:31], s46 offen offset:2048 sc1
    s_waitcnt lgkmcnt(4)
    v_mfma_f32_16x16x32_bf16 v[24:27], v[176:179], v[152:155], v[24:27]
    ds_read_b64_tr_b16 v[168:169], v7 offset:192
    v_mfma_f32_16x16x32_bf16 v[60:63], v[176:179], v[156:159], v[60:63]
    ds_read_b64_tr_b16 v[170:171], v7 offset:5312
    buffer_load_dwordx4 v[148:151], v9, s[28:31], s46 offen offset:3072 sc1
    v_mfma_f32_16x16x32_bf16 v[28:31], v[180:183], v[152:155], v[28:31]
    ds_read_b64_tr_b16 v[172:173], v8 offset:192
    v_mfma_f32_16x16x32_bf16 v[64:67], v[180:183], v[156:159], v[64:67]
    ds_read_b64_tr_b16 v[174:175], v8 offset:5312
    s_waitcnt lgkmcnt(4)
    v_mfma_f32_16x16x32_bf16 v[32:35], v[184:187], v[152:155], v[32:35]
    ds_read_b64_tr_b16 v[176:177], v7 offset:256
    v_mfma_f32_16x16x32_bf16 v[68:71], v[184:187], v[156:159], v[68:71]
    ds_read_b64_tr_b16 v[178:179], v7 offset:5376
    v_mfma_f32_16x16x32_bf16 v[36:39], v[188:191], v[152:155], v[36:39]
    ds_read_b64_tr_b16 v[180:181], v7 offset:10240
    v_mfma_f32_16x16x32_bf16 v[72:75], v[188:191], v[156:159], v[72:75]
    ds_read_b64_tr_b16 v[182:183], v7 offset:15360
    s_waitcnt lgkmcnt(4)
    v_mfma_f32_16x16x32_bf16 v[40:43], v[168:171], v[152:155], v[40:43]
    ds_read_b64_tr_b16 v[184:185], v8 offset:10240
    v_mfma_f32_16x16x32_bf16 v[76:79], v[168:171], v[156:159], v[76:79]
    ds_read_b64_tr_b16 v[186:187], v8 offset:15360
    v_mfma_f32_16x16x32_bf16 v[44:47], v[172:175], v[152:155], v[44:47]
    ds_read_b64_tr_b16 v[188:189], v7 offset:10304
    v_mfma_f32_16x16x32_bf16 v[80:83], v[172:175], v[156:159], v[80:83]
    ds_read_b64_tr_b16 v[190:191], v7 offset:15424
    s_waitcnt lgkmcnt(4)
    v_mfma_f32_16x16x32_bf16 v[48:51], v[176:179], v[152:155], v[48:51]
    ds_read_b64_tr_b16 v[168:169], v8 offset:10304
    v_mfma_f32_16x16x32_bf16 v[84:87], v[176:179], v[156:159], v[84:87]
    ds_read_b64_tr_b16 v[170:171], v8 offset:15424
    s_waitcnt vmcnt(20)
    v_mfma_f32_16x16x32_bf16 v[16:19], v[180:183], v[160:163], v[16:19]
    ds_read_b64_tr_b16 v[172:173], v7 offset:10368
    v_mfma_f32_16x16x32_bf16 v[52:55], v[180:183], v[164:167], v[52:55]
    ds_read_b64_tr_b16 v[174:175], v7 offset:15488
    s_mov_b32 s46, 36864
    s_waitcnt lgkmcnt(4)
    v_mfma_f32_16x16x32_bf16 v[20:23], v[184:187], v[160:163], v[20:23]
    ds_read_b64_tr_b16 v[176:177], v8 offset:10368
    v_mfma_f32_16x16x32_bf16 v[56:59], v[184:187], v[164:167], v[56:59]
    ds_read_b64_tr_b16 v[178:179], v8 offset:15488
    buffer_load_dwordx4 v[152:155], v9, s[28:31], s46 offen offset:0 sc1
    v_mfma_f32_16x16x32_bf16 v[24:27], v[188:191], v[160:163], v[24:27]
    ds_read_b64_tr_b16 v[180:181], v7 offset:10432
    v_mfma_f32_16x16x32_bf16 v[60:63], v[188:191], v[164:167], v[60:63]
    ds_read_b64_tr_b16 v[182:183], v7 offset:15552
    buffer_load_dwordx4 v[156:159], v9, s[28:31], s46 offen offset:1024 sc1
    s_waitcnt lgkmcnt(4)
    v_mfma_f32_16x16x32_bf16 v[28:31], v[168:171], v[160:163], v[28:31]
    ds_read_b64_tr_b16 v[184:185], v8 offset:10432
    v_mfma_f32_16x16x32_bf16 v[64:67], v[168:171], v[164:167], v[64:67]
    ds_read_b64_tr_b16 v[186:187], v8 offset:15552
    v_mfma_f32_16x16x32_bf16 v[32:35], v[172:175], v[160:163], v[32:35]
    ds_read_b64_tr_b16 v[188:189], v7 offset:10496
    v_mfma_f32_16x16x32_bf16 v[68:71], v[172:175], v[164:167], v[68:71]
    ds_read_b64_tr_b16 v[190:191], v7 offset:15616
    s_waitcnt vmcnt(8)
    s_waitcnt lgkmcnt(4)
    v_mfma_f32_16x16x32_bf16 v[36:39], v[176:179], v[160:163], v[36:39]
    ds_read_b64_tr_b16 v[168:169], v7 offset:20480
    v_mfma_f32_16x16x32_bf16 v[72:75], v[176:179], v[164:167], v[72:75]
    ds_read_b64_tr_b16 v[170:171], v7 offset:25600
    v_add_u32 v228, 40960, v226
    v_add_u32 v227, 122880, v226
    v_mfma_f32_16x16x32_bf16 v[40:43], v[180:183], v[160:163], v[40:43]
    ds_read_b64_tr_b16 v[172:173], v8 offset:20480
    v_mfma_f32_16x16x32_bf16 v[76:79], v[180:183], v[164:167], v[76:79]
    ds_read_b64_tr_b16 v[174:175], v8 offset:25600
    v_add_u32 v226, 81920, v226
    v_add_u32 v231, 40960, v229
    s_waitcnt lgkmcnt(4)
    v_mfma_f32_16x16x32_bf16 v[44:47], v[184:187], v[160:163], v[44:47]
    ds_read_b64_tr_b16 v[176:177], v7 offset:20544
    v_mfma_f32_16x16x32_bf16 v[80:83], v[184:187], v[164:167], v[80:83]
    ds_read_b64_tr_b16 v[178:179], v7 offset:25664
    v_add_u32 v230, 122880, v229
    v_add_u32 v229, 81920, v229
    v_mfma_f32_16x16x32_bf16 v[48:51], v[188:191], v[160:163], v[48:51]
    ds_read_b64_tr_b16 v[180:181], v8 offset:20544
    v_mfma_f32_16x16x32_bf16 v[84:87], v[188:191], v[164:167], v[84:87]
    ds_read_b64_tr_b16 v[182:183], v8 offset:25664
    v_add_u32 v219, 40960, v217
    v_add_u32 v218, 122880, v217
    s_waitcnt lgkmcnt(4)
    v_mfma_f32_16x16x32_bf16 v[16:19], v[168:171], v[88:91], v[16:19]
    ds_read_b64_tr_b16 v[184:185], v7 offset:20608
    v_mfma_f32_16x16x32_bf16 v[52:55], v[168:171], v[92:95], v[52:55]
    ds_read_b64_tr_b16 v[186:187], v7 offset:25728
    s_mov_b32 s46, 36864
    v_mfma_f32_16x16x32_bf16 v[20:23], v[172:175], v[88:91], v[20:23]
    ds_read_b64_tr_b16 v[188:189], v8 offset:20608
    v_mfma_f32_16x16x32_bf16 v[56:59], v[172:175], v[92:95], v[56:59]
    ds_read_b64_tr_b16 v[190:191], v8 offset:25728
    buffer_load_dwordx4 v[160:163], v9, s[28:31], s46 offen offset:2048 sc1
    s_waitcnt lgkmcnt(4)
    v_mfma_f32_16x16x32_bf16 v[24:27], v[176:179], v[88:91], v[24:27]
    ds_read_b64_tr_b16 v[168:169], v7 offset:20672
    v_mfma_f32_16x16x32_bf16 v[60:63], v[176:179], v[92:95], v[60:63]
    ds_read_b64_tr_b16 v[170:171], v7 offset:25792
    buffer_load_dwordx4 v[164:167], v9, s[28:31], s46 offen offset:3072 sc1
    v_mfma_f32_16x16x32_bf16 v[28:31], v[180:183], v[88:91], v[28:31]
    ds_read_b64_tr_b16 v[172:173], v8 offset:20672
    v_mfma_f32_16x16x32_bf16 v[64:67], v[180:183], v[92:95], v[64:67]
    ds_read_b64_tr_b16 v[174:175], v8 offset:25792
    v_add_u32 v217, 81920, v217
    s_mul_i32 s51, s41, 18432
    s_waitcnt lgkmcnt(4)
    v_mfma_f32_16x16x32_bf16 v[32:35], v[184:187], v[88:91], v[32:35]
    ds_read_b64_tr_b16 v[176:177], v7 offset:20736
    v_mfma_f32_16x16x32_bf16 v[68:71], v[184:187], v[92:95], v[68:71]
    ds_read_b64_tr_b16 v[178:179], v7 offset:25856
    s_lshl_b32 s52, s47, 5
    s_add_u32 s52, s52, s51
    v_mfma_f32_16x16x32_bf16 v[36:39], v[188:191], v[88:91], v[36:39]
    ds_read_b64_tr_b16 v[180:181], v7 offset:30720
    v_mfma_f32_16x16x32_bf16 v[72:75], v[188:191], v[92:95], v[72:75]
    ds_read_b64_tr_b16 v[182:183], v7 offset:35840
    s_cmp_eq_u32 s49, 0
    s_cselect_b32 s53, 0, 0x40000000
    s_waitcnt lgkmcnt(4)
    v_mfma_f32_16x16x32_bf16 v[40:43], v[168:171], v[88:91], v[40:43]
    ds_read_b64_tr_b16 v[184:185], v8 offset:30720
    v_mfma_f32_16x16x32_bf16 v[76:79], v[168:171], v[92:95], v[76:79]
    ds_read_b64_tr_b16 v[186:187], v8 offset:35840
    s_add_u32 s52, s52, s53
    v_add_u32 v240, s52, v238
    v_mfma_f32_16x16x32_bf16 v[44:47], v[172:175], v[88:91], v[44:47]
    ds_read_b64_tr_b16 v[188:189], v7 offset:30784
    v_mfma_f32_16x16x32_bf16 v[80:83], v[172:175], v[92:95], v[80:83]
    ds_read_b64_tr_b16 v[190:191], v7 offset:35904
    s_lshl_b32 s52, s44, 5
    s_add_u32 s52, s52, s51
    s_waitcnt lgkmcnt(4)
    v_mfma_f32_16x16x32_bf16 v[48:51], v[176:179], v[88:91], v[48:51]
    ds_read_b64_tr_b16 v[168:169], v8 offset:30784
    v_mfma_f32_16x16x32_bf16 v[84:87], v[176:179], v[92:95], v[84:87]
    ds_read_b64_tr_b16 v[170:171], v8 offset:35904
    s_add_u32 s53, s52, 32
    v_add_u32 v239, s53, v238
    v_mfma_f32_16x16x32_bf16 v[16:19], v[180:183], v[96:99], v[16:19]
    ds_read_b64_tr_b16 v[172:173], v7 offset:30848
    v_mfma_f32_16x16x32_bf16 v[52:55], v[180:183], v[100:103], v[52:55]
    ds_read_b64_tr_b16 v[174:175], v7 offset:35968
    s_mov_b32 s46, 40960
    s_waitcnt lgkmcnt(4)
    v_mfma_f32_16x16x32_bf16 v[20:23], v[184:187], v[96:99], v[20:23]
    ds_read_b64_tr_b16 v[176:177], v8 offset:30848
    v_mfma_f32_16x16x32_bf16 v[56:59], v[184:187], v[100:103], v[56:59]
    ds_read_b64_tr_b16 v[178:179], v8 offset:35968
    buffer_load_dwordx4 v[88:91], v9, s[28:31], s46 offen offset:0 sc1
    v_mfma_f32_16x16x32_bf16 v[24:27], v[188:191], v[96:99], v[24:27]
    ds_read_b64_tr_b16 v[180:181], v7 offset:30912
    v_mfma_f32_16x16x32_bf16 v[60:63], v[188:191], v[100:103], v[60:63]
    ds_read_b64_tr_b16 v[182:183], v7 offset:36032
    buffer_load_dwordx4 v[92:95], v9, s[28:31], s46 offen offset:1024 sc1
    s_waitcnt lgkmcnt(4)
    v_mfma_f32_16x16x32_bf16 v[28:31], v[168:171], v[96:99], v[28:31]
    ds_read_b64_tr_b16 v[184:185], v8 offset:30912
    v_mfma_f32_16x16x32_bf16 v[64:67], v[168:171], v[100:103], v[64:67]
    ds_read_b64_tr_b16 v[186:187], v8 offset:36032
    v_add_u32 v238, s52, v238
    v_mfma_f32_16x16x32_bf16 v[32:35], v[172:175], v[96:99], v[32:35]
    ds_read_b64_tr_b16 v[188:189], v7 offset:30976
    v_mfma_f32_16x16x32_bf16 v[68:71], v[172:175], v[100:103], v[68:71]
    ds_read_b64_tr_b16 v[190:191], v7 offset:36096
    s_waitcnt lgkmcnt(0)
    s_barrier
    v_mfma_f32_16x16x32_bf16 v[36:39], v[176:179], v[96:99], v[36:39]
    ds_read_b64_tr_b16 v[168:169], v3 offset:0
    v_mfma_f32_16x16x32_bf16 v[72:75], v[176:179], v[100:103], v[72:75]
    ds_read_b64_tr_b16 v[170:171], v3 offset:5120
    v_mfma_f32_16x16x32_bf16 v[40:43], v[180:183], v[96:99], v[40:43]
    ds_read_b64_tr_b16 v[172:173], v4 offset:0
    v_mfma_f32_16x16x32_bf16 v[76:79], v[180:183], v[100:103], v[76:79]
    ds_read_b64_tr_b16 v[174:175], v4 offset:5120
    v_mfma_f32_16x16x32_bf16 v[44:47], v[184:187], v[96:99], v[44:47]
    ds_read_b64_tr_b16 v[176:177], v3 offset:64
    v_mfma_f32_16x16x32_bf16 v[80:83], v[184:187], v[100:103], v[80:83]
    ds_read_b64_tr_b16 v[178:179], v3 offset:5184
    v_mfma_f32_16x16x32_bf16 v[48:51], v[188:191], v[96:99], v[48:51]
    ds_read_b64_tr_b16 v[180:181], v4 offset:64
    v_mfma_f32_16x16x32_bf16 v[84:87], v[188:191], v[100:103], v[84:87]
    ds_read_b64_tr_b16 v[182:183], v4 offset:5184
    s_waitcnt lgkmcnt(4)
    v_mfma_f32_16x16x32_bf16 v[16:19], v[168:171], v[104:107], v[16:19]
    ds_read_b64_tr_b16 v[184:185], v3 offset:128
    v_mfma_f32_16x16x32_bf16 v[52:55], v[168:171], v[108:111], v[52:55]
    ds_read_b64_tr_b16 v[186:187], v3 offset:5248
    s_mov_b32 s46, 40960
    v_mfma_f32_16x16x32_bf16 v[20:23], v[172:175], v[104:107], v[20:23]
    ds_read_b64_tr_b16 v[188:189], v4 offset:128
    v_mfma_f32_16x16x32_bf16 v[56:59], v[172:175], v[108:111], v[56:59]
    ds_read_b64_tr_b16 v[190:191], v4 offset:5248
    buffer_load_dwordx4 v[96:99], v9, s[28:31], s46 offen offset:2048 sc1
    s_waitcnt lgkmcnt(4)
    v_mfma_f32_16x16x32_bf16 v[24:27], v[176:179], v[104:107], v[24:27]
    ds_read_b64_tr_b16 v[168:169], v3 offset:192
    v_mfma_f32_16x16x32_bf16 v[60:63], v[176:179], v[108:111], v[60:63]
    ds_read_b64_tr_b16 v[170:171], v3 offset:5312
    buffer_load_dwordx4 v[100:103], v9, s[28:31], s46 offen offset:3072 sc1
    v_mfma_f32_16x16x32_bf16 v[28:31], v[180:183], v[104:107], v[28:31]
    ds_read_b64_tr_b16 v[172:173], v4 offset:192
    v_mfma_f32_16x16x32_bf16 v[64:67], v[180:183], v[108:111], v[64:67]
    ds_read_b64_tr_b16 v[174:175], v4 offset:5312
    s_waitcnt lgkmcnt(4)
    v_mfma_f32_16x16x32_bf16 v[32:35], v[184:187], v[104:107], v[32:35]
    ds_read_b64_tr_b16 v[176:177], v3 offset:256
    v_mfma_f32_16x16x32_bf16 v[68:71], v[184:187], v[108:111], v[68:71]
    ds_read_b64_tr_b16 v[178:179], v3 offset:5376
    v_mfma_f32_16x16x32_bf16 v[36:39], v[188:191], v[104:107], v[36:39]
    ds_read_b64_tr_b16 v[180:181], v3 offset:10240
    v_mfma_f32_16x16x32_bf16 v[72:75], v[188:191], v[108:111], v[72:75]
    ds_read_b64_tr_b16 v[182:183], v3 offset:15360
    s_waitcnt lgkmcnt(4)
    v_mfma_f32_16x16x32_bf16 v[40:43], v[168:171], v[104:107], v[40:43]
    ds_read_b64_tr_b16 v[184:185], v4 offset:10240
    v_mfma_f32_16x16x32_bf16 v[76:79], v[168:171], v[108:111], v[76:79]
    ds_read_b64_tr_b16 v[186:187], v4 offset:15360
    v_mfma_f32_16x16x32_bf16 v[44:47], v[172:175], v[104:107], v[44:47]
    ds_read_b64_tr_b16 v[188:189], v3 offset:10304
    v_mfma_f32_16x16x32_bf16 v[80:83], v[172:175], v[108:111], v[80:83]
    ds_read_b64_tr_b16 v[190:191], v3 offset:15424
    s_waitcnt lgkmcnt(4)
    v_mfma_f32_16x16x32_bf16 v[48:51], v[176:179], v[104:107], v[48:51]
    ds_read_b64_tr_b16 v[168:169], v4 offset:10304
    v_mfma_f32_16x16x32_bf16 v[84:87], v[176:179], v[108:111], v[84:87]
    ds_read_b64_tr_b16 v[170:171], v4 offset:15424
    v_mfma_f32_16x16x32_bf16 v[16:19], v[180:183], v[112:115], v[16:19]
    ds_read_b64_tr_b16 v[172:173], v3 offset:10368
    v_mfma_f32_16x16x32_bf16 v[52:55], v[180:183], v[116:119], v[52:55]
    ds_read_b64_tr_b16 v[174:175], v3 offset:15488
    s_mov_b32 s46, 45056
    s_waitcnt lgkmcnt(4)
    v_mfma_f32_16x16x32_bf16 v[20:23], v[184:187], v[112:115], v[20:23]
    ds_read_b64_tr_b16 v[176:177], v4 offset:10368
    v_mfma_f32_16x16x32_bf16 v[56:59], v[184:187], v[116:119], v[56:59]
    ds_read_b64_tr_b16 v[178:179], v4 offset:15488
    buffer_load_dwordx4 v[104:107], v9, s[28:31], s46 offen offset:0 sc1
    v_mfma_f32_16x16x32_bf16 v[24:27], v[188:191], v[112:115], v[24:27]
    ds_read_b64_tr_b16 v[180:181], v3 offset:10432
    v_mfma_f32_16x16x32_bf16 v[60:63], v[188:191], v[116:119], v[60:63]
    ds_read_b64_tr_b16 v[182:183], v3 offset:15552
    buffer_load_dwordx4 v[108:111], v9, s[28:31], s46 offen offset:1024 sc1
    s_waitcnt lgkmcnt(4)
    v_mfma_f32_16x16x32_bf16 v[28:31], v[168:171], v[112:115], v[28:31]
    ds_read_b64_tr_b16 v[184:185], v4 offset:10432
    v_mfma_f32_16x16x32_bf16 v[64:67], v[168:171], v[116:119], v[64:67]
    ds_read_b64_tr_b16 v[186:187], v4 offset:15552
    v_mfma_f32_16x16x32_bf16 v[32:35], v[172:175], v[112:115], v[32:35]
    ds_read_b64_tr_b16 v[188:189], v3 offset:10496
    v_mfma_f32_16x16x32_bf16 v[68:71], v[172:175], v[116:119], v[68:71]
    ds_read_b64_tr_b16 v[190:191], v3 offset:15616
    s_waitcnt lgkmcnt(4)
    v_mfma_f32_16x16x32_bf16 v[36:39], v[176:179], v[112:115], v[36:39]
    ds_read_b64_tr_b16 v[168:169], v3 offset:20480
    v_mfma_f32_16x16x32_bf16 v[72:75], v[176:179], v[116:119], v[72:75]
    ds_read_b64_tr_b16 v[170:171], v3 offset:25600
    v_mfma_f32_16x16x32_bf16 v[40:43], v[180:183], v[112:115], v[40:43]
    ds_read_b64_tr_b16 v[172:173], v4 offset:20480
    v_mfma_f32_16x16x32_bf16 v[76:79], v[180:183], v[116:119], v[76:79]
    ds_read_b64_tr_b16 v[174:175], v4 offset:25600
    s_waitcnt lgkmcnt(4)
    v_mfma_f32_16x16x32_bf16 v[44:47], v[184:187], v[112:115], v[44:47]
    ds_read_b64_tr_b16 v[176:177], v3 offset:20544
    v_mfma_f32_16x16x32_bf16 v[80:83], v[184:187], v[116:119], v[80:83]
    ds_read_b64_tr_b16 v[178:179], v3 offset:25664
    v_mfma_f32_16x16x32_bf16 v[48:51], v[188:191], v[112:115], v[48:51]
    ds_read_b64_tr_b16 v[180:181], v4 offset:20544
    v_mfma_f32_16x16x32_bf16 v[84:87], v[188:191], v[116:119], v[84:87]
    ds_read_b64_tr_b16 v[182:183], v4 offset:25664
    s_waitcnt lgkmcnt(4)
    v_mfma_f32_16x16x32_bf16 v[16:19], v[168:171], v[120:123], v[16:19]
    ds_read_b64_tr_b16 v[184:185], v3 offset:20608
    v_mfma_f32_16x16x32_bf16 v[52:55], v[168:171], v[124:127], v[52:55]
    ds_read_b64_tr_b16 v[186:187], v3 offset:25728
    s_mov_b32 s46, 45056
    v_mfma_f32_16x16x32_bf16 v[20:23], v[172:175], v[120:123], v[20:23]
    ds_read_b64_tr_b16 v[188:189], v4 offset:20608
    v_mfma_f32_16x16x32_bf16 v[56:59], v[172:175], v[124:127], v[56:59]
    ds_read_b64_tr_b16 v[190:191], v4 offset:25728
    buffer_load_dwordx4 v[112:115], v9, s[28:31], s46 offen offset:2048 sc1
    s_waitcnt lgkmcnt(4)
    v_mfma_f32_16x16x32_bf16 v[24:27], v[176:179], v[120:123], v[24:27]
    ds_read_b64_tr_b16 v[168:169], v3 offset:20672
    v_mfma_f32_16x16x32_bf16 v[60:63], v[176:179], v[124:127], v[60:63]
    ds_read_b64_tr_b16 v[170:171], v3 offset:25792
    buffer_load_dwordx4 v[116:119], v9, s[28:31], s46 offen offset:3072 sc1
    v_mfma_f32_16x16x32_bf16 v[28:31], v[180:183], v[120:123], v[28:31]
    ds_read_b64_tr_b16 v[172:173], v4 offset:20672
    v_mfma_f32_16x16x32_bf16 v[64:67], v[180:183], v[124:127], v[64:67]
    ds_read_b64_tr_b16 v[174:175], v4 offset:25792
    s_waitcnt lgkmcnt(4)
    v_mfma_f32_16x16x32_bf16 v[32:35], v[184:187], v[120:123], v[32:35]
    ds_read_b64_tr_b16 v[176:177], v3 offset:20736
    v_mfma_f32_16x16x32_bf16 v[68:71], v[184:187], v[124:127], v[68:71]
    ds_read_b64_tr_b16 v[178:179], v3 offset:25856
    v_mfma_f32_16x16x32_bf16 v[36:39], v[188:191], v[120:123], v[36:39]
    ds_read_b64_tr_b16 v[180:181], v3 offset:30720
    v_mfma_f32_16x16x32_bf16 v[72:75], v[188:191], v[124:127], v[72:75]
    ds_read_b64_tr_b16 v[182:183], v3 offset:35840
    s_waitcnt lgkmcnt(4)
    v_mfma_f32_16x16x32_bf16 v[40:43], v[168:171], v[120:123], v[40:43]
    ds_read_b64_tr_b16 v[184:185], v4 offset:30720
    v_mfma_f32_16x16x32_bf16 v[76:79], v[168:171], v[124:127], v[76:79]
    ds_read_b64_tr_b16 v[186:187], v4 offset:35840
    v_mfma_f32_16x16x32_bf16 v[44:47], v[172:175], v[120:123], v[44:47]
    ds_read_b64_tr_b16 v[188:189], v3 offset:30784
    v_mfma_f32_16x16x32_bf16 v[80:83], v[172:175], v[124:127], v[80:83]
    ds_read_b64_tr_b16 v[190:191], v3 offset:35904
    s_waitcnt lgkmcnt(4)
    v_mfma_f32_16x16x32_bf16 v[48:51], v[176:179], v[120:123], v[48:51]
    ds_read_b64_tr_b16 v[168:169], v4 offset:30784
    v_mfma_f32_16x16x32_bf16 v[84:87], v[176:179], v[124:127], v[84:87]
    ds_read_b64_tr_b16 v[170:171], v4 offset:35904
    s_waitcnt vmcnt(16)
    v_mfma_f32_16x16x32_bf16 v[16:19], v[180:183], v[128:131], v[16:19]
    ds_read_b64_tr_b16 v[172:173], v3 offset:30848
    v_mfma_f32_16x16x32_bf16 v[52:55], v[180:183], v[132:135], v[52:55]
    ds_read_b64_tr_b16 v[174:175], v3 offset:35968
    s_mov_b32 s46, 49152
    s_waitcnt lgkmcnt(4)
    v_mfma_f32_16x16x32_bf16 v[20:23], v[184:187], v[128:131], v[20:23]
    ds_read_b64_tr_b16 v[176:177], v4 offset:30848
    v_mfma_f32_16x16x32_bf16 v[56:59], v[184:187], v[132:135], v[56:59]
    ds_read_b64_tr_b16 v[178:179], v4 offset:35968
    buffer_load_dwordx4 v[120:123], v9, s[28:31], s46 offen offset:0 sc1
    v_mfma_f32_16x16x32_bf16 v[24:27], v[188:191], v[128:131], v[24:27]
    ds_read_b64_tr_b16 v[180:181], v3 offset:30912
    v_mfma_f32_16x16x32_bf16 v[60:63], v[188:191], v[132:135], v[60:63]
    ds_read_b64_tr_b16 v[182:183], v3 offset:36032
    buffer_load_dwordx4 v[124:127], v9, s[28:31], s46 offen offset:1024 sc1
    s_waitcnt lgkmcnt(4)
    v_mfma_f32_16x16x32_bf16 v[28:31], v[168:171], v[128:131], v[28:31]
    ds_read_b64_tr_b16 v[184:185], v4 offset:30912
    v_mfma_f32_16x16x32_bf16 v[64:67], v[168:171], v[132:135], v[64:67]
    ds_read_b64_tr_b16 v[186:187], v4 offset:36032
    v_mfma_f32_16x16x32_bf16 v[32:35], v[172:175], v[128:131], v[32:35]
    ds_read_b64_tr_b16 v[188:189], v3 offset:30976
    v_mfma_f32_16x16x32_bf16 v[68:71], v[172:175], v[132:135], v[68:71]
    ds_read_b64_tr_b16 v[190:191], v3 offset:36096
    s_waitcnt lgkmcnt(0)
    s_barrier
    v_mfma_f32_16x16x32_bf16 v[36:39], v[176:179], v[128:131], v[36:39]
    ds_read_b64_tr_b16 v[168:169], v5 offset:0
    v_mfma_f32_16x16x32_bf16 v[72:75], v[176:179], v[132:135], v[72:75]
    ds_read_b64_tr_b16 v[170:171], v5 offset:5120
    v_mfma_f32_16x16x32_bf16 v[40:43], v[180:183], v[128:131], v[40:43]
    ds_read_b64_tr_b16 v[172:173], v6 offset:0
    v_mfma_f32_16x16x32_bf16 v[76:79], v[180:183], v[132:135], v[76:79]
    ds_read_b64_tr_b16 v[174:175], v6 offset:5120
    v_mfma_f32_16x16x32_bf16 v[44:47], v[184:187], v[128:131], v[44:47]
    ds_read_b64_tr_b16 v[176:177], v5 offset:64
    v_mfma_f32_16x16x32_bf16 v[80:83], v[184:187], v[132:135], v[80:83]
    ds_read_b64_tr_b16 v[178:179], v5 offset:5184
    v_mfma_f32_16x16x32_bf16 v[48:51], v[188:191], v[128:131], v[48:51]
    ds_read_b64_tr_b16 v[180:181], v6 offset:64
    v_mfma_f32_16x16x32_bf16 v[84:87], v[188:191], v[132:135], v[84:87]
    ds_read_b64_tr_b16 v[182:183], v6 offset:5184
    s_waitcnt vmcnt(16)
    s_waitcnt lgkmcnt(4)
    v_mfma_f32_16x16x32_bf16 v[16:19], v[168:171], v[136:139], v[16:19]
    ds_read_b64_tr_b16 v[184:185], v5 offset:128
    v_mfma_f32_16x16x32_bf16 v[52:55], v[168:171], v[140:143], v[52:55]
    ds_read_b64_tr_b16 v[186:187], v5 offset:5248
    s_mov_b32 s46, 49152
    v_mfma_f32_16x16x32_bf16 v[20:23], v[172:175], v[136:139], v[20:23]
    ds_read_b64_tr_b16 v[188:189], v6 offset:128
    v_mfma_f32_16x16x32_bf16 v[56:59], v[172:175], v[140:143], v[56:59]
    ds_read_b64_tr_b16 v[190:191], v6 offset:5248
    buffer_load_dwordx4 v[128:131], v9, s[28:31], s46 offen offset:2048 sc1
    s_waitcnt lgkmcnt(4)
    v_mfma_f32_16x16x32_bf16 v[24:27], v[176:179], v[136:139], v[24:27]
    ds_read_b64_tr_b16 v[168:169], v5 offset:192
    v_mfma_f32_16x16x32_bf16 v[60:63], v[176:179], v[140:143], v[60:63]
    ds_read_b64_tr_b16 v[170:171], v5 offset:5312
    buffer_load_dwordx4 v[132:135], v9, s[28:31], s46 offen offset:3072 sc1
    v_mfma_f32_16x16x32_bf16 v[28:31], v[180:183], v[136:139], v[28:31]
    ds_read_b64_tr_b16 v[172:173], v6 offset:192
    v_mfma_f32_16x16x32_bf16 v[64:67], v[180:183], v[140:143], v[64:67]
    ds_read_b64_tr_b16 v[174:175], v6 offset:5312
    s_waitcnt lgkmcnt(4)
    v_mfma_f32_16x16x32_bf16 v[32:35], v[184:187], v[136:139], v[32:35]
    ds_read_b64_tr_b16 v[176:177], v5 offset:256
    v_mfma_f32_16x16x32_bf16 v[68:71], v[184:187], v[140:143], v[68:71]
    ds_read_b64_tr_b16 v[178:179], v5 offset:5376
    v_mfma_f32_16x16x32_bf16 v[36:39], v[188:191], v[136:139], v[36:39]
    ds_read_b64_tr_b16 v[180:181], v5 offset:10240
    v_mfma_f32_16x16x32_bf16 v[72:75], v[188:191], v[140:143], v[72:75]
    ds_read_b64_tr_b16 v[182:183], v5 offset:15360
    s_waitcnt lgkmcnt(4)
    v_mfma_f32_16x16x32_bf16 v[40:43], v[168:171], v[136:139], v[40:43]
    ds_read_b64_tr_b16 v[184:185], v6 offset:10240
    v_mfma_f32_16x16x32_bf16 v[76:79], v[168:171], v[140:143], v[76:79]
    ds_read_b64_tr_b16 v[186:187], v6 offset:15360
    v_mfma_f32_16x16x32_bf16 v[44:47], v[172:175], v[136:139], v[44:47]
    ds_read_b64_tr_b16 v[188:189], v5 offset:10304
    v_mfma_f32_16x16x32_bf16 v[80:83], v[172:175], v[140:143], v[80:83]
    ds_read_b64_tr_b16 v[190:191], v5 offset:15424
    s_waitcnt lgkmcnt(4)
    v_mfma_f32_16x16x32_bf16 v[48:51], v[176:179], v[136:139], v[48:51]
    ds_read_b64_tr_b16 v[168:169], v6 offset:10304
    v_mfma_f32_16x16x32_bf16 v[84:87], v[176:179], v[140:143], v[84:87]
    ds_read_b64_tr_b16 v[170:171], v6 offset:15424
    s_waitcnt vmcnt(16)
    v_mfma_f32_16x16x32_bf16 v[16:19], v[180:183], v[144:147], v[16:19]
    ds_read_b64_tr_b16 v[172:173], v5 offset:10368
    v_mfma_f32_16x16x32_bf16 v[52:55], v[180:183], v[148:151], v[52:55]
    ds_read_b64_tr_b16 v[174:175], v5 offset:15488
    s_mov_b32 s46, 53248
    s_waitcnt lgkmcnt(4)
    v_mfma_f32_16x16x32_bf16 v[20:23], v[184:187], v[144:147], v[20:23]
    ds_read_b64_tr_b16 v[176:177], v6 offset:10368
    v_mfma_f32_16x16x32_bf16 v[56:59], v[184:187], v[148:151], v[56:59]
    ds_read_b64_tr_b16 v[178:179], v6 offset:15488
    buffer_load_dwordx4 v[136:139], v9, s[28:31], s46 offen offset:0 sc1
    v_mfma_f32_16x16x32_bf16 v[24:27], v[188:191], v[144:147], v[24:27]
    ds_read_b64_tr_b16 v[180:181], v5 offset:10432
    v_mfma_f32_16x16x32_bf16 v[60:63], v[188:191], v[148:151], v[60:63]
    ds_read_b64_tr_b16 v[182:183], v5 offset:15552
    buffer_load_dwordx4 v[140:143], v9, s[28:31], s46 offen offset:1024 sc1
    s_waitcnt lgkmcnt(4)
    v_mfma_f32_16x16x32_bf16 v[28:31], v[168:171], v[144:147], v[28:31]
    ds_read_b64_tr_b16 v[184:185], v6 offset:10432
    v_mfma_f32_16x16x32_bf16 v[64:67], v[168:171], v[148:151], v[64:67]
    ds_read_b64_tr_b16 v[186:187], v6 offset:15552
    v_mfma_f32_16x16x32_bf16 v[32:35], v[172:175], v[144:147], v[32:35]
    ds_read_b64_tr_b16 v[188:189], v5 offset:10496
    v_mfma_f32_16x16x32_bf16 v[68:71], v[172:175], v[148:151], v[68:71]
    ds_read_b64_tr_b16 v[190:191], v5 offset:15616
    s_waitcnt lgkmcnt(4)
    v_mfma_f32_16x16x32_bf16 v[36:39], v[176:179], v[144:147], v[36:39]
    ds_read_b64_tr_b16 v[168:169], v5 offset:20480
    v_mfma_f32_16x16x32_bf16 v[72:75], v[176:179], v[148:151], v[72:75]
    ds_read_b64_tr_b16 v[170:171], v5 offset:25600
    v_mfma_f32_16x16x32_bf16 v[40:43], v[180:183], v[144:147], v[40:43]
    ds_read_b64_tr_b16 v[172:173], v6 offset:20480
    v_mfma_f32_16x16x32_bf16 v[76:79], v[180:183], v[148:151], v[76:79]
    ds_read_b64_tr_b16 v[174:175], v6 offset:25600
    s_waitcnt lgkmcnt(4)
    v_mfma_f32_16x16x32_bf16 v[44:47], v[184:187], v[144:147], v[44:47]
    ds_read_b64_tr_b16 v[176:177], v5 offset:20544
    v_mfma_f32_16x16x32_bf16 v[80:83], v[184:187], v[148:151], v[80:83]
    ds_read_b64_tr_b16 v[178:179], v5 offset:25664
    v_mfma_f32_16x16x32_bf16 v[48:51], v[188:191], v[144:147], v[48:51]
    ds_read_b64_tr_b16 v[180:181], v6 offset:20544
    v_mfma_f32_16x16x32_bf16 v[84:87], v[188:191], v[148:151], v[84:87]
    ds_read_b64_tr_b16 v[182:183], v6 offset:25664
    s_waitcnt vmcnt(16)
    s_waitcnt lgkmcnt(4)
    v_mfma_f32_16x16x32_bf16 v[16:19], v[168:171], v[152:155], v[16:19]
    ds_read_b64_tr_b16 v[184:185], v5 offset:20608
    v_mfma_f32_16x16x32_bf16 v[52:55], v[168:171], v[156:159], v[52:55]
    ds_read_b64_tr_b16 v[186:187], v5 offset:25728
    s_mov_b32 s46, 53248
    v_mfma_f32_16x16x32_bf16 v[20:23], v[172:175], v[152:155], v[20:23]
    ds_read_b64_tr_b16 v[188:189], v6 offset:20608
    v_mfma_f32_16x16x32_bf16 v[56:59], v[172:175], v[156:159], v[56:59]
    ds_read_b64_tr_b16 v[190:191], v6 offset:25728
    buffer_load_dwordx4 v[144:147], v9, s[28:31], s46 offen offset:2048 sc1
    s_waitcnt lgkmcnt(4)
    v_mfma_f32_16x16x32_bf16 v[24:27], v[176:179], v[152:155], v[24:27]
    ds_read_b64_tr_b16 v[168:169], v5 offset:20672
    v_mfma_f32_16x16x32_bf16 v[60:63], v[176:179], v[156:159], v[60:63]
    ds_read_b64_tr_b16 v[170:171], v5 offset:25792
    buffer_load_dwordx4 v[148:151], v9, s[28:31], s46 offen offset:3072 sc1
    v_mfma_f32_16x16x32_bf16 v[28:31], v[180:183], v[152:155], v[28:31]
    ds_read_b64_tr_b16 v[172:173], v6 offset:20672
    v_mfma_f32_16x16x32_bf16 v[64:67], v[180:183], v[156:159], v[64:67]
    ds_read_b64_tr_b16 v[174:175], v6 offset:25792
    s_waitcnt lgkmcnt(4)
    v_mfma_f32_16x16x32_bf16 v[32:35], v[184:187], v[152:155], v[32:35]
    ds_read_b64_tr_b16 v[176:177], v5 offset:20736
    v_mfma_f32_16x16x32_bf16 v[68:71], v[184:187], v[156:159], v[68:71]
    ds_read_b64_tr_b16 v[178:179], v5 offset:25856
    v_mfma_f32_16x16x32_bf16 v[36:39], v[188:191], v[152:155], v[36:39]
    ds_read_b64_tr_b16 v[180:181], v5 offset:30720
    v_mfma_f32_16x16x32_bf16 v[72:75], v[188:191], v[156:159], v[72:75]
    ds_read_b64_tr_b16 v[182:183], v5 offset:35840
    s_waitcnt lgkmcnt(4)
    v_mfma_f32_16x16x32_bf16 v[40:43], v[168:171], v[152:155], v[40:43]
    ds_read_b64_tr_b16 v[184:185], v6 offset:30720
    v_mfma_f32_16x16x32_bf16 v[76:79], v[168:171], v[156:159], v[76:79]
    ds_read_b64_tr_b16 v[186:187], v6 offset:35840
    v_mfma_f32_16x16x32_bf16 v[44:47], v[172:175], v[152:155], v[44:47]
    ds_read_b64_tr_b16 v[188:189], v5 offset:30784
    v_mfma_f32_16x16x32_bf16 v[80:83], v[172:175], v[156:159], v[80:83]
    ds_read_b64_tr_b16 v[190:191], v5 offset:35904
    s_waitcnt lgkmcnt(4)
    v_mfma_f32_16x16x32_bf16 v[48:51], v[176:179], v[152:155], v[48:51]
    ds_read_b64_tr_b16 v[168:169], v6 offset:30784
    v_mfma_f32_16x16x32_bf16 v[84:87], v[176:179], v[156:159], v[84:87]
    ds_read_b64_tr_b16 v[170:171], v6 offset:35904
    s_waitcnt vmcnt(16)
    v_mfma_f32_16x16x32_bf16 v[16:19], v[180:183], v[160:163], v[16:19]
    ds_read_b64_tr_b16 v[172:173], v5 offset:30848
    v_mfma_f32_16x16x32_bf16 v[52:55], v[180:183], v[164:167], v[52:55]
    ds_read_b64_tr_b16 v[174:175], v5 offset:35968
    s_mov_b32 s46, 57344
    s_waitcnt lgkmcnt(4)
    v_mfma_f32_16x16x32_bf16 v[20:23], v[184:187], v[160:163], v[20:23]
    ds_read_b64_tr_b16 v[176:177], v6 offset:30848
    v_mfma_f32_16x16x32_bf16 v[56:59], v[184:187], v[164:167], v[56:59]
    ds_read_b64_tr_b16 v[178:179], v6 offset:35968
    buffer_load_dwordx4 v[152:155], v9, s[28:31], s46 offen offset:0 sc1
    v_mfma_f32_16x16x32_bf16 v[24:27], v[188:191], v[160:163], v[24:27]
    ds_read_b64_tr_b16 v[180:181], v5 offset:30912
    v_mfma_f32_16x16x32_bf16 v[60:63], v[188:191], v[164:167], v[60:63]
    ds_read_b64_tr_b16 v[182:183], v5 offset:36032
    buffer_load_dwordx4 v[156:159], v9, s[28:31], s46 offen offset:1024 sc1
    s_waitcnt lgkmcnt(4)
    v_mfma_f32_16x16x32_bf16 v[28:31], v[168:171], v[160:163], v[28:31]
    ds_read_b64_tr_b16 v[184:185], v6 offset:30912
    v_mfma_f32_16x16x32_bf16 v[64:67], v[168:171], v[164:167], v[64:67]
    ds_read_b64_tr_b16 v[186:187], v6 offset:36032
    v_mfma_f32_16x16x32_bf16 v[32:35], v[172:175], v[160:163], v[32:35]
    ds_read_b64_tr_b16 v[188:189], v5 offset:30976
    v_mfma_f32_16x16x32_bf16 v[68:71], v[172:175], v[164:167], v[68:71]
    ds_read_b64_tr_b16 v[190:191], v5 offset:36096
    s_waitcnt lgkmcnt(0)
    s_barrier
    v_mfma_f32_16x16x32_bf16 v[36:39], v[176:179], v[160:163], v[36:39]
    ds_read_b64_tr_b16 v[168:169], v7 offset:0
    v_mfma_f32_16x16x32_bf16 v[72:75], v[176:179], v[164:167], v[72:75]
    ds_read_b64_tr_b16 v[170:171], v7 offset:5120
    v_mfma_f32_16x16x32_bf16 v[40:43], v[180:183], v[160:163], v[40:43]
    ds_read_b64_tr_b16 v[172:173], v8 offset:0
    v_mfma_f32_16x16x32_bf16 v[76:79], v[180:183], v[164:167], v[76:79]
    ds_read_b64_tr_b16 v[174:175], v8 offset:5120
    v_mfma_f32_16x16x32_bf16 v[44:47], v[184:187], v[160:163], v[44:47]
    ds_read_b64_tr_b16 v[176:177], v7 offset:64
    v_mfma_f32_16x16x32_bf16 v[80:83], v[184:187], v[164:167], v[80:83]
    ds_read_b64_tr_b16 v[178:179], v7 offset:5184
    v_mfma_f32_16x16x32_bf16 v[48:51], v[188:191], v[160:163], v[48:51]
    ds_read_b64_tr_b16 v[180:181], v8 offset:64
    v_mfma_f32_16x16x32_bf16 v[84:87], v[188:191], v[164:167], v[84:87]
    ds_read_b64_tr_b16 v[182:183], v8 offset:5184
    s_waitcnt vmcnt(16)
    s_waitcnt lgkmcnt(4)
    v_mfma_f32_16x16x32_bf16 v[16:19], v[168:171], v[88:91], v[16:19]
    ds_read_b64_tr_b16 v[184:185], v7 offset:128
    v_mfma_f32_16x16x32_bf16 v[52:55], v[168:171], v[92:95], v[52:55]
    ds_read_b64_tr_b16 v[186:187], v7 offset:5248
    s_mov_b32 s46, 57344
    v_mfma_f32_16x16x32_bf16 v[20:23], v[172:175], v[88:91], v[20:23]
    ds_read_b64_tr_b16 v[188:189], v8 offset:128
    v_mfma_f32_16x16x32_bf16 v[56:59], v[172:175], v[92:95], v[56:59]
    ds_read_b64_tr_b16 v[190:191], v8 offset:5248
    buffer_load_dwordx4 v[160:163], v9, s[28:31], s46 offen offset:2048 sc1
    s_waitcnt lgkmcnt(4)
    v_mfma_f32_16x16x32_bf16 v[24:27], v[176:179], v[88:91], v[24:27]
    ds_read_b64_tr_b16 v[168:169], v7 offset:192
    v_mfma_f32_16x16x32_bf16 v[60:63], v[176:179], v[92:95], v[60:63]
    ds_read_b64_tr_b16 v[170:171], v7 offset:5312
    buffer_load_dwordx4 v[164:167], v9, s[28:31], s46 offen offset:3072 sc1
    v_mfma_f32_16x16x32_bf16 v[28:31], v[180:183], v[88:91], v[28:31]
    ds_read_b64_tr_b16 v[172:173], v8 offset:192
    v_mfma_f32_16x16x32_bf16 v[64:67], v[180:183], v[92:95], v[64:67]
    ds_read_b64_tr_b16 v[174:175], v8 offset:5312
    s_waitcnt lgkmcnt(4)
    v_mfma_f32_16x16x32_bf16 v[32:35], v[184:187], v[88:91], v[32:35]
    ds_read_b64_tr_b16 v[176:177], v7 offset:256
    v_mfma_f32_16x16x32_bf16 v[68:71], v[184:187], v[92:95], v[68:71]
    ds_read_b64_tr_b16 v[178:179], v7 offset:5376
    v_mfma_f32_16x16x32_bf16 v[36:39], v[188:191], v[88:91], v[36:39]
    ds_read_b64_tr_b16 v[180:181], v7 offset:10240
    v_mfma_f32_16x16x32_bf16 v[72:75], v[188:191], v[92:95], v[72:75]
    ds_read_b64_tr_b16 v[182:183], v7 offset:15360
    s_waitcnt lgkmcnt(4)
    v_mfma_f32_16x16x32_bf16 v[40:43], v[168:171], v[88:91], v[40:43]
    ds_read_b64_tr_b16 v[184:185], v8 offset:10240
    v_mfma_f32_16x16x32_bf16 v[76:79], v[168:171], v[92:95], v[76:79]
    ds_read_b64_tr_b16 v[186:187], v8 offset:15360
    v_mfma_f32_16x16x32_bf16 v[44:47], v[172:175], v[88:91], v[44:47]
    ds_read_b64_tr_b16 v[188:189], v7 offset:10304
    v_mfma_f32_16x16x32_bf16 v[80:83], v[172:175], v[92:95], v[80:83]
    ds_read_b64_tr_b16 v[190:191], v7 offset:15424
    s_waitcnt lgkmcnt(4)
    v_mfma_f32_16x16x32_bf16 v[48:51], v[176:179], v[88:91], v[48:51]
    ds_read_b64_tr_b16 v[168:169], v8 offset:10304
    v_mfma_f32_16x16x32_bf16 v[84:87], v[176:179], v[92:95], v[84:87]
    ds_read_b64_tr_b16 v[170:171], v8 offset:15424
    s_waitcnt vmcnt(16)
    v_mfma_f32_16x16x32_bf16 v[16:19], v[180:183], v[96:99], v[16:19]
    ds_read_b64_tr_b16 v[172:173], v7 offset:10368
    v_mfma_f32_16x16x32_bf16 v[52:55], v[180:183], v[100:103], v[52:55]
    ds_read_b64_tr_b16 v[174:175], v7 offset:15488
    s_mov_b32 s46, 61440
    s_waitcnt lgkmcnt(4)
    v_mfma_f32_16x16x32_bf16 v[20:23], v[184:187], v[96:99], v[20:23]
    ds_read_b64_tr_b16 v[176:177], v8 offset:10368
    v_mfma_f32_16x16x32_bf16 v[56:59], v[184:187], v[100:103], v[56:59]
    ds_read_b64_tr_b16 v[178:179], v8 offset:15488
    buffer_load_dwordx4 v[88:91], v9, s[28:31], s46 offen offset:0 sc1
    v_mfma_f32_16x16x32_bf16 v[24:27], v[188:191], v[96:99], v[24:27]
    ds_read_b64_tr_b16 v[180:181], v7 offset:10432
    v_mfma_f32_16x16x32_bf16 v[60:63], v[188:191], v[100:103], v[60:63]
    ds_read_b64_tr_b16 v[182:183], v7 offset:15552
    buffer_load_dwordx4 v[92:95], v9, s[28:31], s46 offen offset:1024 sc1
    s_waitcnt lgkmcnt(4)
    v_mfma_f32_16x16x32_bf16 v[28:31], v[168:171], v[96:99], v[28:31]
    ds_read_b64_tr_b16 v[184:185], v8 offset:10432
    v_mfma_f32_16x16x32_bf16 v[64:67], v[168:171], v[100:103], v[64:67]
    ds_read_b64_tr_b16 v[186:187], v8 offset:15552
    v_mfma_f32_16x16x32_bf16 v[32:35], v[172:175], v[96:99], v[32:35]
    ds_read_b64_tr_b16 v[188:189], v7 offset:10496
    v_mfma_f32_16x16x32_bf16 v[68:71], v[172:175], v[100:103], v[68:71]
    ds_read_b64_tr_b16 v[190:191], v7 offset:15616
    s_waitcnt lgkmcnt(4)
    v_mfma_f32_16x16x32_bf16 v[36:39], v[176:179], v[96:99], v[36:39]
    ds_read_b64_tr_b16 v[168:169], v7 offset:20480
    v_mfma_f32_16x16x32_bf16 v[72:75], v[176:179], v[100:103], v[72:75]
    ds_read_b64_tr_b16 v[170:171], v7 offset:25600
    v_mfma_f32_16x16x32_bf16 v[40:43], v[180:183], v[96:99], v[40:43]
    ds_read_b64_tr_b16 v[172:173], v8 offset:20480
    v_mfma_f32_16x16x32_bf16 v[76:79], v[180:183], v[100:103], v[76:79]
    ds_read_b64_tr_b16 v[174:175], v8 offset:25600
    s_waitcnt lgkmcnt(4)
    v_mfma_f32_16x16x32_bf16 v[44:47], v[184:187], v[96:99], v[44:47]
    ds_read_b64_tr_b16 v[176:177], v7 offset:20544
    v_mfma_f32_16x16x32_bf16 v[80:83], v[184:187], v[100:103], v[80:83]
    ds_read_b64_tr_b16 v[178:179], v7 offset:25664
    v_mfma_f32_16x16x32_bf16 v[48:51], v[188:191], v[96:99], v[48:51]
    ds_read_b64_tr_b16 v[180:181], v8 offset:20544
    v_mfma_f32_16x16x32_bf16 v[84:87], v[188:191], v[100:103], v[84:87]
    ds_read_b64_tr_b16 v[182:183], v8 offset:25664
    s_waitcnt vmcnt(16)
    s_waitcnt lgkmcnt(4)
    v_mfma_f32_16x16x32_bf16 v[16:19], v[168:171], v[104:107], v[16:19]
    ds_read_b64_tr_b16 v[184:185], v7 offset:20608
    v_mfma_f32_16x16x32_bf16 v[52:55], v[168:171], v[108:111], v[52:55]
    ds_read_b64_tr_b16 v[186:187], v7 offset:25728
    s_mov_b32 s46, 61440
    v_mfma_f32_16x16x32_bf16 v[20:23], v[172:175], v[104:107], v[20:23]
    ds_read_b64_tr_b16 v[188:189], v8 offset:20608
    v_mfma_f32_16x16x32_bf16 v[56:59], v[172:175], v[108:111], v[56:59]
    ds_read_b64_tr_b16 v[190:191], v8 offset:25728
    buffer_load_dwordx4 v[96:99], v9, s[28:31], s46 offen offset:2048 sc1
    s_waitcnt lgkmcnt(4)
    v_mfma_f32_16x16x32_bf16 v[24:27], v[176:179], v[104:107], v[24:27]
    ds_read_b64_tr_b16 v[168:169], v7 offset:20672
    v_mfma_f32_16x16x32_bf16 v[60:63], v[176:179], v[108:111], v[60:63]
    ds_read_b64_tr_b16 v[170:171], v7 offset:25792
    buffer_load_dwordx4 v[100:103], v9, s[28:31], s46 offen offset:3072 sc1
    v_mfma_f32_16x16x32_bf16 v[28:31], v[180:183], v[104:107], v[28:31]
    ds_read_b64_tr_b16 v[172:173], v8 offset:20672
    v_mfma_f32_16x16x32_bf16 v[64:67], v[180:183], v[108:111], v[64:67]
    ds_read_b64_tr_b16 v[174:175], v8 offset:25792
    s_waitcnt lgkmcnt(4)
    v_mfma_f32_16x16x32_bf16 v[32:35], v[184:187], v[104:107], v[32:35]
    ds_read_b64_tr_b16 v[176:177], v7 offset:20736
    v_mfma_f32_16x16x32_bf16 v[68:71], v[184:187], v[108:111], v[68:71]
    ds_read_b64_tr_b16 v[178:179], v7 offset:25856
    v_mfma_f32_16x16x32_bf16 v[36:39], v[188:191], v[104:107], v[36:39]
    ds_read_b64_tr_b16 v[180:181], v7 offset:30720
    v_mfma_f32_16x16x32_bf16 v[72:75], v[188:191], v[108:111], v[72:75]
    ds_read_b64_tr_b16 v[182:183], v7 offset:35840
    s_waitcnt lgkmcnt(4)
    v_mfma_f32_16x16x32_bf16 v[40:43], v[168:171], v[104:107], v[40:43]
    ds_read_b64_tr_b16 v[184:185], v8 offset:30720
    v_mfma_f32_16x16x32_bf16 v[76:79], v[168:171], v[108:111], v[76:79]
    ds_read_b64_tr_b16 v[186:187], v8 offset:35840
    v_mfma_f32_16x16x32_bf16 v[44:47], v[172:175], v[104:107], v[44:47]
    ds_read_b64_tr_b16 v[188:189], v7 offset:30784
    v_mfma_f32_16x16x32_bf16 v[80:83], v[172:175], v[108:111], v[80:83]
    ds_read_b64_tr_b16 v[190:191], v7 offset:35904
    s_waitcnt lgkmcnt(4)
    v_mfma_f32_16x16x32_bf16 v[48:51], v[176:179], v[104:107], v[48:51]
    ds_read_b64_tr_b16 v[168:169], v8 offset:30784
    v_mfma_f32_16x16x32_bf16 v[84:87], v[176:179], v[108:111], v[84:87]
    ds_read_b64_tr_b16 v[170:171], v8 offset:35904
    s_waitcnt vmcnt(16)
    v_mfma_f32_16x16x32_bf16 v[16:19], v[180:183], v[112:115], v[16:19]
    ds_read_b64_tr_b16 v[172:173], v7 offset:30848
    v_mfma_f32_16x16x32_bf16 v[52:55], v[180:183], v[116:119], v[52:55]
    ds_read_b64_tr_b16 v[174:175], v7 offset:35968
    s_mov_b32 s46, 65536
    s_waitcnt lgkmcnt(4)
    v_mfma_f32_16x16x32_bf16 v[20:23], v[184:187], v[112:115], v[20:23]
    ds_read_b64_tr_b16 v[176:177], v8 offset:30848
    v_mfma_f32_16x16x32_bf16 v[56:59], v[184:187], v[116:119], v[56:59]
    ds_read_b64_tr_b16 v[178:179], v8 offset:35968
    buffer_load_dwordx4 v[104:107], v9, s[28:31], s46 offen offset:0 sc1
    v_mfma_f32_16x16x32_bf16 v[24:27], v[188:191], v[112:115], v[24:27]
    ds_read_b64_tr_b16 v[180:181], v7 offset:30912
    v_mfma_f32_16x16x32_bf16 v[60:63], v[188:191], v[116:119], v[60:63]
    ds_read_b64_tr_b16 v[182:183], v7 offset:36032
    buffer_load_dwordx4 v[108:111], v9, s[28:31], s46 offen offset:1024 sc1
    s_waitcnt lgkmcnt(4)
    v_mfma_f32_16x16x32_bf16 v[28:31], v[168:171], v[112:115], v[28:31]
    ds_read_b64_tr_b16 v[184:185], v8 offset:30912
    v_mfma_f32_16x16x32_bf16 v[64:67], v[168:171], v[116:119], v[64:67]
    ds_read_b64_tr_b16 v[186:187], v8 offset:36032
    v_mfma_f32_16x16x32_bf16 v[32:35], v[172:175], v[112:115], v[32:35]
    ds_read_b64_tr_b16 v[188:189], v7 offset:30976
    v_mfma_f32_16x16x32_bf16 v[68:71], v[172:175], v[116:119], v[68:71]
    ds_read_b64_tr_b16 v[190:191], v7 offset:36096
    s_waitcnt lgkmcnt(0)
    s_barrier
    v_mfma_f32_16x16x32_bf16 v[36:39], v[176:179], v[112:115], v[36:39]
    ds_read_b64_tr_b16 v[168:169], v3 offset:0
    v_mfma_f32_16x16x32_bf16 v[72:75], v[176:179], v[116:119], v[72:75]
    ds_read_b64_tr_b16 v[170:171], v3 offset:5120
    v_mfma_f32_16x16x32_bf16 v[40:43], v[180:183], v[112:115], v[40:43]
    ds_read_b64_tr_b16 v[172:173], v4 offset:0
    v_mfma_f32_16x16x32_bf16 v[76:79], v[180:183], v[116:119], v[76:79]
    ds_read_b64_tr_b16 v[174:175], v4 offset:5120
    v_mfma_f32_16x16x32_bf16 v[44:47], v[184:187], v[112:115], v[44:47]
    ds_read_b64_tr_b16 v[176:177], v3 offset:64
    v_mfma_f32_16x16x32_bf16 v[80:83], v[184:187], v[116:119], v[80:83]
    ds_read_b64_tr_b16 v[178:179], v3 offset:5184
    v_mfma_f32_16x16x32_bf16 v[48:51], v[188:191], v[112:115], v[48:51]
    ds_read_b64_tr_b16 v[180:181], v4 offset:64
    v_mfma_f32_16x16x32_bf16 v[84:87], v[188:191], v[116:119], v[84:87]
    ds_read_b64_tr_b16 v[182:183], v4 offset:5184
    s_waitcnt vmcnt(16)
    s_waitcnt lgkmcnt(4)
    v_mfma_f32_16x16x32_bf16 v[16:19], v[168:171], v[120:123], v[16:19]
    ds_read_b64_tr_b16 v[184:185], v3 offset:128
    v_mfma_f32_16x16x32_bf16 v[52:55], v[168:171], v[124:127], v[52:55]
    ds_read_b64_tr_b16 v[186:187], v3 offset:5248
    s_mov_b32 s46, 65536
    v_mfma_f32_16x16x32_bf16 v[20:23], v[172:175], v[120:123], v[20:23]
    ds_read_b64_tr_b16 v[188:189], v4 offset:128
    v_mfma_f32_16x16x32_bf16 v[56:59], v[172:175], v[124:127], v[56:59]
    ds_read_b64_tr_b16 v[190:191], v4 offset:5248
    buffer_load_dwordx4 v[112:115], v9, s[28:31], s46 offen offset:2048 sc1
    s_waitcnt lgkmcnt(4)
    v_mfma_f32_16x16x32_bf16 v[24:27], v[176:179], v[120:123], v[24:27]
    ds_read_b64_tr_b16 v[168:169], v3 offset:192
    v_mfma_f32_16x16x32_bf16 v[60:63], v[176:179], v[124:127], v[60:63]
    ds_read_b64_tr_b16 v[170:171], v3 offset:5312
    buffer_load_dwordx4 v[116:119], v9, s[28:31], s46 offen offset:3072 sc1
    v_mfma_f32_16x16x32_bf16 v[28:31], v[180:183], v[120:123], v[28:31]
    ds_read_b64_tr_b16 v[172:173], v4 offset:192
    v_mfma_f32_16x16x32_bf16 v[64:67], v[180:183], v[124:127], v[64:67]
    ds_read_b64_tr_b16 v[174:175], v4 offset:5312
    s_waitcnt lgkmcnt(4)
    v_mfma_f32_16x16x32_bf16 v[32:35], v[184:187], v[120:123], v[32:35]
    ds_read_b64_tr_b16 v[176:177], v3 offset:256
    v_mfma_f32_16x16x32_bf16 v[68:71], v[184:187], v[124:127], v[68:71]
    ds_read_b64_tr_b16 v[178:179], v3 offset:5376
    v_mfma_f32_16x16x32_bf16 v[36:39], v[188:191], v[120:123], v[36:39]
    ds_read_b64_tr_b16 v[180:181], v3 offset:10240
    v_mfma_f32_16x16x32_bf16 v[72:75], v[188:191], v[124:127], v[72:75]
    ds_read_b64_tr_b16 v[182:183], v3 offset:15360
    s_waitcnt lgkmcnt(4)
    v_mfma_f32_16x16x32_bf16 v[40:43], v[168:171], v[120:123], v[40:43]
    ds_read_b64_tr_b16 v[184:185], v4 offset:10240
    v_mfma_f32_16x16x32_bf16 v[76:79], v[168:171], v[124:127], v[76:79]
    ds_read_b64_tr_b16 v[186:187], v4 offset:15360
    v_mfma_f32_16x16x32_bf16 v[44:47], v[172:175], v[120:123], v[44:47]
    ds_read_b64_tr_b16 v[188:189], v3 offset:10304
    v_mfma_f32_16x16x32_bf16 v[80:83], v[172:175], v[124:127], v[80:83]
    ds_read_b64_tr_b16 v[190:191], v3 offset:15424
    s_waitcnt lgkmcnt(4)
    v_mfma_f32_16x16x32_bf16 v[48:51], v[176:179], v[120:123], v[48:51]
    ds_read_b64_tr_b16 v[168:169], v4 offset:10304
    v_mfma_f32_16x16x32_bf16 v[84:87], v[176:179], v[124:127], v[84:87]
    ds_read_b64_tr_b16 v[170:171], v4 offset:15424
    s_waitcnt vmcnt(16)
    v_mfma_f32_16x16x32_bf16 v[16:19], v[180:183], v[128:131], v[16:19]
    ds_read_b64_tr_b16 v[172:173], v3 offset:10368
    v_mfma_f32_16x16x32_bf16 v[52:55], v[180:183], v[132:135], v[52:55]
    ds_read_b64_tr_b16 v[174:175], v3 offset:15488
    s_mov_b32 s46, 69632
    s_waitcnt lgkmcnt(4)
    v_mfma_f32_16x16x32_bf16 v[20:23], v[184:187], v[128:131], v[20:23]
    ds_read_b64_tr_b16 v[176:177], v4 offset:10368
    v_mfma_f32_16x16x32_bf16 v[56:59], v[184:187], v[132:135], v[56:59]
    ds_read_b64_tr_b16 v[178:179], v4 offset:15488
    buffer_load_dwordx4 v[120:123], v9, s[28:31], s46 offen offset:0 sc1
    v_mfma_f32_16x16x32_bf16 v[24:27], v[188:191], v[128:131], v[24:27]
    ds_read_b64_tr_b16 v[180:181], v3 offset:10432
    v_mfma_f32_16x16x32_bf16 v[60:63], v[188:191], v[132:135], v[60:63]
    ds_read_b64_tr_b16 v[182:183], v3 offset:15552
    buffer_load_dwordx4 v[124:127], v9, s[28:31], s46 offen offset:1024 sc1
    s_waitcnt lgkmcnt(4)
    v_mfma_f32_16x16x32_bf16 v[28:31], v[168:171], v[128:131], v[28:31]
    ds_read_b64_tr_b16 v[184:185], v4 offset:10432
    v_mfma_f32_16x16x32_bf16 v[64:67], v[168:171], v[132:135], v[64:67]
    ds_read_b64_tr_b16 v[186:187], v4 offset:15552
    v_mfma_f32_16x16x32_bf16 v[32:35], v[172:175], v[128:131], v[32:35]
    ds_read_b64_tr_b16 v[188:189], v3 offset:10496
    v_mfma_f32_16x16x32_bf16 v[68:71], v[172:175], v[132:135], v[68:71]
    ds_read_b64_tr_b16 v[190:191], v3 offset:15616
    s_waitcnt lgkmcnt(4)
    v_mfma_f32_16x16x32_bf16 v[36:39], v[176:179], v[128:131], v[36:39]
    ds_read_b64_tr_b16 v[168:169], v3 offset:20480
    v_mfma_f32_16x16x32_bf16 v[72:75], v[176:179], v[132:135], v[72:75]
    ds_read_b64_tr_b16 v[170:171], v3 offset:25600
    v_mfma_f32_16x16x32_bf16 v[40:43], v[180:183], v[128:131], v[40:43]
    ds_read_b64_tr_b16 v[172:173], v4 offset:20480
    v_mfma_f32_16x16x32_bf16 v[76:79], v[180:183], v[132:135], v[76:79]
    ds_read_b64_tr_b16 v[174:175], v4 offset:25600
    s_waitcnt lgkmcnt(4)
    v_mfma_f32_16x16x32_bf16 v[44:47], v[184:187], v[128:131], v[44:47]
    ds_read_b64_tr_b16 v[176:177], v3 offset:20544
    v_mfma_f32_16x16x32_bf16 v[80:83], v[184:187], v[132:135], v[80:83]
    ds_read_b64_tr_b16 v[178:179], v3 offset:25664
    v_mfma_f32_16x16x32_bf16 v[48:51], v[188:191], v[128:131], v[48:51]
    ds_read_b64_tr_b16 v[180:181], v4 offset:20544
    v_mfma_f32_16x16x32_bf16 v[84:87], v[188:191], v[132:135], v[84:87]
    ds_read_b64_tr_b16 v[182:183], v4 offset:25664
    s_waitcnt vmcnt(16)
    s_waitcnt lgkmcnt(4)
    v_mfma_f32_16x16x32_bf16 v[16:19], v[168:171], v[136:139], v[16:19]
    ds_read_b64_tr_b16 v[184:185], v3 offset:20608
    v_mfma_f32_16x16x32_bf16 v[52:55], v[168:171], v[140:143], v[52:55]
    ds_read_b64_tr_b16 v[186:187], v3 offset:25728
    s_mov_b32 s46, 69632
    v_mfma_f32_16x16x32_bf16 v[20:23], v[172:175], v[136:139], v[20:23]
    ds_read_b64_tr_b16 v[188:189], v4 offset:20608
    v_mfma_f32_16x16x32_bf16 v[56:59], v[172:175], v[140:143], v[56:59]
    ds_read_b64_tr_b16 v[190:191], v4 offset:25728
    buffer_load_dwordx4 v[128:131], v9, s[28:31], s46 offen offset:2048 sc1
    s_waitcnt lgkmcnt(4)
    v_mfma_f32_16x16x32_bf16 v[24:27], v[176:179], v[136:139], v[24:27]
    ds_read_b64_tr_b16 v[168:169], v3 offset:20672
    v_mfma_f32_16x16x32_bf16 v[60:63], v[176:179], v[140:143], v[60:63]
    ds_read_b64_tr_b16 v[170:171], v3 offset:25792
    buffer_load_dwordx4 v[132:135], v9, s[28:31], s46 offen offset:3072 sc1
    v_mfma_f32_16x16x32_bf16 v[28:31], v[180:183], v[136:139], v[28:31]
    ds_read_b64_tr_b16 v[172:173], v4 offset:20672
    v_mfma_f32_16x16x32_bf16 v[64:67], v[180:183], v[140:143], v[64:67]
    ds_read_b64_tr_b16 v[174:175], v4 offset:25792
    s_waitcnt lgkmcnt(4)
    v_mfma_f32_16x16x32_bf16 v[32:35], v[184:187], v[136:139], v[32:35]
    ds_read_b64_tr_b16 v[176:177], v3 offset:20736
    v_mfma_f32_16x16x32_bf16 v[68:71], v[184:187], v[140:143], v[68:71]
    ds_read_b64_tr_b16 v[178:179], v3 offset:25856
    v_mfma_f32_16x16x32_bf16 v[36:39], v[188:191], v[136:139], v[36:39]
    ds_read_b64_tr_b16 v[180:181], v3 offset:30720
    v_mfma_f32_16x16x32_bf16 v[72:75], v[188:191], v[140:143], v[72:75]
    ds_read_b64_tr_b16 v[182:183], v3 offset:35840
    s_waitcnt lgkmcnt(4)
    v_mfma_f32_16x16x32_bf16 v[40:43], v[168:171], v[136:139], v[40:43]
    ds_read_b64_tr_b16 v[184:185], v4 offset:30720
    v_mfma_f32_16x16x32_bf16 v[76:79], v[168:171], v[140:143], v[76:79]
    ds_read_b64_tr_b16 v[186:187], v4 offset:35840
    v_mfma_f32_16x16x32_bf16 v[44:47], v[172:175], v[136:139], v[44:47]
    ds_read_b64_tr_b16 v[188:189], v3 offset:30784
    v_mfma_f32_16x16x32_bf16 v[80:83], v[172:175], v[140:143], v[80:83]
    ds_read_b64_tr_b16 v[190:191], v3 offset:35904
    s_waitcnt lgkmcnt(4)
    v_mfma_f32_16x16x32_bf16 v[48:51], v[176:179], v[136:139], v[48:51]
    ds_read_b64_tr_b16 v[168:169], v4 offset:30784
    v_mfma_f32_16x16x32_bf16 v[84:87], v[176:179], v[140:143], v[84:87]
    ds_read_b64_tr_b16 v[170:171], v4 offset:35904
    s_waitcnt vmcnt(16)
    v_mfma_f32_16x16x32_bf16 v[16:19], v[180:183], v[144:147], v[16:19]
    ds_read_b64_tr_b16 v[172:173], v3 offset:30848
    v_mfma_f32_16x16x32_bf16 v[52:55], v[180:183], v[148:151], v[52:55]
    ds_read_b64_tr_b16 v[174:175], v3 offset:35968
    s_waitcnt lgkmcnt(4)
    v_mfma_f32_16x16x32_bf16 v[20:23], v[184:187], v[144:147], v[20:23]
    ds_read_b64_tr_b16 v[176:177], v4 offset:30848
    v_mfma_f32_16x16x32_bf16 v[56:59], v[184:187], v[148:151], v[56:59]
    ds_read_b64_tr_b16 v[178:179], v4 offset:35968
    v_mfma_f32_16x16x32_bf16 v[24:27], v[188:191], v[144:147], v[24:27]
    ds_read_b64_tr_b16 v[180:181], v3 offset:30912
    v_mfma_f32_16x16x32_bf16 v[60:63], v[188:191], v[148:151], v[60:63]
    ds_read_b64_tr_b16 v[182:183], v3 offset:36032
    s_waitcnt lgkmcnt(4)
    v_mfma_f32_16x16x32_bf16 v[28:31], v[168:171], v[144:147], v[28:31]
    ds_read_b64_tr_b16 v[184:185], v4 offset:30912
    v_mfma_f32_16x16x32_bf16 v[64:67], v[168:171], v[148:151], v[64:67]
    ds_read_b64_tr_b16 v[186:187], v4 offset:36032
    v_mfma_f32_16x16x32_bf16 v[32:35], v[172:175], v[144:147], v[32:35]
    ds_read_b64_tr_b16 v[188:189], v3 offset:30976
    v_mfma_f32_16x16x32_bf16 v[68:71], v[172:175], v[148:151], v[68:71]
    ds_read_b64_tr_b16 v[190:191], v3 offset:36096
    s_waitcnt lgkmcnt(0)
    s_barrier
    v_mfma_f32_16x16x32_bf16 v[36:39], v[176:179], v[144:147], v[36:39]
    ds_read_b64_tr_b16 v[168:169], v5 offset:0
    v_mfma_f32_16x16x32_bf16 v[72:75], v[176:179], v[148:151], v[72:75]
    ds_read_b64_tr_b16 v[170:171], v5 offset:5120
    v_mfma_f32_16x16x32_bf16 v[40:43], v[180:183], v[144:147], v[40:43]
    ds_read_b64_tr_b16 v[172:173], v6 offset:0
    v_mfma_f32_16x16x32_bf16 v[76:79], v[180:183], v[148:151], v[76:79]
    ds_read_b64_tr_b16 v[174:175], v6 offset:5120
    v_mfma_f32_16x16x32_bf16 v[44:47], v[184:187], v[144:147], v[44:47]
    ds_read_b64_tr_b16 v[176:177], v5 offset:64
    v_mfma_f32_16x16x32_bf16 v[80:83], v[184:187], v[148:151], v[80:83]
    ds_read_b64_tr_b16 v[178:179], v5 offset:5184
    v_mfma_f32_16x16x32_bf16 v[48:51], v[188:191], v[144:147], v[48:51]
    ds_read_b64_tr_b16 v[180:181], v6 offset:64
    v_mfma_f32_16x16x32_bf16 v[84:87], v[188:191], v[148:151], v[84:87]
    ds_read_b64_tr_b16 v[182:183], v6 offset:5184
    s_waitcnt vmcnt(14)
    s_waitcnt lgkmcnt(4)
    v_mfma_f32_16x16x32_bf16 v[16:19], v[168:171], v[152:155], v[16:19]
    ds_read_b64_tr_b16 v[184:185], v5 offset:128
    v_mfma_f32_16x16x32_bf16 v[52:55], v[168:171], v[156:159], v[52:55]
    ds_read_b64_tr_b16 v[186:187], v5 offset:5248
    v_mfma_f32_16x16x32_bf16 v[20:23], v[172:175], v[152:155], v[20:23]
    ds_read_b64_tr_b16 v[188:189], v6 offset:128
    v_mfma_f32_16x16x32_bf16 v[56:59], v[172:175], v[156:159], v[56:59]
    ds_read_b64_tr_b16 v[190:191], v6 offset:5248
    s_waitcnt lgkmcnt(4)
    v_mfma_f32_16x16x32_bf16 v[24:27], v[176:179], v[152:155], v[24:27]
    ds_read_b64_tr_b16 v[168:169], v5 offset:192
    v_mfma_f32_16x16x32_bf16 v[60:63], v[176:179], v[156:159], v[60:63]
    ds_read_b64_tr_b16 v[170:171], v5 offset:5312
    v_mfma_f32_16x16x32_bf16 v[28:31], v[180:183], v[152:155], v[28:31]
    ds_read_b64_tr_b16 v[172:173], v6 offset:192
    v_mfma_f32_16x16x32_bf16 v[64:67], v[180:183], v[156:159], v[64:67]
    ds_read_b64_tr_b16 v[174:175], v6 offset:5312
    s_waitcnt lgkmcnt(4)
    v_mfma_f32_16x16x32_bf16 v[32:35], v[184:187], v[152:155], v[32:35]
    ds_read_b64_tr_b16 v[176:177], v5 offset:256
    v_mfma_f32_16x16x32_bf16 v[68:71], v[184:187], v[156:159], v[68:71]
    ds_read_b64_tr_b16 v[178:179], v5 offset:5376
    v_mfma_f32_16x16x32_bf16 v[36:39], v[188:191], v[152:155], v[36:39]
    ds_read_b64_tr_b16 v[180:181], v5 offset:10240
    v_mfma_f32_16x16x32_bf16 v[72:75], v[188:191], v[156:159], v[72:75]
    ds_read_b64_tr_b16 v[182:183], v5 offset:15360
    s_waitcnt lgkmcnt(4)
    v_mfma_f32_16x16x32_bf16 v[40:43], v[168:171], v[152:155], v[40:43]
    ds_read_b64_tr_b16 v[184:185], v6 offset:10240
    v_mfma_f32_16x16x32_bf16 v[76:79], v[168:171], v[156:159], v[76:79]
    ds_read_b64_tr_b16 v[186:187], v6 offset:15360
    v_mfma_f32_16x16x32_bf16 v[44:47], v[172:175], v[152:155], v[44:47]
    ds_read_b64_tr_b16 v[188:189], v5 offset:10304
    v_mfma_f32_16x16x32_bf16 v[80:83], v[172:175], v[156:159], v[80:83]
    ds_read_b64_tr_b16 v[190:191], v5 offset:15424
    s_waitcnt lgkmcnt(4)
    v_mfma_f32_16x16x32_bf16 v[48:51], v[176:179], v[152:155], v[48:51]
    ds_read_b64_tr_b16 v[168:169], v6 offset:10304
    v_mfma_f32_16x16x32_bf16 v[84:87], v[176:179], v[156:159], v[84:87]
    ds_read_b64_tr_b16 v[170:171], v6 offset:15424
    s_waitcnt vmcnt(12)
    v_mfma_f32_16x16x32_bf16 v[16:19], v[180:183], v[160:163], v[16:19]
    ds_read_b64_tr_b16 v[172:173], v5 offset:10368
    v_mfma_f32_16x16x32_bf16 v[52:55], v[180:183], v[164:167], v[52:55]
    ds_read_b64_tr_b16 v[174:175], v5 offset:15488
    s_waitcnt lgkmcnt(4)
    v_mfma_f32_16x16x32_bf16 v[20:23], v[184:187], v[160:163], v[20:23]
    ds_read_b64_tr_b16 v[176:177], v6 offset:10368
    v_mfma_f32_16x16x32_bf16 v[56:59], v[184:187], v[164:167], v[56:59]
    ds_read_b64_tr_b16 v[178:179], v6 offset:15488
    v_mfma_f32_16x16x32_bf16 v[24:27], v[188:191], v[160:163], v[24:27]
    ds_read_b64_tr_b16 v[180:181], v5 offset:10432
    v_mfma_f32_16x16x32_bf16 v[60:63], v[188:191], v[164:167], v[60:63]
    ds_read_b64_tr_b16 v[182:183], v5 offset:15552
    s_waitcnt lgkmcnt(4)
    v_mfma_f32_16x16x32_bf16 v[28:31], v[168:171], v[160:163], v[28:31]
    ds_read_b64_tr_b16 v[184:185], v6 offset:10432
    v_mfma_f32_16x16x32_bf16 v[64:67], v[168:171], v[164:167], v[64:67]
    ds_read_b64_tr_b16 v[186:187], v6 offset:15552
    v_mfma_f32_16x16x32_bf16 v[32:35], v[172:175], v[160:163], v[32:35]
    ds_read_b64_tr_b16 v[188:189], v5 offset:10496
    v_mfma_f32_16x16x32_bf16 v[68:71], v[172:175], v[164:167], v[68:71]
    ds_read_b64_tr_b16 v[190:191], v5 offset:15616
    s_waitcnt lgkmcnt(4)
    v_mfma_f32_16x16x32_bf16 v[36:39], v[176:179], v[160:163], v[36:39]
    ds_read_b64_tr_b16 v[168:169], v5 offset:20480
    v_mfma_f32_16x16x32_bf16 v[72:75], v[176:179], v[164:167], v[72:75]
    ds_read_b64_tr_b16 v[170:171], v5 offset:25600
    v_mfma_f32_16x16x32_bf16 v[40:43], v[180:183], v[160:163], v[40:43]
    ds_read_b64_tr_b16 v[172:173], v6 offset:20480
    v_mfma_f32_16x16x32_bf16 v[76:79], v[180:183], v[164:167], v[76:79]
    ds_read_b64_tr_b16 v[174:175], v6 offset:25600
    s_waitcnt lgkmcnt(4)
    v_mfma_f32_16x16x32_bf16 v[44:47], v[184:187], v[160:163], v[44:47]
    ds_read_b64_tr_b16 v[176:177], v5 offset:20544
    v_mfma_f32_16x16x32_bf16 v[80:83], v[184:187], v[164:167], v[80:83]
    ds_read_b64_tr_b16 v[178:179], v5 offset:25664
    v_mfma_f32_16x16x32_bf16 v[48:51], v[188:191], v[160:163], v[48:51]
    ds_read_b64_tr_b16 v[180:181], v6 offset:20544
    v_mfma_f32_16x16x32_bf16 v[84:87], v[188:191], v[164:167], v[84:87]
    ds_read_b64_tr_b16 v[182:183], v6 offset:25664
    s_waitcnt vmcnt(10)
    s_waitcnt lgkmcnt(4)
    v_mfma_f32_16x16x32_bf16 v[16:19], v[168:171], v[88:91], v[16:19]
    ds_read_b64_tr_b16 v[184:185], v5 offset:20608
    v_mfma_f32_16x16x32_bf16 v[52:55], v[168:171], v[92:95], v[52:55]
    ds_read_b64_tr_b16 v[186:187], v5 offset:25728
    v_mfma_f32_16x16x32_bf16 v[20:23], v[172:175], v[88:91], v[20:23]
    ds_read_b64_tr_b16 v[188:189], v6 offset:20608
    v_mfma_f32_16x16x32_bf16 v[56:59], v[172:175], v[92:95], v[56:59]
    ds_read_b64_tr_b16 v[190:191], v6 offset:25728
    s_waitcnt lgkmcnt(4)
    v_mfma_f32_16x16x32_bf16 v[24:27], v[176:179], v[88:91], v[24:27]
    ds_read_b64_tr_b16 v[168:169], v5 offset:20672
    v_mfma_f32_16x16x32_bf16 v[60:63], v[176:179], v[92:95], v[60:63]
    ds_read_b64_tr_b16 v[170:171], v5 offset:25792
    v_mfma_f32_16x16x32_bf16 v[28:31], v[180:183], v[88:91], v[28:31]
    ds_read_b64_tr_b16 v[172:173], v6 offset:20672
    v_mfma_f32_16x16x32_bf16 v[64:67], v[180:183], v[92:95], v[64:67]
    ds_read_b64_tr_b16 v[174:175], v6 offset:25792
    s_waitcnt lgkmcnt(4)
    v_mfma_f32_16x16x32_bf16 v[32:35], v[184:187], v[88:91], v[32:35]
    ds_read_b64_tr_b16 v[176:177], v5 offset:20736
    v_mfma_f32_16x16x32_bf16 v[68:71], v[184:187], v[92:95], v[68:71]
    ds_read_b64_tr_b16 v[178:179], v5 offset:25856
    v_mfma_f32_16x16x32_bf16 v[36:39], v[188:191], v[88:91], v[36:39]
    ds_read_b64_tr_b16 v[180:181], v5 offset:30720
    v_mfma_f32_16x16x32_bf16 v[72:75], v[188:191], v[92:95], v[72:75]
    ds_read_b64_tr_b16 v[182:183], v5 offset:35840
    s_waitcnt lgkmcnt(4)
    v_mfma_f32_16x16x32_bf16 v[40:43], v[168:171], v[88:91], v[40:43]
    ds_read_b64_tr_b16 v[184:185], v6 offset:30720
    v_mfma_f32_16x16x32_bf16 v[76:79], v[168:171], v[92:95], v[76:79]
    ds_read_b64_tr_b16 v[186:187], v6 offset:35840
    v_mfma_f32_16x16x32_bf16 v[44:47], v[172:175], v[88:91], v[44:47]
    ds_read_b64_tr_b16 v[188:189], v5 offset:30784
    v_mfma_f32_16x16x32_bf16 v[80:83], v[172:175], v[92:95], v[80:83]
    ds_read_b64_tr_b16 v[190:191], v5 offset:35904
    s_waitcnt lgkmcnt(4)
    v_mfma_f32_16x16x32_bf16 v[48:51], v[176:179], v[88:91], v[48:51]
    ds_read_b64_tr_b16 v[168:169], v6 offset:30784
    v_mfma_f32_16x16x32_bf16 v[84:87], v[176:179], v[92:95], v[84:87]
    ds_read_b64_tr_b16 v[170:171], v6 offset:35904
    s_waitcnt vmcnt(8)
    v_mfma_f32_16x16x32_bf16 v[16:19], v[180:183], v[96:99], v[16:19]
    ds_read_b64_tr_b16 v[172:173], v5 offset:30848
    v_mfma_f32_16x16x32_bf16 v[52:55], v[180:183], v[100:103], v[52:55]
    ds_read_b64_tr_b16 v[174:175], v5 offset:35968
    s_waitcnt lgkmcnt(4)
    v_mfma_f32_16x16x32_bf16 v[20:23], v[184:187], v[96:99], v[20:23]
    ds_read_b64_tr_b16 v[176:177], v6 offset:30848
    v_mfma_f32_16x16x32_bf16 v[56:59], v[184:187], v[100:103], v[56:59]
    ds_read_b64_tr_b16 v[178:179], v6 offset:35968
    v_mfma_f32_16x16x32_bf16 v[24:27], v[188:191], v[96:99], v[24:27]
    ds_read_b64_tr_b16 v[180:181], v5 offset:30912
    v_mfma_f32_16x16x32_bf16 v[60:63], v[188:191], v[100:103], v[60:63]
    ds_read_b64_tr_b16 v[182:183], v5 offset:36032
    s_waitcnt lgkmcnt(4)
    v_mfma_f32_16x16x32_bf16 v[28:31], v[168:171], v[96:99], v[28:31]
    ds_read_b64_tr_b16 v[184:185], v6 offset:30912
    v_mfma_f32_16x16x32_bf16 v[64:67], v[168:171], v[100:103], v[64:67]
    ds_read_b64_tr_b16 v[186:187], v6 offset:36032
    v_mfma_f32_16x16x32_bf16 v[32:35], v[172:175], v[96:99], v[32:35]
    ds_read_b64_tr_b16 v[188:189], v5 offset:30976
    v_mfma_f32_16x16x32_bf16 v[68:71], v[172:175], v[100:103], v[68:71]
    ds_read_b64_tr_b16 v[190:191], v5 offset:36096
    s_waitcnt lgkmcnt(0)
    s_barrier
    v_mfma_f32_16x16x32_bf16 v[36:39], v[176:179], v[96:99], v[36:39]
    ds_read_b64_tr_b16 v[168:169], v7 offset:0
    v_mfma_f32_16x16x32_bf16 v[72:75], v[176:179], v[100:103], v[72:75]
    ds_read_b64_tr_b16 v[170:171], v7 offset:5120
    v_mfma_f32_16x16x32_bf16 v[40:43], v[180:183], v[96:99], v[40:43]
    ds_read_b64_tr_b16 v[172:173], v8 offset:0
    v_mfma_f32_16x16x32_bf16 v[76:79], v[180:183], v[100:103], v[76:79]
    ds_read_b64_tr_b16 v[174:175], v8 offset:5120
    v_mfma_f32_16x16x32_bf16 v[44:47], v[184:187], v[96:99], v[44:47]
    ds_read_b64_tr_b16 v[176:177], v7 offset:64
    v_mfma_f32_16x16x32_bf16 v[80:83], v[184:187], v[100:103], v[80:83]
    ds_read_b64_tr_b16 v[178:179], v7 offset:5184
    v_mfma_f32_16x16x32_bf16 v[48:51], v[188:191], v[96:99], v[48:51]
    ds_read_b64_tr_b16 v[180:181], v8 offset:64
    v_mfma_f32_16x16x32_bf16 v[84:87], v[188:191], v[100:103], v[84:87]
    ds_read_b64_tr_b16 v[182:183], v8 offset:5184
    s_waitcnt vmcnt(6)
    s_waitcnt lgkmcnt(4)
    v_mfma_f32_16x16x32_bf16 v[16:19], v[168:171], v[104:107], v[16:19]
    ds_read_b64_tr_b16 v[184:185], v7 offset:128
    v_mfma_f32_16x16x32_bf16 v[52:55], v[168:171], v[108:111], v[52:55]
    ds_read_b64_tr_b16 v[186:187], v7 offset:5248
    v_mfma_f32_16x16x32_bf16 v[20:23], v[172:175], v[104:107], v[20:23]
    ds_read_b64_tr_b16 v[188:189], v8 offset:128
    v_mfma_f32_16x16x32_bf16 v[56:59], v[172:175], v[108:111], v[56:59]
    ds_read_b64_tr_b16 v[190:191], v8 offset:5248
    s_waitcnt lgkmcnt(4)
    v_mfma_f32_16x16x32_bf16 v[24:27], v[176:179], v[104:107], v[24:27]
    ds_read_b64_tr_b16 v[168:169], v7 offset:192
    v_mfma_f32_16x16x32_bf16 v[60:63], v[176:179], v[108:111], v[60:63]
    ds_read_b64_tr_b16 v[170:171], v7 offset:5312
    v_mfma_f32_16x16x32_bf16 v[28:31], v[180:183], v[104:107], v[28:31]
    ds_read_b64_tr_b16 v[172:173], v8 offset:192
    v_mfma_f32_16x16x32_bf16 v[64:67], v[180:183], v[108:111], v[64:67]
    ds_read_b64_tr_b16 v[174:175], v8 offset:5312
    s_waitcnt lgkmcnt(4)
    v_mfma_f32_16x16x32_bf16 v[32:35], v[184:187], v[104:107], v[32:35]
    ds_read_b64_tr_b16 v[176:177], v7 offset:256
    v_mfma_f32_16x16x32_bf16 v[68:71], v[184:187], v[108:111], v[68:71]
    ds_read_b64_tr_b16 v[178:179], v7 offset:5376
    v_mfma_f32_16x16x32_bf16 v[36:39], v[188:191], v[104:107], v[36:39]
    ds_read_b64_tr_b16 v[180:181], v7 offset:10240
    v_mfma_f32_16x16x32_bf16 v[72:75], v[188:191], v[108:111], v[72:75]
    ds_read_b64_tr_b16 v[182:183], v7 offset:15360
    s_waitcnt lgkmcnt(4)
    v_mfma_f32_16x16x32_bf16 v[40:43], v[168:171], v[104:107], v[40:43]
    ds_read_b64_tr_b16 v[184:185], v8 offset:10240
    v_mfma_f32_16x16x32_bf16 v[76:79], v[168:171], v[108:111], v[76:79]
    ds_read_b64_tr_b16 v[186:187], v8 offset:15360
    v_mfma_f32_16x16x32_bf16 v[44:47], v[172:175], v[104:107], v[44:47]
    ds_read_b64_tr_b16 v[188:189], v7 offset:10304
    v_mfma_f32_16x16x32_bf16 v[80:83], v[172:175], v[108:111], v[80:83]
    ds_read_b64_tr_b16 v[190:191], v7 offset:15424
    s_waitcnt lgkmcnt(4)
    v_mfma_f32_16x16x32_bf16 v[48:51], v[176:179], v[104:107], v[48:51]
    ds_read_b64_tr_b16 v[168:169], v8 offset:10304
    v_mfma_f32_16x16x32_bf16 v[84:87], v[176:179], v[108:111], v[84:87]
    ds_read_b64_tr_b16 v[170:171], v8 offset:15424
    s_waitcnt vmcnt(4)
    v_mfma_f32_16x16x32_bf16 v[16:19], v[180:183], v[112:115], v[16:19]
    ds_read_b64_tr_b16 v[172:173], v7 offset:10368
    v_mfma_f32_16x16x32_bf16 v[52:55], v[180:183], v[116:119], v[52:55]
    ds_read_b64_tr_b16 v[174:175], v7 offset:15488
    s_waitcnt lgkmcnt(4)
    v_mfma_f32_16x16x32_bf16 v[20:23], v[184:187], v[112:115], v[20:23]
    ds_read_b64_tr_b16 v[176:177], v8 offset:10368
    v_mfma_f32_16x16x32_bf16 v[56:59], v[184:187], v[116:119], v[56:59]
    ds_read_b64_tr_b16 v[178:179], v8 offset:15488
    v_mfma_f32_16x16x32_bf16 v[24:27], v[188:191], v[112:115], v[24:27]
    ds_read_b64_tr_b16 v[180:181], v7 offset:10432
    v_mfma_f32_16x16x32_bf16 v[60:63], v[188:191], v[116:119], v[60:63]
    ds_read_b64_tr_b16 v[182:183], v7 offset:15552
    s_waitcnt lgkmcnt(4)
    v_mfma_f32_16x16x32_bf16 v[28:31], v[168:171], v[112:115], v[28:31]
    ds_read_b64_tr_b16 v[184:185], v8 offset:10432
    v_mfma_f32_16x16x32_bf16 v[64:67], v[168:171], v[116:119], v[64:67]
    ds_read_b64_tr_b16 v[186:187], v8 offset:15552
    v_mfma_f32_16x16x32_bf16 v[32:35], v[172:175], v[112:115], v[32:35]
    ds_read_b64_tr_b16 v[188:189], v7 offset:10496
    v_mfma_f32_16x16x32_bf16 v[68:71], v[172:175], v[116:119], v[68:71]
    ds_read_b64_tr_b16 v[190:191], v7 offset:15616
    s_waitcnt lgkmcnt(4)
    v_mfma_f32_16x16x32_bf16 v[36:39], v[176:179], v[112:115], v[36:39]
    ds_read_b64_tr_b16 v[168:169], v7 offset:20480
    v_mfma_f32_16x16x32_bf16 v[72:75], v[176:179], v[116:119], v[72:75]
    ds_read_b64_tr_b16 v[170:171], v7 offset:25600
    v_mfma_f32_16x16x32_bf16 v[40:43], v[180:183], v[112:115], v[40:43]
    ds_read_b64_tr_b16 v[172:173], v8 offset:20480
    v_mfma_f32_16x16x32_bf16 v[76:79], v[180:183], v[116:119], v[76:79]
    ds_read_b64_tr_b16 v[174:175], v8 offset:25600
    s_waitcnt lgkmcnt(4)
    v_mfma_f32_16x16x32_bf16 v[44:47], v[184:187], v[112:115], v[44:47]
    ds_read_b64_tr_b16 v[176:177], v7 offset:20544
    v_mfma_f32_16x16x32_bf16 v[80:83], v[184:187], v[116:119], v[80:83]
    ds_read_b64_tr_b16 v[178:179], v7 offset:25664
    v_mfma_f32_16x16x32_bf16 v[48:51], v[188:191], v[112:115], v[48:51]
    ds_read_b64_tr_b16 v[180:181], v8 offset:20544
    v_mfma_f32_16x16x32_bf16 v[84:87], v[188:191], v[116:119], v[84:87]
    ds_read_b64_tr_b16 v[182:183], v8 offset:25664
    s_waitcnt vmcnt(2)
    s_waitcnt lgkmcnt(4)
    v_mfma_f32_16x16x32_bf16 v[16:19], v[168:171], v[120:123], v[16:19]
    ds_read_b64_tr_b16 v[184:185], v7 offset:20608
    v_mfma_f32_16x16x32_bf16 v[52:55], v[168:171], v[124:127], v[52:55]
    ds_read_b64_tr_b16 v[186:187], v7 offset:25728
    v_mfma_f32_16x16x32_bf16 v[20:23], v[172:175], v[120:123], v[20:23]
    ds_read_b64_tr_b16 v[188:189], v8 offset:20608
    v_mfma_f32_16x16x32_bf16 v[56:59], v[172:175], v[124:127], v[56:59]
    ds_read_b64_tr_b16 v[190:191], v8 offset:25728
    s_waitcnt lgkmcnt(4)
    v_mfma_f32_16x16x32_bf16 v[24:27], v[176:179], v[120:123], v[24:27]
    ds_read_b64_tr_b16 v[168:169], v7 offset:20672
    v_mfma_f32_16x16x32_bf16 v[60:63], v[176:179], v[124:127], v[60:63]
    ds_read_b64_tr_b16 v[170:171], v7 offset:25792
    v_mfma_f32_16x16x32_bf16 v[28:31], v[180:183], v[120:123], v[28:31]
    ds_read_b64_tr_b16 v[172:173], v8 offset:20672
    v_mfma_f32_16x16x32_bf16 v[64:67], v[180:183], v[124:127], v[64:67]
    ds_read_b64_tr_b16 v[174:175], v8 offset:25792
    s_waitcnt lgkmcnt(4)
    v_mfma_f32_16x16x32_bf16 v[32:35], v[184:187], v[120:123], v[32:35]
    ds_read_b64_tr_b16 v[176:177], v7 offset:20736
    v_mfma_f32_16x16x32_bf16 v[68:71], v[184:187], v[124:127], v[68:71]
    ds_read_b64_tr_b16 v[178:179], v7 offset:25856
    v_mfma_f32_16x16x32_bf16 v[36:39], v[188:191], v[120:123], v[36:39]
    ds_read_b64_tr_b16 v[180:181], v7 offset:30720
    v_mfma_f32_16x16x32_bf16 v[72:75], v[188:191], v[124:127], v[72:75]
    ds_read_b64_tr_b16 v[182:183], v7 offset:35840
    s_waitcnt lgkmcnt(4)
    v_mfma_f32_16x16x32_bf16 v[40:43], v[168:171], v[120:123], v[40:43]
    ds_read_b64_tr_b16 v[184:185], v8 offset:30720
    v_mfma_f32_16x16x32_bf16 v[76:79], v[168:171], v[124:127], v[76:79]
    ds_read_b64_tr_b16 v[186:187], v8 offset:35840
    v_mfma_f32_16x16x32_bf16 v[44:47], v[172:175], v[120:123], v[44:47]
    ds_read_b64_tr_b16 v[188:189], v7 offset:30784
    v_mfma_f32_16x16x32_bf16 v[80:83], v[172:175], v[124:127], v[80:83]
    ds_read_b64_tr_b16 v[190:191], v7 offset:35904
    s_waitcnt lgkmcnt(4)
    v_mfma_f32_16x16x32_bf16 v[48:51], v[176:179], v[120:123], v[48:51]
    ds_read_b64_tr_b16 v[168:169], v8 offset:30784
    v_mfma_f32_16x16x32_bf16 v[84:87], v[176:179], v[124:127], v[84:87]
    ds_read_b64_tr_b16 v[170:171], v8 offset:35904
    s_waitcnt vmcnt(0)
    v_mfma_f32_16x16x32_bf16 v[16:19], v[180:183], v[128:131], v[16:19]
    ds_read_b64_tr_b16 v[172:173], v7 offset:30848
    v_mfma_f32_16x16x32_bf16 v[52:55], v[180:183], v[132:135], v[52:55]
    ds_read_b64_tr_b16 v[174:175], v7 offset:35968
    s_waitcnt lgkmcnt(4)
    v_mfma_f32_16x16x32_bf16 v[20:23], v[184:187], v[128:131], v[20:23]
    ds_read_b64_tr_b16 v[176:177], v8 offset:30848
    v_mfma_f32_16x16x32_bf16 v[56:59], v[184:187], v[132:135], v[56:59]
    ds_read_b64_tr_b16 v[178:179], v8 offset:35968
    v_mfma_f32_16x16x32_bf16 v[24:27], v[188:191], v[128:131], v[24:27]
    ds_read_b64_tr_b16 v[180:181], v7 offset:30912
    v_mfma_f32_16x16x32_bf16 v[60:63], v[188:191], v[132:135], v[60:63]
    ds_read_b64_tr_b16 v[182:183], v7 offset:36032
    s_waitcnt lgkmcnt(4)
    v_mfma_f32_16x16x32_bf16 v[28:31], v[168:171], v[128:131], v[28:31]
    ds_read_b64_tr_b16 v[184:185], v8 offset:30912
    v_mfma_f32_16x16x32_bf16 v[64:67], v[168:171], v[132:135], v[64:67]
    ds_read_b64_tr_b16 v[186:187], v8 offset:36032
    v_mfma_f32_16x16x32_bf16 v[32:35], v[172:175], v[128:131], v[32:35]
    ds_read_b64_tr_b16 v[188:189], v7 offset:30976
    v_mfma_f32_16x16x32_bf16 v[68:71], v[172:175], v[132:135], v[68:71]
    ds_read_b64_tr_b16 v[190:191], v7 offset:36096
    s_waitcnt lgkmcnt(4)
    v_mfma_f32_16x16x32_bf16 v[36:39], v[176:179], v[128:131], v[36:39]
    v_mfma_f32_16x16x32_bf16 v[72:75], v[176:179], v[132:135], v[72:75]
    v_mfma_f32_16x16x32_bf16 v[40:43], v[180:183], v[128:131], v[40:43]
    v_mfma_f32_16x16x32_bf16 v[76:79], v[180:183], v[132:135], v[76:79]
    s_waitcnt lgkmcnt(0)
    v_mfma_f32_16x16x32_bf16 v[44:47], v[184:187], v[128:131], v[44:47]
    v_mfma_f32_16x16x32_bf16 v[80:83], v[184:187], v[132:135], v[80:83]
    v_mfma_f32_16x16x32_bf16 v[48:51], v[188:191], v[128:131], v[48:51]
    v_mfma_f32_16x16x32_bf16 v[84:87], v[188:191], v[132:135], v[84:87]
    buffer_load_dwordx2 v[232:233], v238, s[4:7], 0 offen
    buffer_load_dwordx2 v[234:235], v239, s[4:7], 0 offen
    buffer_load_dwordx2 v[236:237], v240, s[4:7], 0 offen
    s_waitcnt lgkmcnt(0)
    s_barrier
    s_nop 4
    s_cmp_eq_u32 s37, s43
    s_cbranch_scc1 Lpo_32
    v_cvt_pk_bf16_f32 v88, v16, v17
    v_cvt_pk_bf16_f32 v89, v18, v19
    v_cvt_pk_bf16_f32 v90, v20, v21
    v_cvt_pk_bf16_f32 v91, v22, v23
    s_mov_b32 s46, 0
    buffer_store_dwordx4 v[88:91], v9, s[32:35], s46 offen offset:0 sc1
    v_cvt_pk_bf16_f32 v92, v24, v25
    v_cvt_pk_bf16_f32 v93, v26, v27
    v_cvt_pk_bf16_f32 v94, v24, v25
    v_cvt_pk_bf16_f32 v95, v26, v27
    buffer_store_dwordx4 v[92:95], v9, s[32:35], s46 offen offset:1024 sc1
    v_cvt_pk_bf16_f32 v96, v28, v29
    v_cvt_pk_bf16_f32 v97, v30, v31
    v_cvt_pk_bf16_f32 v98, v32, v33
    v_cvt_pk_bf16_f32 v99, v34, v35
    buffer_store_dwordx4 v[96:99], v9, s[32:35], s46 offen offset:2048 sc1
    v_cvt_pk_bf16_f32 v100, v36, v37
    v_cvt_pk_bf16_f32 v101, v38, v39
    v_cvt_pk_bf16_f32 v102, v40, v41
    v_cvt_pk_bf16_f32 v103, v42, v43
    buffer_store_dwordx4 v[100:103], v9, s[32:35], s46 offen offset:3072 sc1
    v_cvt_pk_bf16_f32 v104, v44, v45
    v_cvt_pk_bf16_f32 v105, v46, v47
    v_cvt_pk_bf16_f32 v106, v48, v49
    v_cvt_pk_bf16_f32 v107, v50, v51
    s_mov_b32 s46, 4096
    buffer_store_dwordx4 v[104:107], v9, s[32:35], s46 offen offset:0 sc1
    v_cvt_pk_bf16_f32 v108, v52, v53
    v_cvt_pk_bf16_f32 v109, v54, v55
    v_cvt_pk_bf16_f32 v110, v56, v57
    v_cvt_pk_bf16_f32 v111, v58, v59
    buffer_store_dwordx4 v[108:111], v9, s[32:35], s46 offen offset:1024 sc1
    v_cvt_pk_bf16_f32 v112, v60, v61
    v_cvt_pk_bf16_f32 v113, v62, v63
    v_cvt_pk_bf16_f32 v114, v60, v61
    v_cvt_pk_bf16_f32 v115, v62, v63
    buffer_store_dwordx4 v[112:115], v9, s[32:35], s46 offen offset:2048 sc1
    v_cvt_pk_bf16_f32 v116, v64, v65
    v_cvt_pk_bf16_f32 v117, v66, v67
    v_cvt_pk_bf16_f32 v118, v68, v69
    v_cvt_pk_bf16_f32 v119, v70, v71
    buffer_store_dwordx4 v[116:119], v9, s[32:35], s46 offen offset:3072 sc1
    v_cvt_pk_bf16_f32 v120, v72, v73
    v_cvt_pk_bf16_f32 v121, v74, v75
    v_cvt_pk_bf16_f32 v122, v76, v77
    v_cvt_pk_bf16_f32 v123, v78, v79
    s_mov_b32 s46, 8192
    buffer_store_dwordx4 v[120:123], v9, s[32:35], s46 offen offset:0 sc1
    v_cvt_pk_bf16_f32 v124, v80, v81
    v_cvt_pk_bf16_f32 v125, v82, v83
    v_cvt_pk_bf16_f32 v126, v84, v85
    v_cvt_pk_bf16_f32 v127, v86, v87
    buffer_store_dwordx4 v[124:127], v9, s[32:35], s46 offen offset:1024 sc1
    s_branch Lpf_33
Lpo_32:
    v_cvt_pk_bf16_f32 v88, v16, v17
    v_cvt_pk_bf16_f32 v89, v18, v19
    v_cvt_pk_bf16_f32 v90, v20, v21
    v_cvt_pk_bf16_f32 v91, v22, v23
    v_cvt_pk_bf16_f32 v92, v24, v25
    v_cvt_pk_bf16_f32 v93, v26, v27
    v_cvt_pk_bf16_f32 v94, v24, v25
    v_cvt_pk_bf16_f32 v95, v26, v27
    v_cvt_pk_bf16_f32 v96, v28, v29
    v_cvt_pk_bf16_f32 v97, v30, v31
    v_cvt_pk_bf16_f32 v98, v32, v33
    v_cvt_pk_bf16_f32 v99, v34, v35
    v_cvt_pk_bf16_f32 v100, v36, v37
    v_cvt_pk_bf16_f32 v101, v38, v39
    v_cvt_pk_bf16_f32 v102, v40, v41
    v_cvt_pk_bf16_f32 v103, v42, v43
    v_cvt_pk_bf16_f32 v104, v44, v45
    v_cvt_pk_bf16_f32 v105, v46, v47
    v_cvt_pk_bf16_f32 v106, v48, v49
    v_cvt_pk_bf16_f32 v107, v50, v51
    v_cvt_pk_bf16_f32 v108, v52, v53
    v_cvt_pk_bf16_f32 v109, v54, v55
    v_cvt_pk_bf16_f32 v110, v56, v57
    v_cvt_pk_bf16_f32 v111, v58, v59
    v_cvt_pk_bf16_f32 v112, v60, v61
    v_cvt_pk_bf16_f32 v113, v62, v63
    v_cvt_pk_bf16_f32 v114, v60, v61
    v_cvt_pk_bf16_f32 v115, v62, v63
    v_cvt_pk_bf16_f32 v116, v64, v65
    v_cvt_pk_bf16_f32 v117, v66, v67
    v_cvt_pk_bf16_f32 v118, v68, v69
    v_cvt_pk_bf16_f32 v119, v70, v71
    v_cvt_pk_bf16_f32 v120, v72, v73
    v_cvt_pk_bf16_f32 v121, v74, v75
    v_cvt_pk_bf16_f32 v122, v76, v77
    v_cvt_pk_bf16_f32 v123, v78, v79
    v_cvt_pk_bf16_f32 v124, v80, v81
    v_cvt_pk_bf16_f32 v125, v82, v83
    v_cvt_pk_bf16_f32 v126, v84, v85
    v_cvt_pk_bf16_f32 v127, v86, v87
Lpf_33:
    s_waitcnt lgkmcnt(0)
    s_barrier
    s_lshl_b32 s51, s41, 10
    v_lshlrev_b32 v1, 4, v0
    v_add_u32 v1, s51, v1
    ds_read_b128 v[128:131], v1 offset:0
    ds_read_b128 v[132:135], v1 offset:2048
    ds_read_b128 v[136:139], v1 offset:4096
    ds_read_b128 v[140:143], v1 offset:6144
    ds_read_b128 v[144:147], v1 offset:8192
    ds_read_b128 v[148:151], v1 offset:10240
    ds_read_b128 v[152:155], v1 offset:12288
    ds_read_b128 v[156:159], v1 offset:14336
    ds_read_b128 v[160:163], v1 offset:16384
    ds_read_b128 v[164:167], v1 offset:18432
    ds_read_b128 v[168:171], v1 offset:20480
    ds_read_b128 v[172:175], v1 offset:22528
    ds_read_b128 v[176:179], v1 offset:24576
    ds_read_b128 v[180:183], v1 offset:26624
    ds_read_b128 v[184:187], v1 offset:28672
    ds_read_b128 v[188:191], v1 offset:30720
    ds_read_b128 v[192:195], v1 offset:32768
    ds_read_b128 v[196:199], v1 offset:34816
    ds_read_b64_tr_b16 v[16:17], v226 offset:0
    ds_read_b64_tr_b16 v[18:19], v226 offset:5120
    ds_read_b64_tr_b16 v[20:21], v229 offset:0
    ds_read_b64_tr_b16 v[22:23], v229 offset:5120
    ds_read_b64_tr_b16 v[24:25], v226 offset:10240
    ds_read_b64_tr_b16 v[26:27], v226 offset:15360
    ds_read_b64_tr_b16 v[28:29], v229 offset:10240
    ds_read_b64_tr_b16 v[30:31], v229 offset:15360
    ds_read_b64_tr_b16 v[32:33], v226 offset:20480
    ds_read_b64_tr_b16 v[34:35], v226 offset:25600
    s_waitcnt lgkmcnt(8)
    v_mfma_f32_16x16x32_bf16 v[244:247], v[16:19], v[128:131], 0
    ds_read_b64_tr_b16 v[36:37], v229 offset:20480
    ds_read_b64_tr_b16 v[38:39], v229 offset:25600
    s_waitcnt lgkmcnt(8)
    v_mfma_f32_16x16x32_bf16 v[248:251], v[20:23], v[128:131], 0
    ds_read_b64_tr_b16 v[16:17], v226 offset:30720
    ds_read_b64_tr_b16 v[18:19], v226 offset:35840
    s_waitcnt lgkmcnt(8)
    v_mfma_f32_16x16x32_bf16 v[244:247], v[24:27], v[132:135], v[244:247]
    ds_read_b64_tr_b16 v[20:21], v229 offset:30720
    ds_read_b64_tr_b16 v[22:23], v229 offset:35840
    s_waitcnt lgkmcnt(8)
    v_mfma_f32_16x16x32_bf16 v[248:251], v[28:31], v[132:135], v[248:251]
    ds_read_b64_tr_b16 v[24:25], v227 offset:0
    ds_read_b64_tr_b16 v[26:27], v227 offset:5120
    s_waitcnt lgkmcnt(8)
    v_mfma_f32_16x16x32_bf16 v[244:247], v[32:35], v[136:139], v[244:247]
    ds_read_b64_tr_b16 v[28:29], v230 offset:0
    ds_read_b64_tr_b16 v[30:31], v230 offset:5120
    s_waitcnt lgkmcnt(8)
    v_mfma_f32_16x16x32_bf16 v[248:251], v[36:39], v[136:139], v[248:251]
    ds_read_b64_tr_b16 v[32:33], v227 offset:10240
    ds_read_b64_tr_b16 v[34:35], v227 offset:15360
    s_waitcnt lgkmcnt(8)
    v_mfma_f32_16x16x32_bf16 v[244:247], v[16:19], v[140:143], v[244:247]
    ds_read_b64_tr_b16 v[36:37], v230 offset:10240
    ds_read_b64_tr_b16 v[38:39], v230 offset:15360
    s_waitcnt lgkmcnt(8)
    v_mfma_f32_16x16x32_bf16 v[248:251], v[20:23], v[140:143], v[248:251]
    ds_read_b64_tr_b16 v[16:17], v227 offset:20480
    ds_read_b64_tr_b16 v[18:19], v227 offset:25600
    s_waitcnt lgkmcnt(8)
    v_mfma_f32_16x16x32_bf16 v[244:247], v[24:27], v[144:147], v[244:247]
    ds_read_b64_tr_b16 v[20:21], v230 offset:20480
    ds_read_b64_tr_b16 v[22:23], v230 offset:25600
    s_waitcnt lgkmcnt(8)
    v_mfma_f32_16x16x32_bf16 v[248:251], v[28:31], v[144:147], v[248:251]
    ds_read_b64_tr_b16 v[24:25], v227 offset:30720
    ds_read_b64_tr_b16 v[26:27], v227 offset:35840
    s_waitcnt lgkmcnt(8)
    v_mfma_f32_16x16x32_bf16 v[244:247], v[32:35], v[148:151], v[244:247]
    ds_read_b64_tr_b16 v[28:29], v230 offset:30720
    ds_read_b64_tr_b16 v[30:31], v230 offset:35840
    s_waitcnt lgkmcnt(8)
    v_mfma_f32_16x16x32_bf16 v[248:251], v[36:39], v[148:151], v[248:251]
    s_waitcnt lgkmcnt(6)
    v_mfma_f32_16x16x32_bf16 v[244:247], v[16:19], v[152:155], v[244:247]
    s_waitcnt lgkmcnt(4)
    v_mfma_f32_16x16x32_bf16 v[248:251], v[20:23], v[152:155], v[248:251]
    s_waitcnt lgkmcnt(2)
    v_mfma_f32_16x16x32_bf16 v[244:247], v[24:27], v[156:159], v[244:247]
    s_waitcnt lgkmcnt(0)
    v_mfma_f32_16x16x32_bf16 v[248:251], v[28:31], v[156:159], v[248:251]
    s_cmp_eq_u32 s49, 0
    s_cbranch_scc0 Lw3_34
    ds_read_b64_tr_b16 v[16:17], v217 offset:0
    ds_read_b64_tr_b16 v[18:19], v217 offset:5120
    ds_read_b64_tr_b16 v[20:21], v217 offset:10240
    ds_read_b64_tr_b16 v[22:23], v217 offset:15360
    ds_read_b64_tr_b16 v[24:25], v217 offset:20480
    ds_read_b64_tr_b16 v[26:27], v217 offset:25600
    ds_read_b64_tr_b16 v[28:29], v217 offset:30720
    ds_read_b64_tr_b16 v[30:31], v217 offset:35840
    ds_read_b64_tr_b16 v[32:33], v218 offset:0
    ds_read_b64_tr_b16 v[34:35], v218 offset:5120
    s_waitcnt lgkmcnt(8)
    v_mfma_f32_16x16x32_bf16 v[252:255], v[16:19], v[128:131], 0
    ds_read_b64_tr_b16 v[36:37], v218 offset:10240
    ds_read_b64_tr_b16 v[38:39], v218 offset:15360
    s_waitcnt lgkmcnt(8)
    v_mfma_f32_16x16x32_bf16 v[252:255], v[20:23], v[132:135], v[252:255]
    ds_read_b64_tr_b16 v[16:17], v218 offset:20480
    ds_read_b64_tr_b16 v[18:19], v218 offset:25600
    s_waitcnt lgkmcnt(8)
    v_mfma_f32_16x16x32_bf16 v[252:255], v[24:27], v[136:139], v[252:255]
    ds_read_b64_tr_b16 v[20:21], v218 offset:30720
    ds_read_b64_tr_b16 v[22:23], v218 offset:35840
    s_waitcnt lgkmcnt(8)
    v_mfma_f32_16x16x32_bf16 v[252:255], v[28:31], v[140:143], v[252:255]
    s_waitcnt lgkmcnt(6)
    v_mfma_f32_16x16x32_bf16 v[252:255], v[32:35], v[144:147], v[252:255]
    s_waitcnt lgkmcnt(4)
    v_mfma_f32_16x16x32_bf16 v[252:255], v[36:39], v[148:151], v[252:255]
    s_waitcnt lgkmcnt(2)
    v_mfma_f32_16x16x32_bf16 v[252:255], v[16:19], v[152:155], v[252:255]
    s_waitcnt lgkmcnt(0)
    v_mfma_f32_16x16x32_bf16 v[252:255], v[20:23], v[156:159], v[252:255]
    s_waitcnt lgkmcnt(0)
Lw3_34:
    s_waitcnt vmcnt(0)
    s_cmp_eq_u32 s37, s43
    s_cbranch_scc1 Lpfl_35
    s_lshl_b32 s55, s39, 11
    s_mul_i32 s59, s42, 512
    s_add_u32 s55, s55, s59
    s_mul_i32 s59, s37, 128
    s_add_u32 s55, s55, s59
    s_mul_i32 s59, s43, 8
    s_add_u32 s55, s55, s59
    s_add_u32 s55, s55, 50528256
    v_mov_b32 v8, s84
    v_mov_b32 v9, s85
    s_mov_b64 s[60:61], exec
    s_mov_b64 exec, 1
    buffer_store_dwordx2 v[8:9], off, s[24:27], s55 sc1
    s_mov_b64 exec, s[60:61]
Lpfl_35:
    s_waitcnt lgkmcnt(0)
    s_barrier
    s_cmp_eq_u32 s37, s43
    s_cbranch_scc0 Lown_36
    v_mov_b32 v1, v9
    ds_write_b128 v1, v[88:91] offset:0
    ds_write_b128 v1, v[92:95] offset:1024
    ds_write_b128 v1, v[96:99] offset:2048
    ds_write_b128 v1, v[100:103] offset:3072
    ds_write_b128 v1, v[104:107] offset:4096
    ds_write_b128 v1, v[108:111] offset:5120
    ds_write_b128 v1, v[112:115] offset:6144
    ds_write_b128 v1, v[116:119] offset:7168
    ds_write_b128 v1, v[120:123] offset:8192
    ds_write_b128 v1, v[124:127] offset:9216
Lown_36:
    ds_read_b64_tr_b16 v[16:17], v228 offset:0
    ds_read_b64_tr_b16 v[18:19], v228 offset:5120
    ds_read_b64_tr_b16 v[20:21], v231 offset:0
    ds_read_b64_tr_b16 v[22:23], v231 offset:5120
    ds_read_b64_tr_b16 v[24:25], v228 offset:10240
    ds_read_b64_tr_b16 v[26:27], v228 offset:15360
    ds_read_b64_tr_b16 v[28:29], v231 offset:10240
    ds_read_b64_tr_b16 v[30:31], v231 offset:15360
    ds_read_b64_tr_b16 v[32:33], v228 offset:20480
    ds_read_b64_tr_b16 v[34:35], v228 offset:25600
    s_waitcnt lgkmcnt(8)
    v_mfma_f32_16x16x32_bf16 v[244:247], v[16:19], v[160:163], v[244:247]
    ds_read_b64_tr_b16 v[36:37], v231 offset:20480
    ds_read_b64_tr_b16 v[38:39], v231 offset:25600
    s_waitcnt lgkmcnt(8)
    v_mfma_f32_16x16x32_bf16 v[248:251], v[20:23], v[160:163], v[248:251]
    ds_read_b64_tr_b16 v[16:17], v228 offset:30720
    ds_read_b64_tr_b16 v[18:19], v228 offset:35840
    s_waitcnt lgkmcnt(8)
    v_mfma_f32_16x16x32_bf16 v[244:247], v[24:27], v[164:167], v[244:247]
    ds_read_b64_tr_b16 v[20:21], v231 offset:30720
    ds_read_b64_tr_b16 v[22:23], v231 offset:35840
    s_waitcnt lgkmcnt(8)
    v_mfma_f32_16x16x32_bf16 v[248:251], v[28:31], v[164:167], v[248:251]
    s_waitcnt lgkmcnt(6)
    v_mfma_f32_16x16x32_bf16 v[244:247], v[32:35], v[168:171], v[244:247]
    s_waitcnt lgkmcnt(4)
    v_mfma_f32_16x16x32_bf16 v[248:251], v[36:39], v[168:171], v[248:251]
    s_waitcnt lgkmcnt(2)
    v_mfma_f32_16x16x32_bf16 v[244:247], v[16:19], v[172:175], v[244:247]
    s_waitcnt lgkmcnt(0)
    v_mfma_f32_16x16x32_bf16 v[248:251], v[20:23], v[172:175], v[248:251]
    s_cmp_eq_u32 s49, 0
    s_cbranch_scc0 Lw3_37
    ds_read_b64_tr_b16 v[16:17], v219 offset:0
    ds_read_b64_tr_b16 v[18:19], v219 offset:5120
    ds_read_b64_tr_b16 v[20:21], v219 offset:10240
    ds_read_b64_tr_b16 v[22:23], v219 offset:15360
    ds_read_b64_tr_b16 v[24:25], v219 offset:20480
    ds_read_b64_tr_b16 v[26:27], v219 offset:25600
    ds_read_b64_tr_b16 v[28:29], v219 offset:30720
    ds_read_b64_tr_b16 v[30:31], v219 offset:35840
    s_waitcnt lgkmcnt(6)
    v_mfma_f32_16x16x32_bf16 v[252:255], v[16:19], v[160:163], v[252:255]
    s_waitcnt lgkmcnt(4)
    v_mfma_f32_16x16x32_bf16 v[252:255], v[20:23], v[164:167], v[252:255]
    s_waitcnt lgkmcnt(2)
    v_mfma_f32_16x16x32_bf16 v[252:255], v[24:27], v[168:171], v[252:255]
    s_waitcnt lgkmcnt(0)
    v_mfma_f32_16x16x32_bf16 v[252:255], v[28:31], v[172:175], v[252:255]
    s_waitcnt lgkmcnt(0)
Lw3_37:
    s_lshl_b32 s55, s39, 11
    s_mul_i32 s59, s42, 512
    s_add_u32 s55, s55, s59
    s_mul_i32 s59, s43, 128
    s_add_u32 s55, s55, s59
    s_add_u32 s55, s55, 50528256
    s_lshl_b32 s51, 1, s43
    s_andn2_b32 s56, 15, s51
    s_mov_b32 s57, 0
    v_lshlrev_b32 v78, 3, v0
    s_mov_b64 s[60:61], exec
    s_mov_b64 exec, s[56:57]
    s_mov_b32 s58, 400000
Lpoll_38:
    buffer_load_dwordx2 v[76:77], v78, s[24:27], s55 offen sc1
    s_waitcnt vmcnt(0)
    v_cmp_eq_u32 vcc, s84, v76
    v_cmp_eq_u32 s[62:63], s85, v77
    s_nop 3
    s_and_b64 vcc, vcc, s[62:63]
    s_cmp_eq_u64 vcc, exec
    s_cbranch_scc1 Lpd_39
    s_sub_u32 s58, s58, 1
    s_cmp_eq_u32 s58, 0
    s_cbranch_scc1 Lpd_39
    s_branch Lpoll_38
Lpd_39:
    s_mov_b64 exec, s[60:61]
    s_add_u32 s51, s43, 1
    s_and_b32 s51, s51, 3
    s_mul_i32 s46, s51, 40960
    buffer_load_dwordx4 v[48:51], v241, s[8:11], s46 offen sc1
    buffer_load_dwordx2 v[52:53], v242, s[8:11], s46 offen sc1
    s_add_u32 s51, s43, 2
    s_and_b32 s51, s51, 3
    s_mul_i32 s46, s51, 40960
    buffer_load_dwordx4 v[56:59], v241, s[8:11], s46 offen sc1
    buffer_load_dwordx2 v[60:61], v242, s[8:11], s46 offen sc1
    s_add_u32 s51, s43, 3
    s_and_b32 s51, s51, 3
    s_mul_i32 s46, s51, 40960
    buffer_load_dwordx4 v[64:67], v241, s[8:11], s46 offen sc1
    buffer_load_dwordx2 v[68:69], v242, s[8:11], s46 offen sc1
    s_waitcnt lgkmcnt(0)
    s_barrier
    ds_read_b64_tr_b16 v[16:17], v226 offset:0
    ds_read_b64_tr_b16 v[18:19], v226 offset:5120
    ds_read_b64_tr_b16 v[20:21], v229 offset:0
    ds_read_b64_tr_b16 v[22:23], v229 offset:5120
    ds_read_b64_tr_b16 v[24:25], v226 offset:10240
    ds_read_b64_tr_b16 v[26:27], v226 offset:15360
    ds_read_b64_tr_b16 v[28:29], v229 offset:10240
    ds_read_b64_tr_b16 v[30:31], v229 offset:15360
    ds_read_b64_tr_b16 v[32:33], v226 offset:20480
    ds_read_b64_tr_b16 v[34:35], v226 offset:25600
    s_waitcnt lgkmcnt(8)
    v_mfma_f32_16x16x32_bf16 v[244:247], v[16:19], v[176:179], v[244:247]
    ds_read_b64_tr_b16 v[36:37], v229 offset:20480
    ds_read_b64_tr_b16 v[38:39], v229 offset:25600
    s_waitcnt lgkmcnt(8)
    v_mfma_f32_16x16x32_bf16 v[248:251], v[20:23], v[176:179], v[248:251]
    ds_read_b64_tr_b16 v[16:17], v226 offset:30720
    ds_read_b64_tr_b16 v[18:19], v226 offset:35840
    s_waitcnt lgkmcnt(8)
    v_mfma_f32_16x16x32_bf16 v[244:247], v[24:27], v[180:183], v[244:247]
    ds_read_b64_tr_b16 v[20:21], v229 offset:30720
    ds_read_b64_tr_b16 v[22:23], v229 offset:35840
    s_waitcnt lgkmcnt(8)
    v_mfma_f32_16x16x32_bf16 v[248:251], v[28:31], v[180:183], v[248:251]
    ds_read_b64_tr_b16 v[24:25], v227 offset:0
    ds_read_b64_tr_b16 v[26:27], v227 offset:5120
    s_waitcnt lgkmcnt(8)
    v_mfma_f32_16x16x32_bf16 v[244:247], v[32:35], v[184:187], v[244:247]
    ds_read_b64_tr_b16 v[28:29], v230 offset:0
    ds_read_b64_tr_b16 v[30:31], v230 offset:5120
    s_waitcnt lgkmcnt(8)
    v_mfma_f32_16x16x32_bf16 v[248:251], v[36:39], v[184:187], v[248:251]
    ds_read_b64_tr_b16 v[32:33], v227 offset:10240
    ds_read_b64_tr_b16 v[34:35], v227 offset:15360
    s_waitcnt lgkmcnt(8)
    v_mfma_f32_16x16x32_bf16 v[244:247], v[16:19], v[188:191], v[244:247]
    ds_read_b64_tr_b16 v[36:37], v230 offset:10240
    ds_read_b64_tr_b16 v[38:39], v230 offset:15360
    s_waitcnt lgkmcnt(8)
    v_mfma_f32_16x16x32_bf16 v[248:251], v[20:23], v[188:191], v[248:251]
    s_waitcnt lgkmcnt(6)
    v_mfma_f32_16x16x32_bf16 v[244:247], v[24:27], v[192:195], v[244:247]
    s_waitcnt lgkmcnt(4)
    v_mfma_f32_16x16x32_bf16 v[248:251], v[28:31], v[192:195], v[248:251]
    s_waitcnt lgkmcnt(2)
    v_mfma_f32_16x16x32_bf16 v[244:247], v[32:35], v[196:199], v[244:247]
    s_waitcnt lgkmcnt(0)
    v_mfma_f32_16x16x32_bf16 v[248:251], v[36:39], v[196:199], v[248:251]
    s_cmp_eq_u32 s49, 0
    s_cbranch_scc0 Lw3_40
    ds_read_b64_tr_b16 v[16:17], v217 offset:0
    ds_read_b64_tr_b16 v[18:19], v217 offset:5120
    ds_read_b64_tr_b16 v[20:21], v217 offset:10240
    ds_read_b64_tr_b16 v[22:23], v217 offset:15360
    ds_read_b64_tr_b16 v[24:25], v217 offset:20480
    ds_read_b64_tr_b16 v[26:27], v217 offset:25600
    ds_read_b64_tr_b16 v[28:29], v217 offset:30720
    ds_read_b64_tr_b16 v[30:31], v217 offset:35840
    ds_read_b64_tr_b16 v[32:33], v218 offset:0
    ds_read_b64_tr_b16 v[34:35], v218 offset:5120
    s_waitcnt lgkmcnt(8)
    v_mfma_f32_16x16x32_bf16 v[252:255], v[16:19], v[176:179], v[252:255]
    ds_read_b64_tr_b16 v[36:37], v218 offset:10240
    ds_read_b64_tr_b16 v[38:39], v218 offset:15360
    s_waitcnt lgkmcnt(8)
    v_mfma_f32_16x16x32_bf16 v[252:255], v[20:23], v[180:183], v[252:255]
    s_waitcnt lgkmcnt(6)
    v_mfma_f32_16x16x32_bf16 v[252:255], v[24:27], v[184:187], v[252:255]
    s_waitcnt lgkmcnt(4)
    v_mfma_f32_16x16x32_bf16 v[252:255], v[28:31], v[188:191], v[252:255]
    s_waitcnt lgkmcnt(2)
    v_mfma_f32_16x16x32_bf16 v[252:255], v[32:35], v[192:195], v[252:255]
    s_waitcnt lgkmcnt(0)
    v_mfma_f32_16x16x32_bf16 v[252:255], v[36:39], v[196:199], v[252:255]
    s_waitcnt lgkmcnt(0)
Lw3_40:
    ds_read_b128 v[40:43], v241 offset:0
    ds_read_b64 v[44:45], v242 offset:0
    s_waitcnt lgkmcnt(0)
    v_mul_f32 v243, v243, v243
    v_lshlrev_b32 v16, 16, v40
    v_and_b32 v17, 0xffff0000, v40
    v_lshlrev_b32 v18, 16, v41
    v_and_b32 v19, 0xffff0000, v41
    v_lshlrev_b32 v20, 16, v42
    v_and_b32 v21, 0xffff0000, v42
    v_lshlrev_b32 v22, 16, v43
    v_and_b32 v23, 0xffff0000, v43
    v_lshlrev_b32 v24, 16, v44
    v_and_b32 v25, 0xffff0000, v44
    v_lshlrev_b32 v26, 16, v45
    v_and_b32 v27, 0xffff0000, v45
    v_lshlrev_b32 v92, 16, v232
    v_and_b32 v93, 0xffff0000, v232
    v_lshlrev_b32 v94, 16, v233
    v_and_b32 v95, 0xffff0000, v233
    v_lshlrev_b32 v96, 16, v234
    v_and_b32 v97, 0xffff0000, v234
    v_lshlrev_b32 v98, 16, v235
    v_and_b32 v99, 0xffff0000, v235
    v_lshlrev_b32 v100, 16, v236
    v_and_b32 v101, 0xffff0000, v236
    v_lshlrev_b32 v102, 16, v237
    v_and_b32 v103, 0xffff0000, v237
    s_waitcnt vmcnt(4)
    v_lshlrev_b32 v76, 16, v48
    v_and_b32 v77, 0xffff0000, v48
    v_lshlrev_b32 v78, 16, v49
    v_and_b32 v79, 0xffff0000, v49
    v_lshlrev_b32 v80, 16, v50
    v_and_b32 v81, 0xffff0000, v50
    v_lshlrev_b32 v82, 16, v51
    v_and_b32 v83, 0xffff0000, v51
    v_lshlrev_b32 v84, 16, v52
    v_and_b32 v85, 0xffff0000, v52
    v_lshlrev_b32 v86, 16, v53
    v_and_b32 v87, 0xffff0000, v53
    v_add_f32 v16, v16, v76
    v_add_f32 v17, v17, v77
    v_add_f32 v18, v18, v78
    v_add_f32 v19, v19, v79
    v_add_f32 v20, v20, v80
    v_add_f32 v21, v21, v81
    v_add_f32 v22, v22, v82
    v_add_f32 v23, v23, v83
    v_add_f32 v24, v24, v84
    v_add_f32 v25, v25, v85
    v_add_f32 v26, v26, v86
    v_add_f32 v27, v27, v87
    s_waitcnt vmcnt(2)
    v_lshlrev_b32 v76, 16, v56
    v_and_b32 v77, 0xffff0000, v56
    v_lshlrev_b32 v78, 16, v57
    v_and_b32 v79, 0xffff0000, v57
    v_lshlrev_b32 v80, 16, v58
    v_and_b32 v81, 0xffff0000, v58
    v_lshlrev_b32 v82, 16, v59
    v_and_b32 v83, 0xffff0000, v59
    v_lshlrev_b32 v84, 16, v60
    v_and_b32 v85, 0xffff0000, v60
    v_lshlrev_b32 v86, 16, v61
    v_and_b32 v87, 0xffff0000, v61
    v_add_f32 v16, v16, v76
    v_add_f32 v17, v17, v77
    v_add_f32 v18, v18, v78
    v_add_f32 v19, v19, v79
    v_add_f32 v20, v20, v80
    v_add_f32 v21, v21, v81
    v_add_f32 v22, v22, v82
    v_add_f32 v23, v23, v83
    v_add_f32 v24, v24, v84
    v_add_f32 v25, v25, v85
    v_add_f32 v26, v26, v86
    v_add_f32 v27, v27, v87
    s_waitcnt vmcnt(0)
    v_lshlrev_b32 v76, 16, v64
    v_and_b32 v77, 0xffff0000, v64
    v_lshlrev_b32 v78, 16, v65
    v_and_b32 v79, 0xffff0000, v65
    v_lshlrev_b32 v80, 16, v66
    v_and_b32 v81, 0xffff0000, v66
    v_lshlrev_b32 v82, 16, v67
    v_and_b32 v83, 0xffff0000, v67
    v_lshlrev_b32 v84, 16, v68
    v_and_b32 v85, 0xffff0000, v68
    v_lshlrev_b32 v86, 16, v69
    v_and_b32 v87, 0xffff0000, v69
    v_add_f32 v16, v16, v76
    v_add_f32 v17, v17, v77
    v_add_f32 v18, v18, v78
    v_add_f32 v19, v19, v79
    v_add_f32 v20, v20, v80
    v_add_f32 v21, v21, v81
    v_add_f32 v22, v22, v82
    v_add_f32 v23, v23, v83
    v_add_f32 v24, v24, v84
    v_add_f32 v25, v25, v85
    v_add_f32 v26, v26, v86
    v_add_f32 v27, v27, v87
    v_mul_f32 v16, v243, v16
    v_mul_f32 v17, v243, v17
    v_mul_f32 v18, v243, v18
    v_mul_f32 v19, v243, v19
    v_mul_f32 v20, v243, v20
    v_mul_f32 v21, v243, v21
    v_mul_f32 v22, v243, v22
    v_mul_f32 v23, v243, v23
    v_mul_f32 v24, v243, v24
    v_mul_f32 v25, v243, v25
    v_mul_f32 v26, v243, v26
    v_mul_f32 v27, v243, v27
    s_mov_b32 s51, 0xbfb8aa3b
    v_mul_f32 v76, s51, v16
    v_mul_f32 v77, s51, v17
    v_mul_f32 v78, s51, v18
    v_mul_f32 v79, s51, v19
    v_mul_f32 v80, s51, v20
    v_mul_f32 v81, s51, v21
    v_mul_f32 v82, s51, v22
    v_mul_f32 v83, s51, v23
    v_mul_f32 v84, s51, v24
    v_mul_f32 v85, s51, v25
    v_mul_f32 v86, s51, v26
    v_mul_f32 v87, s51, v27
    v_exp_f32 v76, v76
    v_exp_f32 v77, v77
    v_exp_f32 v78, v78
    v_exp_f32 v79, v79
    v_exp_f32 v80, v80
    v_exp_f32 v81, v81
    v_exp_f32 v82, v82
    v_exp_f32 v83, v83
    v_exp_f32 v84, v84
    v_exp_f32 v85, v85
    v_exp_f32 v86, v86
    v_exp_f32 v87, v87
    s_nop 0
    v_add_f32 v76, 1.0, v76
    v_add_f32 v77, 1.0, v77
    v_add_f32 v78, 1.0, v78
    v_add_f32 v79, 1.0, v79
    v_add_f32 v80, 1.0, v80
    v_add_f32 v81, 1.0, v81
    v_add_f32 v82, 1.0, v82
    v_add_f32 v83, 1.0, v83
    v_add_f32 v84, 1.0, v84
    v_add_f32 v85, 1.0, v85
    v_add_f32 v86, 1.0, v86
    v_add_f32 v87, 1.0, v87
    v_rcp_f32 v76, v76
    v_rcp_f32 v77, v77
    v_rcp_f32 v78, v78
    v_rcp_f32 v79, v79
    v_rcp_f32 v80, v80
    v_rcp_f32 v81, v81
    v_rcp_f32 v82, v82
    v_rcp_f32 v83, v83
    v_rcp_f32 v84, v84
    v_rcp_f32 v85, v85
    v_rcp_f32 v86, v86
    v_rcp_f32 v87, v87
    s_nop 0
    v_mul_f32 v16, v16, v76
    v_mul_f32 v17, v17, v77
    v_mul_f32 v18, v18, v78
    v_mul_f32 v19, v19, v79
    v_mul_f32 v20, v20, v80
    v_mul_f32 v21, v21, v81
    v_mul_f32 v22, v22, v82
    v_mul_f32 v23, v23, v83
    v_mul_f32 v24, v24, v84
    v_mul_f32 v25, v25, v85
    v_mul_f32 v26, v26, v86
    v_mul_f32 v27, v27, v87
    v_fma_f32 v16, v244, v16, v92
    v_fma_f32 v17, v245, v17, v93
    v_fma_f32 v18, v246, v18, v94
    v_fma_f32 v19, v247, v19, v95
    v_fma_f32 v20, v248, v20, v96
    v_fma_f32 v21, v249, v21, v97
    v_fma_f32 v22, v250, v22, v98
    v_fma_f32 v23, v251, v23, v99
    v_fma_f32 v24, v252, v24, v100
    v_fma_f32 v25, v253, v25, v101
    v_fma_f32 v26, v254, v26, v102
    v_fma_f32 v27, v255, v27, v103
    v_cvt_pk_bf16_f32 v232, v16, v17
    v_cvt_pk_bf16_f32 v233, v18, v19
    v_cvt_pk_bf16_f32 v234, v20, v21
    v_cvt_pk_bf16_f32 v235, v22, v23
    v_cvt_pk_bf16_f32 v236, v24, v25
    v_cvt_pk_bf16_f32 v237, v26, v27
    buffer_store_dwordx2 v[232:233], v238, s[12:15], 0 offen
    buffer_store_dwordx2 v[234:235], v239, s[12:15], 0 offen
    buffer_store_dwordx2 v[236:237], v240, s[12:15], 0 offen
    s_endpgm
L_helper:
    .p2align 3
    s_barrier
    ds_read_b64_tr_b16 v[224:225], v4 offset:24576
    s_cmp_eq_u32 s36, 4
    s_cbranch_scc0 Lpf_41
    s_and_b32 s55, s39, 15
    s_mul_i32 s55, s55, 12
    v_min_u32 v1, 11, v0
    v_add_u32 v1, s55, v1
    v_mul_u32_u24 v1, 9216, v1
    s_mul_i32 s55, s41, 640
    s_add_u32 s55, s55, 384
    buffer_load_dword v11, v1, s[8:11], s55 offen
Lpf_41:
    ds_read_b64_tr_b16 v[226:227], v4 offset:26624
    ds_read_b64_tr_b16 v[228:229], v4 offset:28672
    ds_read_b64_tr_b16 v[230:231], v4 offset:30720
    ds_read_b64_tr_b16 v[232:233], v4 offset:32768
    ds_read_b64_tr_b16 v[234:235], v4 offset:34816
    ds_read_b64_tr_b16 v[236:237], v4 offset:36864
    ds_read_b64_tr_b16 v[238:239], v4 offset:38912
    s_waitcnt lgkmcnt(4)
    v_mfma_f32_16x16x32_bf16 v[160:163], v[224:227], v[16:19], 0
    ds_read_b64_tr_b16 v[240:241], v4 offset:40960
    v_mfma_f32_16x16x32_bf16 v[164:167], v[224:227], v[88:91], 0
    ds_read_b64_tr_b16 v[242:243], v4 offset:43008
    v_mfma_f32_16x16x32_bf16 v[164:167], v[228:231], v[92:95], v[164:167]
    ds_read_b64_tr_b16 v[244:245], v4 offset:45056
    v_mfma_f32_16x16x32_bf16 v[160:163], v[228:231], v[20:23], v[160:163]
    ds_read_b64_tr_b16 v[246:247], v4 offset:47104
    s_waitcnt lgkmcnt(4)
    v_mfma_f32_16x16x32_bf16 v[160:163], v[232:235], v[24:27], v[160:163]
    ds_read_b64_tr_b16 v[224:225], v7 offset:24576
    v_mfma_f32_16x16x32_bf16 v[164:167], v[232:235], v[96:99], v[164:167]
    ds_read_b64_tr_b16 v[226:227], v7 offset:26624
    v_mfma_f32_16x16x32_bf16 v[172:175], v[236:239], v[88:91], 0
    ds_read_b64_tr_b16 v[228:229], v7 offset:28672
    v_mfma_f32_16x16x32_bf16 v[168:171], v[236:239], v[16:19], 0
    ds_read_b64_tr_b16 v[230:231], v7 offset:30720
    s_waitcnt lgkmcnt(4)
    v_mfma_f32_16x16x32_bf16 v[168:171], v[240:243], v[20:23], v[168:171]
    ds_read_b64_tr_b16 v[232:233], v7 offset:32768
    v_mfma_f32_16x16x32_bf16 v[172:175], v[240:243], v[92:95], v[172:175]
    ds_read_b64_tr_b16 v[234:235], v7 offset:34816
    v_mfma_f32_16x16x32_bf16 v[172:175], v[244:247], v[96:99], v[172:175]
    ds_read_b64_tr_b16 v[236:237], v7 offset:36864
    v_mfma_f32_16x16x32_bf16 v[168:171], v[244:247], v[24:27], v[168:171]
    ds_read_b64_tr_b16 v[238:239], v7 offset:38912
    s_waitcnt lgkmcnt(4)
    v_mfma_f32_16x16x32_bf16 v[176:179], v[224:227], v[16:19], 0
    ds_read_b64_tr_b16 v[240:241], v7 offset:40960
    v_mfma_f32_16x16x32_bf16 v[180:183], v[224:227], v[88:91], 0
    ds_read_b64_tr_b16 v[242:243], v7 offset:43008
    v_mfma_f32_16x16x32_bf16 v[180:183], v[228:231], v[92:95], v[180:183]
    ds_read_b64_tr_b16 v[244:245], v7 offset:45056
    v_mfma_f32_16x16x32_bf16 v[176:179], v[228:231], v[20:23], v[176:179]
    ds_read_b64_tr_b16 v[246:247], v7 offset:47104
    s_barrier
    v_mov_b32 v1, 0
    global_load_dwordx2 v[194:195], v1, s[80:81] sc1
    s_waitcnt lgkmcnt(4)
    v_mfma_f32_16x16x32_bf16 v[176:179], v[232:235], v[24:27], v[176:179]
    ds_read_b64_tr_b16 v[224:225], v5 offset:0
    s_cmp_eq_u32 s36, 5
    s_cbranch_scc0 Lpf_42
    s_and_b32 s55, s39, 15
    s_mul_i32 s55, s55, 12
    v_min_u32 v1, 11, v0
    v_add_u32 v1, s55, v1
    v_mul_u32_u24 v1, 9216, v1
    s_mul_i32 s55, s41, 640
    s_add_u32 s55, s55, 384
    buffer_load_dword v11, v1, s[28:31], s55 offen
Lpf_42:
    v_mfma_f32_16x16x32_bf16 v[180:183], v[232:235], v[96:99], v[180:183]
    ds_read_b64_tr_b16 v[226:227], v5 offset:2048
    v_mfma_f32_16x16x32_bf16 v[188:191], v[236:239], v[88:91], 0
    ds_read_b64_tr_b16 v[228:229], v5 offset:4096
    v_mfma_f32_16x16x32_bf16 v[184:187], v[236:239], v[16:19], 0
    ds_read_b64_tr_b16 v[230:231], v5 offset:6144
    s_waitcnt lgkmcnt(4)
    v_mfma_f32_16x16x32_bf16 v[184:187], v[240:243], v[20:23], v[184:187]
    ds_read_b64_tr_b16 v[232:233], v5 offset:8192
    v_mfma_f32_16x16x32_bf16 v[188:191], v[240:243], v[92:95], v[188:191]
    ds_read_b64_tr_b16 v[234:235], v5 offset:10240
    v_mfma_f32_16x16x32_bf16 v[188:191], v[244:247], v[96:99], v[188:191]
    ds_read_b64_tr_b16 v[236:237], v5 offset:12288
    v_mfma_f32_16x16x32_bf16 v[184:187], v[244:247], v[24:27], v[184:187]
    ds_read_b64_tr_b16 v[238:239], v5 offset:14336
    s_waitcnt lgkmcnt(4)
    v_mfma_f32_16x16x32_bf16 v[160:163], v[224:227], v[28:31], v[160:163]
    ds_read_b64_tr_b16 v[240:241], v5 offset:16384
    v_mfma_f32_16x16x32_bf16 v[164:167], v[224:227], v[100:103], v[164:167]
    ds_read_b64_tr_b16 v[242:243], v5 offset:18432
    v_mfma_f32_16x16x32_bf16 v[164:167], v[228:231], v[104:107], v[164:167]
    ds_read_b64_tr_b16 v[244:245], v5 offset:20480
    v_mfma_f32_16x16x32_bf16 v[160:163], v[228:231], v[32:35], v[160:163]
    ds_read_b64_tr_b16 v[246:247], v5 offset:22528
    s_waitcnt lgkmcnt(4)
    v_mfma_f32_16x16x32_bf16 v[160:163], v[232:235], v[36:39], v[160:163]
    ds_read_b64_tr_b16 v[224:225], v8 offset:0
    v_mfma_f32_16x16x32_bf16 v[164:167], v[232:235], v[108:111], v[164:167]
    ds_read_b64_tr_b16 v[226:227], v8 offset:2048
    v_mfma_f32_16x16x32_bf16 v[172:175], v[236:239], v[100:103], v[172:175]
    ds_read_b64_tr_b16 v[228:229], v8 offset:4096
    v_mfma_f32_16x16x32_bf16 v[168:171], v[236:239], v[28:31], v[168:171]
    ds_read_b64_tr_b16 v[230:231], v8 offset:6144
    s_waitcnt lgkmcnt(4)
    v_mfma_f32_16x16x32_bf16 v[168:171], v[240:243], v[32:35], v[168:171]
    ds_read_b64_tr_b16 v[232:233], v8 offset:8192
    v_mfma_f32_16x16x32_bf16 v[172:175], v[240:243], v[104:107], v[172:175]
    ds_read_b64_tr_b16 v[234:235], v8 offset:10240
    v_mfma_f32_16x16x32_bf16 v[172:175], v[244:247], v[108:111], v[172:175]
    ds_read_b64_tr_b16 v[236:237], v8 offset:12288
    v_mfma_f32_16x16x32_bf16 v[168:171], v[244:247], v[36:39], v[168:171]
    ds_read_b64_tr_b16 v[238:239], v8 offset:14336
    s_waitcnt lgkmcnt(4)
    v_mfma_f32_16x16x32_bf16 v[176:179], v[224:227], v[28:31], v[176:179]
    ds_read_b64_tr_b16 v[240:241], v8 offset:16384
    v_mfma_f32_16x16x32_bf16 v[180:183], v[224:227], v[100:103], v[180:183]
    ds_read_b64_tr_b16 v[242:243], v8 offset:18432
    v_mfma_f32_16x16x32_bf16 v[180:183], v[228:231], v[104:107], v[180:183]
    ds_read_b64_tr_b16 v[244:245], v8 offset:20480
    v_mfma_f32_16x16x32_bf16 v[176:179], v[228:231], v[32:35], v[176:179]
    ds_read_b64_tr_b16 v[246:247], v8 offset:22528
    s_barrier
    s_waitcnt lgkmcnt(4)
    v_mfma_f32_16x16x32_bf16 v[176:179], v[232:235], v[36:39], v[176:179]
    ds_read_b64_tr_b16 v[224:225], v5 offset:24576
    s_cmp_eq_u32 s36, 6
    s_cbranch_scc0 Lpf_43
    s_and_b32 s55, s39, 15
    s_mul_i32 s55, s55, 12
    v_min_u32 v1, 11, v0
    v_add_u32 v1, s55, v1
    v_mul_u32_u24 v1, 9216, v1
    s_mul_i32 s55, s41, 640
    s_add_u32 s55, s55, 1769856
    buffer_load_dword v11, v1, s[8:11], s55 offen
Lpf_43:
    v_mfma_f32_16x16x32_bf16 v[180:183], v[232:235], v[108:111], v[180:183]
    ds_read_b64_tr_b16 v[226:227], v5 offset:26624
    v_mfma_f32_16x16x32_bf16 v[188:191], v[236:239], v[100:103], v[188:191]
    ds_read_b64_tr_b16 v[228:229], v5 offset:28672
    v_mfma_f32_16x16x32_bf16 v[184:187], v[236:239], v[28:31], v[184:187]
    ds_read_b64_tr_b16 v[230:231], v5 offset:30720
    s_waitcnt lgkmcnt(4)
    v_mfma_f32_16x16x32_bf16 v[184:187], v[240:243], v[32:35], v[184:187]
    ds_read_b64_tr_b16 v[232:233], v5 offset:32768
    v_mfma_f32_16x16x32_bf16 v[188:191], v[240:243], v[104:107], v[188:191]
    ds_read_b64_tr_b16 v[234:235], v5 offset:34816
    v_mfma_f32_16x16x32_bf16 v[188:191], v[244:247], v[108:111], v[188:191]
    ds_read_b64_tr_b16 v[236:237], v5 offset:36864
    v_mfma_f32_16x16x32_bf16 v[184:187], v[244:247], v[36:39], v[184:187]
    ds_read_b64_tr_b16 v[238:239], v5 offset:38912
    s_waitcnt lgkmcnt(4)
    v_mfma_f32_16x16x32_bf16 v[160:163], v[224:227], v[40:43], v[160:163]
    ds_read_b64_tr_b16 v[240:241], v5 offset:40960
    v_mfma_f32_16x16x32_bf16 v[164:167], v[224:227], v[112:115], v[164:167]
    ds_read_b64_tr_b16 v[242:243], v5 offset:43008
    v_mfma_f32_16x16x32_bf16 v[164:167], v[228:231], v[116:119], v[164:167]
    ds_read_b64_tr_b16 v[244:245], v5 offset:45056
    v_mfma_f32_16x16x32_bf16 v[160:163], v[228:231], v[44:47], v[160:163]
    ds_read_b64_tr_b16 v[246:247], v5 offset:47104
    s_waitcnt lgkmcnt(4)
    v_mfma_f32_16x16x32_bf16 v[160:163], v[232:235], v[48:51], v[160:163]
    ds_read_b64_tr_b16 v[224:225], v8 offset:24576
    v_mfma_f32_16x16x32_bf16 v[164:167], v[232:235], v[120:123], v[164:167]
    ds_read_b64_tr_b16 v[226:227], v8 offset:26624
    v_mfma_f32_16x16x32_bf16 v[172:175], v[236:239], v[112:115], v[172:175]
    ds_read_b64_tr_b16 v[228:229], v8 offset:28672
    v_mfma_f32_16x16x32_bf16 v[168:171], v[236:239], v[40:43], v[168:171]
    ds_read_b64_tr_b16 v[230:231], v8 offset:30720
    s_waitcnt lgkmcnt(4)
    v_mfma_f32_16x16x32_bf16 v[168:171], v[240:243], v[44:47], v[168:171]
    ds_read_b64_tr_b16 v[232:233], v8 offset:32768
    v_mfma_f32_16x16x32_bf16 v[172:175], v[240:243], v[116:119], v[172:175]
    ds_read_b64_tr_b16 v[234:235], v8 offset:34816
    v_mfma_f32_16x16x32_bf16 v[172:175], v[244:247], v[120:123], v[172:175]
    ds_read_b64_tr_b16 v[236:237], v8 offset:36864
    v_mfma_f32_16x16x32_bf16 v[168:171], v[244:247], v[48:51], v[168:171]
    ds_read_b64_tr_b16 v[238:239], v8 offset:38912
    s_waitcnt lgkmcnt(4)
    v_mfma_f32_16x16x32_bf16 v[176:179], v[224:227], v[40:43], v[176:179]
    ds_read_b64_tr_b16 v[240:241], v8 offset:40960
    v_mfma_f32_16x16x32_bf16 v[180:183], v[224:227], v[112:115], v[180:183]
    ds_read_b64_tr_b16 v[242:243], v8 offset:43008
    v_mfma_f32_16x16x32_bf16 v[180:183], v[228:231], v[116:119], v[180:183]
    ds_read_b64_tr_b16 v[244:245], v8 offset:45056
    v_mfma_f32_16x16x32_bf16 v[176:179], v[228:231], v[44:47], v[176:179]
    ds_read_b64_tr_b16 v[246:247], v8 offset:47104
    s_barrier
    s_waitcnt lgkmcnt(4)
    v_mfma_f32_16x16x32_bf16 v[176:179], v[232:235], v[48:51], v[176:179]
    ds_read_b64_tr_b16 v[224:225], v3 offset:0
    s_cmp_eq_u32 s36, 7
    s_cbranch_scc0 Lpf_44
    s_and_b32 s55, s39, 15
    s_mul_i32 s55, s55, 12
    v_min_u32 v1, 11, v0
    v_add_u32 v1, s55, v1
    v_mul_u32_u24 v1, 9216, v1
    s_mul_i32 s55, s41, 640
    s_add_u32 s55, s55, 1769856
    buffer_load_dword v11, v1, s[28:31], s55 offen
Lpf_44:
    v_mfma_f32_16x16x32_bf16 v[180:183], v[232:235], v[120:123], v[180:183]
    ds_read_b64_tr_b16 v[226:227], v3 offset:2048
    v_mfma_f32_16x16x32_bf16 v[188:191], v[236:239], v[112:115], v[188:191]
    ds_read_b64_tr_b16 v[228:229], v3 offset:4096
    v_mfma_f32_16x16x32_bf16 v[184:187], v[236:239], v[40:43], v[184:187]
    ds_read_b64_tr_b16 v[230:231], v3 offset:6144
    s_waitcnt lgkmcnt(4)
    v_mfma_f32_16x16x32_bf16 v[184:187], v[240:243], v[44:47], v[184:187]
    ds_read_b64_tr_b16 v[232:233], v3 offset:8192
    v_mfma_f32_16x16x32_bf16 v[188:191], v[240:243], v[116:119], v[188:191]
    ds_read_b64_tr_b16 v[234:235], v3 offset:10240
    v_mfma_f32_16x16x32_bf16 v[188:191], v[244:247], v[120:123], v[188:191]
    ds_read_b64_tr_b16 v[236:237], v3 offset:12288
    v_mfma_f32_16x16x32_bf16 v[184:187], v[244:247], v[48:51], v[184:187]
    ds_read_b64_tr_b16 v[238:239], v3 offset:14336
    s_waitcnt lgkmcnt(4)
    v_mfma_f32_16x16x32_bf16 v[160:163], v[224:227], v[52:55], v[160:163]
    ds_read_b64_tr_b16 v[240:241], v3 offset:16384
    v_mfma_f32_16x16x32_bf16 v[164:167], v[224:227], v[124:127], v[164:167]
    ds_read_b64_tr_b16 v[242:243], v3 offset:18432
    v_mfma_f32_16x16x32_bf16 v[164:167], v[228:231], v[128:131], v[164:167]
    ds_read_b64_tr_b16 v[244:245], v3 offset:20480
    v_mfma_f32_16x16x32_bf16 v[160:163], v[228:231], v[56:59], v[160:163]
    ds_read_b64_tr_b16 v[246:247], v3 offset:22528
    s_waitcnt lgkmcnt(4)
    v_mfma_f32_16x16x32_bf16 v[160:163], v[232:235], v[60:63], v[160:163]
    ds_read_b64_tr_b16 v[224:225], v6 offset:0
    v_mfma_f32_16x16x32_bf16 v[164:167], v[232:235], v[132:135], v[164:167]
    ds_read_b64_tr_b16 v[226:227], v6 offset:2048
    v_mfma_f32_16x16x32_bf16 v[172:175], v[236:239], v[124:127], v[172:175]
    ds_read_b64_tr_b16 v[228:229], v6 offset:4096
    v_mfma_f32_16x16x32_bf16 v[168:171], v[236:239], v[52:55], v[168:171]
    ds_read_b64_tr_b16 v[230:231], v6 offset:6144
    s_waitcnt lgkmcnt(4)
    v_mfma_f32_16x16x32_bf16 v[168:171], v[240:243], v[56:59], v[168:171]
    ds_read_b64_tr_b16 v[232:233], v6 offset:8192
    v_mfma_f32_16x16x32_bf16 v[172:175], v[240:243], v[128:131], v[172:175]
    ds_read_b64_tr_b16 v[234:235], v6 offset:10240
    v_mfma_f32_16x16x32_bf16 v[172:175], v[244:247], v[132:135], v[172:175]
    ds_read_b64_tr_b16 v[236:237], v6 offset:12288
    v_mfma_f32_16x16x32_bf16 v[168:171], v[244:247], v[60:63], v[168:171]
    ds_read_b64_tr_b16 v[238:239], v6 offset:14336
    s_waitcnt lgkmcnt(4)
    v_mfma_f32_16x16x32_bf16 v[176:179], v[224:227], v[52:55], v[176:179]
    ds_read_b64_tr_b16 v[240:241], v6 offset:16384
    v_mfma_f32_16x16x32_bf16 v[180:183], v[224:227], v[124:127], v[180:183]
    ds_read_b64_tr_b16 v[242:243], v6 offset:18432
    v_mfma_f32_16x16x32_bf16 v[180:183], v[228:231], v[128:131], v[180:183]
    ds_read_b64_tr_b16 v[244:245], v6 offset:20480
    v_mfma_f32_16x16x32_bf16 v[176:179], v[228:231], v[56:59], v[176:179]
    ds_read_b64_tr_b16 v[246:247], v6 offset:22528
    s_barrier
    s_waitcnt lgkmcnt(4)
    v_mfma_f32_16x16x32_bf16 v[176:179], v[232:235], v[60:63], v[176:179]
    ds_read_b64_tr_b16 v[224:225], v3 offset:24576
    s_cmp_eq_u32 s36, 4
    s_cbranch_scc0 Lpf_45
    s_and_b32 s55, s39, 15
    s_mul_i32 s55, s55, 12
    v_min_u32 v1, 11, v0
    v_add_u32 v1, s55, v1
    v_mul_u32_u24 v1, 9216, v1
    s_mul_i32 s55, s41, 640
    s_add_u32 s55, s55, 3539328
    buffer_load_dword v11, v1, s[8:11], s55 offen
Lpf_45:
    v_mfma_f32_16x16x32_bf16 v[180:183], v[232:235], v[132:135], v[180:183]
    ds_read_b64_tr_b16 v[226:227], v3 offset:26624
    v_mfma_f32_16x16x32_bf16 v[188:191], v[236:239], v[124:127], v[188:191]
    ds_read_b64_tr_b16 v[228:229], v3 offset:28672
    v_mfma_f32_16x16x32_bf16 v[184:187], v[236:239], v[52:55], v[184:187]
    ds_read_b64_tr_b16 v[230:231], v3 offset:30720
    s_waitcnt lgkmcnt(4)
    v_mfma_f32_16x16x32_bf16 v[184:187], v[240:243], v[56:59], v[184:187]
    ds_read_b64_tr_b16 v[232:233], v3 offset:32768
    v_mfma_f32_16x16x32_bf16 v[188:191], v[240:243], v[128:131], v[188:191]
    ds_read_b64_tr_b16 v[234:235], v3 offset:34816
    v_mfma_f32_16x16x32_bf16 v[188:191], v[244:247], v[132:135], v[188:191]
    ds_read_b64_tr_b16 v[236:237], v3 offset:36864
    v_mfma_f32_16x16x32_bf16 v[184:187], v[244:247], v[60:63], v[184:187]
    ds_read_b64_tr_b16 v[238:239], v3 offset:38912
    s_waitcnt lgkmcnt(4)
    v_mfma_f32_16x16x32_bf16 v[160:163], v[224:227], v[64:67], v[160:163]
    ds_read_b64_tr_b16 v[240:241], v3 offset:40960
    v_mfma_f32_16x16x32_bf16 v[164:167], v[224:227], v[136:139], v[164:167]
    ds_read_b64_tr_b16 v[242:243], v3 offset:43008
    v_mfma_f32_16x16x32_bf16 v[164:167], v[228:231], v[140:143], v[164:167]
    ds_read_b64_tr_b16 v[244:245], v3 offset:45056
    v_mfma_f32_16x16x32_bf16 v[160:163], v[228:231], v[68:71], v[160:163]
    ds_read_b64_tr_b16 v[246:247], v3 offset:47104
    s_waitcnt lgkmcnt(4)
    v_mfma_f32_16x16x32_bf16 v[160:163], v[232:235], v[72:75], v[160:163]
    ds_read_b64_tr_b16 v[224:225], v6 offset:24576
    v_mfma_f32_16x16x32_bf16 v[164:167], v[232:235], v[144:147], v[164:167]
    ds_read_b64_tr_b16 v[226:227], v6 offset:26624
    v_mfma_f32_16x16x32_bf16 v[172:175], v[236:239], v[136:139], v[172:175]
    ds_read_b64_tr_b16 v[228:229], v6 offset:28672
    v_mfma_f32_16x16x32_bf16 v[168:171], v[236:239], v[64:67], v[168:171]
    ds_read_b64_tr_b16 v[230:231], v6 offset:30720
    s_waitcnt lgkmcnt(4)
    v_mfma_f32_16x16x32_bf16 v[168:171], v[240:243], v[68:71], v[168:171]
    ds_read_b64_tr_b16 v[232:233], v6 offset:32768
    v_mfma_f32_16x16x32_bf16 v[172:175], v[240:243], v[140:143], v[172:175]
    ds_read_b64_tr_b16 v[234:235], v6 offset:34816
    v_mfma_f32_16x16x32_bf16 v[172:175], v[244:247], v[144:147], v[172:175]
    ds_read_b64_tr_b16 v[236:237], v6 offset:36864
    v_mfma_f32_16x16x32_bf16 v[168:171], v[244:247], v[72:75], v[168:171]
    ds_read_b64_tr_b16 v[238:239], v6 offset:38912
    s_waitcnt lgkmcnt(4)
    v_mfma_f32_16x16x32_bf16 v[176:179], v[224:227], v[64:67], v[176:179]
    ds_read_b64_tr_b16 v[240:241], v6 offset:40960
    v_mfma_f32_16x16x32_bf16 v[180:183], v[224:227], v[136:139], v[180:183]
    ds_read_b64_tr_b16 v[242:243], v6 offset:43008
    v_mfma_f32_16x16x32_bf16 v[180:183], v[228:231], v[140:143], v[180:183]
    ds_read_b64_tr_b16 v[244:245], v6 offset:45056
    v_mfma_f32_16x16x32_bf16 v[176:179], v[228:231], v[68:71], v[176:179]
    ds_read_b64_tr_b16 v[246:247], v6 offset:47104
    s_waitcnt vmcnt(0)
    s_waitcnt vmcnt(0)
    s_mov_b32 s58, 400000
Lnsp_47:
    v_readfirstlane_b32 s84, v194
    v_readfirstlane_b32 s85, v195
    s_nop 3
    s_not_b32 s57, s84
    s_cmp_eq_u32 s57, s85
    s_cbranch_scc1 Lnok_46
    s_sub_u32 s58, s58, 1
    s_cmp_eq_u32 s58, 0
    s_cbranch_scc1 Lnok_46
    v_mov_b32 v1, 0
    global_load_dwordx2 v[194:195], v1, s[80:81] sc1
    s_waitcnt vmcnt(0)
    s_branch Lnsp_47
Lnok_46:
    s_barrier
    s_waitcnt lgkmcnt(4)
    v_mfma_f32_16x16x32_bf16 v[176:179], v[232:235], v[72:75], v[176:179]
    ds_read_b64_tr_b16 v[224:225], v4 offset:0
    s_cmp_eq_u32 s36, 5
    s_cbranch_scc0 Lpf_48
    s_and_b32 s55, s39, 15
    s_mul_i32 s55, s55, 12
    v_min_u32 v1, 11, v0
    v_add_u32 v1, s55, v1
    v_mul_u32_u24 v1, 9216, v1
    s_mul_i32 s55, s41, 640
    s_add_u32 s55, s55, 3539328
    buffer_load_dword v11, v1, s[28:31], s55 offen
Lpf_48:
    v_mfma_f32_16x16x32_bf16 v[180:183], v[232:235], v[144:147], v[180:183]
    ds_read_b64_tr_b16 v[226:227], v4 offset:2048
    v_mfma_f32_16x16x32_bf16 v[188:191], v[236:239], v[136:139], v[188:191]
    ds_read_b64_tr_b16 v[228:229], v4 offset:4096
    v_mfma_f32_16x16x32_bf16 v[184:187], v[236:239], v[64:67], v[184:187]
    ds_read_b64_tr_b16 v[230:231], v4 offset:6144
    s_waitcnt lgkmcnt(4)
    v_mfma_f32_16x16x32_bf16 v[184:187], v[240:243], v[68:71], v[184:187]
    ds_read_b64_tr_b16 v[232:233], v4 offset:8192
    v_mfma_f32_16x16x32_bf16 v[188:191], v[240:243], v[140:143], v[188:191]
    ds_read_b64_tr_b16 v[234:235], v4 offset:10240
    v_mfma_f32_16x16x32_bf16 v[188:191], v[244:247], v[144:147], v[188:191]
    ds_read_b64_tr_b16 v[236:237], v4 offset:12288
    v_mfma_f32_16x16x32_bf16 v[184:187], v[244:247], v[72:75], v[184:187]
    ds_read_b64_tr_b16 v[238:239], v4 offset:14336
    s_waitcnt lgkmcnt(4)
    v_mfma_f32_16x16x32_bf16 v[160:163], v[224:227], v[76:79], v[160:163]
    ds_read_b64_tr_b16 v[240:241], v4 offset:16384
    v_mfma_f32_16x16x32_bf16 v[164:167], v[224:227], v[148:151], v[164:167]
    ds_read_b64_tr_b16 v[242:243], v4 offset:18432
    v_mfma_f32_16x16x32_bf16 v[164:167], v[228:231], v[152:155], v[164:167]
    ds_read_b64_tr_b16 v[244:245], v4 offset:20480
    v_mfma_f32_16x16x32_bf16 v[160:163], v[228:231], v[80:83], v[160:163]
    ds_read_b64_tr_b16 v[246:247], v4 offset:22528
    s_waitcnt lgkmcnt(4)
    v_mfma_f32_16x16x32_bf16 v[160:163], v[232:235], v[84:87], v[160:163]
    ds_read_b64_tr_b16 v[224:225], v7 offset:0
    v_mfma_f32_16x16x32_bf16 v[164:167], v[232:235], v[156:159], v[164:167]
    ds_read_b64_tr_b16 v[226:227], v7 offset:2048
    v_mfma_f32_16x16x32_bf16 v[172:175], v[236:239], v[148:151], v[172:175]
    ds_read_b64_tr_b16 v[228:229], v7 offset:4096
    v_mfma_f32_16x16x32_bf16 v[168:171], v[236:239], v[76:79], v[168:171]
    ds_read_b64_tr_b16 v[230:231], v7 offset:6144
    s_waitcnt lgkmcnt(4)
    v_mfma_f32_16x16x32_bf16 v[168:171], v[240:243], v[80:83], v[168:171]
    ds_read_b64_tr_b16 v[232:233], v7 offset:8192
    v_mfma_f32_16x16x32_bf16 v[172:175], v[240:243], v[152:155], v[172:175]
    ds_read_b64_tr_b16 v[234:235], v7 offset:10240
    v_mfma_f32_16x16x32_bf16 v[172:175], v[244:247], v[156:159], v[172:175]
    ds_read_b64_tr_b16 v[236:237], v7 offset:12288
    v_mfma_f32_16x16x32_bf16 v[168:171], v[244:247], v[84:87], v[168:171]
    ds_read_b64_tr_b16 v[238:239], v7 offset:14336
    s_waitcnt lgkmcnt(4)
    v_mfma_f32_16x16x32_bf16 v[176:179], v[224:227], v[76:79], v[176:179]
    ds_read_b64_tr_b16 v[240:241], v7 offset:16384
    v_mfma_f32_16x16x32_bf16 v[180:183], v[224:227], v[148:151], v[180:183]
    ds_read_b64_tr_b16 v[242:243], v7 offset:18432
    v_mfma_f32_16x16x32_bf16 v[180:183], v[228:231], v[152:155], v[180:183]
    ds_read_b64_tr_b16 v[244:245], v7 offset:20480
    v_mfma_f32_16x16x32_bf16 v[176:179], v[228:231], v[80:83], v[176:179]
    ds_read_b64_tr_b16 v[246:247], v7 offset:22528
    s_barrier
    s_waitcnt lgkmcnt(4)
    v_mfma_f32_16x16x32_bf16 v[176:179], v[232:235], v[84:87], v[176:179]
    ds_read_b64_tr_b16 v[224:225], v4 offset:24576
    s_cmp_eq_u32 s36, 6
    s_cbranch_scc0 Lpf_49
    s_and_b32 s55, s39, 15
    s_mul_i32 s55, s55, 12
    v_min_u32 v1, 11, v0
    v_add_u32 v1, s55, v1
    v_mul_u32_u24 v1, 9216, v1
    s_mov_b32 s55, 512
    buffer_load_dword v11, v1, s[8:11], s55 offen
Lpf_49:
    v_mfma_f32_16x16x32_bf16 v[180:183], v[232:235], v[156:159], v[180:183]
    ds_read_b64_tr_b16 v[226:227], v4 offset:26624
    v_mfma_f32_16x16x32_bf16 v[188:191], v[236:239], v[148:151], v[188:191]
    ds_read_b64_tr_b16 v[228:229], v4 offset:28672
    v_mfma_f32_16x16x32_bf16 v[184:187], v[236:239], v[76:79], v[184:187]
    ds_read_b64_tr_b16 v[230:231], v4 offset:30720
    s_waitcnt lgkmcnt(4)
    v_mfma_f32_16x16x32_bf16 v[184:187], v[240:243], v[80:83], v[184:187]
    ds_read_b64_tr_b16 v[232:233], v4 offset:32768
    v_mfma_f32_16x16x32_bf16 v[188:191], v[240:243], v[152:155], v[188:191]
    ds_read_b64_tr_b16 v[234:235], v4 offset:34816
    v_mfma_f32_16x16x32_bf16 v[188:191], v[244:247], v[156:159], v[188:191]
    ds_read_b64_tr_b16 v[236:237], v4 offset:36864
    v_mfma_f32_16x16x32_bf16 v[184:187], v[244:247], v[84:87], v[184:187]
    ds_read_b64_tr_b16 v[238:239], v4 offset:38912
    s_waitcnt lgkmcnt(4)
    v_mfma_f32_16x16x32_bf16 v[192:195], v[224:227], v[16:19], 0
    ds_read_b64_tr_b16 v[240:241], v4 offset:40960
    v_mfma_f32_16x16x32_bf16 v[196:199], v[224:227], v[88:91], 0
    ds_read_b64_tr_b16 v[242:243], v4 offset:43008
    v_mfma_f32_16x16x32_bf16 v[196:199], v[228:231], v[92:95], v[196:199]
    ds_read_b64_tr_b16 v[244:245], v4 offset:45056
    v_mfma_f32_16x16x32_bf16 v[192:195], v[228:231], v[20:23], v[192:195]
    ds_read_b64_tr_b16 v[246:247], v4 offset:47104
    s_waitcnt lgkmcnt(4)
    v_mfma_f32_16x16x32_bf16 v[192:195], v[232:235], v[24:27], v[192:195]
    ds_read_b64_tr_b16 v[224:225], v7 offset:24576
    v_mfma_f32_16x16x32_bf16 v[196:199], v[232:235], v[96:99], v[196:199]
    ds_read_b64_tr_b16 v[226:227], v7 offset:26624
    v_mfma_f32_16x16x32_bf16 v[204:207], v[236:239], v[88:91], 0
    ds_read_b64_tr_b16 v[228:229], v7 offset:28672
    v_max_f32 v160, 0, v160
    v_mfma_f32_16x16x32_bf16 v[200:203], v[236:239], v[16:19], 0
    ds_read_b64_tr_b16 v[230:231], v7 offset:30720
    v_max_f32 v161, 0, v161
    s_waitcnt lgkmcnt(4)
    v_mfma_f32_16x16x32_bf16 v[200:203], v[240:243], v[20:23], v[200:203]
    ds_read_b64_tr_b16 v[232:233], v7 offset:32768
    v_max_f32 v162, 0, v162
    v_mfma_f32_16x16x32_bf16 v[204:207], v[240:243], v[92:95], v[204:207]
    ds_read_b64_tr_b16 v[234:235], v7 offset:34816
    v_max_f32 v163, 0, v163
    v_mfma_f32_16x16x32_bf16 v[204:207], v[244:247], v[96:99], v[204:207]
    ds_read_b64_tr_b16 v[236:237], v7 offset:36864
    v_mul_f32 v160, v160, v168
    v_mfma_f32_16x16x32_bf16 v[200:203], v[244:247], v[24:27], v[200:203]
    ds_read_b64_tr_b16 v[238:239], v7 offset:38912
    v_mul_f32 v161, v161, v169
    s_waitcnt lgkmcnt(4)
    v_mfma_f32_16x16x32_bf16 v[208:211], v[224:227], v[16:19], 0
    ds_read_b64_tr_b16 v[240:241], v7 offset:40960
    v_mul_f32 v162, v162, v170
    v_mfma_f32_16x16x32_bf16 v[212:215], v[224:227], v[88:91], 0
    ds_read_b64_tr_b16 v[242:243], v7 offset:43008
    v_mul_f32 v163, v163, v171
    v_mfma_f32_16x16x32_bf16 v[212:215], v[228:231], v[92:95], v[212:215]
    ds_read_b64_tr_b16 v[244:245], v7 offset:45056
    v_cvt_pk_bf16_f32 v248, v160, v161
    v_mfma_f32_16x16x32_bf16 v[208:211], v[228:231], v[20:23], v[208:211]
    ds_read_b64_tr_b16 v[246:247], v7 offset:47104
    v_cvt_pk_bf16_f32 v249, v162, v163
    s_barrier
    s_waitcnt lgkmcnt(4)
    v_mfma_f32_16x16x32_bf16 v[208:211], v[232:235], v[24:27], v[208:211]
    ds_read_b64_tr_b16 v[224:225], v5 offset:0
    v_max_f32 v176, 0, v176
    v_mfma_f32_16x16x32_bf16 v[212:215], v[232:235], v[96:99], v[212:215]
    ds_read_b64_tr_b16 v[226:227], v5 offset:2048
    v_max_f32 v177, 0, v177
    v_mfma_f32_16x16x32_bf16 v[220:223], v[236:239], v[88:91], 0
    ds_read_b64_tr_b16 v[228:229], v5 offset:4096
    v_max_f32 v178, 0, v178
    v_mfma_f32_16x16x32_bf16 v[216:219], v[236:239], v[16:19], 0
    ds_read_b64_tr_b16 v[230:231], v5 offset:6144
    v_max_f32 v179, 0, v179
    s_waitcnt lgkmcnt(4)
    v_mfma_f32_16x16x32_bf16 v[216:219], v[240:243], v[20:23], v[216:219]
    ds_read_b64_tr_b16 v[232:233], v5 offset:8192
    v_mul_f32 v176, v176, v184
    v_mfma_f32_16x16x32_bf16 v[220:223], v[240:243], v[92:95], v[220:223]
    ds_read_b64_tr_b16 v[234:235], v5 offset:10240
    v_mul_f32 v177, v177, v185
    v_mfma_f32_16x16x32_bf16 v[220:223], v[244:247], v[96:99], v[220:223]
    ds_read_b64_tr_b16 v[236:237], v5 offset:12288
    v_mul_f32 v178, v178, v186
    v_mfma_f32_16x16x32_bf16 v[216:219], v[244:247], v[24:27], v[216:219]
    ds_read_b64_tr_b16 v[238:239], v5 offset:14336
    v_mul_f32 v179, v179, v187
    s_waitcnt lgkmcnt(4)
    v_mfma_f32_16x16x32_bf16 v[192:195], v[224:227], v[28:31], v[192:195]
    ds_read_b64_tr_b16 v[240:241], v5 offset:16384
    v_cvt_pk_bf16_f32 v250, v176, v177
    v_mfma_f32_16x16x32_bf16 v[196:199], v[224:227], v[100:103], v[196:199]
    ds_read_b64_tr_b16 v[242:243], v5 offset:18432
    v_cvt_pk_bf16_f32 v251, v178, v179
    v_mfma_f32_16x16x32_bf16 v[196:199], v[228:231], v[104:107], v[196:199]
    ds_read_b64_tr_b16 v[244:245], v5 offset:20480
    v_max_f32 v164, 0, v164
    v_mfma_f32_16x16x32_bf16 v[192:195], v[228:231], v[32:35], v[192:195]
    ds_read_b64_tr_b16 v[246:247], v5 offset:22528
    v_max_f32 v165, 0, v165
    s_waitcnt lgkmcnt(4)
    v_mfma_f32_16x16x32_bf16 v[192:195], v[232:235], v[36:39], v[192:195]
    ds_read_b64_tr_b16 v[224:225], v8 offset:0
    v_max_f32 v166, 0, v166
    v_mfma_f32_16x16x32_bf16 v[196:199], v[232:235], v[108:111], v[196:199]
    ds_read_b64_tr_b16 v[226:227], v8 offset:2048
    v_max_f32 v167, 0, v167
    v_mfma_f32_16x16x32_bf16 v[204:207], v[236:239], v[100:103], v[204:207]
    ds_read_b64_tr_b16 v[228:229], v8 offset:4096
    v_mul_f32 v164, v164, v172
    v_mfma_f32_16x16x32_bf16 v[200:203], v[236:239], v[28:31], v[200:203]
    ds_read_b64_tr_b16 v[230:231], v8 offset:6144
    v_mul_f32 v165, v165, v173
    s_waitcnt lgkmcnt(4)
    v_mfma_f32_16x16x32_bf16 v[200:203], v[240:243], v[32:35], v[200:203]
    ds_read_b64_tr_b16 v[232:233], v8 offset:8192
    v_mul_f32 v166, v166, v174
    v_mfma_f32_16x16x32_bf16 v[204:207], v[240:243], v[104:107], v[204:207]
    ds_read_b64_tr_b16 v[234:235], v8 offset:10240
    v_mul_f32 v167, v167, v175
    v_mfma_f32_16x16x32_bf16 v[204:207], v[244:247], v[108:111], v[204:207]
    ds_read_b64_tr_b16 v[236:237], v8 offset:12288
    v_cvt_pk_bf16_f32 v252, v164, v165
    v_mfma_f32_16x16x32_bf16 v[200:203], v[244:247], v[36:39], v[200:203]
    ds_read_b64_tr_b16 v[238:239], v8 offset:14336
    v_cvt_pk_bf16_f32 v253, v166, v167
    s_waitcnt lgkmcnt(4)
    v_mfma_f32_16x16x32_bf16 v[208:211], v[224:227], v[28:31], v[208:211]
    ds_read_b64_tr_b16 v[240:241], v8 offset:16384
    v_max_f32 v180, 0, v180
    v_mfma_f32_16x16x32_bf16 v[212:215], v[224:227], v[100:103], v[212:215]
    ds_read_b64_tr_b16 v[242:243], v8 offset:18432
    v_max_f32 v181, 0, v181
    v_mfma_f32_16x16x32_bf16 v[212:215], v[228:231], v[104:107], v[212:215]
    ds_read_b64_tr_b16 v[244:245], v8 offset:20480
    v_max_f32 v182, 0, v182
    v_mfma_f32_16x16x32_bf16 v[208:211], v[228:231], v[32:35], v[208:211]
    ds_read_b64_tr_b16 v[246:247], v8 offset:22528
    v_max_f32 v183, 0, v183
    s_barrier
    s_waitcnt lgkmcnt(4)
    v_mfma_f32_16x16x32_bf16 v[208:211], v[232:235], v[36:39], v[208:211]
    ds_read_b64_tr_b16 v[224:225], v5 offset:24576
    v_mul_f32 v180, v180, v188
    v_mfma_f32_16x16x32_bf16 v[212:215], v[232:235], v[108:111], v[212:215]
    ds_read_b64_tr_b16 v[226:227], v5 offset:26624
    v_mul_f32 v181, v181, v189
    v_mfma_f32_16x16x32_bf16 v[220:223], v[236:239], v[100:103], v[220:223]
    ds_read_b64_tr_b16 v[228:229], v5 offset:28672
    v_mul_f32 v182, v182, v190
    v_mfma_f32_16x16x32_bf16 v[216:219], v[236:239], v[28:31], v[216:219]
    ds_read_b64_tr_b16 v[230:231], v5 offset:30720
    v_mul_f32 v183, v183, v191
    s_waitcnt lgkmcnt(4)
    v_mfma_f32_16x16x32_bf16 v[216:219], v[240:243], v[32:35], v[216:219]
    ds_read_b64_tr_b16 v[232:233], v5 offset:32768
    v_cvt_pk_bf16_f32 v254, v180, v181
    v_mfma_f32_16x16x32_bf16 v[220:223], v[240:243], v[104:107], v[220:223]
    ds_read_b64_tr_b16 v[234:235], v5 offset:34816
    v_cvt_pk_bf16_f32 v255, v182, v183
    v_mfma_f32_16x16x32_bf16 v[220:223], v[244:247], v[108:111], v[220:223]
    ds_read_b64_tr_b16 v[236:237], v5 offset:36864
    s_lshl_b32 s55, s41, 11
    s_add_u32 s55, s55, 2048
    v_lshlrev_b32 v1, 4, v0
    buffer_store_dwordx4 v[248:251], v1, s[16:19], s55 offen offset:1024 sc1
    buffer_store_dwordx4 v[252:255], v1, s[16:19], s55 offen offset:0 sc1
    v_mfma_f32_16x16x32_bf16 v[216:219], v[244:247], v[36:39], v[216:219]
    ds_read_b64_tr_b16 v[238:239], v5 offset:38912
    s_cmp_eq_u32 s36, 7
    s_cbranch_scc0 Lpf_50
    s_and_b32 s55, s39, 15
    s_mul_i32 s55, s55, 12
    v_min_u32 v1, 11, v0
    v_add_u32 v1, s55, v1
    v_mul_u32_u24 v1, 9216, v1
    s_mov_b32 s55, 512
    buffer_load_dword v11, v1, s[28:31], s55 offen
Lpf_50:
    s_waitcnt lgkmcnt(4)
    v_mfma_f32_16x16x32_bf16 v[192:195], v[224:227], v[40:43], v[192:195]
    ds_read_b64_tr_b16 v[240:241], v5 offset:40960
    s_cmp_eq_u32 s36, 4
    s_cbranch_scc0 Lpf_51
    s_and_b32 s55, s39, 15
    s_mul_i32 s55, s55, 12
    v_min_u32 v1, 11, v0
    v_add_u32 v1, s55, v1
    v_mul_u32_u24 v1, 9216, v1
    s_mov_b32 s55, 1769984
    buffer_load_dword v11, v1, s[8:11], s55 offen
Lpf_51:
    v_mfma_f32_16x16x32_bf16 v[196:199], v[224:227], v[112:115], v[196:199]
    ds_read_b64_tr_b16 v[242:243], v5 offset:43008
    v_mfma_f32_16x16x32_bf16 v[196:199], v[228:231], v[116:119], v[196:199]
    ds_read_b64_tr_b16 v[244:245], v5 offset:45056
    v_mfma_f32_16x16x32_bf16 v[192:195], v[228:231], v[44:47], v[192:195]
    ds_read_b64_tr_b16 v[246:247], v5 offset:47104
    s_waitcnt lgkmcnt(4)
    v_mfma_f32_16x16x32_bf16 v[192:195], v[232:235], v[48:51], v[192:195]
    ds_read_b64_tr_b16 v[224:225], v8 offset:24576
    v_mfma_f32_16x16x32_bf16 v[196:199], v[232:235], v[120:123], v[196:199]
    ds_read_b64_tr_b16 v[226:227], v8 offset:26624
    v_mfma_f32_16x16x32_bf16 v[204:207], v[236:239], v[112:115], v[204:207]
    ds_read_b64_tr_b16 v[228:229], v8 offset:28672
    v_mfma_f32_16x16x32_bf16 v[200:203], v[236:239], v[40:43], v[200:203]
    ds_read_b64_tr_b16 v[230:231], v8 offset:30720
    s_waitcnt lgkmcnt(4)
    v_mfma_f32_16x16x32_bf16 v[200:203], v[240:243], v[44:47], v[200:203]
    ds_read_b64_tr_b16 v[232:233], v8 offset:32768
    v_mfma_f32_16x16x32_bf16 v[204:207], v[240:243], v[116:119], v[204:207]
    ds_read_b64_tr_b16 v[234:235], v8 offset:34816
    v_mfma_f32_16x16x32_bf16 v[204:207], v[244:247], v[120:123], v[204:207]
    ds_read_b64_tr_b16 v[236:237], v8 offset:36864
    v_mfma_f32_16x16x32_bf16 v[200:203], v[244:247], v[48:51], v[200:203]
    ds_read_b64_tr_b16 v[238:239], v8 offset:38912
    s_waitcnt lgkmcnt(4)
    v_mfma_f32_16x16x32_bf16 v[208:211], v[224:227], v[40:43], v[208:211]
    ds_read_b64_tr_b16 v[240:241], v8 offset:40960
    v_mfma_f32_16x16x32_bf16 v[212:215], v[224:227], v[112:115], v[212:215]
    ds_read_b64_tr_b16 v[242:243], v8 offset:43008
    v_mfma_f32_16x16x32_bf16 v[212:215], v[228:231], v[116:119], v[212:215]
    ds_read_b64_tr_b16 v[244:245], v8 offset:45056
    v_mfma_f32_16x16x32_bf16 v[208:211], v[228:231], v[44:47], v[208:211]
    ds_read_b64_tr_b16 v[246:247], v8 offset:47104
    s_barrier
    s_waitcnt lgkmcnt(4)
    v_mfma_f32_16x16x32_bf16 v[208:211], v[232:235], v[48:51], v[208:211]
    ds_read_b64_tr_b16 v[224:225], v3 offset:0
    s_cmp_eq_u32 s36, 5
    s_cbranch_scc0 Lpf_52
    s_and_b32 s55, s39, 15
    s_mul_i32 s55, s55, 12
    v_min_u32 v1, 11, v0
    v_add_u32 v1, s55, v1
    v_mul_u32_u24 v1, 9216, v1
    s_mov_b32 s55, 1769984
    buffer_load_dword v11, v1, s[28:31], s55 offen
Lpf_52:
    v_mfma_f32_16x16x32_bf16 v[212:215], v[232:235], v[120:123], v[212:215]
    ds_read_b64_tr_b16 v[226:227], v3 offset:2048
    v_mfma_f32_16x16x32_bf16 v[220:223], v[236:239], v[112:115], v[220:223]
    ds_read_b64_tr_b16 v[228:229], v3 offset:4096
    v_mfma_f32_16x16x32_bf16 v[216:219], v[236:239], v[40:43], v[216:219]
    ds_read_b64_tr_b16 v[230:231], v3 offset:6144
    s_waitcnt lgkmcnt(4)
    v_mfma_f32_16x16x32_bf16 v[216:219], v[240:243], v[44:47], v[216:219]
    ds_read_b64_tr_b16 v[232:233], v3 offset:8192
    v_mfma_f32_16x16x32_bf16 v[220:223], v[240:243], v[116:119], v[220:223]
    ds_read_b64_tr_b16 v[234:235], v3 offset:10240
    v_mfma_f32_16x16x32_bf16 v[220:223], v[244:247], v[120:123], v[220:223]
    ds_read_b64_tr_b16 v[236:237], v3 offset:12288
    v_mfma_f32_16x16x32_bf16 v[216:219], v[244:247], v[48:51], v[216:219]
    ds_read_b64_tr_b16 v[238:239], v3 offset:14336
    s_waitcnt lgkmcnt(4)
    v_mfma_f32_16x16x32_bf16 v[192:195], v[224:227], v[52:55], v[192:195]
    ds_read_b64_tr_b16 v[240:241], v3 offset:16384
    v_mfma_f32_16x16x32_bf16 v[196:199], v[224:227], v[124:127], v[196:199]
    ds_read_b64_tr_b16 v[242:243], v3 offset:18432
    v_mfma_f32_16x16x32_bf16 v[196:199], v[228:231], v[128:131], v[196:199]
    ds_read_b64_tr_b16 v[244:245], v3 offset:20480
    v_mfma_f32_16x16x32_bf16 v[192:195], v[228:231], v[56:59], v[192:195]
    ds_read_b64_tr_b16 v[246:247], v3 offset:22528
    s_waitcnt lgkmcnt(4)
    v_mfma_f32_16x16x32_bf16 v[192:195], v[232:235], v[60:63], v[192:195]
    ds_read_b64_tr_b16 v[224:225], v6 offset:0
    v_mfma_f32_16x16x32_bf16 v[196:199], v[232:235], v[132:135], v[196:199]
    ds_read_b64_tr_b16 v[226:227], v6 offset:2048
    v_mfma_f32_16x16x32_bf16 v[204:207], v[236:239], v[124:127], v[204:207]
    ds_read_b64_tr_b16 v[228:229], v6 offset:4096
    v_mfma_f32_16x16x32_bf16 v[200:203], v[236:239], v[52:55], v[200:203]
    ds_read_b64_tr_b16 v[230:231], v6 offset:6144
    s_waitcnt lgkmcnt(4)
    v_mfma_f32_16x16x32_bf16 v[200:203], v[240:243], v[56:59], v[200:203]
    ds_read_b64_tr_b16 v[232:233], v6 offset:8192
    v_mfma_f32_16x16x32_bf16 v[204:207], v[240:243], v[128:131], v[204:207]
    ds_read_b64_tr_b16 v[234:235], v6 offset:10240
    v_mfma_f32_16x16x32_bf16 v[204:207], v[244:247], v[132:135], v[204:207]
    ds_read_b64_tr_b16 v[236:237], v6 offset:12288
    v_mfma_f32_16x16x32_bf16 v[200:203], v[244:247], v[60:63], v[200:203]
    ds_read_b64_tr_b16 v[238:239], v6 offset:14336
    s_waitcnt lgkmcnt(4)
    v_mfma_f32_16x16x32_bf16 v[208:211], v[224:227], v[52:55], v[208:211]
    ds_read_b64_tr_b16 v[240:241], v6 offset:16384
    v_mfma_f32_16x16x32_bf16 v[212:215], v[224:227], v[124:127], v[212:215]
    ds_read_b64_tr_b16 v[242:243], v6 offset:18432
    v_mfma_f32_16x16x32_bf16 v[212:215], v[228:231], v[128:131], v[212:215]
    ds_read_b64_tr_b16 v[244:245], v6 offset:20480
    v_mfma_f32_16x16x32_bf16 v[208:211], v[228:231], v[56:59], v[208:211]
    ds_read_b64_tr_b16 v[246:247], v6 offset:22528
    s_barrier
    s_waitcnt lgkmcnt(4)
    v_mfma_f32_16x16x32_bf16 v[208:211], v[232:235], v[60:63], v[208:211]
    ds_read_b64_tr_b16 v[224:225], v3 offset:24576
    s_cmp_eq_u32 s36, 6
    s_cbranch_scc0 Lpf_53
    s_and_b32 s55, s39, 15
    s_mul_i32 s55, s55, 12
    v_min_u32 v1, 11, v0
    v_add_u32 v1, s55, v1
    v_mul_u32_u24 v1, 9216, v1
    s_mov_b32 s55, 3539456
    buffer_load_dword v11, v1, s[8:11], s55 offen
Lpf_53:
    v_mfma_f32_16x16x32_bf16 v[212:215], v[232:235], v[132:135], v[212:215]
    ds_read_b64_tr_b16 v[226:227], v3 offset:26624
    s_cmp_eq_u32 s36, 4
    s_cbranch_scc0 Lpf_54
    s_and_b32 s55, s39, 15
    s_lshl_b32 s55, s55, 2
    s_add_u32 s55, s55, s42
    v_add_u32 v1, 0, v0
    v_min_u32 v1, 161, v1
    s_mul_i32 s55, s55, 20736
    s_mul_i32 s56, s43, 1327104
    s_add_u32 s55, s55, s56
    s_mov_b32 s32, s76
    s_mov_b32 s33, s77
    s_mov_b32 s34, 5308416
    s_mov_b32 s35, 0x20000
    v_lshlrev_b32 v1, 7, v1
    buffer_load_dword v11, v1, s[32:35], s55 offen
Lpf_54:
    v_mfma_f32_16x16x32_bf16 v[220:223], v[236:239], v[124:127], v[220:223]
    ds_read_b64_tr_b16 v[228:229], v3 offset:28672
    v_mfma_f32_16x16x32_bf16 v[216:219], v[236:239], v[52:55], v[216:219]
    ds_read_b64_tr_b16 v[230:231], v3 offset:30720
    s_waitcnt lgkmcnt(4)
    v_mfma_f32_16x16x32_bf16 v[216:219], v[240:243], v[56:59], v[216:219]
    ds_read_b64_tr_b16 v[232:233], v3 offset:32768
    v_mfma_f32_16x16x32_bf16 v[220:223], v[240:243], v[128:131], v[220:223]
    ds_read_b64_tr_b16 v[234:235], v3 offset:34816
    v_mfma_f32_16x16x32_bf16 v[220:223], v[244:247], v[132:135], v[220:223]
    ds_read_b64_tr_b16 v[236:237], v3 offset:36864
    v_mfma_f32_16x16x32_bf16 v[216:219], v[244:247], v[60:63], v[216:219]
    ds_read_b64_tr_b16 v[238:239], v3 offset:38912
    s_waitcnt lgkmcnt(4)
    v_mfma_f32_16x16x32_bf16 v[192:195], v[224:227], v[64:67], v[192:195]
    ds_read_b64_tr_b16 v[240:241], v3 offset:40960
    v_mfma_f32_16x16x32_bf16 v[196:199], v[224:227], v[136:139], v[196:199]
    ds_read_b64_tr_b16 v[242:243], v3 offset:43008
    v_mfma_f32_16x16x32_bf16 v[196:199], v[228:231], v[140:143], v[196:199]
    ds_read_b64_tr_b16 v[244:245], v3 offset:45056
    v_mfma_f32_16x16x32_bf16 v[192:195], v[228:231], v[68:71], v[192:195]
    ds_read_b64_tr_b16 v[246:247], v3 offset:47104
    s_waitcnt lgkmcnt(4)
    v_mfma_f32_16x16x32_bf16 v[192:195], v[232:235], v[72:75], v[192:195]
    ds_read_b64_tr_b16 v[224:225], v6 offset:24576
    v_mfma_f32_16x16x32_bf16 v[196:199], v[232:235], v[144:147], v[196:199]
    ds_read_b64_tr_b16 v[226:227], v6 offset:26624
    v_mfma_f32_16x16x32_bf16 v[204:207], v[236:239], v[136:139], v[204:207]
    ds_read_b64_tr_b16 v[228:229], v6 offset:28672
    v_mfma_f32_16x16x32_bf16 v[200:203], v[236:239], v[64:67], v[200:203]
    ds_read_b64_tr_b16 v[230:231], v6 offset:30720
    s_waitcnt lgkmcnt(4)
    v_mfma_f32_16x16x32_bf16 v[200:203], v[240:243], v[68:71], v[200:203]
    ds_read_b64_tr_b16 v[232:233], v6 offset:32768
    v_mfma_f32_16x16x32_bf16 v[204:207], v[240:243], v[140:143], v[204:207]
    ds_read_b64_tr_b16 v[234:235], v6 offset:34816
    v_mfma_f32_16x16x32_bf16 v[204:207], v[244:247], v[144:147], v[204:207]
    ds_read_b64_tr_b16 v[236:237], v6 offset:36864
    v_mfma_f32_16x16x32_bf16 v[200:203], v[244:247], v[72:75], v[200:203]
    ds_read_b64_tr_b16 v[238:239], v6 offset:38912
    s_waitcnt lgkmcnt(4)
    v_mfma_f32_16x16x32_bf16 v[208:211], v[224:227], v[64:67], v[208:211]
    ds_read_b64_tr_b16 v[240:241], v6 offset:40960
    v_mfma_f32_16x16x32_bf16 v[212:215], v[224:227], v[136:139], v[212:215]
    ds_read_b64_tr_b16 v[242:243], v6 offset:43008
    v_mfma_f32_16x16x32_bf16 v[212:215], v[228:231], v[140:143], v[212:215]
    ds_read_b64_tr_b16 v[244:245], v6 offset:45056
    v_mfma_f32_16x16x32_bf16 v[208:211], v[228:231], v[68:71], v[208:211]
    ds_read_b64_tr_b16 v[246:247], v6 offset:47104
    s_barrier
    s_waitcnt lgkmcnt(4)
    v_mfma_f32_16x16x32_bf16 v[208:211], v[232:235], v[72:75], v[208:211]
    ds_read_b64_tr_b16 v[224:225], v4 offset:0
    s_cmp_eq_u32 s36, 7
    s_cbranch_scc0 Lpf_55
    s_and_b32 s55, s39, 15
    s_mul_i32 s55, s55, 12
    v_min_u32 v1, 11, v0
    v_add_u32 v1, s55, v1
    v_mul_u32_u24 v1, 9216, v1
    s_mov_b32 s55, 3539456
    buffer_load_dword v11, v1, s[28:31], s55 offen
Lpf_55:
    v_mfma_f32_16x16x32_bf16 v[212:215], v[232:235], v[144:147], v[212:215]
    ds_read_b64_tr_b16 v[226:227], v4 offset:2048
    s_cmp_eq_u32 s36, 5
    s_cbranch_scc0 Lpf_56
    s_and_b32 s55, s39, 15
    s_lshl_b32 s55, s55, 2
    s_add_u32 s55, s55, s42
    v_add_u32 v1, 64, v0
    v_min_u32 v1, 161, v1
    s_mul_i32 s55, s55, 20736
    s_mul_i32 s56, s43, 1327104
    s_add_u32 s55, s55, s56
    s_mov_b32 s32, s76
    s_mov_b32 s33, s77
    s_mov_b32 s34, 5308416
    s_mov_b32 s35, 0x20000
    v_lshlrev_b32 v1, 7, v1
    buffer_load_dword v11, v1, s[32:35], s55 offen
Lpf_56:
    v_mfma_f32_16x16x32_bf16 v[220:223], v[236:239], v[136:139], v[220:223]
    ds_read_b64_tr_b16 v[228:229], v4 offset:4096
    v_mfma_f32_16x16x32_bf16 v[216:219], v[236:239], v[64:67], v[216:219]
    ds_read_b64_tr_b16 v[230:231], v4 offset:6144
    s_waitcnt lgkmcnt(4)
    v_mfma_f32_16x16x32_bf16 v[216:219], v[240:243], v[68:71], v[216:219]
    ds_read_b64_tr_b16 v[232:233], v4 offset:8192
    v_mfma_f32_16x16x32_bf16 v[220:223], v[240:243], v[140:143], v[220:223]
    ds_read_b64_tr_b16 v[234:235], v4 offset:10240
    v_mfma_f32_16x16x32_bf16 v[220:223], v[244:247], v[144:147], v[220:223]
    ds_read_b64_tr_b16 v[236:237], v4 offset:12288
    v_mfma_f32_16x16x32_bf16 v[216:219], v[244:247], v[72:75], v[216:219]
    ds_read_b64_tr_b16 v[238:239], v4 offset:14336
    s_waitcnt lgkmcnt(4)
    v_mfma_f32_16x16x32_bf16 v[192:195], v[224:227], v[76:79], v[192:195]
    ds_read_b64_tr_b16 v[240:241], v4 offset:16384
    v_mfma_f32_16x16x32_bf16 v[196:199], v[224:227], v[148:151], v[196:199]
    ds_read_b64_tr_b16 v[242:243], v4 offset:18432
    v_mfma_f32_16x16x32_bf16 v[196:199], v[228:231], v[152:155], v[196:199]
    ds_read_b64_tr_b16 v[244:245], v4 offset:20480
    v_mfma_f32_16x16x32_bf16 v[192:195], v[228:231], v[80:83], v[192:195]
    ds_read_b64_tr_b16 v[246:247], v4 offset:22528
    s_waitcnt lgkmcnt(4)
    v_mfma_f32_16x16x32_bf16 v[192:195], v[232:235], v[84:87], v[192:195]
    ds_read_b64_tr_b16 v[224:225], v7 offset:0
    v_mfma_f32_16x16x32_bf16 v[196:199], v[232:235], v[156:159], v[196:199]
    ds_read_b64_tr_b16 v[226:227], v7 offset:2048
    v_mfma_f32_16x16x32_bf16 v[204:207], v[236:239], v[148:151], v[204:207]
    ds_read_b64_tr_b16 v[228:229], v7 offset:4096
    v_mfma_f32_16x16x32_bf16 v[200:203], v[236:239], v[76:79], v[200:203]
    ds_read_b64_tr_b16 v[230:231], v7 offset:6144
    s_waitcnt lgkmcnt(4)
    v_mfma_f32_16x16x32_bf16 v[200:203], v[240:243], v[80:83], v[200:203]
    ds_read_b64_tr_b16 v[232:233], v7 offset:8192
    v_mfma_f32_16x16x32_bf16 v[204:207], v[240:243], v[152:155], v[204:207]
    ds_read_b64_tr_b16 v[234:235], v7 offset:10240
    v_mfma_f32_16x16x32_bf16 v[204:207], v[244:247], v[156:159], v[204:207]
    ds_read_b64_tr_b16 v[236:237], v7 offset:12288
    v_mfma_f32_16x16x32_bf16 v[200:203], v[244:247], v[84:87], v[200:203]
    ds_read_b64_tr_b16 v[238:239], v7 offset:14336
    s_waitcnt lgkmcnt(4)
    v_mfma_f32_16x16x32_bf16 v[208:211], v[224:227], v[76:79], v[208:211]
    ds_read_b64_tr_b16 v[240:241], v7 offset:16384
    v_mfma_f32_16x16x32_bf16 v[212:215], v[224:227], v[148:151], v[212:215]
    ds_read_b64_tr_b16 v[242:243], v7 offset:18432
    v_mfma_f32_16x16x32_bf16 v[212:215], v[228:231], v[152:155], v[212:215]
    ds_read_b64_tr_b16 v[244:245], v7 offset:20480
    v_mfma_f32_16x16x32_bf16 v[208:211], v[228:231], v[80:83], v[208:211]
    ds_read_b64_tr_b16 v[246:247], v7 offset:22528
    s_barrier
    s_waitcnt lgkmcnt(4)
    v_mfma_f32_16x16x32_bf16 v[208:211], v[232:235], v[84:87], v[208:211]
    ds_read_b64_tr_b16 v[224:225], v4 offset:24576
    s_cmp_eq_u32 s36, 6
    s_cbranch_scc0 Lpf_57
    s_and_b32 s55, s39, 15
    s_lshl_b32 s55, s55, 2
    s_add_u32 s55, s55, s42
    v_add_u32 v1, 128, v0
    v_min_u32 v1, 161, v1
    s_mul_i32 s55, s55, 20736
    s_mul_i32 s56, s43, 1327104
    s_add_u32 s55, s55, s56
    s_mov_b32 s32, s76
    s_mov_b32 s33, s77
    s_mov_b32 s34, 5308416
    s_mov_b32 s35, 0x20000
    v_lshlrev_b32 v1, 7, v1
    buffer_load_dword v11, v1, s[32:35], s55 offen
Lpf_57:
    v_mfma_f32_16x16x32_bf16 v[212:215], v[232:235], v[156:159], v[212:215]
    ds_read_b64_tr_b16 v[226:227], v4 offset:26624
    v_mfma_f32_16x16x32_bf16 v[220:223], v[236:239], v[148:151], v[220:223]
    ds_read_b64_tr_b16 v[228:229], v4 offset:28672
    v_mfma_f32_16x16x32_bf16 v[216:219], v[236:239], v[76:79], v[216:219]
    ds_read_b64_tr_b16 v[230:231], v4 offset:30720
    s_waitcnt lgkmcnt(4)
    v_mfma_f32_16x16x32_bf16 v[216:219], v[240:243], v[80:83], v[216:219]
    ds_read_b64_tr_b16 v[232:233], v4 offset:32768
    v_mfma_f32_16x16x32_bf16 v[220:223], v[240:243], v[152:155], v[220:223]
    ds_read_b64_tr_b16 v[234:235], v4 offset:34816
    v_mfma_f32_16x16x32_bf16 v[220:223], v[244:247], v[156:159], v[220:223]
    ds_read_b64_tr_b16 v[236:237], v4 offset:36864
    v_mfma_f32_16x16x32_bf16 v[216:219], v[244:247], v[84:87], v[216:219]
    ds_read_b64_tr_b16 v[238:239], v4 offset:38912
    s_waitcnt lgkmcnt(4)
    v_mfma_f32_16x16x32_bf16 v[160:163], v[224:227], v[16:19], 0
    ds_read_b64_tr_b16 v[240:241], v4 offset:40960
    v_mfma_f32_16x16x32_bf16 v[164:167], v[224:227], v[88:91], 0
    ds_read_b64_tr_b16 v[242:243], v4 offset:43008
    v_mfma_f32_16x16x32_bf16 v[164:167], v[228:231], v[92:95], v[164:167]
    ds_read_b64_tr_b16 v[244:245], v4 offset:45056
    v_mfma_f32_16x16x32_bf16 v[160:163], v[228:231], v[20:23], v[160:163]
    ds_read_b64_tr_b16 v[246:247], v4 offset:47104
    s_waitcnt lgkmcnt(4)
    v_mfma_f32_16x16x32_bf16 v[160:163], v[232:235], v[24:27], v[160:163]
    ds_read_b64_tr_b16 v[224:225], v7 offset:24576
    v_mfma_f32_16x16x32_bf16 v[164:167], v[232:235], v[96:99], v[164:167]
    ds_read_b64_tr_b16 v[226:227], v7 offset:26624
    v_mfma_f32_16x16x32_bf16 v[172:175], v[236:239], v[88:91], 0
    ds_read_b64_tr_b16 v[228:229], v7 offset:28672
    v_max_f32 v192, 0, v192
    v_mfma_f32_16x16x32_bf16 v[168:171], v[236:239], v[16:19], 0
    ds_read_b64_tr_b16 v[230:231], v7 offset:30720
    v_max_f32 v193, 0, v193
    s_waitcnt lgkmcnt(4)
    v_mfma_f32_16x16x32_bf16 v[168:171], v[240:243], v[20:23], v[168:171]
    ds_read_b64_tr_b16 v[232:233], v7 offset:32768
    v_max_f32 v194, 0, v194
    v_mfma_f32_16x16x32_bf16 v[172:175], v[240:243], v[92:95], v[172:175]
    ds_read_b64_tr_b16 v[234:235], v7 offset:34816
    v_max_f32 v195, 0, v195
    v_mfma_f32_16x16x32_bf16 v[172:175], v[244:247], v[96:99], v[172:175]
    ds_read_b64_tr_b16 v[236:237], v7 offset:36864
    v_mul_f32 v192, v192, v200
    v_mfma_f32_16x16x32_bf16 v[168:171], v[244:247], v[24:27], v[168:171]
    ds_read_b64_tr_b16 v[238:239], v7 offset:38912
    v_mul_f32 v193, v193, v201
    s_waitcnt lgkmcnt(4)
    v_mfma_f32_16x16x32_bf16 v[176:179], v[224:227], v[16:19], 0
    ds_read_b64_tr_b16 v[240:241], v7 offset:40960
    v_mul_f32 v194, v194, v202
    v_mfma_f32_16x16x32_bf16 v[180:183], v[224:227], v[88:91], 0
    ds_read_b64_tr_b16 v[242:243], v7 offset:43008
    v_mul_f32 v195, v195, v203
    v_mfma_f32_16x16x32_bf16 v[180:183], v[228:231], v[92:95], v[180:183]
    ds_read_b64_tr_b16 v[244:245], v7 offset:45056
    v_cvt_pk_bf16_f32 v248, v192, v193
    v_mfma_f32_16x16x32_bf16 v[176:179], v[228:231], v[20:23], v[176:179]
    ds_read_b64_tr_b16 v[246:247], v7 offset:47104
    v_cvt_pk_bf16_f32 v249, v194, v195
    s_barrier
    s_waitcnt lgkmcnt(4)
    v_mfma_f32_16x16x32_bf16 v[176:179], v[232:235], v[24:27], v[176:179]
    ds_read_b64_tr_b16 v[224:225], v5 offset:0
    v_max_f32 v208, 0, v208
    v_mfma_f32_16x16x32_bf16 v[180:183], v[232:235], v[96:99], v[180:183]
    ds_read_b64_tr_b16 v[226:227], v5 offset:2048
    v_max_f32 v209, 0, v209
    v_mfma_f32_16x16x32_bf16 v[188:191], v[236:239], v[88:91], 0
    ds_read_b64_tr_b16 v[228:229], v5 offset:4096
    v_max_f32 v210, 0, v210
    v_mfma_f32_16x16x32_bf16 v[184:187], v[236:239], v[16:19], 0
    ds_read_b64_tr_b16 v[230:231], v5 offset:6144
    v_max_f32 v211, 0, v211
    s_waitcnt lgkmcnt(4)
    v_mfma_f32_16x16x32_bf16 v[184:187], v[240:243], v[20:23], v[184:187]
    ds_read_b64_tr_b16 v[232:233], v5 offset:8192
    v_mul_f32 v208, v208, v216
    v_mfma_f32_16x16x32_bf16 v[188:191], v[240:243], v[92:95], v[188:191]
    ds_read_b64_tr_b16 v[234:235], v5 offset:10240
    v_mul_f32 v209, v209, v217
    v_mfma_f32_16x16x32_bf16 v[188:191], v[244:247], v[96:99], v[188:191]
    ds_read_b64_tr_b16 v[236:237], v5 offset:12288
    v_mul_f32 v210, v210, v218
    v_mfma_f32_16x16x32_bf16 v[184:187], v[244:247], v[24:27], v[184:187]
    ds_read_b64_tr_b16 v[238:239], v5 offset:14336
    v_mul_f32 v211, v211, v219
    s_waitcnt lgkmcnt(4)
    v_mfma_f32_16x16x32_bf16 v[160:163], v[224:227], v[28:31], v[160:163]
    ds_read_b64_tr_b16 v[240:241], v5 offset:16384
    v_cvt_pk_bf16_f32 v250, v208, v209
    v_mfma_f32_16x16x32_bf16 v[164:167], v[224:227], v[100:103], v[164:167]
    ds_read_b64_tr_b16 v[242:243], v5 offset:18432
    v_cvt_pk_bf16_f32 v251, v210, v211
    v_mfma_f32_16x16x32_bf16 v[164:167], v[228:231], v[104:107], v[164:167]
    ds_read_b64_tr_b16 v[244:245], v5 offset:20480
    v_max_f32 v196, 0, v196
    v_mfma_f32_16x16x32_bf16 v[160:163], v[228:231], v[32:35], v[160:163]
    ds_read_b64_tr_b16 v[246:247], v5 offset:22528
    v_max_f32 v197, 0, v197
    s_waitcnt lgkmcnt(4)
    v_mfma_f32_16x16x32_bf16 v[160:163], v[232:235], v[36:39], v[160:163]
    ds_read_b64_tr_b16 v[224:225], v8 offset:0
    v_max_f32 v198, 0, v198
    v_mfma_f32_16x16x32_bf16 v[164:167], v[232:235], v[108:111], v[164:167]
    ds_read_b64_tr_b16 v[226:227], v8 offset:2048
    v_max_f32 v199, 0, v199
    v_mfma_f32_16x16x32_bf16 v[172:175], v[236:239], v[100:103], v[172:175]
    ds_read_b64_tr_b16 v[228:229], v8 offset:4096
    v_mul_f32 v196, v196, v204
    v_mfma_f32_16x16x32_bf16 v[168:171], v[236:239], v[28:31], v[168:171]
    ds_read_b64_tr_b16 v[230:231], v8 offset:6144
    v_mul_f32 v197, v197, v205
    s_waitcnt lgkmcnt(4)
    v_mfma_f32_16x16x32_bf16 v[168:171], v[240:243], v[32:35], v[168:171]
    ds_read_b64_tr_b16 v[232:233], v8 offset:8192
    v_mul_f32 v198, v198, v206
    v_mfma_f32_16x16x32_bf16 v[172:175], v[240:243], v[104:107], v[172:175]
    ds_read_b64_tr_b16 v[234:235], v8 offset:10240
    v_mul_f32 v199, v199, v207
    v_mfma_f32_16x16x32_bf16 v[172:175], v[244:247], v[108:111], v[172:175]
    ds_read_b64_tr_b16 v[236:237], v8 offset:12288
    v_cvt_pk_bf16_f32 v252, v196, v197
    v_mfma_f32_16x16x32_bf16 v[168:171], v[244:247], v[36:39], v[168:171]
    ds_read_b64_tr_b16 v[238:239], v8 offset:14336
    v_cvt_pk_bf16_f32 v253, v198, v199
    s_waitcnt lgkmcnt(4)
    v_mfma_f32_16x16x32_bf16 v[176:179], v[224:227], v[28:31], v[176:179]
    ds_read_b64_tr_b16 v[240:241], v8 offset:16384
    v_max_f32 v212, 0, v212
    v_mfma_f32_16x16x32_bf16 v[180:183], v[224:227], v[100:103], v[180:183]
    ds_read_b64_tr_b16 v[242:243], v8 offset:18432
    v_max_f32 v213, 0, v213
    v_mfma_f32_16x16x32_bf16 v[180:183], v[228:231], v[104:107], v[180:183]
    ds_read_b64_tr_b16 v[244:245], v8 offset:20480
    v_max_f32 v214, 0, v214
    v_mfma_f32_16x16x32_bf16 v[176:179], v[228:231], v[32:35], v[176:179]
    ds_read_b64_tr_b16 v[246:247], v8 offset:22528
    v_max_f32 v215, 0, v215
    s_barrier
    s_waitcnt lgkmcnt(4)
    v_mfma_f32_16x16x32_bf16 v[176:179], v[232:235], v[36:39], v[176:179]
    ds_read_b64_tr_b16 v[224:225], v5 offset:24576
    v_mul_f32 v212, v212, v220
    v_mfma_f32_16x16x32_bf16 v[180:183], v[232:235], v[108:111], v[180:183]
    ds_read_b64_tr_b16 v[226:227], v5 offset:26624
    v_mul_f32 v213, v213, v221
    v_mfma_f32_16x16x32_bf16 v[188:191], v[236:239], v[100:103], v[188:191]
    ds_read_b64_tr_b16 v[228:229], v5 offset:28672
    v_mul_f32 v214, v214, v222
    v_mfma_f32_16x16x32_bf16 v[184:187], v[236:239], v[28:31], v[184:187]
    ds_read_b64_tr_b16 v[230:231], v5 offset:30720
    v_mul_f32 v215, v215, v223
    s_waitcnt lgkmcnt(4)
    v_mfma_f32_16x16x32_bf16 v[184:187], v[240:243], v[32:35], v[184:187]
    ds_read_b64_tr_b16 v[232:233], v5 offset:32768
    v_cvt_pk_bf16_f32 v254, v212, v213
    v_mfma_f32_16x16x32_bf16 v[188:191], v[240:243], v[104:107], v[188:191]
    ds_read_b64_tr_b16 v[234:235], v5 offset:34816
    v_cvt_pk_bf16_f32 v255, v214, v215
    v_mfma_f32_16x16x32_bf16 v[188:191], v[244:247], v[108:111], v[188:191]
    ds_read_b64_tr_b16 v[236:237], v5 offset:36864
    s_lshl_b32 s55, s41, 11
    s_add_u32 s55, s55, 6144
    v_lshlrev_b32 v1, 4, v0
    buffer_store_dwordx4 v[248:251], v1, s[16:19], s55 offen offset:1024 sc1
    buffer_store_dwordx4 v[252:255], v1, s[16:19], s55 offen offset:0 sc1
    v_mfma_f32_16x16x32_bf16 v[184:187], v[244:247], v[36:39], v[184:187]
    ds_read_b64_tr_b16 v[238:239], v5 offset:38912
    s_waitcnt lgkmcnt(4)
    v_mfma_f32_16x16x32_bf16 v[160:163], v[224:227], v[40:43], v[160:163]
    ds_read_b64_tr_b16 v[240:241], v5 offset:40960
    v_mfma_f32_16x16x32_bf16 v[164:167], v[224:227], v[112:115], v[164:167]
    ds_read_b64_tr_b16 v[242:243], v5 offset:43008
    v_mfma_f32_16x16x32_bf16 v[164:167], v[228:231], v[116:119], v[164:167]
    ds_read_b64_tr_b16 v[244:245], v5 offset:45056
    v_mfma_f32_16x16x32_bf16 v[160:163], v[228:231], v[44:47], v[160:163]
    ds_read_b64_tr_b16 v[246:247], v5 offset:47104
    s_waitcnt lgkmcnt(4)
    v_mfma_f32_16x16x32_bf16 v[160:163], v[232:235], v[48:51], v[160:163]
    ds_read_b64_tr_b16 v[224:225], v8 offset:24576
    v_mfma_f32_16x16x32_bf16 v[164:167], v[232:235], v[120:123], v[164:167]
    ds_read_b64_tr_b16 v[226:227], v8 offset:26624
    v_mfma_f32_16x16x32_bf16 v[172:175], v[236:239], v[112:115], v[172:175]
    ds_read_b64_tr_b16 v[228:229], v8 offset:28672
    v_mfma_f32_16x16x32_bf16 v[168:171], v[236:239], v[40:43], v[168:171]
    ds_read_b64_tr_b16 v[230:231], v8 offset:30720
    s_waitcnt lgkmcnt(4)
    v_mfma_f32_16x16x32_bf16 v[168:171], v[240:243], v[44:47], v[168:171]
    ds_read_b64_tr_b16 v[232:233], v8 offset:32768
    v_mfma_f32_16x16x32_bf16 v[172:175], v[240:243], v[116:119], v[172:175]
    ds_read_b64_tr_b16 v[234:235], v8 offset:34816
    v_mfma_f32_16x16x32_bf16 v[172:175], v[244:247], v[120:123], v[172:175]
    ds_read_b64_tr_b16 v[236:237], v8 offset:36864
    v_mfma_f32_16x16x32_bf16 v[168:171], v[244:247], v[48:51], v[168:171]
    ds_read_b64_tr_b16 v[238:239], v8 offset:38912
    s_waitcnt lgkmcnt(4)
    v_mfma_f32_16x16x32_bf16 v[176:179], v[224:227], v[40:43], v[176:179]
    ds_read_b64_tr_b16 v[240:241], v8 offset:40960
    v_mfma_f32_16x16x32_bf16 v[180:183], v[224:227], v[112:115], v[180:183]
    ds_read_b64_tr_b16 v[242:243], v8 offset:43008
    v_mfma_f32_16x16x32_bf16 v[180:183], v[228:231], v[116:119], v[180:183]
    ds_read_b64_tr_b16 v[244:245], v8 offset:45056
    v_mfma_f32_16x16x32_bf16 v[176:179], v[228:231], v[44:47], v[176:179]
    ds_read_b64_tr_b16 v[246:247], v8 offset:47104
    s_barrier
    s_waitcnt lgkmcnt(4)
    v_mfma_f32_16x16x32_bf16 v[176:179], v[232:235], v[48:51], v[176:179]
    ds_read_b64_tr_b16 v[224:225], v3 offset:0
    s_cmp_eq_u32 s36, 6
    s_cbranch_scc0 Lpf_58
    s_mov_b32 s55, s2
    v_add_u32 v1, 0, v0
    v_min_u32 v1, 20, v1
    s_mul_i32 s55, s55, 2688
    s_mov_b32 s32, s68
    s_mov_b32 s33, s69
    s_mov_b32 s34, 663552
    s_mov_b32 s35, 0x20000
    v_lshlrev_b32 v1, 7, v1
    buffer_load_dword v11, v1, s[32:35], s55 offen
Lpf_58:
    v_mfma_f32_16x16x32_bf16 v[180:183], v[232:235], v[120:123], v[180:183]
    ds_read_b64_tr_b16 v[226:227], v3 offset:2048
    v_mfma_f32_16x16x32_bf16 v[188:191], v[236:239], v[112:115], v[188:191]
    ds_read_b64_tr_b16 v[228:229], v3 offset:4096
    v_mfma_f32_16x16x32_bf16 v[184:187], v[236:239], v[40:43], v[184:187]
    ds_read_b64_tr_b16 v[230:231], v3 offset:6144
    s_waitcnt lgkmcnt(4)
    v_mfma_f32_16x16x32_bf16 v[184:187], v[240:243], v[44:47], v[184:187]
    ds_read_b64_tr_b16 v[232:233], v3 offset:8192
    v_mfma_f32_16x16x32_bf16 v[188:191], v[240:243], v[116:119], v[188:191]
    ds_read_b64_tr_b16 v[234:235], v3 offset:10240
    v_mfma_f32_16x16x32_bf16 v[188:191], v[244:247], v[120:123], v[188:191]
    ds_read_b64_tr_b16 v[236:237], v3 offset:12288
    v_mfma_f32_16x16x32_bf16 v[184:187], v[244:247], v[48:51], v[184:187]
    ds_read_b64_tr_b16 v[238:239], v3 offset:14336
    s_waitcnt lgkmcnt(4)
    v_mfma_f32_16x16x32_bf16 v[160:163], v[224:227], v[52:55], v[160:163]
    ds_read_b64_tr_b16 v[240:241], v3 offset:16384
    v_mfma_f32_16x16x32_bf16 v[164:167], v[224:227], v[124:127], v[164:167]
    ds_read_b64_tr_b16 v[242:243], v3 offset:18432
    v_mfma_f32_16x16x32_bf16 v[164:167], v[228:231], v[128:131], v[164:167]
    ds_read_b64_tr_b16 v[244:245], v3 offset:20480
    v_mfma_f32_16x16x32_bf16 v[160:163], v[228:231], v[56:59], v[160:163]
    ds_read_b64_tr_b16 v[246:247], v3 offset:22528
    s_waitcnt lgkmcnt(4)
    v_mfma_f32_16x16x32_bf16 v[160:163], v[232:235], v[60:63], v[160:163]
    ds_read_b64_tr_b16 v[224:225], v6 offset:0
    v_mfma_f32_16x16x32_bf16 v[164:167], v[232:235], v[132:135], v[164:167]
    ds_read_b64_tr_b16 v[226:227], v6 offset:2048
    v_mfma_f32_16x16x32_bf16 v[172:175], v[236:239], v[124:127], v[172:175]
    ds_read_b64_tr_b16 v[228:229], v6 offset:4096
    v_mfma_f32_16x16x32_bf16 v[168:171], v[236:239], v[52:55], v[168:171]
    ds_read_b64_tr_b16 v[230:231], v6 offset:6144
    s_waitcnt lgkmcnt(4)
    v_mfma_f32_16x16x32_bf16 v[168:171], v[240:243], v[56:59], v[168:171]
    ds_read_b64_tr_b16 v[232:233], v6 offset:8192
    v_mfma_f32_16x16x32_bf16 v[172:175], v[240:243], v[128:131], v[172:175]
    ds_read_b64_tr_b16 v[234:235], v6 offset:10240
    v_mfma_f32_16x16x32_bf16 v[172:175], v[244:247], v[132:135], v[172:175]
    ds_read_b64_tr_b16 v[236:237], v6 offset:12288
    v_mfma_f32_16x16x32_bf16 v[168:171], v[244:247], v[60:63], v[168:171]
    ds_read_b64_tr_b16 v[238:239], v6 offset:14336
    s_waitcnt lgkmcnt(4)
    v_mfma_f32_16x16x32_bf16 v[176:179], v[224:227], v[52:55], v[176:179]
    ds_read_b64_tr_b16 v[240:241], v6 offset:16384
    v_mfma_f32_16x16x32_bf16 v[180:183], v[224:227], v[124:127], v[180:183]
    ds_read_b64_tr_b16 v[242:243], v6 offset:18432
    v_mfma_f32_16x16x32_bf16 v[180:183], v[228:231], v[128:131], v[180:183]
    ds_read_b64_tr_b16 v[244:245], v6 offset:20480
    v_mfma_f32_16x16x32_bf16 v[176:179], v[228:231], v[56:59], v[176:179]
    ds_read_b64_tr_b16 v[246:247], v6 offset:22528
    s_barrier
    s_waitcnt lgkmcnt(4)
    v_mfma_f32_16x16x32_bf16 v[176:179], v[232:235], v[60:63], v[176:179]
    ds_read_b64_tr_b16 v[224:225], v3 offset:24576
    v_mfma_f32_16x16x32_bf16 v[180:183], v[232:235], v[132:135], v[180:183]
    ds_read_b64_tr_b16 v[226:227], v3 offset:26624
    v_mfma_f32_16x16x32_bf16 v[188:191], v[236:239], v[124:127], v[188:191]
    ds_read_b64_tr_b16 v[228:229], v3 offset:28672
    v_mfma_f32_16x16x32_bf16 v[184:187], v[236:239], v[52:55], v[184:187]
    ds_read_b64_tr_b16 v[230:231], v3 offset:30720
    s_waitcnt lgkmcnt(4)
    v_mfma_f32_16x16x32_bf16 v[184:187], v[240:243], v[56:59], v[184:187]
    ds_read_b64_tr_b16 v[232:233], v3 offset:32768
    v_mfma_f32_16x16x32_bf16 v[188:191], v[240:243], v[128:131], v[188:191]
    ds_read_b64_tr_b16 v[234:235], v3 offset:34816
    v_mfma_f32_16x16x32_bf16 v[188:191], v[244:247], v[132:135], v[188:191]
    ds_read_b64_tr_b16 v[236:237], v3 offset:36864
    v_mfma_f32_16x16x32_bf16 v[184:187], v[244:247], v[60:63], v[184:187]
    ds_read_b64_tr_b16 v[238:239], v3 offset:38912
    s_waitcnt lgkmcnt(4)
    v_mfma_f32_16x16x32_bf16 v[160:163], v[224:227], v[64:67], v[160:163]
    ds_read_b64_tr_b16 v[240:241], v3 offset:40960
    v_mfma_f32_16x16x32_bf16 v[164:167], v[224:227], v[136:139], v[164:167]
    ds_read_b64_tr_b16 v[242:243], v3 offset:43008
    v_mfma_f32_16x16x32_bf16 v[164:167], v[228:231], v[140:143], v[164:167]
    ds_read_b64_tr_b16 v[244:245], v3 offset:45056
    v_mfma_f32_16x16x32_bf16 v[160:163], v[228:231], v[68:71], v[160:163]
    ds_read_b64_tr_b16 v[246:247], v3 offset:47104
    s_waitcnt lgkmcnt(4)
    v_mfma_f32_16x16x32_bf16 v[160:163], v[232:235], v[72:75], v[160:163]
    ds_read_b64_tr_b16 v[224:225], v6 offset:24576
    v_mfma_f32_16x16x32_bf16 v[164:167], v[232:235], v[144:147], v[164:167]
    ds_read_b64_tr_b16 v[226:227], v6 offset:26624
    v_mfma_f32_16x16x32_bf16 v[172:175], v[236:239], v[136:139], v[172:175]
    ds_read_b64_tr_b16 v[228:229], v6 offset:28672
    v_mfma_f32_16x16x32_bf16 v[168:171], v[236:239], v[64:67], v[168:171]
    ds_read_b64_tr_b16 v[230:231], v6 offset:30720
    s_waitcnt lgkmcnt(4)
    v_mfma_f32_16x16x32_bf16 v[168:171], v[240:243], v[68:71], v[168:171]
    ds_read_b64_tr_b16 v[232:233], v6 offset:32768
    v_mfma_f32_16x16x32_bf16 v[172:175], v[240:243], v[140:143], v[172:175]
    ds_read_b64_tr_b16 v[234:235], v6 offset:34816
    v_mfma_f32_16x16x32_bf16 v[172:175], v[244:247], v[144:147], v[172:175]
    ds_read_b64_tr_b16 v[236:237], v6 offset:36864
    v_mfma_f32_16x16x32_bf16 v[168:171], v[244:247], v[72:75], v[168:171]
    ds_read_b64_tr_b16 v[238:239], v6 offset:38912
    s_waitcnt lgkmcnt(4)
    v_mfma_f32_16x16x32_bf16 v[176:179], v[224:227], v[64:67], v[176:179]
    ds_read_b64_tr_b16 v[240:241], v6 offset:40960
    v_mfma_f32_16x16x32_bf16 v[180:183], v[224:227], v[136:139], v[180:183]
    ds_read_b64_tr_b16 v[242:243], v6 offset:43008
    v_mfma_f32_16x16x32_bf16 v[180:183], v[228:231], v[140:143], v[180:183]
    ds_read_b64_tr_b16 v[244:245], v6 offset:45056
    v_mfma_f32_16x16x32_bf16 v[176:179], v[228:231], v[68:71], v[176:179]
    ds_read_b64_tr_b16 v[246:247], v6 offset:47104
    s_barrier
    s_waitcnt lgkmcnt(4)
    v_mfma_f32_16x16x32_bf16 v[176:179], v[232:235], v[72:75], v[176:179]
    ds_read_b64_tr_b16 v[224:225], v4 offset:0
    s_cmp_eq_u32 s36, 6
    s_cbranch_scc0 Lpf_59
    s_and_b32 s55, s39, 15
    s_lshl_b32 s55, s55, 2
    s_add_u32 s55, s55, s42
    v_add_u32 v1, 0, v0
    v_min_u32 v1, 80, v1
    v_mul_u32_u24 v2, 7282, v1
    v_lshrrev_b32 v2, 16, v2
    s_mul_i32 s55, s55, 9
    v_mul_u32_u24 v11, 9, v2
    v_sub_u32 v1, v1, v11
    v_add_u32 v2, s55, v2
    v_mul_u32_u24 v2, 3456, v2
    v_mul_u32_u24 v11, 22, v1
    v_lshrrev_b32 v11, 6, v11
    v_mul_u32_u24 v11, 768, v11
    v_lshl_add_u32 v1, v1, 7, v2
    v_add_u32 v1, v1, v11
    s_mul_i32 s55, s43, 288
    s_andn2_b32 s55, s55, 127
    s_mov_b32 s32, s66
    s_mov_b32 s33, s67
    s_mov_b32 s34, 1990656
    s_mov_b32 s35, 0x20000
    buffer_load_dword v11, v1, s[32:35], s55 offen
Lpf_59:
    v_mfma_f32_16x16x32_bf16 v[180:183], v[232:235], v[144:147], v[180:183]
    ds_read_b64_tr_b16 v[226:227], v4 offset:2048
    v_mfma_f32_16x16x32_bf16 v[188:191], v[236:239], v[136:139], v[188:191]
    ds_read_b64_tr_b16 v[228:229], v4 offset:4096
    v_mfma_f32_16x16x32_bf16 v[184:187], v[236:239], v[64:67], v[184:187]
    ds_read_b64_tr_b16 v[230:231], v4 offset:6144
    s_waitcnt lgkmcnt(4)
    v_mfma_f32_16x16x32_bf16 v[184:187], v[240:243], v[68:71], v[184:187]
    ds_read_b64_tr_b16 v[232:233], v4 offset:8192
    v_mfma_f32_16x16x32_bf16 v[188:191], v[240:243], v[140:143], v[188:191]
    ds_read_b64_tr_b16 v[234:235], v4 offset:10240
    v_mfma_f32_16x16x32_bf16 v[188:191], v[244:247], v[144:147], v[188:191]
    ds_read_b64_tr_b16 v[236:237], v4 offset:12288
    v_mfma_f32_16x16x32_bf16 v[184:187], v[244:247], v[72:75], v[184:187]
    ds_read_b64_tr_b16 v[238:239], v4 offset:14336
    s_waitcnt lgkmcnt(4)
    v_mfma_f32_16x16x32_bf16 v[160:163], v[224:227], v[76:79], v[160:163]
    ds_read_b64_tr_b16 v[240:241], v4 offset:16384
    v_mfma_f32_16x16x32_bf16 v[164:167], v[224:227], v[148:151], v[164:167]
    ds_read_b64_tr_b16 v[242:243], v4 offset:18432
    v_mfma_f32_16x16x32_bf16 v[164:167], v[228:231], v[152:155], v[164:167]
    ds_read_b64_tr_b16 v[244:245], v4 offset:20480
    v_mfma_f32_16x16x32_bf16 v[160:163], v[228:231], v[80:83], v[160:163]
    ds_read_b64_tr_b16 v[246:247], v4 offset:22528
    s_waitcnt lgkmcnt(4)
    v_mfma_f32_16x16x32_bf16 v[160:163], v[232:235], v[84:87], v[160:163]
    ds_read_b64_tr_b16 v[224:225], v7 offset:0
    v_mfma_f32_16x16x32_bf16 v[164:167], v[232:235], v[156:159], v[164:167]
    ds_read_b64_tr_b16 v[226:227], v7 offset:2048
    v_mfma_f32_16x16x32_bf16 v[172:175], v[236:239], v[148:151], v[172:175]
    ds_read_b64_tr_b16 v[228:229], v7 offset:4096
    v_mfma_f32_16x16x32_bf16 v[168:171], v[236:239], v[76:79], v[168:171]
    ds_read_b64_tr_b16 v[230:231], v7 offset:6144
    s_waitcnt lgkmcnt(4)
    v_mfma_f32_16x16x32_bf16 v[168:171], v[240:243], v[80:83], v[168:171]
    ds_read_b64_tr_b16 v[232:233], v7 offset:8192
    v_mfma_f32_16x16x32_bf16 v[172:175], v[240:243], v[152:155], v[172:175]
    ds_read_b64_tr_b16 v[234:235], v7 offset:10240
    v_mfma_f32_16x16x32_bf16 v[172:175], v[244:247], v[156:159], v[172:175]
    ds_read_b64_tr_b16 v[236:237], v7 offset:12288
    v_mfma_f32_16x16x32_bf16 v[168:171], v[244:247], v[84:87], v[168:171]
    ds_read_b64_tr_b16 v[238:239], v7 offset:14336
    s_waitcnt lgkmcnt(4)
    v_mfma_f32_16x16x32_bf16 v[176:179], v[224:227], v[76:79], v[176:179]
    ds_read_b64_tr_b16 v[240:241], v7 offset:16384
    v_mfma_f32_16x16x32_bf16 v[180:183], v[224:227], v[148:151], v[180:183]
    ds_read_b64_tr_b16 v[242:243], v7 offset:18432
    v_mfma_f32_16x16x32_bf16 v[180:183], v[228:231], v[152:155], v[180:183]
    ds_read_b64_tr_b16 v[244:245], v7 offset:20480
    v_mfma_f32_16x16x32_bf16 v[176:179], v[228:231], v[80:83], v[176:179]
    ds_read_b64_tr_b16 v[246:247], v7 offset:22528
    s_barrier
    s_waitcnt lgkmcnt(4)
    v_mfma_f32_16x16x32_bf16 v[176:179], v[232:235], v[84:87], v[176:179]
    ds_read_b64_tr_b16 v[224:225], v4 offset:24576
    s_cmp_eq_u32 s36, 7
    s_cbranch_scc0 Lpf_60
    s_and_b32 s55, s39, 15
    s_lshl_b32 s55, s55, 2
    s_add_u32 s55, s55, s42
    v_add_u32 v1, 64, v0
    v_min_u32 v1, 80, v1
    v_mul_u32_u24 v2, 7282, v1
    v_lshrrev_b32 v2, 16, v2
    s_mul_i32 s55, s55, 9
    v_mul_u32_u24 v11, 9, v2
    v_sub_u32 v1, v1, v11
    v_add_u32 v2, s55, v2
    v_mul_u32_u24 v2, 3456, v2
    v_mul_u32_u24 v11, 22, v1
    v_lshrrev_b32 v11, 6, v11
    v_mul_u32_u24 v11, 768, v11
    v_lshl_add_u32 v1, v1, 7, v2
    v_add_u32 v1, v1, v11
    s_mul_i32 s55, s43, 288
    s_andn2_b32 s55, s55, 127
    s_mov_b32 s32, s66
    s_mov_b32 s33, s67
    s_mov_b32 s34, 1990656
    s_mov_b32 s35, 0x20000
    buffer_load_dword v11, v1, s[32:35], s55 offen
Lpf_60:
    v_mfma_f32_16x16x32_bf16 v[180:183], v[232:235], v[156:159], v[180:183]
    ds_read_b64_tr_b16 v[226:227], v4 offset:26624
    v_mfma_f32_16x16x32_bf16 v[188:191], v[236:239], v[148:151], v[188:191]
    ds_read_b64_tr_b16 v[228:229], v4 offset:28672
    v_mfma_f32_16x16x32_bf16 v[184:187], v[236:239], v[76:79], v[184:187]
    ds_read_b64_tr_b16 v[230:231], v4 offset:30720
    s_waitcnt lgkmcnt(4)
    v_mfma_f32_16x16x32_bf16 v[184:187], v[240:243], v[80:83], v[184:187]
    ds_read_b64_tr_b16 v[232:233], v4 offset:32768
    v_mfma_f32_16x16x32_bf16 v[188:191], v[240:243], v[152:155], v[188:191]
    ds_read_b64_tr_b16 v[234:235], v4 offset:34816
    v_mfma_f32_16x16x32_bf16 v[188:191], v[244:247], v[156:159], v[188:191]
    ds_read_b64_tr_b16 v[236:237], v4 offset:36864
    v_mfma_f32_16x16x32_bf16 v[184:187], v[244:247], v[84:87], v[184:187]
    ds_read_b64_tr_b16 v[238:239], v4 offset:38912
    s_waitcnt lgkmcnt(4)
    v_mfma_f32_16x16x32_bf16 v[192:195], v[224:227], v[16:19], 0
    ds_read_b64_tr_b16 v[240:241], v4 offset:40960
    v_mfma_f32_16x16x32_bf16 v[196:199], v[224:227], v[88:91], 0
    ds_read_b64_tr_b16 v[242:243], v4 offset:43008
    v_mfma_f32_16x16x32_bf16 v[196:199], v[228:231], v[92:95], v[196:199]
    ds_read_b64_tr_b16 v[244:245], v4 offset:45056
    v_mfma_f32_16x16x32_bf16 v[192:195], v[228:231], v[20:23], v[192:195]
    ds_read_b64_tr_b16 v[246:247], v4 offset:47104
    s_waitcnt lgkmcnt(4)
    v_mfma_f32_16x16x32_bf16 v[192:195], v[232:235], v[24:27], v[192:195]
    ds_read_b64_tr_b16 v[224:225], v7 offset:24576
    v_mfma_f32_16x16x32_bf16 v[196:199], v[232:235], v[96:99], v[196:199]
    ds_read_b64_tr_b16 v[226:227], v7 offset:26624
    v_mfma_f32_16x16x32_bf16 v[204:207], v[236:239], v[88:91], 0
    ds_read_b64_tr_b16 v[228:229], v7 offset:28672
    v_max_f32 v160, 0, v160
    v_mfma_f32_16x16x32_bf16 v[200:203], v[236:239], v[16:19], 0
    ds_read_b64_tr_b16 v[230:231], v7 offset:30720
    v_max_f32 v161, 0, v161
    s_waitcnt lgkmcnt(4)
    v_mfma_f32_16x16x32_bf16 v[200:203], v[240:243], v[20:23], v[200:203]
    ds_read_b64_tr_b16 v[232:233], v7 offset:32768
    v_max_f32 v162, 0, v162
    v_mfma_f32_16x16x32_bf16 v[204:207], v[240:243], v[92:95], v[204:207]
    ds_read_b64_tr_b16 v[234:235], v7 offset:34816
    v_max_f32 v163, 0, v163
    v_mfma_f32_16x16x32_bf16 v[204:207], v[244:247], v[96:99], v[204:207]
    ds_read_b64_tr_b16 v[236:237], v7 offset:36864
    v_mul_f32 v160, v160, v168
    v_mfma_f32_16x16x32_bf16 v[200:203], v[244:247], v[24:27], v[200:203]
    ds_read_b64_tr_b16 v[238:239], v7 offset:38912
    v_mul_f32 v161, v161, v169
    s_waitcnt lgkmcnt(4)
    v_mfma_f32_16x16x32_bf16 v[208:211], v[224:227], v[16:19], 0
    ds_read_b64_tr_b16 v[240:241], v7 offset:40960
    v_mul_f32 v162, v162, v170
    v_mfma_f32_16x16x32_bf16 v[212:215], v[224:227], v[88:91], 0
    ds_read_b64_tr_b16 v[242:243], v7 offset:43008
    v_mul_f32 v163, v163, v171
    v_mfma_f32_16x16x32_bf16 v[212:215], v[228:231], v[92:95], v[212:215]
    ds_read_b64_tr_b16 v[244:245], v7 offset:45056
    v_cvt_pk_bf16_f32 v248, v160, v161
    v_mfma_f32_16x16x32_bf16 v[208:211], v[228:231], v[20:23], v[208:211]
    ds_read_b64_tr_b16 v[246:247], v7 offset:47104
    v_cvt_pk_bf16_f32 v249, v162, v163
    s_barrier
    s_waitcnt lgkmcnt(4)
    v_mfma_f32_16x16x32_bf16 v[208:211], v[232:235], v[24:27], v[208:211]
    ds_read_b64_tr_b16 v[224:225], v5 offset:0
    v_max_f32 v176, 0, v176
    v_mfma_f32_16x16x32_bf16 v[212:215], v[232:235], v[96:99], v[212:215]
    ds_read_b64_tr_b16 v[226:227], v5 offset:2048
    v_max_f32 v177, 0, v177
    v_mfma_f32_16x16x32_bf16 v[220:223], v[236:239], v[88:91], 0
    ds_read_b64_tr_b16 v[228:229], v5 offset:4096
    v_max_f32 v178, 0, v178
    v_mfma_f32_16x16x32_bf16 v[216:219], v[236:239], v[16:19], 0
    ds_read_b64_tr_b16 v[230:231], v5 offset:6144
    v_max_f32 v179, 0, v179
    s_waitcnt lgkmcnt(4)
    v_mfma_f32_16x16x32_bf16 v[216:219], v[240:243], v[20:23], v[216:219]
    ds_read_b64_tr_b16 v[232:233], v5 offset:8192
    v_mul_f32 v176, v176, v184
    v_mfma_f32_16x16x32_bf16 v[220:223], v[240:243], v[92:95], v[220:223]
    ds_read_b64_tr_b16 v[234:235], v5 offset:10240
    v_mul_f32 v177, v177, v185
    v_mfma_f32_16x16x32_bf16 v[220:223], v[244:247], v[96:99], v[220:223]
    ds_read_b64_tr_b16 v[236:237], v5 offset:12288
    v_mul_f32 v178, v178, v186
    v_mfma_f32_16x16x32_bf16 v[216:219], v[244:247], v[24:27], v[216:219]
    ds_read_b64_tr_b16 v[238:239], v5 offset:14336
    v_mul_f32 v179, v179, v187
    s_waitcnt lgkmcnt(4)
    v_mfma_f32_16x16x32_bf16 v[192:195], v[224:227], v[28:31], v[192:195]
    ds_read_b64_tr_b16 v[240:241], v5 offset:16384
    v_cvt_pk_bf16_f32 v250, v176, v177
    v_mfma_f32_16x16x32_bf16 v[196:199], v[224:227], v[100:103], v[196:199]
    ds_read_b64_tr_b16 v[242:243], v5 offset:18432
    v_cvt_pk_bf16_f32 v251, v178, v179
    v_mfma_f32_16x16x32_bf16 v[196:199], v[228:231], v[104:107], v[196:199]
    ds_read_b64_tr_b16 v[244:245], v5 offset:20480
    v_max_f32 v164, 0, v164
    v_mfma_f32_16x16x32_bf16 v[192:195], v[228:231], v[32:35], v[192:195]
    ds_read_b64_tr_b16 v[246:247], v5 offset:22528
    v_max_f32 v165, 0, v165
    s_waitcnt lgkmcnt(4)
    v_mfma_f32_16x16x32_bf16 v[192:195], v[232:235], v[36:39], v[192:195]
    ds_read_b64_tr_b16 v[224:225], v8 offset:0
    v_max_f32 v166, 0, v166
    v_mfma_f32_16x16x32_bf16 v[196:199], v[232:235], v[108:111], v[196:199]
    ds_read_b64_tr_b16 v[226:227], v8 offset:2048
    v_max_f32 v167, 0, v167
    v_mfma_f32_16x16x32_bf16 v[204:207], v[236:239], v[100:103], v[204:207]
    ds_read_b64_tr_b16 v[228:229], v8 offset:4096
    v_mul_f32 v164, v164, v172
    v_mfma_f32_16x16x32_bf16 v[200:203], v[236:239], v[28:31], v[200:203]
    ds_read_b64_tr_b16 v[230:231], v8 offset:6144
    v_mul_f32 v165, v165, v173
    s_waitcnt lgkmcnt(4)
    v_mfma_f32_16x16x32_bf16 v[200:203], v[240:243], v[32:35], v[200:203]
    ds_read_b64_tr_b16 v[232:233], v8 offset:8192
    v_mul_f32 v166, v166, v174
    v_mfma_f32_16x16x32_bf16 v[204:207], v[240:243], v[104:107], v[204:207]
    ds_read_b64_tr_b16 v[234:235], v8 offset:10240
    v_mul_f32 v167, v167, v175
    v_mfma_f32_16x16x32_bf16 v[204:207], v[244:247], v[108:111], v[204:207]
    ds_read_b64_tr_b16 v[236:237], v8 offset:12288
    v_cvt_pk_bf16_f32 v252, v164, v165
    v_mfma_f32_16x16x32_bf16 v[200:203], v[244:247], v[36:39], v[200:203]
    ds_read_b64_tr_b16 v[238:239], v8 offset:14336
    v_cvt_pk_bf16_f32 v253, v166, v167
    s_waitcnt lgkmcnt(4)
    v_mfma_f32_16x16x32_bf16 v[208:211], v[224:227], v[28:31], v[208:211]
    ds_read_b64_tr_b16 v[240:241], v8 offset:16384
    v_max_f32 v180, 0, v180
    v_mfma_f32_16x16x32_bf16 v[212:215], v[224:227], v[100:103], v[212:215]
    ds_read_b64_tr_b16 v[242:243], v8 offset:18432
    v_max_f32 v181, 0, v181
    v_mfma_f32_16x16x32_bf16 v[212:215], v[228:231], v[104:107], v[212:215]
    ds_read_b64_tr_b16 v[244:245], v8 offset:20480
    v_max_f32 v182, 0, v182
    v_mfma_f32_16x16x32_bf16 v[208:211], v[228:231], v[32:35], v[208:211]
    ds_read_b64_tr_b16 v[246:247], v8 offset:22528
    v_max_f32 v183, 0, v183
    s_barrier
    s_waitcnt lgkmcnt(4)
    v_mfma_f32_16x16x32_bf16 v[208:211], v[232:235], v[36:39], v[208:211]
    ds_read_b64_tr_b16 v[224:225], v5 offset:24576
    v_mul_f32 v180, v180, v188
    v_mfma_f32_16x16x32_bf16 v[212:215], v[232:235], v[108:111], v[212:215]
    ds_read_b64_tr_b16 v[226:227], v5 offset:26624
    v_mul_f32 v181, v181, v189
    v_mfma_f32_16x16x32_bf16 v[220:223], v[236:239], v[100:103], v[220:223]
    ds_read_b64_tr_b16 v[228:229], v5 offset:28672
    v_mul_f32 v182, v182, v190
    v_mfma_f32_16x16x32_bf16 v[216:219], v[236:239], v[28:31], v[216:219]
    ds_read_b64_tr_b16 v[230:231], v5 offset:30720
    v_mul_f32 v183, v183, v191
    s_waitcnt lgkmcnt(4)
    v_mfma_f32_16x16x32_bf16 v[216:219], v[240:243], v[32:35], v[216:219]
    ds_read_b64_tr_b16 v[232:233], v5 offset:32768
    v_cvt_pk_bf16_f32 v254, v180, v181
    v_mfma_f32_16x16x32_bf16 v[220:223], v[240:243], v[104:107], v[220:223]
    ds_read_b64_tr_b16 v[234:235], v5 offset:34816
    v_cvt_pk_bf16_f32 v255, v182, v183
    v_mfma_f32_16x16x32_bf16 v[220:223], v[244:247], v[108:111], v[220:223]
    ds_read_b64_tr_b16 v[236:237], v5 offset:36864
    s_lshl_b32 s55, s41, 11
    s_add_u32 s55, s55, 10240
    v_lshlrev_b32 v1, 4, v0
    buffer_store_dwordx4 v[248:251], v1, s[16:19], s55 offen offset:1024 sc1
    buffer_store_dwordx4 v[252:255], v1, s[16:19], s55 offen offset:0 sc1
    v_mfma_f32_16x16x32_bf16 v[216:219], v[244:247], v[36:39], v[216:219]
    ds_read_b64_tr_b16 v[238:239], v5 offset:38912
    s_waitcnt lgkmcnt(4)
    v_mfma_f32_16x16x32_bf16 v[192:195], v[224:227], v[40:43], v[192:195]
    ds_read_b64_tr_b16 v[240:241], v5 offset:40960
    v_mfma_f32_16x16x32_bf16 v[196:199], v[224:227], v[112:115], v[196:199]
    ds_read_b64_tr_b16 v[242:243], v5 offset:43008
    v_mfma_f32_16x16x32_bf16 v[196:199], v[228:231], v[116:119], v[196:199]
    ds_read_b64_tr_b16 v[244:245], v5 offset:45056
    v_mfma_f32_16x16x32_bf16 v[192:195], v[228:231], v[44:47], v[192:195]
    ds_read_b64_tr_b16 v[246:247], v5 offset:47104
    s_waitcnt lgkmcnt(4)
    v_mfma_f32_16x16x32_bf16 v[192:195], v[232:235], v[48:51], v[192:195]
    ds_read_b64_tr_b16 v[224:225], v8 offset:24576
    v_mfma_f32_16x16x32_bf16 v[196:199], v[232:235], v[120:123], v[196:199]
    ds_read_b64_tr_b16 v[226:227], v8 offset:26624
    v_mfma_f32_16x16x32_bf16 v[204:207], v[236:239], v[112:115], v[204:207]
    ds_read_b64_tr_b16 v[228:229], v8 offset:28672
    v_mfma_f32_16x16x32_bf16 v[200:203], v[236:239], v[40:43], v[200:203]
    ds_read_b64_tr_b16 v[230:231], v8 offset:30720
    s_waitcnt lgkmcnt(4)
    v_mfma_f32_16x16x32_bf16 v[200:203], v[240:243], v[44:47], v[200:203]
    ds_read_b64_tr_b16 v[232:233], v8 offset:32768
    v_mfma_f32_16x16x32_bf16 v[204:207], v[240:243], v[116:119], v[204:207]
    ds_read_b64_tr_b16 v[234:235], v8 offset:34816
    v_mfma_f32_16x16x32_bf16 v[204:207], v[244:247], v[120:123], v[204:207]
    ds_read_b64_tr_b16 v[236:237], v8 offset:36864
    v_mfma_f32_16x16x32_bf16 v[200:203], v[244:247], v[48:51], v[200:203]
    ds_read_b64_tr_b16 v[238:239], v8 offset:38912
    s_waitcnt lgkmcnt(4)
    v_mfma_f32_16x16x32_bf16 v[208:211], v[224:227], v[40:43], v[208:211]
    ds_read_b64_tr_b16 v[240:241], v8 offset:40960
    v_mfma_f32_16x16x32_bf16 v[212:215], v[224:227], v[112:115], v[212:215]
    ds_read_b64_tr_b16 v[242:243], v8 offset:43008
    v_mfma_f32_16x16x32_bf16 v[212:215], v[228:231], v[116:119], v[212:215]
    ds_read_b64_tr_b16 v[244:245], v8 offset:45056
    v_mfma_f32_16x16x32_bf16 v[208:211], v[228:231], v[44:47], v[208:211]
    ds_read_b64_tr_b16 v[246:247], v8 offset:47104
    s_barrier
    s_waitcnt lgkmcnt(4)
    v_mfma_f32_16x16x32_bf16 v[208:211], v[232:235], v[48:51], v[208:211]
    ds_read_b64_tr_b16 v[224:225], v3 offset:0
    v_lshlrev_b32 v1, 2, v0
    v_mfma_f32_16x16x32_bf16 v[212:215], v[232:235], v[120:123], v[212:215]
    ds_read_b64_tr_b16 v[226:227], v3 offset:2048
    s_mul_i32 s58, s40, 72
    v_mfma_f32_16x16x32_bf16 v[220:223], v[236:239], v[112:115], v[220:223]
    ds_read_b64_tr_b16 v[228:229], v3 offset:4096
    s_and_b32 s58, s58, 63
    v_mfma_f32_16x16x32_bf16 v[216:219], v[236:239], v[40:43], v[216:219]
    ds_read_b64_tr_b16 v[230:231], v3 offset:6144
    s_mul_i32 s58, s58, 224
    s_waitcnt lgkmcnt(4)
    v_mfma_f32_16x16x32_bf16 v[216:219], v[240:243], v[44:47], v[216:219]
    ds_read_b64_tr_b16 v[232:233], v3 offset:8192
    buffer_load_dword v176, v1, s[72:75], s58 offen offset:3072
    v_mfma_f32_16x16x32_bf16 v[220:223], v[240:243], v[116:119], v[220:223]
    ds_read_b64_tr_b16 v[234:235], v3 offset:10240
    buffer_load_dword v179, v1, s[72:75], s58 offen offset:3328
    v_mfma_f32_16x16x32_bf16 v[220:223], v[244:247], v[120:123], v[220:223]
    ds_read_b64_tr_b16 v[236:237], v3 offset:12288
    buffer_load_dword v182, v1, s[72:75], s58 offen offset:3584
    v_mfma_f32_16x16x32_bf16 v[216:219], v[244:247], v[48:51], v[216:219]
    ds_read_b64_tr_b16 v[238:239], v3 offset:14336
    buffer_load_dword v185, v1, s[72:75], s58 offen offset:3840
    s_waitcnt lgkmcnt(4)
    v_mfma_f32_16x16x32_bf16 v[192:195], v[224:227], v[52:55], v[192:195]
    ds_read_b64_tr_b16 v[240:241], v3 offset:16384
    v_mfma_f32_16x16x32_bf16 v[196:199], v[224:227], v[124:127], v[196:199]
    ds_read_b64_tr_b16 v[242:243], v3 offset:18432
    v_mfma_f32_16x16x32_bf16 v[196:199], v[228:231], v[128:131], v[196:199]
    ds_read_b64_tr_b16 v[244:245], v3 offset:20480
    v_mfma_f32_16x16x32_bf16 v[192:195], v[228:231], v[56:59], v[192:195]
    ds_read_b64_tr_b16 v[246:247], v3 offset:22528
    s_waitcnt lgkmcnt(4)
    v_mfma_f32_16x16x32_bf16 v[192:195], v[232:235], v[60:63], v[192:195]
    ds_read_b64_tr_b16 v[224:225], v6 offset:0
    v_mfma_f32_16x16x32_bf16 v[196:199], v[232:235], v[132:135], v[196:199]
    ds_read_b64_tr_b16 v[226:227], v6 offset:2048
    v_mfma_f32_16x16x32_bf16 v[204:207], v[236:239], v[124:127], v[204:207]
    ds_read_b64_tr_b16 v[228:229], v6 offset:4096
    v_mfma_f32_16x16x32_bf16 v[200:203], v[236:239], v[52:55], v[200:203]
    ds_read_b64_tr_b16 v[230:231], v6 offset:6144
    s_waitcnt lgkmcnt(4)
    v_mfma_f32_16x16x32_bf16 v[200:203], v[240:243], v[56:59], v[200:203]
    ds_read_b64_tr_b16 v[232:233], v6 offset:8192
    v_mfma_f32_16x16x32_bf16 v[204:207], v[240:243], v[128:131], v[204:207]
    ds_read_b64_tr_b16 v[234:235], v6 offset:10240
    v_mfma_f32_16x16x32_bf16 v[204:207], v[244:247], v[132:135], v[204:207]
    ds_read_b64_tr_b16 v[236:237], v6 offset:12288
    v_mfma_f32_16x16x32_bf16 v[200:203], v[244:247], v[60:63], v[200:203]
    ds_read_b64_tr_b16 v[238:239], v6 offset:14336
    s_waitcnt lgkmcnt(4)
    v_mfma_f32_16x16x32_bf16 v[208:211], v[224:227], v[52:55], v[208:211]
    ds_read_b64_tr_b16 v[240:241], v6 offset:16384
    v_mfma_f32_16x16x32_bf16 v[212:215], v[224:227], v[124:127], v[212:215]
    ds_read_b64_tr_b16 v[242:243], v6 offset:18432
    v_mfma_f32_16x16x32_bf16 v[212:215], v[228:231], v[128:131], v[212:215]
    ds_read_b64_tr_b16 v[244:245], v6 offset:20480
    v_mfma_f32_16x16x32_bf16 v[208:211], v[228:231], v[56:59], v[208:211]
    ds_read_b64_tr_b16 v[246:247], v6 offset:22528
    s_barrier
    s_waitcnt lgkmcnt(4)
    v_mfma_f32_16x16x32_bf16 v[208:211], v[232:235], v[60:63], v[208:211]
    ds_read_b64_tr_b16 v[224:225], v3 offset:24576
    v_mfma_f32_16x16x32_bf16 v[212:215], v[232:235], v[132:135], v[212:215]
    ds_read_b64_tr_b16 v[226:227], v3 offset:26624
    v_mfma_f32_16x16x32_bf16 v[220:223], v[236:239], v[124:127], v[220:223]
    ds_read_b64_tr_b16 v[228:229], v3 offset:28672
    v_mfma_f32_16x16x32_bf16 v[216:219], v[236:239], v[52:55], v[216:219]
    ds_read_b64_tr_b16 v[230:231], v3 offset:30720
    s_waitcnt lgkmcnt(4)
    v_mfma_f32_16x16x32_bf16 v[216:219], v[240:243], v[56:59], v[216:219]
    ds_read_b64_tr_b16 v[232:233], v3 offset:32768
    v_mfma_f32_16x16x32_bf16 v[220:223], v[240:243], v[128:131], v[220:223]
    ds_read_b64_tr_b16 v[234:235], v3 offset:34816
    v_mfma_f32_16x16x32_bf16 v[220:223], v[244:247], v[132:135], v[220:223]
    ds_read_b64_tr_b16 v[236:237], v3 offset:36864
    v_mfma_f32_16x16x32_bf16 v[216:219], v[244:247], v[60:63], v[216:219]
    ds_read_b64_tr_b16 v[238:239], v3 offset:38912
    s_waitcnt lgkmcnt(4)
    v_mfma_f32_16x16x32_bf16 v[192:195], v[224:227], v[64:67], v[192:195]
    ds_read_b64_tr_b16 v[240:241], v3 offset:40960
    v_mfma_f32_16x16x32_bf16 v[196:199], v[224:227], v[136:139], v[196:199]
    ds_read_b64_tr_b16 v[242:243], v3 offset:43008
    v_mfma_f32_16x16x32_bf16 v[196:199], v[228:231], v[140:143], v[196:199]
    ds_read_b64_tr_b16 v[244:245], v3 offset:45056
    v_mfma_f32_16x16x32_bf16 v[192:195], v[228:231], v[68:71], v[192:195]
    ds_read_b64_tr_b16 v[246:247], v3 offset:47104
    s_waitcnt lgkmcnt(4)
    v_mfma_f32_16x16x32_bf16 v[192:195], v[232:235], v[72:75], v[192:195]
    ds_read_b64_tr_b16 v[224:225], v6 offset:24576
    v_mfma_f32_16x16x32_bf16 v[196:199], v[232:235], v[144:147], v[196:199]
    ds_read_b64_tr_b16 v[226:227], v6 offset:26624
    v_mfma_f32_16x16x32_bf16 v[204:207], v[236:239], v[136:139], v[204:207]
    ds_read_b64_tr_b16 v[228:229], v6 offset:28672
    v_mfma_f32_16x16x32_bf16 v[200:203], v[236:239], v[64:67], v[200:203]
    ds_read_b64_tr_b16 v[230:231], v6 offset:30720
    s_waitcnt lgkmcnt(4)
    v_mfma_f32_16x16x32_bf16 v[200:203], v[240:243], v[68:71], v[200:203]
    ds_read_b64_tr_b16 v[232:233], v6 offset:32768
    v_mfma_f32_16x16x32_bf16 v[204:207], v[240:243], v[140:143], v[204:207]
    ds_read_b64_tr_b16 v[234:235], v6 offset:34816
    v_mfma_f32_16x16x32_bf16 v[204:207], v[244:247], v[144:147], v[204:207]
    ds_read_b64_tr_b16 v[236:237], v6 offset:36864
    v_mfma_f32_16x16x32_bf16 v[200:203], v[244:247], v[72:75], v[200:203]
    ds_read_b64_tr_b16 v[238:239], v6 offset:38912
    s_waitcnt lgkmcnt(4)
    v_mfma_f32_16x16x32_bf16 v[208:211], v[224:227], v[64:67], v[208:211]
    ds_read_b64_tr_b16 v[240:241], v6 offset:40960
    v_mfma_f32_16x16x32_bf16 v[212:215], v[224:227], v[136:139], v[212:215]
    ds_read_b64_tr_b16 v[242:243], v6 offset:43008
    v_mfma_f32_16x16x32_bf16 v[212:215], v[228:231], v[140:143], v[212:215]
    ds_read_b64_tr_b16 v[244:245], v6 offset:45056
    v_mfma_f32_16x16x32_bf16 v[208:211], v[228:231], v[68:71], v[208:211]
    ds_read_b64_tr_b16 v[246:247], v6 offset:47104
    s_barrier
    s_waitcnt lgkmcnt(4)
    v_mfma_f32_16x16x32_bf16 v[208:211], v[232:235], v[72:75], v[208:211]
    ds_read_b64_tr_b16 v[224:225], v4 offset:0
    v_mfma_f32_16x16x32_bf16 v[212:215], v[232:235], v[144:147], v[212:215]
    ds_read_b64_tr_b16 v[226:227], v4 offset:2048
    v_mfma_f32_16x16x32_bf16 v[220:223], v[236:239], v[136:139], v[220:223]
    ds_read_b64_tr_b16 v[228:229], v4 offset:4096
    v_mfma_f32_16x16x32_bf16 v[216:219], v[236:239], v[64:67], v[216:219]
    ds_read_b64_tr_b16 v[230:231], v4 offset:6144
    s_waitcnt lgkmcnt(4)
    v_mfma_f32_16x16x32_bf16 v[216:219], v[240:243], v[68:71], v[216:219]
    ds_read_b64_tr_b16 v[232:233], v4 offset:8192
    v_mfma_f32_16x16x32_bf16 v[220:223], v[240:243], v[140:143], v[220:223]
    ds_read_b64_tr_b16 v[234:235], v4 offset:10240
    v_mfma_f32_16x16x32_bf16 v[220:223], v[244:247], v[144:147], v[220:223]
    ds_read_b64_tr_b16 v[236:237], v4 offset:12288
    v_mfma_f32_16x16x32_bf16 v[216:219], v[244:247], v[72:75], v[216:219]
    ds_read_b64_tr_b16 v[238:239], v4 offset:14336
    s_waitcnt lgkmcnt(4)
    v_mfma_f32_16x16x32_bf16 v[192:195], v[224:227], v[76:79], v[192:195]
    ds_read_b64_tr_b16 v[240:241], v4 offset:16384
    v_mfma_f32_16x16x32_bf16 v[196:199], v[224:227], v[148:151], v[196:199]
    ds_read_b64_tr_b16 v[242:243], v4 offset:18432
    v_mfma_f32_16x16x32_bf16 v[196:199], v[228:231], v[152:155], v[196:199]
    ds_read_b64_tr_b16 v[244:245], v4 offset:20480
    v_mfma_f32_16x16x32_bf16 v[192:195], v[228:231], v[80:83], v[192:195]
    ds_read_b64_tr_b16 v[246:247], v4 offset:22528
    s_waitcnt lgkmcnt(4)
    v_mfma_f32_16x16x32_bf16 v[192:195], v[232:235], v[84:87], v[192:195]
    ds_read_b64_tr_b16 v[224:225], v7 offset:0
    v_mfma_f32_16x16x32_bf16 v[196:199], v[232:235], v[156:159], v[196:199]
    ds_read_b64_tr_b16 v[226:227], v7 offset:2048
    v_mfma_f32_16x16x32_bf16 v[204:207], v[236:239], v[148:151], v[204:207]
    ds_read_b64_tr_b16 v[228:229], v7 offset:4096
    v_mfma_f32_16x16x32_bf16 v[200:203], v[236:239], v[76:79], v[200:203]
    ds_read_b64_tr_b16 v[230:231], v7 offset:6144
    s_waitcnt lgkmcnt(4)
    v_mfma_f32_16x16x32_bf16 v[200:203], v[240:243], v[80:83], v[200:203]
    ds_read_b64_tr_b16 v[232:233], v7 offset:8192
    v_mfma_f32_16x16x32_bf16 v[204:207], v[240:243], v[152:155], v[204:207]
    ds_read_b64_tr_b16 v[234:235], v7 offset:10240
    v_mfma_f32_16x16x32_bf16 v[204:207], v[244:247], v[156:159], v[204:207]
    ds_read_b64_tr_b16 v[236:237], v7 offset:12288
    v_mfma_f32_16x16x32_bf16 v[200:203], v[244:247], v[84:87], v[200:203]
    ds_read_b64_tr_b16 v[238:239], v7 offset:14336
    s_waitcnt lgkmcnt(4)
    v_mfma_f32_16x16x32_bf16 v[208:211], v[224:227], v[76:79], v[208:211]
    ds_read_b64_tr_b16 v[240:241], v7 offset:16384
    v_mfma_f32_16x16x32_bf16 v[212:215], v[224:227], v[148:151], v[212:215]
    ds_read_b64_tr_b16 v[242:243], v7 offset:18432
    v_mfma_f32_16x16x32_bf16 v[212:215], v[228:231], v[152:155], v[212:215]
    ds_read_b64_tr_b16 v[244:245], v7 offset:20480
    v_mfma_f32_16x16x32_bf16 v[208:211], v[228:231], v[80:83], v[208:211]
    ds_read_b64_tr_b16 v[246:247], v7 offset:22528
    s_barrier
    v_lshrrev_b32 v6, 4, v0
    v_bfe_u32 v7, v0, 2, 2
    v_lshl_add_u32 v6, v6, 2, v7
    v_lshlrev_b32 v6, 6, v6
    v_and_b32 v7, 3, v0
    v_lshl_add_u32 v6, v7, 3, v6
    v_bfe_u32 v7, v0, 4, 1
    v_xor_b32 v7, s38, v7
    v_lshl_add_u32 v3, v7, 5, v6
    v_add_u32 v4, 49152, v3
    v_add_u32 v5, 98304, v3
    s_waitcnt lgkmcnt(4)
    v_mfma_f32_16x16x32_bf16 v[208:211], v[232:235], v[84:87], v[208:211]
    ds_read_b64_tr_b16 v[224:225], v4 offset:24576
    v_mfma_f32_16x16x32_bf16 v[212:215], v[232:235], v[156:159], v[212:215]
    ds_read_b64_tr_b16 v[226:227], v4 offset:25600
    v_mfma_f32_16x16x32_bf16 v[220:223], v[236:239], v[148:151], v[220:223]
    ds_read_b64_tr_b16 v[228:229], v4 offset:26624
    v_mfma_f32_16x16x32_bf16 v[216:219], v[236:239], v[76:79], v[216:219]
    ds_read_b64_tr_b16 v[230:231], v4 offset:27648
    s_waitcnt lgkmcnt(4)
    v_mfma_f32_16x16x32_bf16 v[216:219], v[240:243], v[80:83], v[216:219]
    ds_read_b64_tr_b16 v[232:233], v4 offset:28672
    v_mfma_f32_16x16x32_bf16 v[220:223], v[240:243], v[152:155], v[220:223]
    ds_read_b64_tr_b16 v[234:235], v4 offset:29696
    v_mfma_f32_16x16x32_bf16 v[220:223], v[244:247], v[156:159], v[220:223]
    ds_read_b64_tr_b16 v[236:237], v4 offset:30720
    v_mfma_f32_16x16x32_bf16 v[216:219], v[244:247], v[84:87], v[216:219]
    ds_read_b64_tr_b16 v[238:239], v4 offset:31744
    s_waitcnt lgkmcnt(4)
    v_mfma_f32_16x16x32_bf16 v[160:163], v[224:227], v[16:19], 0
    ds_read_b64_tr_b16 v[240:241], v4 offset:32768
    v_mfma_f32_16x16x32_bf16 v[164:167], v[224:227], v[88:91], 0
    ds_read_b64_tr_b16 v[242:243], v4 offset:33792
    v_mfma_f32_16x16x32_bf16 v[164:167], v[228:231], v[92:95], v[164:167]
    ds_read_b64_tr_b16 v[244:245], v4 offset:34816
    v_mfma_f32_16x16x32_bf16 v[160:163], v[228:231], v[20:23], v[160:163]
    ds_read_b64_tr_b16 v[246:247], v4 offset:35840
    s_waitcnt lgkmcnt(4)
    v_mfma_f32_16x16x32_bf16 v[160:163], v[232:235], v[24:27], v[160:163]
    ds_read_b64_tr_b16 v[224:225], v4 offset:36864
    v_mfma_f32_16x16x32_bf16 v[164:167], v[232:235], v[96:99], v[164:167]
    ds_read_b64_tr_b16 v[226:227], v4 offset:37888
    v_mfma_f32_16x16x32_bf16 v[164:167], v[236:239], v[100:103], v[164:167]
    ds_read_b64_tr_b16 v[228:229], v4 offset:38912
    v_max_f32 v192, 0, v192
    v_mfma_f32_16x16x32_bf16 v[160:163], v[236:239], v[28:31], v[160:163]
    ds_read_b64_tr_b16 v[230:231], v4 offset:39936
    v_max_f32 v193, 0, v193
    s_waitcnt lgkmcnt(4)
    v_mfma_f32_16x16x32_bf16 v[160:163], v[240:243], v[32:35], v[160:163]
    ds_read_b64_tr_b16 v[232:233], v4 offset:40960
    v_max_f32 v194, 0, v194
    v_mfma_f32_16x16x32_bf16 v[164:167], v[240:243], v[104:107], v[164:167]
    ds_read_b64_tr_b16 v[234:235], v4 offset:41984
    v_max_f32 v195, 0, v195
    v_mfma_f32_16x16x32_bf16 v[164:167], v[244:247], v[108:111], v[164:167]
    ds_read_b64_tr_b16 v[236:237], v4 offset:43008
    v_mul_f32 v192, v192, v200
    v_mfma_f32_16x16x32_bf16 v[160:163], v[244:247], v[36:39], v[160:163]
    ds_read_b64_tr_b16 v[238:239], v4 offset:44032
    v_mul_f32 v193, v193, v201
    s_waitcnt lgkmcnt(4)
    v_mfma_f32_16x16x32_bf16 v[168:171], v[224:227], v[16:19], 0
    ds_read_b64_tr_b16 v[240:241], v4 offset:45056
    v_mul_f32 v194, v194, v202
    v_mfma_f32_16x16x32_bf16 v[172:175], v[224:227], v[88:91], 0
    ds_read_b64_tr_b16 v[242:243], v4 offset:46080
    v_mul_f32 v195, v195, v203
    v_mfma_f32_16x16x32_bf16 v[172:175], v[228:231], v[92:95], v[172:175]
    ds_read_b64_tr_b16 v[244:245], v4 offset:47104
    v_cvt_pk_bf16_f32 v248, v192, v193
    v_mfma_f32_16x16x32_bf16 v[168:171], v[228:231], v[20:23], v[168:171]
    ds_read_b64_tr_b16 v[246:247], v4 offset:48128
    v_cvt_pk_bf16_f32 v249, v194, v195
    s_barrier
    s_waitcnt vmcnt(0)
    s_waitcnt lgkmcnt(4)
    v_mfma_f32_16x16x32_bf16 v[168:171], v[232:235], v[24:27], v[168:171]
    ds_read_b64_tr_b16 v[224:225], v5 offset:0
    v_max_f32 v208, 0, v208
    v_mfma_f32_16x16x32_bf16 v[172:175], v[232:235], v[96:99], v[172:175]
    ds_read_b64_tr_b16 v[226:227], v5 offset:1024
    v_max_f32 v209, 0, v209
    v_mfma_f32_16x16x32_bf16 v[172:175], v[236:239], v[100:103], v[172:175]
    ds_read_b64_tr_b16 v[228:229], v5 offset:2048
    v_max_f32 v210, 0, v210
    v_mfma_f32_16x16x32_bf16 v[168:171], v[236:239], v[28:31], v[168:171]
    ds_read_b64_tr_b16 v[230:231], v5 offset:3072
    v_max_f32 v211, 0, v211
    s_waitcnt lgkmcnt(4)
    v_mfma_f32_16x16x32_bf16 v[168:171], v[240:243], v[32:35], v[168:171]
    ds_read_b64_tr_b16 v[232:233], v5 offset:4096
    v_mul_f32 v208, v208, v216
    v_mfma_f32_16x16x32_bf16 v[172:175], v[240:243], v[104:107], v[172:175]
    ds_read_b64_tr_b16 v[234:235], v5 offset:5120
    v_mul_f32 v209, v209, v217
    v_mfma_f32_16x16x32_bf16 v[172:175], v[244:247], v[108:111], v[172:175]
    ds_read_b64_tr_b16 v[236:237], v5 offset:6144
    v_mul_f32 v210, v210, v218
    v_mfma_f32_16x16x32_bf16 v[168:171], v[244:247], v[36:39], v[168:171]
    ds_read_b64_tr_b16 v[238:239], v5 offset:7168
    v_mul_f32 v211, v211, v219
    s_waitcnt lgkmcnt(4)
    v_mfma_f32_16x16x32_bf16 v[160:163], v[224:227], v[40:43], v[160:163]
    ds_read_b64_tr_b16 v[240:241], v5 offset:8192
    v_cvt_pk_bf16_f32 v250, v208, v209
    v_mfma_f32_16x16x32_bf16 v[164:167], v[224:227], v[112:115], v[164:167]
    ds_read_b64_tr_b16 v[242:243], v5 offset:9216
    v_cvt_pk_bf16_f32 v251, v210, v211
    v_mfma_f32_16x16x32_bf16 v[164:167], v[228:231], v[116:119], v[164:167]
    ds_read_b64_tr_b16 v[244:245], v5 offset:10240
    v_max_f32 v196, 0, v196
    v_mfma_f32_16x16x32_bf16 v[160:163], v[228:231], v[44:47], v[160:163]
    ds_read_b64_tr_b16 v[246:247], v5 offset:11264
    v_max_f32 v197, 0, v197
    s_waitcnt lgkmcnt(4)
    v_mfma_f32_16x16x32_bf16 v[160:163], v[232:235], v[48:51], v[160:163]
    ds_read_b64_tr_b16 v[224:225], v5 offset:12288
    v_max_f32 v198, 0, v198
    v_mfma_f32_16x16x32_bf16 v[164:167], v[232:235], v[120:123], v[164:167]
    ds_read_b64_tr_b16 v[226:227], v5 offset:13312
    v_max_f32 v199, 0, v199
    v_mfma_f32_16x16x32_bf16 v[164:167], v[236:239], v[124:127], v[164:167]
    ds_read_b64_tr_b16 v[228:229], v5 offset:14336
    v_mul_f32 v196, v196, v204
    v_mfma_f32_16x16x32_bf16 v[160:163], v[236:239], v[52:55], v[160:163]
    ds_read_b64_tr_b16 v[230:231], v5 offset:15360
    v_mul_f32 v197, v197, v205
    s_waitcnt lgkmcnt(4)
    v_mfma_f32_16x16x32_bf16 v[160:163], v[240:243], v[56:59], v[160:163]
    ds_read_b64_tr_b16 v[232:233], v5 offset:16384
    v_mul_f32 v198, v198, v206
    v_mfma_f32_16x16x32_bf16 v[164:167], v[240:243], v[128:131], v[164:167]
    ds_read_b64_tr_b16 v[234:235], v5 offset:17408
    v_mul_f32 v199, v199, v207
    v_mfma_f32_16x16x32_bf16 v[164:167], v[244:247], v[132:135], v[164:167]
    ds_read_b64_tr_b16 v[236:237], v5 offset:18432
    v_cvt_pk_bf16_f32 v252, v196, v197
    v_mfma_f32_16x16x32_bf16 v[160:163], v[244:247], v[60:63], v[160:163]
    ds_read_b64_tr_b16 v[238:239], v5 offset:19456
    v_cvt_pk_bf16_f32 v253, v198, v199
    s_waitcnt lgkmcnt(4)
    v_mfma_f32_16x16x32_bf16 v[168:171], v[224:227], v[40:43], v[168:171]
    ds_read_b64_tr_b16 v[240:241], v5 offset:20480
    v_max_f32 v212, 0, v212
    v_mfma_f32_16x16x32_bf16 v[172:175], v[224:227], v[112:115], v[172:175]
    ds_read_b64_tr_b16 v[242:243], v5 offset:21504
    v_max_f32 v213, 0, v213
    v_mfma_f32_16x16x32_bf16 v[172:175], v[228:231], v[116:119], v[172:175]
    ds_read_b64_tr_b16 v[244:245], v5 offset:22528
    v_max_f32 v214, 0, v214
    v_mfma_f32_16x16x32_bf16 v[168:171], v[228:231], v[44:47], v[168:171]
    ds_read_b64_tr_b16 v[246:247], v5 offset:23552
    v_max_f32 v215, 0, v215
    s_barrier
    s_waitcnt lgkmcnt(4)
    v_mfma_f32_16x16x32_bf16 v[168:171], v[232:235], v[48:51], v[168:171]
    ds_read_b64_tr_b16 v[224:225], v5 offset:24576
    v_mul_f32 v212, v212, v220
    v_mfma_f32_16x16x32_bf16 v[172:175], v[232:235], v[120:123], v[172:175]
    ds_read_b64_tr_b16 v[226:227], v5 offset:25600
    v_mul_f32 v213, v213, v221
    v_mfma_f32_16x16x32_bf16 v[172:175], v[236:239], v[124:127], v[172:175]
    ds_read_b64_tr_b16 v[228:229], v5 offset:26624
    v_mul_f32 v214, v214, v222
    v_mfma_f32_16x16x32_bf16 v[168:171], v[236:239], v[52:55], v[168:171]
    ds_read_b64_tr_b16 v[230:231], v5 offset:27648
    v_mul_f32 v215, v215, v223
    s_waitcnt lgkmcnt(4)
    v_mfma_f32_16x16x32_bf16 v[168:171], v[240:243], v[56:59], v[168:171]
    ds_read_b64_tr_b16 v[232:233], v5 offset:28672
    v_cvt_pk_bf16_f32 v254, v212, v213
    v_mfma_f32_16x16x32_bf16 v[172:175], v[240:243], v[128:131], v[172:175]
    ds_read_b64_tr_b16 v[234:235], v5 offset:29696
    v_cvt_pk_bf16_f32 v255, v214, v215
    v_mfma_f32_16x16x32_bf16 v[172:175], v[244:247], v[132:135], v[172:175]
    ds_read_b64_tr_b16 v[236:237], v5 offset:30720
    s_lshl_b32 s55, s41, 11
    s_add_u32 s55, s55, 14336
    v_lshlrev_b32 v1, 4, v0
    buffer_store_dwordx4 v[248:251], v1, s[16:19], s55 offen offset:1024 sc1
    buffer_store_dwordx4 v[252:255], v1, s[16:19], s55 offen offset:0 sc1
    v_mfma_f32_16x16x32_bf16 v[168:171], v[244:247], v[60:63], v[168:171]
    ds_read_b64_tr_b16 v[238:239], v5 offset:31744
    v_add_u32 v177, 49152, v176
    s_waitcnt lgkmcnt(4)
    v_mfma_f32_16x16x32_bf16 v[160:163], v[224:227], v[64:67], v[160:163]
    ds_read_b64_tr_b16 v[240:241], v5 offset:32768
    v_add_u32 v178, 98304, v176
    v_mfma_f32_16x16x32_bf16 v[164:167], v[224:227], v[136:139], v[164:167]
    ds_read_b64_tr_b16 v[242:243], v5 offset:33792
    v_add_u32 v180, 49152, v179
    v_mfma_f32_16x16x32_bf16 v[164:167], v[228:231], v[140:143], v[164:167]
    ds_read_b64_tr_b16 v[244:245], v5 offset:34816
    v_add_u32 v181, 98304, v179
    v_mfma_f32_16x16x32_bf16 v[160:163], v[228:231], v[68:71], v[160:163]
    ds_read_b64_tr_b16 v[246:247], v5 offset:35840
    v_add_u32 v183, 49152, v182
    s_waitcnt lgkmcnt(4)
    v_mfma_f32_16x16x32_bf16 v[160:163], v[232:235], v[72:75], v[160:163]
    ds_read_b64_tr_b16 v[224:225], v5 offset:36864
    v_add_u32 v184, 98304, v182
    v_mfma_f32_16x16x32_bf16 v[164:167], v[232:235], v[144:147], v[164:167]
    ds_read_b64_tr_b16 v[226:227], v5 offset:37888
    v_add_u32 v186, 49152, v185
    v_mfma_f32_16x16x32_bf16 v[164:167], v[236:239], v[148:151], v[164:167]
    ds_read_b64_tr_b16 v[228:229], v5 offset:38912
    v_add_u32 v187, 98304, v185
    v_mfma_f32_16x16x32_bf16 v[160:163], v[236:239], v[76:79], v[160:163]
    ds_read_b64_tr_b16 v[230:231], v5 offset:39936
    s_waitcnt lgkmcnt(4)
    v_mfma_f32_16x16x32_bf16 v[160:163], v[240:243], v[80:83], v[160:163]
    ds_read_b64_tr_b16 v[232:233], v5 offset:40960
    v_mfma_f32_16x16x32_bf16 v[164:167], v[240:243], v[152:155], v[164:167]
    ds_read_b64_tr_b16 v[234:235], v5 offset:41984
    v_mfma_f32_16x16x32_bf16 v[164:167], v[244:247], v[156:159], v[164:167]
    ds_read_b64_tr_b16 v[236:237], v5 offset:43008
    v_mfma_f32_16x16x32_bf16 v[160:163], v[244:247], v[84:87], v[160:163]
    ds_read_b64_tr_b16 v[238:239], v5 offset:44032
    s_waitcnt lgkmcnt(4)
    v_mfma_f32_16x16x32_bf16 v[168:171], v[224:227], v[64:67], v[168:171]
    ds_read_b64_tr_b16 v[240:241], v5 offset:45056
    v_mfma_f32_16x16x32_bf16 v[172:175], v[224:227], v[136:139], v[172:175]
    ds_read_b64_tr_b16 v[242:243], v5 offset:46080
    v_mfma_f32_16x16x32_bf16 v[172:175], v[228:231], v[140:143], v[172:175]
    ds_read_b64_tr_b16 v[244:245], v5 offset:47104
    v_mfma_f32_16x16x32_bf16 v[168:171], v[228:231], v[68:71], v[168:171]
    ds_read_b64_tr_b16 v[246:247], v5 offset:48128
    s_barrier
    s_waitcnt lgkmcnt(4)
    v_mfma_f32_16x16x32_bf16 v[168:171], v[232:235], v[72:75], v[168:171]
    ds_read_b64_tr_b16 v[224:225], v176 offset:0
    v_mfma_f32_16x16x32_bf16 v[172:175], v[232:235], v[144:147], v[172:175]
    ds_read_b64_tr_b16 v[226:227], v176 offset:6144
    v_mfma_f32_16x16x32_bf16 v[172:175], v[236:239], v[148:151], v[172:175]
    ds_read_b64_tr_b16 v[228:229], v176 offset:12288
    v_mfma_f32_16x16x32_bf16 v[168:171], v[236:239], v[76:79], v[168:171]
    ds_read_b64_tr_b16 v[230:231], v176 offset:18432
    s_waitcnt lgkmcnt(4)
    v_mfma_f32_16x16x32_bf16 v[168:171], v[240:243], v[80:83], v[168:171]
    ds_read_b64_tr_b16 v[232:233], v179 offset:0
    v_mfma_f32_16x16x32_bf16 v[172:175], v[240:243], v[152:155], v[172:175]
    ds_read_b64_tr_b16 v[234:235], v179 offset:6144
    v_mfma_f32_16x16x32_bf16 v[172:175], v[244:247], v[156:159], v[172:175]
    ds_read_b64_tr_b16 v[236:237], v179 offset:12288
    v_mfma_f32_16x16x32_bf16 v[168:171], v[244:247], v[84:87], v[168:171]
    ds_read_b64_tr_b16 v[238:239], v179 offset:18432
    s_waitcnt lgkmcnt(4)
    v_mfma_f32_16x16x32_bf16 v[192:195], v[224:227], v[16:19], 0
    ds_read_b64_tr_b16 v[240:241], v182 offset:0
    v_mfma_f32_16x16x32_bf16 v[196:199], v[224:227], v[88:91], 0
    ds_read_b64_tr_b16 v[242:243], v182 offset:6144
    v_mfma_f32_16x16x32_bf16 v[196:199], v[228:231], v[92:95], v[196:199]
    ds_read_b64_tr_b16 v[244:245], v182 offset:12288
    v_mfma_f32_16x16x32_bf16 v[192:195], v[228:231], v[20:23], v[192:195]
    ds_read_b64_tr_b16 v[246:247], v182 offset:18432
    s_waitcnt lgkmcnt(4)
    v_mfma_f32_16x16x32_bf16 v[200:203], v[232:235], v[16:19], 0
    ds_read_b64_tr_b16 v[224:225], v185 offset:0
    v_mfma_f32_16x16x32_bf16 v[204:207], v[232:235], v[88:91], 0
    ds_read_b64_tr_b16 v[226:227], v185 offset:6144
    v_mfma_f32_16x16x32_bf16 v[204:207], v[236:239], v[92:95], v[204:207]
    ds_read_b64_tr_b16 v[228:229], v185 offset:12288
    v_max_f32 v160, 0, v160
    v_mfma_f32_16x16x32_bf16 v[200:203], v[236:239], v[20:23], v[200:203]
    ds_read_b64_tr_b16 v[230:231], v185 offset:18432
    v_max_f32 v161, 0, v161
    s_barrier
    s_waitcnt lgkmcnt(4)
    v_mfma_f32_16x16x32_bf16 v[208:211], v[240:243], v[16:19], 0
    ds_read_b64_tr_b16 v[232:233], v176 offset:24576
    v_max_f32 v162, 0, v162
    v_mfma_f32_16x16x32_bf16 v[212:215], v[240:243], v[88:91], 0
    ds_read_b64_tr_b16 v[234:235], v176 offset:30720
    v_max_f32 v163, 0, v163
    v_mfma_f32_16x16x32_bf16 v[212:215], v[244:247], v[92:95], v[212:215]
    ds_read_b64_tr_b16 v[236:237], v176 offset:36864
    v_mul_f32 v160, v160, v168
    v_mfma_f32_16x16x32_bf16 v[208:211], v[244:247], v[20:23], v[208:211]
    ds_read_b64_tr_b16 v[238:239], v176 offset:43008
    v_mul_f32 v161, v161, v169
    s_waitcnt lgkmcnt(4)
    v_mfma_f32_16x16x32_bf16 v[216:219], v[224:227], v[16:19], 0
    ds_read_b64_tr_b16 v[240:241], v179 offset:24576
    v_mul_f32 v162, v162, v170
    v_mfma_f32_16x16x32_bf16 v[220:223], v[224:227], v[88:91], 0
    ds_read_b64_tr_b16 v[242:243], v179 offset:30720
    v_mul_f32 v163, v163, v171
    v_mfma_f32_16x16x32_bf16 v[220:223], v[228:231], v[92:95], v[220:223]
    ds_read_b64_tr_b16 v[244:245], v179 offset:36864
    v_cvt_pk_bf16_f32 v254, v160, v161
    v_mfma_f32_16x16x32_bf16 v[216:219], v[228:231], v[20:23], v[216:219]
    ds_read_b64_tr_b16 v[246:247], v179 offset:43008
    v_cvt_pk_bf16_f32 v255, v162, v163
    s_waitcnt lgkmcnt(4)
    v_mfma_f32_16x16x32_bf16 v[192:195], v[232:235], v[24:27], v[192:195]
    ds_read_b64_tr_b16 v[224:225], v182 offset:24576
    v_max_f32 v164, 0, v164
    v_mfma_f32_16x16x32_bf16 v[196:199], v[232:235], v[96:99], v[196:199]
    ds_read_b64_tr_b16 v[226:227], v182 offset:30720
    v_max_f32 v165, 0, v165
    v_mfma_f32_16x16x32_bf16 v[196:199], v[236:239], v[100:103], v[196:199]
    ds_read_b64_tr_b16 v[228:229], v182 offset:36864
    v_max_f32 v166, 0, v166
    v_mfma_f32_16x16x32_bf16 v[192:195], v[236:239], v[28:31], v[192:195]
    ds_read_b64_tr_b16 v[230:231], v182 offset:43008
    v_max_f32 v167, 0, v167
    s_waitcnt lgkmcnt(4)
    v_mfma_f32_16x16x32_bf16 v[200:203], v[240:243], v[24:27], v[200:203]
    ds_read_b64_tr_b16 v[232:233], v185 offset:24576
    v_mul_f32 v164, v164, v172
    v_mfma_f32_16x16x32_bf16 v[204:207], v[240:243], v[96:99], v[204:207]
    ds_read_b64_tr_b16 v[234:235], v185 offset:30720
    v_mul_f32 v165, v165, v173
    v_mfma_f32_16x16x32_bf16 v[204:207], v[244:247], v[100:103], v[204:207]
    ds_read_b64_tr_b16 v[236:237], v185 offset:36864
    v_mul_f32 v166, v166, v174
    v_mfma_f32_16x16x32_bf16 v[200:203], v[244:247], v[28:31], v[200:203]
    ds_read_b64_tr_b16 v[238:239], v185 offset:43008
    v_mul_f32 v167, v167, v175
    v_cvt_pk_bf16_f32 v250, v164, v165
    v_cvt_pk_bf16_f32 v251, v166, v167
    s_waitcnt lgkmcnt(0)
    s_barrier
    ds_read_b64 v[248:249], v10 offset:0
    ds_read_b64 v[252:253], v10 offset:1024
    v_mfma_f32_16x16x32_bf16 v[208:211], v[224:227], v[24:27], v[208:211]
    ds_read_b64_tr_b16 v[240:241], v177 offset:0
    v_mfma_f32_16x16x32_bf16 v[212:215], v[224:227], v[96:99], v[212:215]
    ds_read_b64_tr_b16 v[242:243], v177 offset:6144
    v_mfma_f32_16x16x32_bf16 v[212:215], v[228:231], v[100:103], v[212:215]
    ds_read_b64_tr_b16 v[244:245], v177 offset:12288
    v_mfma_f32_16x16x32_bf16 v[208:211], v[228:231], v[28:31], v[208:211]
    ds_read_b64_tr_b16 v[246:247], v177 offset:18432
    v_mfma_f32_16x16x32_bf16 v[216:219], v[232:235], v[24:27], v[216:219]
    ds_read_b64_tr_b16 v[224:225], v180 offset:0
    v_mfma_f32_16x16x32_bf16 v[220:223], v[232:235], v[96:99], v[220:223]
    ds_read_b64_tr_b16 v[226:227], v180 offset:6144
    s_waitcnt lgkmcnt(6)
    s_lshl_b32 s55, s41, 14
    s_sub_u32 s55, 16384, s55
    v_lshlrev_b32 v10, 4, v0
    buffer_store_dwordx4 v[248:251], v10, s[16:19], s55 offen offset:0 sc1
    buffer_store_dwordx4 v[252:255], v10, s[16:19], s55 offen offset:1024 sc1
    v_mfma_f32_16x16x32_bf16 v[220:223], v[236:239], v[100:103], v[220:223]
    ds_read_b64_tr_b16 v[228:229], v180 offset:12288
    v_mfma_f32_16x16x32_bf16 v[216:219], v[236:239], v[28:31], v[216:219]
    ds_read_b64_tr_b16 v[230:231], v180 offset:18432
    s_waitcnt lgkmcnt(4)
    v_mfma_f32_16x16x32_bf16 v[192:195], v[240:243], v[32:35], v[192:195]
    ds_read_b64_tr_b16 v[232:233], v183 offset:0
    v_mfma_f32_16x16x32_bf16 v[196:199], v[240:243], v[104:107], v[196:199]
    ds_read_b64_tr_b16 v[234:235], v183 offset:6144
    v_mfma_f32_16x16x32_bf16 v[196:199], v[244:247], v[108:111], v[196:199]
    ds_read_b64_tr_b16 v[236:237], v183 offset:12288
    v_mfma_f32_16x16x32_bf16 v[192:195], v[244:247], v[36:39], v[192:195]
    ds_read_b64_tr_b16 v[238:239], v183 offset:18432
    s_waitcnt lgkmcnt(4)
    v_mfma_f32_16x16x32_bf16 v[200:203], v[224:227], v[32:35], v[200:203]
    ds_read_b64_tr_b16 v[240:241], v186 offset:0
    v_mfma_f32_16x16x32_bf16 v[204:207], v[224:227], v[104:107], v[204:207]
    ds_read_b64_tr_b16 v[242:243], v186 offset:6144
    v_mfma_f32_16x16x32_bf16 v[204:207], v[228:231], v[108:111], v[204:207]
    ds_read_b64_tr_b16 v[244:245], v186 offset:12288
    v_mfma_f32_16x16x32_bf16 v[200:203], v[228:231], v[36:39], v[200:203]
    ds_read_b64_tr_b16 v[246:247], v186 offset:18432
    s_barrier
    s_waitcnt lgkmcnt(4)
    v_mfma_f32_16x16x32_bf16 v[208:211], v[232:235], v[32:35], v[208:211]
    ds_read_b64_tr_b16 v[224:225], v177 offset:24576
    v_mfma_f32_16x16x32_bf16 v[212:215], v[232:235], v[104:107], v[212:215]
    ds_read_b64_tr_b16 v[226:227], v177 offset:30720
    v_mfma_f32_16x16x32_bf16 v[212:215], v[236:239], v[108:111], v[212:215]
    ds_read_b64_tr_b16 v[228:229], v177 offset:36864
    v_mfma_f32_16x16x32_bf16 v[208:211], v[236:239], v[36:39], v[208:211]
    ds_read_b64_tr_b16 v[230:231], v177 offset:43008
    s_waitcnt lgkmcnt(4)
    v_mfma_f32_16x16x32_bf16 v[216:219], v[240:243], v[32:35], v[216:219]
    ds_read_b64_tr_b16 v[232:233], v180 offset:24576
    v_mfma_f32_16x16x32_bf16 v[220:223], v[240:243], v[104:107], v[220:223]
    ds_read_b64_tr_b16 v[234:235], v180 offset:30720
    v_mfma_f32_16x16x32_bf16 v[220:223], v[244:247], v[108:111], v[220:223]
    ds_read_b64_tr_b16 v[236:237], v180 offset:36864
    v_mfma_f32_16x16x32_bf16 v[216:219], v[244:247], v[36:39], v[216:219]
    ds_read_b64_tr_b16 v[238:239], v180 offset:43008
    s_waitcnt lgkmcnt(4)
    v_mfma_f32_16x16x32_bf16 v[192:195], v[224:227], v[40:43], v[192:195]
    ds_read_b64_tr_b16 v[240:241], v183 offset:24576
    v_mfma_f32_16x16x32_bf16 v[196:199], v[224:227], v[112:115], v[196:199]
    ds_read_b64_tr_b16 v[242:243], v183 offset:30720
    v_mfma_f32_16x16x32_bf16 v[196:199], v[228:231], v[116:119], v[196:199]
    ds_read_b64_tr_b16 v[244:245], v183 offset:36864
    v_mfma_f32_16x16x32_bf16 v[192:195], v[228:231], v[44:47], v[192:195]
    ds_read_b64_tr_b16 v[246:247], v183 offset:43008
    s_waitcnt lgkmcnt(4)
    v_mfma_f32_16x16x32_bf16 v[200:203], v[232:235], v[40:43], v[200:203]
    ds_read_b64_tr_b16 v[224:225], v186 offset:24576
    v_mfma_f32_16x16x32_bf16 v[204:207], v[232:235], v[112:115], v[204:207]
    ds_read_b64_tr_b16 v[226:227], v186 offset:30720
    v_mfma_f32_16x16x32_bf16 v[204:207], v[236:239], v[116:119], v[204:207]
    ds_read_b64_tr_b16 v[228:229], v186 offset:36864
    v_mfma_f32_16x16x32_bf16 v[200:203], v[236:239], v[44:47], v[200:203]
    ds_read_b64_tr_b16 v[230:231], v186 offset:43008
    s_barrier
    s_waitcnt lgkmcnt(4)
    v_mfma_f32_16x16x32_bf16 v[208:211], v[240:243], v[40:43], v[208:211]
    ds_read_b64_tr_b16 v[232:233], v178 offset:0
    v_mfma_f32_16x16x32_bf16 v[212:215], v[240:243], v[112:115], v[212:215]
    ds_read_b64_tr_b16 v[234:235], v178 offset:6144
    v_mfma_f32_16x16x32_bf16 v[212:215], v[244:247], v[116:119], v[212:215]
    ds_read_b64_tr_b16 v[236:237], v178 offset:12288
    v_mfma_f32_16x16x32_bf16 v[208:211], v[244:247], v[44:47], v[208:211]
    ds_read_b64_tr_b16 v[238:239], v178 offset:18432
    s_waitcnt lgkmcnt(4)
    v_mfma_f32_16x16x32_bf16 v[216:219], v[224:227], v[40:43], v[216:219]
    ds_read_b64_tr_b16 v[240:241], v181 offset:0
    v_mfma_f32_16x16x32_bf16 v[220:223], v[224:227], v[112:115], v[220:223]
    ds_read_b64_tr_b16 v[242:243], v181 offset:6144
    v_mfma_f32_16x16x32_bf16 v[220:223], v[228:231], v[116:119], v[220:223]
    ds_read_b64_tr_b16 v[244:245], v181 offset:12288
    v_mfma_f32_16x16x32_bf16 v[216:219], v[228:231], v[44:47], v[216:219]
    ds_read_b64_tr_b16 v[246:247], v181 offset:18432
    s_waitcnt lgkmcnt(4)
    v_mfma_f32_16x16x32_bf16 v[192:195], v[232:235], v[48:51], v[192:195]
    ds_read_b64_tr_b16 v[224:225], v184 offset:0
    v_mfma_f32_16x16x32_bf16 v[196:199], v[232:235], v[120:123], v[196:199]
    ds_read_b64_tr_b16 v[226:227], v184 offset:6144
    v_mfma_f32_16x16x32_bf16 v[196:199], v[236:239], v[124:127], v[196:199]
    ds_read_b64_tr_b16 v[228:229], v184 offset:12288
    v_mfma_f32_16x16x32_bf16 v[192:195], v[236:239], v[52:55], v[192:195]
    ds_read_b64_tr_b16 v[230:231], v184 offset:18432
    s_waitcnt lgkmcnt(4)
    v_mfma_f32_16x16x32_bf16 v[200:203], v[240:243], v[48:51], v[200:203]
    ds_read_b64_tr_b16 v[232:233], v187 offset:0
    v_mfma_f32_16x16x32_bf16 v[204:207], v[240:243], v[120:123], v[204:207]
    ds_read_b64_tr_b16 v[234:235], v187 offset:6144
    v_mfma_f32_16x16x32_bf16 v[204:207], v[244:247], v[124:127], v[204:207]
    ds_read_b64_tr_b16 v[236:237], v187 offset:12288
    v_mfma_f32_16x16x32_bf16 v[200:203], v[244:247], v[52:55], v[200:203]
    ds_read_b64_tr_b16 v[238:239], v187 offset:18432
    s_waitcnt vmcnt(0)
    s_barrier
    s_cmp_eq_u32 s37, 0
    s_cbranch_scc0 Lhf_61
    s_lshl_b32 s55, s39, 9
    s_mul_i32 s59, s43, 128
    s_add_u32 s55, s55, s59
    s_mul_i32 s59, s42, 8
    s_add_u32 s55, s55, s59
    s_add_u32 s55, s55, 50397184
    v_mov_b32 v248, s84
    v_mov_b32 v249, s85
    s_mov_b64 s[60:61], exec
    s_mov_b64 exec, 1
    buffer_store_dwordx2 v[248:249], off, s[24:27], s55 sc1
    s_mov_b64 exec, s[60:61]
Lhf_61:
    s_waitcnt lgkmcnt(4)
    v_mfma_f32_16x16x32_bf16 v[208:211], v[224:227], v[48:51], v[208:211]
    ds_read_b64_tr_b16 v[240:241], v178 offset:24576
    v_lshlrev_b32 v1, 4, v0
    v_mfma_f32_16x16x32_bf16 v[212:215], v[224:227], v[120:123], v[212:215]
    ds_read_b64_tr_b16 v[242:243], v178 offset:30720
    s_mov_b32 s59, 45056
    buffer_load_dwordx4 v[4:7], v1, s[72:75], s59 offen offset:1792
    v_mfma_f32_16x16x32_bf16 v[212:215], v[228:231], v[124:127], v[212:215]
    ds_read_b64_tr_b16 v[244:245], v178 offset:36864
    s_mov_b32 s59, 45056
    buffer_load_dword v8, v1, s[72:75], s59 offen offset:2816
    v_mfma_f32_16x16x32_bf16 v[208:211], v[228:231], v[52:55], v[208:211]
    ds_read_b64_tr_b16 v[246:247], v178 offset:43008
    s_mul_i32 s56, s42, 288
    s_andn2_b32 s56, s56, 63
    s_mul_i32 s55, s43, 1327104
    s_mul_i32 s59, s37, 36864
    s_add_u32 s55, s55, s59
    s_add_u32 s55, s55, s56
    s_add_u32 s20, s76, s55
    s_addc_u32 s21, s77, 0
    s_sub_u32 s22, 5308416, s55
    s_mov_b32 s23, 0x20000
    s_mul_i32 s45, s37, 10240
    s_waitcnt lgkmcnt(4)
    v_mfma_f32_16x16x32_bf16 v[216:219], v[232:235], v[48:51], v[216:219]
    ds_read_b64_tr_b16 v[224:225], v181 offset:24576
    v_lshlrev_b32 v1, 4, v0
    v_mfma_f32_16x16x32_bf16 v[220:223], v[232:235], v[120:123], v[220:223]
    ds_read_b64_tr_b16 v[226:227], v181 offset:30720
    s_mov_b32 s59, 32768
    buffer_load_dwordx4 v[160:163], v1, s[72:75], s59 offen offset:1792
    v_mfma_f32_16x16x32_bf16 v[220:223], v[236:239], v[124:127], v[220:223]
    ds_read_b64_tr_b16 v[228:229], v181 offset:36864
    s_mov_b32 s59, 32768
    buffer_load_dwordx4 v[164:167], v1, s[72:75], s59 offen offset:2816
    v_mfma_f32_16x16x32_bf16 v[216:219], v[236:239], v[52:55], v[216:219]
    ds_read_b64_tr_b16 v[230:231], v181 offset:43008
    s_mul_i32 s58, s37, 2048
    s_waitcnt lgkmcnt(4)
    v_mfma_f32_16x16x32_bf16 v[192:195], v[240:243], v[56:59], v[192:195]
    ds_read_b64_tr_b16 v[232:233], v184 offset:24576
    s_add_u32 s59, s58, 36864
    buffer_load_dwordx2 v[168:169], v1, s[72:75], s59 offen offset:2816
    v_mfma_f32_16x16x32_bf16 v[196:199], v[240:243], v[128:131], v[196:199]
    ds_read_b64_tr_b16 v[234:235], v184 offset:30720
    s_mov_b32 s59, 49152
    buffer_load_dwordx4 v[250:253], v1, s[72:75], s59 offen offset:1792
    v_mfma_f32_16x16x32_bf16 v[196:199], v[244:247], v[132:135], v[196:199]
    ds_read_b64_tr_b16 v[236:237], v184 offset:36864
    s_mov_b32 s59, 49152
    buffer_load_dwordx2 v[254:255], v1, s[72:75], s59 offen offset:2816
    v_mfma_f32_16x16x32_bf16 v[192:195], v[244:247], v[60:63], v[192:195]
    ds_read_b64_tr_b16 v[238:239], v184 offset:43008
    s_waitcnt lgkmcnt(4)
    v_mfma_f32_16x16x32_bf16 v[200:203], v[224:227], v[56:59], v[200:203]
    ds_read_b64_tr_b16 v[240:241], v187 offset:24576
    v_mfma_f32_16x16x32_bf16 v[204:207], v[224:227], v[128:131], v[204:207]
    ds_read_b64_tr_b16 v[242:243], v187 offset:30720
    v_mfma_f32_16x16x32_bf16 v[204:207], v[228:231], v[132:135], v[204:207]
    ds_read_b64_tr_b16 v[244:245], v187 offset:36864
    v_mfma_f32_16x16x32_bf16 v[200:203], v[228:231], v[60:63], v[200:203]
    ds_read_b64_tr_b16 v[246:247], v187 offset:43008
    s_barrier
    s_waitcnt vmcnt(5)
    s_waitcnt lgkmcnt(4)
    v_mfma_f32_16x16x32_bf16 v[208:211], v[232:235], v[56:59], v[208:211]
    ds_read_b64_tr_b16 v[224:225], v176 offset:0
    s_mov_b32 s46, 0
    v_mfma_f32_16x16x32_bf16 v[212:215], v[232:235], v[128:131], v[212:215]
    ds_read_b64_tr_b16 v[226:227], v176 offset:6144
    s_add_u32 m0, s45, 81920
    s_nop 0
    v_mfma_f32_16x16x32_bf16 v[212:215], v[236:239], v[132:135], v[212:215]
    ds_read_b64_tr_b16 v[228:229], v176 offset:12288
    buffer_load_dwordx4 v4, s[20:23], s46 offen offset:0  lds
    v_mfma_f32_16x16x32_bf16 v[208:211], v[236:239], v[60:63], v[208:211]
    ds_read_b64_tr_b16 v[230:231], v176 offset:18432
    buffer_load_dwordx4 v5, s[20:23], s46 offen offset:1024  lds
    s_waitcnt lgkmcnt(4)
    v_mfma_f32_16x16x32_bf16 v[216:219], v[240:243], v[56:59], v[216:219]
    ds_read_b64_tr_b16 v[232:233], v179 offset:0
    buffer_load_dwordx4 v6, s[20:23], s46 offen offset:2048  lds
    v_mfma_f32_16x16x32_bf16 v[220:223], v[240:243], v[128:131], v[220:223]
    ds_read_b64_tr_b16 v[234:235], v179 offset:6144
    buffer_load_dwordx4 v7, s[20:23], s46 offen offset:3072  lds
    v_mfma_f32_16x16x32_bf16 v[220:223], v[244:247], v[132:135], v[220:223]
    ds_read_b64_tr_b16 v[236:237], v179 offset:12288
    s_add_u32 m0, s45, 86016
    s_nop 0
    v_mfma_f32_16x16x32_bf16 v[216:219], v[244:247], v[60:63], v[216:219]
    ds_read_b64_tr_b16 v[238:239], v179 offset:18432
    buffer_load_dwordx4 v8, s[20:23], s46 offen offset:0  lds
    s_waitcnt lgkmcnt(4)
    v_mfma_f32_16x16x32_bf16 v[192:195], v[224:227], v[64:67], v[192:195]
    ds_read_b64_tr_b16 v[240:241], v182 offset:0
    s_add_u32 s46, s46, 18432
    v_mfma_f32_16x16x32_bf16 v[196:199], v[224:227], v[136:139], v[196:199]
    ds_read_b64_tr_b16 v[242:243], v182 offset:6144
    s_add_u32 m0, s45, 87040
    s_nop 0
    v_mfma_f32_16x16x32_bf16 v[196:199], v[228:231], v[140:143], v[196:199]
    ds_read_b64_tr_b16 v[244:245], v182 offset:12288
    buffer_load_dwordx4 v4, s[20:23], s46 offen offset:0  lds
    v_mfma_f32_16x16x32_bf16 v[192:195], v[228:231], v[68:71], v[192:195]
    ds_read_b64_tr_b16 v[246:247], v182 offset:18432
    buffer_load_dwordx4 v5, s[20:23], s46 offen offset:1024  lds
    s_waitcnt lgkmcnt(4)
    v_mfma_f32_16x16x32_bf16 v[200:203], v[232:235], v[64:67], v[200:203]
    ds_read_b64_tr_b16 v[224:225], v185 offset:0
    buffer_load_dwordx4 v6, s[20:23], s46 offen offset:2048  lds
    v_mfma_f32_16x16x32_bf16 v[204:207], v[232:235], v[136:139], v[204:207]
    ds_read_b64_tr_b16 v[226:227], v185 offset:6144
    buffer_load_dwordx4 v7, s[20:23], s46 offen offset:3072  lds
    v_mfma_f32_16x16x32_bf16 v[204:207], v[236:239], v[140:143], v[204:207]
    ds_read_b64_tr_b16 v[228:229], v185 offset:12288
    s_add_u32 m0, s45, 91136
    s_nop 0
    v_mfma_f32_16x16x32_bf16 v[200:203], v[236:239], v[68:71], v[200:203]
    ds_read_b64_tr_b16 v[230:231], v185 offset:18432
    buffer_load_dwordx4 v8, s[20:23], s46 offen offset:0  lds
    s_barrier
    s_cmp_eq_u32 s37, 3
    s_cbranch_scc0 Lhq_62
    s_lshl_b32 s55, s39, 9
    s_mul_i32 s59, s43, 128
    s_add_u32 s55, s55, s59
    s_add_u32 s55, s55, 50397184
    v_lshlrev_b32 v250, 3, v0
    s_mov_b64 s[60:61], exec
    s_mov_b64 exec, 15
    buffer_load_dwordx2 v[248:249], v250, s[24:27], s55 offen sc1
    s_mov_b64 exec, s[60:61]
Lhq_62:
    s_waitcnt lgkmcnt(4)
    v_mfma_f32_16x16x32_bf16 v[208:211], v[240:243], v[64:67], v[208:211]
    ds_read_b64_tr_b16 v[232:233], v176 offset:24576
    s_mov_b32 s46, 147456
    v_mfma_f32_16x16x32_bf16 v[212:215], v[240:243], v[136:139], v[212:215]
    ds_read_b64_tr_b16 v[234:235], v176 offset:30720
    s_add_u32 m0, s45, 122880
    s_nop 0
    v_mfma_f32_16x16x32_bf16 v[212:215], v[244:247], v[140:143], v[212:215]
    ds_read_b64_tr_b16 v[236:237], v176 offset:36864
    buffer_load_dwordx4 v4, s[20:23], s46 offen offset:0  lds
    v_mfma_f32_16x16x32_bf16 v[208:211], v[244:247], v[68:71], v[208:211]
    ds_read_b64_tr_b16 v[238:239], v176 offset:43008
    buffer_load_dwordx4 v5, s[20:23], s46 offen offset:1024  lds
    s_waitcnt lgkmcnt(4)
    v_mfma_f32_16x16x32_bf16 v[216:219], v[224:227], v[64:67], v[216:219]
    ds_read_b64_tr_b16 v[240:241], v179 offset:24576
    buffer_load_dwordx4 v6, s[20:23], s46 offen offset:2048  lds
    v_mfma_f32_16x16x32_bf16 v[220:223], v[224:227], v[136:139], v[220:223]
    ds_read_b64_tr_b16 v[242:243], v179 offset:30720
    buffer_load_dwordx4 v7, s[20:23], s46 offen offset:3072  lds
    v_mfma_f32_16x16x32_bf16 v[220:223], v[228:231], v[140:143], v[220:223]
    ds_read_b64_tr_b16 v[244:245], v179 offset:36864
    s_add_u32 m0, s45, 126976
    s_nop 0
    v_mfma_f32_16x16x32_bf16 v[216:219], v[228:231], v[68:71], v[216:219]
    ds_read_b64_tr_b16 v[246:247], v179 offset:43008
    buffer_load_dwordx4 v8, s[20:23], s46 offen offset:0  lds
    s_waitcnt lgkmcnt(4)
    v_mfma_f32_16x16x32_bf16 v[192:195], v[232:235], v[72:75], v[192:195]
    ds_read_b64_tr_b16 v[224:225], v182 offset:24576
    s_add_u32 s46, s46, 18432
    v_mfma_f32_16x16x32_bf16 v[196:199], v[232:235], v[144:147], v[196:199]
    ds_read_b64_tr_b16 v[226:227], v182 offset:30720
    s_add_u32 m0, s45, 128000
    s_nop 0
    v_mfma_f32_16x16x32_bf16 v[196:199], v[236:239], v[148:151], v[196:199]
    ds_read_b64_tr_b16 v[228:229], v182 offset:36864
    buffer_load_dwordx4 v4, s[20:23], s46 offen offset:0  lds
    v_mfma_f32_16x16x32_bf16 v[192:195], v[236:239], v[76:79], v[192:195]
    ds_read_b64_tr_b16 v[230:231], v182 offset:43008
    buffer_load_dwordx4 v5, s[20:23], s46 offen offset:1024  lds
    s_waitcnt lgkmcnt(4)
    v_mfma_f32_16x16x32_bf16 v[200:203], v[240:243], v[72:75], v[200:203]
    ds_read_b64_tr_b16 v[232:233], v185 offset:24576
    buffer_load_dwordx4 v6, s[20:23], s46 offen offset:2048  lds
    v_mfma_f32_16x16x32_bf16 v[204:207], v[240:243], v[144:147], v[204:207]
    ds_read_b64_tr_b16 v[234:235], v185 offset:30720
    buffer_load_dwordx4 v7, s[20:23], s46 offen offset:3072  lds
    v_mfma_f32_16x16x32_bf16 v[204:207], v[244:247], v[148:151], v[204:207]
    ds_read_b64_tr_b16 v[236:237], v185 offset:36864
    s_add_u32 m0, s45, 132096
    s_nop 0
    v_mfma_f32_16x16x32_bf16 v[200:203], v[244:247], v[76:79], v[200:203]
    ds_read_b64_tr_b16 v[238:239], v185 offset:43008
    buffer_load_dwordx4 v8, s[20:23], s46 offen offset:0  lds
    s_cmp_eq_u32 s37, 3
    s_cbranch_scc0 Lhp_63
    s_waitcnt vmcnt(10)
    s_mov_b64 s[60:61], exec
    s_mov_b64 exec, 15
    v_cmp_eq_u32 vcc, s84, v248
    v_cmp_eq_u32 s[62:63], s85, v249
    s_nop 3
    s_and_b64 vcc, vcc, s[62:63]
    s_cmp_eq_u64 vcc, exec
    s_mov_b64 exec, s[60:61]
    s_cbranch_scc1 Lhr_64
    s_lshl_b32 s55, s39, 9
    s_mul_i32 s59, s43, 128
    s_add_u32 s55, s55, s59
    s_add_u32 s55, s55, 50397184
    v_lshlrev_b32 v250, 3, v0
    s_mov_b64 s[60:61], exec
    s_mov_b64 exec, 15
    s_mov_b32 s58, 400000
Lpoll_65:
    buffer_load_dwordx2 v[248:249], v250, s[24:27], s55 offen sc1
    s_waitcnt vmcnt(0)
    v_cmp_eq_u32 vcc, s84, v248
    v_cmp_eq_u32 s[62:63], s85, v249
    s_nop 3
    s_and_b64 vcc, vcc, s[62:63]
    s_cmp_eq_u64 vcc, exec
    s_cbranch_scc1 Lpd_66
    s_sub_u32 s58, s58, 1
    s_cmp_eq_u32 s58, 0
    s_cbranch_scc1 Lpd_66
    s_branch Lpoll_65
Lpd_66:
    s_mov_b64 exec, s[60:61]
Lhr_64:
Lhp_63:
    s_barrier
    s_waitcnt lgkmcnt(4)
    v_mfma_f32_16x16x32_bf16 v[208:211], v[224:227], v[72:75], v[208:211]
    ds_read_b64_tr_b16 v[240:241], v177 offset:0
    v_mfma_f32_16x16x32_bf16 v[212:215], v[224:227], v[144:147], v[212:215]
    ds_read_b64_tr_b16 v[242:243], v177 offset:6144
    v_mfma_f32_16x16x32_bf16 v[212:215], v[228:231], v[148:151], v[212:215]
    ds_read_b64_tr_b16 v[244:245], v177 offset:12288
    v_mfma_f32_16x16x32_bf16 v[208:211], v[228:231], v[76:79], v[208:211]
    ds_read_b64_tr_b16 v[246:247], v177 offset:18432
    s_waitcnt lgkmcnt(4)
    v_mfma_f32_16x16x32_bf16 v[216:219], v[232:235], v[72:75], v[216:219]
    ds_read_b64_tr_b16 v[224:225], v180 offset:0
    v_mfma_f32_16x16x32_bf16 v[220:223], v[232:235], v[144:147], v[220:223]
    ds_read_b64_tr_b16 v[226:227], v180 offset:6144
    v_mfma_f32_16x16x32_bf16 v[220:223], v[236:239], v[148:151], v[220:223]
    ds_read_b64_tr_b16 v[228:229], v180 offset:12288
    v_mfma_f32_16x16x32_bf16 v[216:219], v[236:239], v[76:79], v[216:219]
    ds_read_b64_tr_b16 v[230:231], v180 offset:18432
    s_waitcnt lgkmcnt(4)
    v_mfma_f32_16x16x32_bf16 v[192:195], v[240:243], v[80:83], v[192:195]
    ds_read_b64_tr_b16 v[232:233], v183 offset:0
    v_mfma_f32_16x16x32_bf16 v[196:199], v[240:243], v[152:155], v[196:199]
    ds_read_b64_tr_b16 v[234:235], v183 offset:6144
    v_mfma_f32_16x16x32_bf16 v[196:199], v[244:247], v[156:159], v[196:199]
    ds_read_b64_tr_b16 v[236:237], v183 offset:12288
    v_mfma_f32_16x16x32_bf16 v[192:195], v[244:247], v[84:87], v[192:195]
    ds_read_b64_tr_b16 v[238:239], v183 offset:18432
    s_waitcnt lgkmcnt(4)
    v_mfma_f32_16x16x32_bf16 v[200:203], v[224:227], v[80:83], v[200:203]
    ds_read_b64_tr_b16 v[240:241], v186 offset:0
    v_mfma_f32_16x16x32_bf16 v[204:207], v[224:227], v[152:155], v[204:207]
    ds_read_b64_tr_b16 v[242:243], v186 offset:6144
    v_mfma_f32_16x16x32_bf16 v[204:207], v[228:231], v[156:159], v[204:207]
    ds_read_b64_tr_b16 v[244:245], v186 offset:12288
    v_mfma_f32_16x16x32_bf16 v[200:203], v[228:231], v[84:87], v[200:203]
    ds_read_b64_tr_b16 v[246:247], v186 offset:18432
    s_waitcnt lgkmcnt(4)
    v_mfma_f32_16x16x32_bf16 v[208:211], v[232:235], v[80:83], v[208:211]
    v_mfma_f32_16x16x32_bf16 v[212:215], v[232:235], v[152:155], v[212:215]
    v_mfma_f32_16x16x32_bf16 v[212:215], v[236:239], v[156:159], v[212:215]
    v_mfma_f32_16x16x32_bf16 v[208:211], v[236:239], v[84:87], v[208:211]
    s_waitcnt lgkmcnt(0)
    v_mfma_f32_16x16x32_bf16 v[216:219], v[240:243], v[80:83], v[216:219]
    v_mfma_f32_16x16x32_bf16 v[220:223], v[240:243], v[152:155], v[220:223]
    v_mfma_f32_16x16x32_bf16 v[220:223], v[244:247], v[156:159], v[220:223]
    v_mfma_f32_16x16x32_bf16 v[216:219], v[244:247], v[84:87], v[216:219]
    s_waitcnt lgkmcnt(0)
    s_barrier
    s_waitcnt vmcnt(22)
    v_mul_f32 v192, v14, v192
    v_mul_f32 v193, v14, v193
    v_mul_f32 v194, v14, v194
    v_mul_f32 v195, v14, v195
    v_cvt_pk_bf16_f32 v192, v192, v193
    v_add_u32 v193, v160, v168
    v_cvt_pk_bf16_f32 v194, v194, v195
    v_add_u32 v195, v161, v168
    ds_write_b32 v193, v192 offset:0
    ds_write_b32 v195, v194 offset:0
    v_mul_f32 v196, v15, v196
    v_mul_f32 v197, v15, v197
    v_mul_f32 v198, v15, v198
    v_mul_f32 v199, v15, v199
    v_cvt_pk_bf16_f32 v196, v196, v197
    v_add_u32 v197, v160, v169
    v_cvt_pk_bf16_f32 v198, v198, v199
    v_add_u32 v199, v161, v169
    ds_write_b32 v197, v196 offset:0
    ds_write_b32 v199, v198 offset:0
    v_mul_f32 v200, v14, v200
    v_mul_f32 v201, v14, v201
    v_mul_f32 v202, v14, v202
    v_mul_f32 v203, v14, v203
    v_cvt_pk_bf16_f32 v200, v200, v201
    v_add_u32 v201, v162, v168
    v_cvt_pk_bf16_f32 v202, v202, v203
    v_add_u32 v203, v163, v168
    ds_write_b32 v201, v200 offset:0
    ds_write_b32 v203, v202 offset:0
    v_mul_f32 v204, v15, v204
    v_mul_f32 v205, v15, v205
    v_mul_f32 v206, v15, v206
    v_mul_f32 v207, v15, v207
    v_cvt_pk_bf16_f32 v204, v204, v205
    v_add_u32 v205, v162, v169
    v_cvt_pk_bf16_f32 v206, v206, v207
    v_add_u32 v207, v163, v169
    ds_write_b32 v205, v204 offset:0
    ds_write_b32 v207, v206 offset:0
    v_mul_f32 v208, v14, v208
    v_mul_f32 v209, v14, v209
    v_mul_f32 v210, v14, v210
    v_mul_f32 v211, v14, v211
    v_cvt_pk_bf16_f32 v208, v208, v209
    v_add_u32 v209, v164, v168
    v_cvt_pk_bf16_f32 v210, v210, v211
    v_add_u32 v211, v165, v168
    ds_write_b32 v209, v208 offset:0
    ds_write_b32 v211, v210 offset:0
    v_mul_f32 v212, v15, v212
    v_mul_f32 v213, v15, v213
    v_mul_f32 v214, v15, v214
    v_mul_f32 v215, v15, v215
    v_cvt_pk_bf16_f32 v212, v212, v213
    v_add_u32 v213, v164, v169
    v_cvt_pk_bf16_f32 v214, v214, v215
    v_add_u32 v215, v165, v169
    ds_write_b32 v213, v212 offset:0
    ds_write_b32 v215, v214 offset:0
    v_mul_f32 v216, v14, v216
    v_mul_f32 v217, v14, v217
    v_mul_f32 v218, v14, v218
    v_mul_f32 v219, v14, v219
    v_cvt_pk_bf16_f32 v216, v216, v217
    v_add_u32 v217, v166, v168
    v_cvt_pk_bf16_f32 v218, v218, v219
    v_add_u32 v219, v167, v168
    ds_write_b32 v217, v216 offset:0
    ds_write_b32 v219, v218 offset:0
    v_mul_f32 v220, v15, v220
    v_mul_f32 v221, v15, v221
    v_mul_f32 v222, v15, v222
    v_mul_f32 v223, v15, v223
    v_cvt_pk_bf16_f32 v220, v220, v221
    v_add_u32 v221, v166, v169
    v_cvt_pk_bf16_f32 v222, v222, v223
    v_add_u32 v223, v167, v169
    ds_write_b32 v221, v220 offset:0
    ds_write_b32 v223, v222 offset:0
    ds_write_b32 v168, v14 offset:44
    ds_write_b32 v169, v15 offset:44
    s_waitcnt vmcnt(10)
    s_waitcnt lgkmcnt(0)
    s_barrier
    s_mov_b32 s46, 294912
    s_add_u32 m0, s45, 40960
    s_nop 0
    buffer_load_dwordx4 v4, s[20:23], s46 offen offset:0  lds
    buffer_load_dwordx4 v5, s[20:23], s46 offen offset:1024  lds
    buffer_load_dwordx4 v6, s[20:23], s46 offen offset:2048  lds
    buffer_load_dwordx4 v7, s[20:23], s46 offen offset:3072  lds
    s_add_u32 m0, s45, 45056
    s_nop 0
    buffer_load_dwordx4 v8, s[20:23], s46 offen offset:0  lds
    s_add_u32 s46, s46, 18432
    s_add_u32 m0, s45, 46080
    s_nop 0
    buffer_load_dwordx4 v4, s[20:23], s46 offen offset:0  lds
    buffer_load_dwordx4 v5, s[20:23], s46 offen offset:1024  lds
    buffer_load_dwordx4 v6, s[20:23], s46 offen offset:2048  lds
    buffer_load_dwordx4 v7, s[20:23], s46 offen offset:3072  lds
    s_add_u32 m0, s45, 50176
    s_nop 0
    buffer_load_dwordx4 v8, s[20:23], s46 offen offset:0  lds
    s_cmp_eq_u32 s37, 0
    s_cbranch_scc0 Lu_67
    ds_read_b128 v[24:27], v253 offset:19776
    ds_read_b128 v[28:31], v254 offset:19776
    ds_read_b128 v[32:35], v255 offset:19776
    s_lshl_b32 s56, s39, 16
    s_mul_i32 s59, s40, 4096
    s_add_u32 s56, s56, s59
    s_add_u32 s56, s56, 24117248
    s_waitcnt lgkmcnt(0)
    buffer_store_dwordx4 v[24:27], v250, s[24:27], s56 offen sc1
    buffer_store_dwordx4 v[28:31], v251, s[24:27], s56 offen sc1
    buffer_store_dwordx4 v[32:35], v252, s[24:27], s56 offen sc1
Lu_67:
    s_and_b32 s57, s36, 1
    s_mul_i32 s57, s57, 768
    s_mul_i32 s58, s43, 1536
    s_add_u32 s57, s57, s58
    s_add_u32 s57, s57, 672
    v_and_b32 v243, 15, v0
    v_mul_u32_u24 v243, 48, v243
    v_add_u32 v243, s57, v243
    ds_read_b32 v243, v243 offset:44
    s_cmp_eq_u32 s37, 1
    s_cbranch_scc0 Lu_68
    v_lshlrev_b32 v1, 4, v0
    s_mov_b32 s59, 49152
    buffer_load_dwordx4 v[120:123], v1, s[72:75], s59 offen offset:1792
    s_mov_b32 s59, 49152
    buffer_load_dwordx2 v[124:125], v1, s[72:75], s59 offen offset:2816
Lu_68:
    v_lshlrev_b32 v1, 2, v0
    s_lshl_b32 s55, s37, 9
    s_add_u32 s59, s55, 28672
    buffer_load_dword v250, v1, s[72:75], s59 offen offset:1024
    s_add_u32 s59, s55, 28672
    buffer_load_dword v251, v1, s[72:75], s59 offen offset:1280
    s_mov_b32 s59, 28672
    buffer_load_dword v253, v1, s[72:75], s59 offen offset:3072
    s_lshl_b32 s55, s40, 11
    v_lshl_add_u32 v252, v0, 4, s55
    s_mul_i32 s55, s39, 147456
    s_mul_i32 s59, s37, 36864
    s_add_u32 s55, s55, s59
    s_add_u32 s55, s55, 20971520
    s_add_u32 s32, s82, s55
    s_addc_u32 s33, s83, 0
    s_mov_b32 s34, 36864
    s_mov_b32 s35, 0x20000
    s_waitcnt vmcnt(13)
    s_waitcnt lgkmcnt(0)
    s_barrier
    s_mov_b32 s46, 442368
    s_add_u32 m0, s45, 81920
    s_nop 0
    buffer_load_dwordx4 v4, s[20:23], s46 offen offset:0  lds
    buffer_load_dwordx4 v5, s[20:23], s46 offen offset:1024  lds
    buffer_load_dwordx4 v6, s[20:23], s46 offen offset:2048  lds
    buffer_load_dwordx4 v7, s[20:23], s46 offen offset:3072  lds
    s_add_u32 m0, s45, 86016
    s_nop 0
    buffer_load_dwordx4 v8, s[20:23], s46 offen offset:0  lds
    s_add_u32 s46, s46, 18432
    s_add_u32 m0, s45, 87040
    s_nop 0
    buffer_load_dwordx4 v4, s[20:23], s46 offen offset:0  lds
    buffer_load_dwordx4 v5, s[20:23], s46 offen offset:1024  lds
    buffer_load_dwordx4 v6, s[20:23], s46 offen offset:2048  lds
    buffer_load_dwordx4 v7, s[20:23], s46 offen offset:3072  lds
    s_add_u32 m0, s45, 91136
    s_nop 0
    buffer_load_dwordx4 v8, s[20:23], s46 offen offset:0  lds
    s_cmp_eq_u32 s37, 0
    s_cbranch_scc0 Lu_69
    s_waitcnt vmcnt(0)
    s_lshl_b32 s55, s39, 11
    s_mul_i32 s59, s40, 128
    s_add_u32 s55, s55, s59
    s_add_u32 s55, s55, 50331648
    v_mov_b32 v130, s84
    v_mov_b32 v131, s85
    s_mov_b64 s[60:61], exec
    s_mov_b64 exec, 1
    buffer_store_dwordx2 v[130:131], off, s[24:27], s55 sc1
    s_mov_b64 exec, s[60:61]
Lu_69:
    s_cmp_eq_u32 s37, 1
    s_cbranch_scc0 Lu_70
    s_cmp_eq_u32 s39, 0
    s_cbranch_scc1 Lhq_71
    s_lshl_b32 s55, s39, 11
    s_mul_i32 s59, s40, 128
    s_add_u32 s55, s55, s59
    s_add_u32 s55, s55, 50329600
    v_lshlrev_b32 v128, 3, v0
    s_mov_b64 s[60:61], exec
    s_mov_b64 exec, 1
    buffer_load_dwordx2 v[126:127], v128, s[24:27], s55 offen sc1
    s_mov_b64 exec, s[60:61]
Lhq_71:
Lu_70:
    s_and_b32 s51, s37, 1
    s_lshl_b32 s51, s51, 6
    v_add_u32 v15, s51, v0
    v_add_u32 v1, 14, v15
    v_mul_u32_u24 v1, 48, v1
    s_lshr_b32 s52, s37, 1
    s_mul_i32 s52, s52, 6816
    v_add_u32 v12, s52, v1
    v_add_u32 v13, 12960, v12
    v_add_u32 v14, 26592, v12
    ds_read_b128 v[16:19], v12 offset:0
    ds_read_b128 v[20:23], v12 offset:16
    ds_read_b32 v24, v12 offset:32
    s_lshl_b32 s51, s39, 7
    v_add_u32 v225, s51, v15
    v_mov_b32 v220, 0xf149f2ca
    v_mov_b32 v221, 0
    v_mov_b32 v188, 0
    v_cmp_gt_u32 s[62:63], 2, v225
    s_nop 1
    v_cndmask_b32 v189, v221, v220, s[62:63]
    v_cmp_gt_u32 s[62:63], 4, v225
    s_nop 1
    v_cndmask_b32 v190, v221, v220, s[62:63]
    v_cmp_gt_u32 s[62:63], 6, v225
    s_nop 1
    v_cndmask_b32 v191, v221, v220, s[62:63]
    v_cmp_gt_u32 s[62:63], 8, v225
    s_nop 1
    v_cndmask_b32 v192, v221, v220, s[62:63]
    v_cmp_gt_u32 s[62:63], 10, v225
    s_nop 1
    v_cndmask_b32 v193, v221, v220, s[62:63]
    v_cmp_gt_u32 s[62:63], 12, v225
    s_nop 1
    v_cndmask_b32 v194, v221, v220, s[62:63]
    s_waitcnt vmcnt(13)
    s_waitcnt lgkmcnt(0)
    s_barrier
    s_cmp_eq_u32 s37, 1
    s_cbranch_scc0 Lu_72
    s_cmp_eq_u32 s39, 0
    s_cbranch_scc1 Lhz_73
    s_waitcnt vmcnt(0)
    s_mov_b64 s[60:61], exec
    s_mov_b64 exec, 1
    v_cmp_eq_u32 vcc, s84, v126
    v_cmp_eq_u32 s[62:63], s85, v127
    s_nop 3
    s_and_b64 vcc, vcc, s[62:63]
    s_cmp_eq_u64 vcc, exec
    s_mov_b64 exec, s[60:61]
    s_cbranch_scc1 Lhr_75
    s_lshl_b32 s55, s39, 11
    s_mul_i32 s59, s40, 128
    s_add_u32 s55, s55, s59
    s_add_u32 s55, s55, 50329600
    v_lshlrev_b32 v128, 3, v0
    s_mov_b64 s[60:61], exec
    s_mov_b64 exec, 1
    s_mov_b32 s58, 400000
Lpoll_76:
    buffer_load_dwordx2 v[126:127], v128, s[24:27], s55 offen sc1
    s_waitcnt vmcnt(0)
    v_cmp_eq_u32 vcc, s84, v126
    v_cmp_eq_u32 s[62:63], s85, v127
    s_nop 3
    s_and_b64 vcc, vcc, s[62:63]
    s_cmp_eq_u64 vcc, exec
    s_cbranch_scc1 Lpd_77
    s_sub_u32 s58, s58, 1
    s_cmp_eq_u32 s58, 0
    s_cbranch_scc1 Lpd_77
    s_branch Lpoll_76
Lpd_77:
    s_mov_b64 exec, s[60:61]
Lhr_75:
    s_lshl_b32 s56, s39, 16
    s_mul_i32 s59, s40, 4096
    s_add_u32 s56, s56, s59
    s_add_u32 s56, s56, 24051712
    buffer_load_dwordx4 v[108:111], v120, s[24:27], s56 offen sc1
    buffer_load_dwordx4 v[112:115], v121, s[24:27], s56 offen sc1
    buffer_load_dwordx4 v[116:119], v122, s[24:27], s56 offen sc1
    s_branch Lhw_74
Lhz_73:
    v_mov_b32 v108, 0
    v_mov_b32 v109, 0
    v_mov_b32 v110, 0
    v_mov_b32 v111, 0
    v_mov_b32 v112, 0
    v_mov_b32 v113, 0
    v_mov_b32 v114, 0
    v_mov_b32 v115, 0
    v_mov_b32 v116, 0
    v_mov_b32 v117, 0
    v_mov_b32 v118, 0
    v_mov_b32 v119, 0
Lhw_74:
Lu_72:
    s_mov_b32 s46, 589824
    s_add_u32 m0, s45, 122880
    s_nop 0
    buffer_load_dwordx4 v4, s[20:23], s46 offen offset:0  lds
    buffer_load_dwordx4 v5, s[20:23], s46 offen offset:1024  lds
    buffer_load_dwordx4 v6, s[20:23], s46 offen offset:2048  lds
    buffer_load_dwordx4 v7, s[20:23], s46 offen offset:3072  lds
    s_add_u32 m0, s45, 126976
    s_nop 0
    buffer_load_dwordx4 v8, s[20:23], s46 offen offset:0  lds
    s_add_u32 s46, s46, 18432
    s_add_u32 m0, s45, 128000
    s_nop 0
    buffer_load_dwordx4 v4, s[20:23], s46 offen offset:0  lds
    buffer_load_dwordx4 v5, s[20:23], s46 offen offset:1024  lds
    buffer_load_dwordx4 v6, s[20:23], s46 offen offset:2048  lds
    buffer_load_dwordx4 v7, s[20:23], s46 offen offset:3072  lds
    s_add_u32 m0, s45, 132096
    s_nop 0
    buffer_load_dwordx4 v8, s[20:23], s46 offen offset:0  lds
    v_cmp_gt_u32 s[62:63], 14, v225
    s_nop 1
    v_cndmask_b32 v195, v221, v220, s[62:63]
    v_mov_b32 v200, 0
    v_mov_b32 v201, 0
    v_mov_b32 v202, 0
    v_mov_b32 v203, 0
    v_mov_b32 v204, 0
    v_mov_b32 v205, 0
    v_mov_b32 v206, 0
    v_mov_b32 v207, 0
    v_mov_b32 v208, 0
    v_mov_b32 v209, 0
    v_mov_b32 v210, 0
    v_mov_b32 v211, 0
    v_mov_b32 v212, 0
    v_mov_b32 v213, 0
    v_mov_b32 v214, 0
    v_mov_b32 v215, 0
    v_mov_b32 v216, 0
    v_mov_b32 v217, 0
    v_mul_u32_u24 v224, 80, v15
    s_lshr_b32 s52, s37, 1
    s_mul_i32 s52, s52, 36
    v_add_u32 v224, s52, v224
    s_waitcnt vmcnt(10)
    s_waitcnt lgkmcnt(0)
    s_barrier
    s_mov_b32 s46, 737280
    s_add_u32 m0, s45, 40960
    s_nop 0
    buffer_load_dwordx4 v4, s[20:23], s46 offen offset:0  lds
    buffer_load_dwordx4 v5, s[20:23], s46 offen offset:1024  lds
    buffer_load_dwordx4 v6, s[20:23], s46 offen offset:2048  lds
    buffer_load_dwordx4 v7, s[20:23], s46 offen offset:3072  lds
    s_add_u32 m0, s45, 45056
    s_nop 0
    buffer_load_dwordx4 v8, s[20:23], s46 offen offset:0  lds
    s_add_u32 s46, s46, 18432
    s_add_u32 m0, s45, 46080
    s_nop 0
    buffer_load_dwordx4 v4, s[20:23], s46 offen offset:0  lds
    buffer_load_dwordx4 v5, s[20:23], s46 offen offset:1024  lds
    buffer_load_dwordx4 v6, s[20:23], s46 offen offset:2048  lds
    buffer_load_dwordx4 v7, s[20:23], s46 offen offset:3072  lds
    s_add_u32 m0, s45, 50176
    s_nop 0
    buffer_load_dwordx4 v8, s[20:23], s46 offen offset:0  lds
    s_cmp_eq_u32 s37, 1
    s_cbranch_scc0 Lu_78
    s_waitcnt vmcnt(10)
    ds_write_b128 v123, v[108:111] offset:13632
    ds_write_b128 v124, v[112:115] offset:13632
    ds_write_b128 v125, v[116:119] offset:13632
    s_waitcnt lgkmcnt(0)
Lu_78:
    s_waitcnt vmcnt(10)
    s_waitcnt lgkmcnt(0)
    s_barrier
    s_mov_b32 s46, 884736
    s_add_u32 m0, s45, 81920
    s_nop 0
    buffer_load_dwordx4 v4, s[20:23], s46 offen offset:0  lds
    buffer_load_dwordx4 v5, s[20:23], s46 offen offset:1024  lds
    buffer_load_dwordx4 v6, s[20:23], s46 offen offset:2048  lds
    buffer_load_dwordx4 v7, s[20:23], s46 offen offset:3072  lds
    s_add_u32 m0, s45, 86016
    s_nop 0
    buffer_load_dwordx4 v8, s[20:23], s46 offen offset:0  lds
    s_add_u32 s46, s46, 18432
    s_add_u32 m0, s45, 87040
    s_nop 0
    buffer_load_dwordx4 v4, s[20:23], s46 offen offset:0  lds
    buffer_load_dwordx4 v5, s[20:23], s46 offen offset:1024  lds
    buffer_load_dwordx4 v6, s[20:23], s46 offen offset:2048  lds
    buffer_load_dwordx4 v7, s[20:23], s46 offen offset:3072  lds
    s_add_u32 m0, s45, 91136
    s_nop 0
    buffer_load_dwordx4 v8, s[20:23], s46 offen offset:0  lds
    ds_read_b128 v[28:31], v13 offset:672
    ds_read_b128 v[32:35], v13 offset:688
    ds_read_b32 v36, v13 offset:704
    ds_read_b128 v[38:41], v13 offset:576
    ds_read_b128 v[42:45], v13 offset:592
    ds_read_b32 v46, v13 offset:608
    ds_read_b128 v[48:51], v13 offset:480
    ds_read_b128 v[52:55], v13 offset:496
    ds_read_b32 v56, v13 offset:512
    ds_read_b128 v[58:61], v13 offset:384
    ds_read_b128 v[62:65], v13 offset:400
    ds_read_b32 v66, v13 offset:416
    ds_read_b128 v[68:71], v13 offset:288
    ds_read_b128 v[72:75], v13 offset:304
    ds_read_b32 v76, v13 offset:320
    ds_read_b128 v[78:81], v13 offset:192
    ds_read_b128 v[82:85], v13 offset:208
    ds_read_b32 v86, v13 offset:224
    ds_read_b128 v[88:91], v13 offset:96
    ds_read_b128 v[92:95], v13 offset:112
    ds_read_b32 v96, v13 offset:128
    ds_read_b128 v[98:101], v13 offset:0
    ds_read_b128 v[102:105], v13 offset:16
    ds_read_b32 v106, v13 offset:32
    ds_read_b128 v[108:111], v14 offset:672
    ds_read_b128 v[112:115], v14 offset:688
    ds_read_b32 v116, v14 offset:704
    ds_read_b128 v[118:121], v14 offset:576
    ds_read_b128 v[122:125], v14 offset:592
    ds_read_b32 v126, v14 offset:608
    ds_read_b128 v[128:131], v14 offset:480
    ds_read_b128 v[132:135], v14 offset:496
    ds_read_b32 v136, v14 offset:512
    ds_read_b128 v[138:141], v14 offset:384
    ds_read_b128 v[142:145], v14 offset:400
    ds_read_b32 v146, v14 offset:416
    s_waitcnt lgkmcnt(12)
    ds_read_b128 v[148:151], v14 offset:288
    ds_read_b128 v[152:155], v14 offset:304
    ds_read_b32 v156, v14 offset:320
    ds_read_b128 v[158:161], v14 offset:192
    ds_read_b128 v[162:165], v14 offset:208
    ds_read_b32 v166, v14 offset:224
    ds_read_b128 v[168:171], v14 offset:96
    ds_read_b128 v[172:175], v14 offset:112
    ds_read_b32 v176, v14 offset:128
    ds_read_b128 v[178:181], v14 offset:0
    ds_read_b128 v[182:185], v14 offset:16
    ds_read_b32 v186, v14 offset:32
    v_dot2c_f32_bf16 v188, v16, v28
    v_dot2c_f32_bf16 v189, v16, v38
    v_dot2c_f32_bf16 v190, v16, v48
    v_dot2c_f32_bf16 v191, v16, v58
    v_dot2c_f32_bf16 v192, v16, v68
    v_dot2c_f32_bf16 v193, v16, v78
    v_dot2c_f32_bf16 v194, v16, v88
    v_dot2c_f32_bf16 v195, v16, v98
    v_dot2c_f32_bf16 v188, v17, v29
    v_dot2c_f32_bf16 v189, v17, v39
    v_dot2c_f32_bf16 v190, v17, v49
    v_dot2c_f32_bf16 v191, v17, v59
    v_dot2c_f32_bf16 v192, v17, v69
    v_dot2c_f32_bf16 v193, v17, v79
    v_dot2c_f32_bf16 v194, v17, v89
    v_dot2c_f32_bf16 v195, v17, v99
    v_dot2c_f32_bf16 v188, v18, v30
    v_dot2c_f32_bf16 v189, v18, v40
    v_dot2c_f32_bf16 v190, v18, v50
    v_dot2c_f32_bf16 v191, v18, v60
    v_dot2c_f32_bf16 v192, v18, v70
    v_dot2c_f32_bf16 v193, v18, v80
    v_dot2c_f32_bf16 v194, v18, v90
    v_dot2c_f32_bf16 v195, v18, v100
    v_dot2c_f32_bf16 v188, v19, v31
    v_dot2c_f32_bf16 v189, v19, v41
    v_dot2c_f32_bf16 v190, v19, v51
    v_dot2c_f32_bf16 v191, v19, v61
    v_dot2c_f32_bf16 v192, v19, v71
    v_dot2c_f32_bf16 v193, v19, v81
    v_dot2c_f32_bf16 v194, v19, v91
    v_dot2c_f32_bf16 v195, v19, v101
    v_dot2c_f32_bf16 v188, v20, v32
    v_dot2c_f32_bf16 v189, v20, v42
    v_dot2c_f32_bf16 v190, v20, v52
    v_dot2c_f32_bf16 v191, v20, v62
    v_dot2c_f32_bf16 v192, v20, v72
    v_dot2c_f32_bf16 v193, v20, v82
    v_dot2c_f32_bf16 v194, v20, v92
    v_dot2c_f32_bf16 v195, v20, v102
    v_dot2c_f32_bf16 v188, v21, v33
    v_dot2c_f32_bf16 v189, v21, v43
    v_dot2c_f32_bf16 v190, v21, v53
    v_dot2c_f32_bf16 v191, v21, v63
    v_dot2c_f32_bf16 v192, v21, v73
    v_dot2c_f32_bf16 v193, v21, v83
    v_dot2c_f32_bf16 v194, v21, v93
    v_dot2c_f32_bf16 v195, v21, v103
    v_dot2c_f32_bf16 v188, v22, v34
    v_dot2c_f32_bf16 v189, v22, v44
    v_dot2c_f32_bf16 v190, v22, v54
    v_dot2c_f32_bf16 v191, v22, v64
    v_dot2c_f32_bf16 v192, v22, v74
    v_dot2c_f32_bf16 v193, v22, v84
    v_dot2c_f32_bf16 v194, v22, v94
    v_dot2c_f32_bf16 v195, v22, v104
    v_dot2c_f32_bf16 v188, v23, v35
    v_dot2c_f32_bf16 v189, v23, v45
    v_dot2c_f32_bf16 v190, v23, v55
    v_dot2c_f32_bf16 v191, v23, v65
    v_dot2c_f32_bf16 v192, v23, v75
    v_dot2c_f32_bf16 v193, v23, v85
    v_dot2c_f32_bf16 v194, v23, v95
    v_dot2c_f32_bf16 v195, v23, v105
    v_dot2c_f32_bf16 v188, v24, v36
    v_dot2c_f32_bf16 v189, v24, v46
    v_dot2c_f32_bf16 v190, v24, v56
    v_dot2c_f32_bf16 v191, v24, v66
    v_dot2c_f32_bf16 v192, v24, v76
    v_dot2c_f32_bf16 v193, v24, v86
    v_dot2c_f32_bf16 v194, v24, v96
    v_dot2c_f32_bf16 v195, v24, v106
    s_mov_b32 s51, 0x3eae1a93
    s_nop 1
    v_max3_f32 v220, v188, v189, v190
    v_max3_f32 v221, v191, v192, v193
    v_max3_f32 v220, v220, v194, v195
    v_max_f32 v220, v220, v221
    v_mul_f32 v220, s51, v220
    v_fma_f32 v188, v188, s51, -v220
    v_fma_f32 v189, v189, s51, -v220
    v_fma_f32 v190, v190, s51, -v220
    v_fma_f32 v191, v191, s51, -v220
    v_fma_f32 v192, v192, s51, -v220
    v_fma_f32 v193, v193, s51, -v220
    v_fma_f32 v194, v194, s51, -v220
    v_fma_f32 v195, v195, s51, -v220
    v_exp_f32 v188, v188
    v_exp_f32 v189, v189
    v_exp_f32 v190, v190
    v_exp_f32 v191, v191
    v_exp_f32 v192, v192
    v_exp_f32 v193, v193
    v_exp_f32 v194, v194
    v_exp_f32 v195, v195
    s_nop 0
    v_add_f32 v220, v188, v189
    v_add_f32 v221, v190, v191
    v_add_f32 v222, v192, v193
    v_add_f32 v223, v194, v195
    v_add_f32 v220, v220, v221
    v_add_f32 v222, v222, v223
    s_mov_b32 s51, 0x05040100
    v_add_f32 v220, v220, v222
    s_mov_b32 s52, 0x07060302
    v_rcp_f32 v220, v220
    s_nop 0
    v_mul_f32 v188, v220, v188
    v_mul_f32 v189, v220, v189
    v_mul_f32 v190, v220, v190
    v_mul_f32 v191, v220, v191
    v_mul_f32 v192, v220, v192
    v_mul_f32 v193, v220, v193
    v_mul_f32 v194, v220, v194
    v_mul_f32 v195, v220, v195
    v_cvt_pk_bf16_f32 v196, v188, v189
    v_cvt_pk_bf16_f32 v197, v190, v191
    v_cvt_pk_bf16_f32 v198, v192, v193
    v_cvt_pk_bf16_f32 v199, v194, v195
    s_waitcnt lgkmcnt(15)
    v_perm_b32 v28, v118, v108, s51
    v_perm_b32 v29, v118, v108, s52
    v_perm_b32 v30, v119, v109, s51
    v_perm_b32 v31, v119, v109, s52
    v_perm_b32 v32, v120, v110, s51
    v_perm_b32 v33, v120, v110, s52
    v_dot2c_f32_bf16 v200, v28, v196
    v_dot2c_f32_bf16 v201, v29, v196
    v_dot2c_f32_bf16 v202, v30, v196
    v_dot2c_f32_bf16 v203, v31, v196
    v_dot2c_f32_bf16 v204, v32, v196
    v_dot2c_f32_bf16 v205, v33, v196
    v_perm_b32 v34, v121, v111, s51
    v_perm_b32 v35, v121, v111, s52
    v_perm_b32 v36, v122, v112, s51
    v_perm_b32 v37, v122, v112, s52
    v_perm_b32 v38, v123, v113, s51
    v_perm_b32 v39, v123, v113, s52
    v_dot2c_f32_bf16 v206, v34, v196
    v_dot2c_f32_bf16 v207, v35, v196
    v_dot2c_f32_bf16 v208, v36, v196
    v_dot2c_f32_bf16 v209, v37, v196
    v_dot2c_f32_bf16 v210, v38, v196
    v_dot2c_f32_bf16 v211, v39, v196
    v_perm_b32 v28, v124, v114, s51
    v_perm_b32 v29, v124, v114, s52
    v_perm_b32 v30, v125, v115, s51
    v_perm_b32 v31, v125, v115, s52
    v_perm_b32 v32, v126, v116, s51
    v_perm_b32 v33, v126, v116, s52
    v_dot2c_f32_bf16 v212, v28, v196
    v_dot2c_f32_bf16 v213, v29, v196
    v_dot2c_f32_bf16 v214, v30, v196
    v_dot2c_f32_bf16 v215, v31, v196
    v_dot2c_f32_bf16 v216, v32, v196
    v_dot2c_f32_bf16 v217, v33, v196
    s_waitcnt lgkmcnt(12)
    v_perm_b32 v34, v138, v128, s51
    v_perm_b32 v35, v138, v128, s52
    v_perm_b32 v36, v139, v129, s51
    v_perm_b32 v37, v139, v129, s52
    v_perm_b32 v38, v140, v130, s51
    v_perm_b32 v39, v140, v130, s52
    v_dot2c_f32_bf16 v200, v34, v197
    v_dot2c_f32_bf16 v201, v35, v197
    v_dot2c_f32_bf16 v202, v36, v197
    v_dot2c_f32_bf16 v203, v37, v197
    v_dot2c_f32_bf16 v204, v38, v197
    v_dot2c_f32_bf16 v205, v39, v197
    v_perm_b32 v28, v141, v131, s51
    v_perm_b32 v29, v141, v131, s52
    v_perm_b32 v30, v142, v132, s51
    v_perm_b32 v31, v142, v132, s52
    v_perm_b32 v32, v143, v133, s51
    v_perm_b32 v33, v143, v133, s52
    v_dot2c_f32_bf16 v206, v28, v197
    v_dot2c_f32_bf16 v207, v29, v197
    v_dot2c_f32_bf16 v208, v30, v197
    v_dot2c_f32_bf16 v209, v31, v197
    v_dot2c_f32_bf16 v210, v32, v197
    v_dot2c_f32_bf16 v211, v33, v197
    v_perm_b32 v34, v144, v134, s51
    v_perm_b32 v35, v144, v134, s52
    v_perm_b32 v36, v145, v135, s51
    v_perm_b32 v37, v145, v135, s52
    v_perm_b32 v38, v146, v136, s51
    v_perm_b32 v39, v146, v136, s52
    v_dot2c_f32_bf16 v212, v34, v197
    v_dot2c_f32_bf16 v213, v35, v197
    v_dot2c_f32_bf16 v214, v36, v197
    v_dot2c_f32_bf16 v215, v37, v197
    v_dot2c_f32_bf16 v216, v38, v197
    v_dot2c_f32_bf16 v217, v39, v197
    s_waitcnt lgkmcnt(6)
    v_perm_b32 v28, v158, v148, s51
    v_perm_b32 v29, v158, v148, s52
    v_perm_b32 v30, v159, v149, s51
    v_perm_b32 v31, v159, v149, s52
    v_perm_b32 v32, v160, v150, s51
    v_perm_b32 v33, v160, v150, s52
    v_dot2c_f32_bf16 v200, v28, v198
    v_dot2c_f32_bf16 v201, v29, v198
    v_dot2c_f32_bf16 v202, v30, v198
    v_dot2c_f32_bf16 v203, v31, v198
    v_dot2c_f32_bf16 v204, v32, v198
    v_dot2c_f32_bf16 v205, v33, v198
    v_perm_b32 v34, v161, v151, s51
    v_perm_b32 v35, v161, v151, s52
    v_perm_b32 v36, v162, v152, s51
    v_perm_b32 v37, v162, v152, s52
    v_perm_b32 v38, v163, v153, s51
    v_perm_b32 v39, v163, v153, s52
    v_dot2c_f32_bf16 v206, v34, v198
    v_dot2c_f32_bf16 v207, v35, v198
    v_dot2c_f32_bf16 v208, v36, v198
    v_dot2c_f32_bf16 v209, v37, v198
    v_dot2c_f32_bf16 v210, v38, v198
    v_dot2c_f32_bf16 v211, v39, v198
    v_perm_b32 v28, v164, v154, s51
    v_perm_b32 v29, v164, v154, s52
    v_perm_b32 v30, v165, v155, s51
    v_perm_b32 v31, v165, v155, s52
    v_perm_b32 v32, v166, v156, s51
    v_perm_b32 v33, v166, v156, s52
    v_dot2c_f32_bf16 v212, v28, v198
    v_dot2c_f32_bf16 v213, v29, v198
    v_dot2c_f32_bf16 v214, v30, v198
    v_dot2c_f32_bf16 v215, v31, v198
    v_dot2c_f32_bf16 v216, v32, v198
    v_dot2c_f32_bf16 v217, v33, v198
    s_waitcnt lgkmcnt(0)
    v_perm_b32 v34, v178, v168, s51
    v_perm_b32 v35, v178, v168, s52
    v_perm_b32 v36, v179, v169, s51
    v_perm_b32 v37, v179, v169, s52
    v_perm_b32 v38, v180, v170, s51
    v_perm_b32 v39, v180, v170, s52
    v_dot2c_f32_bf16 v200, v34, v199
    v_dot2c_f32_bf16 v201, v35, v199
    v_dot2c_f32_bf16 v202, v36, v199
    v_dot2c_f32_bf16 v203, v37, v199
    v_dot2c_f32_bf16 v204, v38, v199
    v_dot2c_f32_bf16 v205, v39, v199
    v_perm_b32 v28, v181, v171, s51
    v_perm_b32 v29, v181, v171, s52
    v_perm_b32 v30, v182, v172, s51
    v_perm_b32 v31, v182, v172, s52
    v_perm_b32 v32, v183, v173, s51
    v_perm_b32 v33, v183, v173, s52
    v_dot2c_f32_bf16 v206, v28, v199
    v_dot2c_f32_bf16 v207, v29, v199
    v_dot2c_f32_bf16 v208, v30, v199
    v_dot2c_f32_bf16 v209, v31, v199
    v_dot2c_f32_bf16 v210, v32, v199
    v_dot2c_f32_bf16 v211, v33, v199
    v_perm_b32 v34, v184, v174, s51
    v_perm_b32 v35, v184, v174, s52
    v_perm_b32 v36, v185, v175, s51
    v_perm_b32 v37, v185, v175, s52
    v_perm_b32 v38, v186, v176, s51
    v_perm_b32 v39, v186, v176, s52
    v_dot2c_f32_bf16 v212, v34, v199
    v_dot2c_f32_bf16 v213, v35, v199
    v_dot2c_f32_bf16 v214, v36, v199
    v_dot2c_f32_bf16 v215, v37, v199
    v_dot2c_f32_bf16 v216, v38, v199
    v_dot2c_f32_bf16 v217, v39, v199
    s_nop 1
    v_cvt_pk_bf16_f32 v16, v200, v201
    v_cvt_pk_bf16_f32 v17, v202, v203
    v_cvt_pk_bf16_f32 v18, v204, v205
    v_cvt_pk_bf16_f32 v19, v206, v207
    v_cvt_pk_bf16_f32 v20, v208, v209
    v_cvt_pk_bf16_f32 v21, v210, v211
    v_cvt_pk_bf16_f32 v22, v212, v213
    v_cvt_pk_bf16_f32 v23, v214, v215
    v_cvt_pk_bf16_f32 v24, v216, v217
    ds_write_b32 v224, v16 offset:0
    ds_write_b32 v224, v17 offset:4
    ds_write_b32 v224, v18 offset:8
    ds_write_b32 v224, v19 offset:12
    ds_write_b32 v224, v20 offset:16
    ds_write_b32 v224, v21 offset:20
    ds_write_b32 v224, v22 offset:24
    ds_write_b32 v224, v23 offset:28
    ds_write_b32 v224, v24 offset:32
    s_waitcnt vmcnt(10)
    s_waitcnt lgkmcnt(0)
    s_barrier
    s_mov_b32 s46, 1032192
    s_add_u32 m0, s45, 122880
    s_nop 0
    buffer_load_dwordx4 v4, s[20:23], s46 offen offset:0  lds
    buffer_load_dwordx4 v5, s[20:23], s46 offen offset:1024  lds
    buffer_load_dwordx4 v6, s[20:23], s46 offen offset:2048  lds
    buffer_load_dwordx4 v7, s[20:23], s46 offen offset:3072  lds
    s_add_u32 m0, s45, 126976
    s_nop 0
    buffer_load_dwordx4 v8, s[20:23], s46 offen offset:0  lds
    s_add_u32 s46, s46, 18432
    s_add_u32 m0, s45, 128000
    s_nop 0
    buffer_load_dwordx4 v4, s[20:23], s46 offen offset:0  lds
    buffer_load_dwordx4 v5, s[20:23], s46 offen offset:1024  lds
    buffer_load_dwordx4 v6, s[20:23], s46 offen offset:2048  lds
    buffer_load_dwordx4 v7, s[20:23], s46 offen offset:3072  lds
    s_add_u32 m0, s45, 132096
    s_nop 0
    buffer_load_dwordx4 v8, s[20:23], s46 offen offset:0  lds
    s_lshr_b32 s55, s40, 3
    s_add_u32 s55, s55, 16
    s_lshl_b32 s55, s55, 11
    s_and_b32 s56, s40, 3
    s_lshl_b32 s56, s56, 8
    s_add_u32 s55, s55, s56
    s_bfe_u32 s56, s40, 0x10002
    s_lshl_b32 s56, s56, 3
    s_add_u32 s55, s55, s56
    v_add_u32 v253, s55, v253
    s_and_b32 s41, s36, 1
    s_lshr_b32 s49, s36, 1
    s_lshl_b32 s53, s49, 1
    s_add_u32 s53, s53, 1
    s_cmp_eq_u32 s49, 0
    s_cselect_b32 s44, 0, s53
    s_cselect_b32 s54, 2, 1
    s_add_u32 s47, s54, s44
    v_lshlrev_b32 v1, 2, v0
    s_and_b32 s53, s42, 1
    s_add_u32 s54, s53, s44
    s_lshl_b32 s54, s54, 8
    s_add_u32 s59, s54, 24576
    buffer_load_dword v226, v1, s[72:75], s59 offen offset:1024
    s_add_u32 s59, s54, 24576
    buffer_load_dword v229, v1, s[72:75], s59 offen offset:1280
    s_mov_b32 s59, 28672
    buffer_load_dword v238, v1, s[72:75], s59 offen offset:3328
    s_mul_i32 s51, s39, 147456
    s_mul_i32 s59, s43, 36864
    s_add_u32 s51, s51, s59
    s_mul_i32 s59, s42, 288
    s_add_u32 s51, s51, s59
    s_add_u32 s4, s64, s51
    s_addc_u32 s5, s65, 0
    s_sub_u32 s6, 2359296, s51
    s_mov_b32 s7, 0x20000
    s_add_u32 s12, s78, s51
    s_addc_u32 s13, s79, 0
    s_sub_u32 s14, 2359296, s51
    s_mov_b32 s15, 0x20000
    s_cmp_eq_u32 s49, 0
    s_cselect_b32 s51, 0, 1
    s_add_u32 s51, s51, s49
    s_mul_i32 s52, s41, 5
    s_add_u32 s51, s51, s52
    s_lshl_b32 s51, s51, 10
    v_lshl_add_u32 v241, v0, 4, s51
    s_cmp_eq_u32 s49, 0
    s_cselect_b32 s52, 1024, 8
    v_add_u32 v242, s52, v241
    s_mul_i32 s51, s39, 655360
    s_mul_i32 s59, s42, 163840
    s_add_u32 s51, s51, s59
    s_mul_i32 s59, s43, 10240
    s_add_u32 s51, s51, s59
    s_add_u32 s51, s51, 25165824
    s_add_u32 s8, s82, s51
    s_addc_u32 s9, s83, 0
    s_mov_b32 s10, 133120
    s_mov_b32 s11, 0x20000
    ds_read2_b64 v[16:19], v250 offset0:0 offset1:4
    ds_read2_b64 v[20:23], v250 offset0:160 offset1:164
    ds_read_b64 v[24:25], v251
    s_waitcnt lgkmcnt(1)
    buffer_store_dwordx4 v[16:19], v252, s[32:35], 0 offen offset:0 sc1
    buffer_store_dwordx4 v[20:23], v252, s[32:35], 0 offen offset:1024 sc1
    s_waitcnt lgkmcnt(0)
    s_mov_b64 s[60:61], exec
    s_mov_b64 exec, 0xffffffff
    buffer_store_dwordx2 v[24:25], v253, s[32:35], 0 offen sc1
    s_mov_b64 exec, s[60:61]
    s_waitcnt vmcnt(16)
    s_waitcnt lgkmcnt(0)
    s_barrier
    s_mov_b32 s46, 1179648
    s_add_u32 m0, s45, 40960
    s_nop 0
    buffer_load_dwordx4 v4, s[20:23], s46 offen offset:0  lds
    buffer_load_dwordx4 v5, s[20:23], s46 offen offset:1024  lds
    buffer_load_dwordx4 v6, s[20:23], s46 offen offset:2048  lds
    buffer_load_dwordx4 v7, s[20:23], s46 offen offset:3072  lds
    s_add_u32 m0, s45, 45056
    s_nop 0
    buffer_load_dwordx4 v8, s[20:23], s46 offen offset:0  lds
    s_add_u32 s46, s46, 18432
    s_add_u32 m0, s45, 46080
    s_nop 0
    buffer_load_dwordx4 v4, s[20:23], s46 offen offset:0  lds
    buffer_load_dwordx4 v5, s[20:23], s46 offen offset:1024  lds
    buffer_load_dwordx4 v6, s[20:23], s46 offen offset:2048  lds
    buffer_load_dwordx4 v7, s[20:23], s46 offen offset:3072  lds
    s_add_u32 m0, s45, 50176
    s_nop 0
    buffer_load_dwordx4 v8, s[20:23], s46 offen offset:0  lds
    s_waitcnt vmcnt(13)
    v_add_u32 v228, 40960, v226
    v_add_u32 v227, 122880, v226
    v_add_u32 v226, 81920, v226
    v_add_u32 v231, 40960, v229
    v_add_u32 v230, 122880, v229
    v_add_u32 v229, 81920, v229
    s_mul_i32 s51, s41, 18432
    s_lshl_b32 s52, s47, 5
    s_add_u32 s52, s52, s51
    s_cmp_eq_u32 s49, 0
    s_cselect_b32 s53, 0, 0x40000000
    s_add_u32 s52, s52, s53
    v_add_u32 v240, s52, v238
    s_lshl_b32 s52, s44, 5
    s_add_u32 s52, s52, s51
    s_add_u32 s53, s52, 32
    v_add_u32 v239, s53, v238
    v_add_u32 v238, s52, v238
    buffer_load_dwordx2 v[232:233], v238, s[4:7], 0 offen
    buffer_load_dwordx2 v[234:235], v239, s[4:7], 0 offen
    buffer_load_dwordx2 v[236:237], v240, s[4:7], 0 offen
    s_waitcnt vmcnt(13)
    s_lshl_b32 s55, s39, 9
    s_mul_i32 s59, s40, 32
    s_add_u32 s55, s55, s59
    s_mul_i32 s59, s37, 8
    s_add_u32 s55, s55, s59
    s_add_u32 s55, s55, 50462720
    v_mov_b32 v16, s84
    v_mov_b32 v17, s85
    s_mov_b64 s[60:61], exec
    s_mov_b64 exec, 1
    buffer_store_dwordx2 v[16:17], off, s[24:27], s55 sc1
    s_mov_b64 exec, s[60:61]
    s_waitcnt lgkmcnt(0)
    s_barrier
    s_mul_i32 s51, s42, 288
    s_andn2_b32 s51, s51, 63
    s_add_u32 s28, s68, s51
    s_addc_u32 s29, s69, 0
    s_sub_u32 s30, 663552, s51
    s_mov_b32 s31, 0x20000
    s_add_u32 s51, s37, 0
    s_mul_i32 s46, s51, 41472
    s_add_u32 m0, s45, 81920
    s_nop 0
    buffer_load_dwordx4 v4, s[28:31], s46 offen offset:0  lds
    buffer_load_dwordx4 v5, s[28:31], s46 offen offset:1024  lds
    buffer_load_dwordx4 v6, s[28:31], s46 offen offset:2048  lds
    buffer_load_dwordx4 v7, s[28:31], s46 offen offset:3072  lds
    s_add_u32 m0, s45, 86016
    s_nop 0
    buffer_load_dwordx4 v8, s[28:31], s46 offen offset:0  lds
    s_add_u32 s46, s46, 18432
    s_add_u32 m0, s45, 87040
    s_nop 0
    buffer_load_dwordx4 v4, s[28:31], s46 offen offset:0  lds
    buffer_load_dwordx4 v5, s[28:31], s46 offen offset:1024  lds
    buffer_load_dwordx4 v6, s[28:31], s46 offen offset:2048  lds
    buffer_load_dwordx4 v7, s[28:31], s46 offen offset:3072  lds
    s_add_u32 m0, s45, 91136
    s_nop 0
    buffer_load_dwordx4 v8, s[28:31], s46 offen offset:0  lds
    v_lshlrev_b32 v1, 4, v0
    s_mov_b32 s59, 45056
    buffer_load_dwordx4 v[28:31], v1, s[72:75], s59 offen offset:3840
    s_mov_b32 s59, 49152
    buffer_load_dword v32, v1, s[72:75], s59 offen offset:768
    s_waitcnt vmcnt(15)
    s_waitcnt lgkmcnt(0)
    s_barrier
    s_add_u32 s51, s37, 4
    s_mul_i32 s46, s51, 41472
    s_add_u32 m0, s45, 122880
    s_nop 0
    buffer_load_dwordx4 v4, s[28:31], s46 offen offset:0  lds
    buffer_load_dwordx4 v5, s[28:31], s46 offen offset:1024  lds
    buffer_load_dwordx4 v6, s[28:31], s46 offen offset:2048  lds
    buffer_load_dwordx4 v7, s[28:31], s46 offen offset:3072  lds
    s_add_u32 m0, s45, 126976
    s_nop 0
    buffer_load_dwordx4 v8, s[28:31], s46 offen offset:0  lds
    s_add_u32 s46, s46, 18432
    s_add_u32 m0, s45, 128000
    s_nop 0
    buffer_load_dwordx4 v4, s[28:31], s46 offen offset:0  lds
    buffer_load_dwordx4 v5, s[28:31], s46 offen offset:1024  lds
    buffer_load_dwordx4 v6, s[28:31], s46 offen offset:2048  lds
    buffer_load_dwordx4 v7, s[28:31], s46 offen offset:3072  lds
    s_add_u32 m0, s45, 132096
    s_nop 0
    buffer_load_dwordx4 v8, s[28:31], s46 offen offset:0  lds
    s_lshl_b32 s55, s39, 9
    s_add_u32 s55, s55, 50462720
    v_lshlrev_b32 v22, 3, v0
    s_mov_b64 s[60:61], exec
    s_mov_b64 exec, -1
    buffer_load_dwordx2 v[20:21], v22, s[24:27], s55 offen sc1
    s_mov_b64 exec, s[60:61]
    s_waitcnt vmcnt(0)
    s_mov_b64 s[60:61], exec
    s_mov_b64 exec, -1
    v_cmp_eq_u32 vcc, s84, v20
    v_cmp_eq_u32 s[62:63], s85, v21
    s_nop 3
    s_and_b64 vcc, vcc, s[62:63]
    s_cmp_eq_u64 vcc, exec
    s_mov_b64 exec, s[60:61]
    s_cbranch_scc1 Lord_79
    s_mov_b32 s48, 0
    s_branch Lonx_80
Lord_79:
    s_mov_b32 s48, 1
    s_mul_i32 s51, s39, 147456
    s_mul_i32 s59, s43, 36864
    s_add_u32 s51, s51, s59
    s_add_u32 s51, s51, 20971520
    s_add_u32 s32, s82, s51
    s_addc_u32 s33, s83, 0
    s_mov_b32 s34, 36864
    s_mov_b32 s35, 0x20000
    v_lshlrev_b32 v16, 4, v0
    s_mul_i32 s52, s37, 9216
    s_add_u32 m0, s52, 0
    s_add_u32 s46, s52, 0
    buffer_load_dwordx4 v16, s[32:35], s46 offen offset:0 sc1 lds
    buffer_load_dwordx4 v16, s[32:35], s46 offen offset:1024 sc1 lds
    buffer_load_dwordx4 v16, s[32:35], s46 offen offset:2048 sc1 lds
    buffer_load_dwordx4 v16, s[32:35], s46 offen offset:3072 sc1 lds
    s_add_u32 m0, s52, 4096
    s_add_u32 s46, s52, 4096
    buffer_load_dwordx4 v16, s[32:35], s46 offen offset:0 sc1 lds
    buffer_load_dwordx4 v16, s[32:35], s46 offen offset:1024 sc1 lds
    buffer_load_dwordx4 v16, s[32:35], s46 offen offset:2048 sc1 lds
    buffer_load_dwordx4 v16, s[32:35], s46 offen offset:3072 sc1 lds
    s_add_u32 m0, s52, 8192
    s_add_u32 s46, s52, 8192
    buffer_load_dwordx4 v16, s[32:35], s46 offen offset:0 sc1 lds
Lonx_80:
    s_barrier
    s_add_u32 s51, s37, 8
    s_mul_i32 s46, s51, 41472
    s_add_u32 m0, s45, 40960
    s_nop 0
    buffer_load_dwordx4 v4, s[28:31], s46 offen offset:0  lds
    buffer_load_dwordx4 v5, s[28:31], s46 offen offset:1024  lds
    buffer_load_dwordx4 v6, s[28:31], s46 offen offset:2048  lds
    buffer_load_dwordx4 v7, s[28:31], s46 offen offset:3072  lds
    s_add_u32 m0, s45, 45056
    s_nop 0
    buffer_load_dwordx4 v8, s[28:31], s46 offen offset:0  lds
    s_add_u32 s46, s46, 18432
    s_add_u32 m0, s45, 46080
    s_nop 0
    buffer_load_dwordx4 v4, s[28:31], s46 offen offset:0  lds
    buffer_load_dwordx4 v5, s[28:31], s46 offen offset:1024  lds
    buffer_load_dwordx4 v6, s[28:31], s46 offen offset:2048  lds
    buffer_load_dwordx4 v7, s[28:31], s46 offen offset:3072  lds
    s_add_u32 m0, s45, 50176
    s_nop 0
    buffer_load_dwordx4 v8, s[28:31], s46 offen offset:0  lds
    s_cmp_eq_u32 s48, 1
    s_cbranch_scc1 Lodn_81
    s_lshl_b32 s55, s39, 9
    s_add_u32 s55, s55, 50462720
    v_lshlrev_b32 v22, 3, v0
    s_mov_b64 s[60:61], exec
    s_mov_b64 exec, -1
    s_mov_b32 s58, 400000
Lpoll_82:
    buffer_load_dwordx2 v[20:21], v22, s[24:27], s55 offen sc1
    s_waitcnt vmcnt(0)
    v_cmp_eq_u32 vcc, s84, v20
    v_cmp_eq_u32 s[62:63], s85, v21
    s_nop 3
    s_and_b64 vcc, vcc, s[62:63]
    s_cmp_eq_u64 vcc, exec
    s_cbranch_scc1 Lpd_83
    s_sub_u32 s58, s58, 1
    s_cmp_eq_u32 s58, 0
    s_cbranch_scc1 Lpd_83
    s_branch Lpoll_82
Lpd_83:
    s_mov_b64 exec, s[60:61]
    s_mul_i32 s51, s39, 147456
    s_mul_i32 s59, s43, 36864
    s_add_u32 s51, s51, s59
    s_add_u32 s51, s51, 20971520
    s_add_u32 s32, s82, s51
    s_addc_u32 s33, s83, 0
    s_mov_b32 s34, 36864
    s_mov_b32 s35, 0x20000
    v_lshlrev_b32 v16, 4, v0
    s_mul_i32 s52, s37, 9216
    s_add_u32 m0, s52, 0
    s_add_u32 s46, s52, 0
    buffer_load_dwordx4 v16, s[32:35], s46 offen offset:0 sc1 lds
    buffer_load_dwordx4 v16, s[32:35], s46 offen offset:1024 sc1 lds
    buffer_load_dwordx4 v16, s[32:35], s46 offen offset:2048 sc1 lds
    buffer_load_dwordx4 v16, s[32:35], s46 offen offset:3072 sc1 lds
    s_add_u32 m0, s52, 4096
    s_add_u32 s46, s52, 4096
    buffer_load_dwordx4 v16, s[32:35], s46 offen offset:0 sc1 lds
    buffer_load_dwordx4 v16, s[32:35], s46 offen offset:1024 sc1 lds
    buffer_load_dwordx4 v16, s[32:35], s46 offen offset:2048 sc1 lds
    buffer_load_dwordx4 v16, s[32:35], s46 offen offset:3072 sc1 lds
    s_add_u32 m0, s52, 8192
    s_add_u32 s46, s52, 8192
    buffer_load_dwordx4 v16, s[32:35], s46 offen offset:0 sc1 lds
    s_waitcnt vmcnt(0)
Lodn_81:
    s_waitcnt vmcnt(10)
    s_waitcnt lgkmcnt(0)
    s_barrier
    s_lshl_b32 s51, s41, 10
    v_lshlrev_b32 v1, 4, v0
    v_add_u32 v1, s51, v1
    ds_read_b128 v[88:91], v1 offset:0
    ds_read_b128 v[92:95], v1 offset:2048
    ds_read_b128 v[96:99], v1 offset:4096
    ds_read_b128 v[100:103], v1 offset:6144
    ds_read_b128 v[104:107], v1 offset:8192
    ds_read_b128 v[108:111], v1 offset:10240
    ds_read_b128 v[112:115], v1 offset:12288
    ds_read_b128 v[116:119], v1 offset:14336
    ds_read_b128 v[120:123], v1 offset:16384
    ds_read_b128 v[124:127], v1 offset:18432
    ds_read_b128 v[128:131], v1 offset:20480
    ds_read_b128 v[132:135], v1 offset:22528
    ds_read_b128 v[136:139], v1 offset:24576
    ds_read_b128 v[140:143], v1 offset:26624
    ds_read_b128 v[144:147], v1 offset:28672
    ds_read_b128 v[148:151], v1 offset:30720
    ds_read_b128 v[152:155], v1 offset:32768
    ds_read_b128 v[156:159], v1 offset:34816
    ds_read_b64_tr_b16 v[168:169], v226 offset:0
    ds_read_b64_tr_b16 v[170:171], v226 offset:5120
    ds_read_b64_tr_b16 v[172:173], v229 offset:0
    ds_read_b64_tr_b16 v[174:175], v229 offset:5120
    ds_read_b64_tr_b16 v[176:177], v226 offset:10240
    ds_read_b64_tr_b16 v[178:179], v226 offset:15360
    ds_read_b64_tr_b16 v[180:181], v229 offset:10240
    ds_read_b64_tr_b16 v[182:183], v229 offset:15360
    ds_read_b64_tr_b16 v[184:185], v226 offset:20480
    ds_read_b64_tr_b16 v[186:187], v226 offset:25600
    s_waitcnt lgkmcnt(8)
    v_mfma_f32_16x16x32_bf16 v[244:247], v[168:171], v[88:91], 0
    ds_read_b64_tr_b16 v[188:189], v229 offset:20480
    ds_read_b64_tr_b16 v[190:191], v229 offset:25600
    s_waitcnt lgkmcnt(8)
    v_mfma_f32_16x16x32_bf16 v[248:251], v[172:175], v[88:91], 0
    ds_read_b64_tr_b16 v[168:169], v226 offset:30720
    ds_read_b64_tr_b16 v[170:171], v226 offset:35840
    s_waitcnt lgkmcnt(8)
    v_mfma_f32_16x16x32_bf16 v[244:247], v[176:179], v[92:95], v[244:247]
    ds_read_b64_tr_b16 v[172:173], v229 offset:30720
    ds_read_b64_tr_b16 v[174:175], v229 offset:35840
    s_waitcnt lgkmcnt(8)
    v_mfma_f32_16x16x32_bf16 v[248:251], v[180:183], v[92:95], v[248:251]
    ds_read_b64_tr_b16 v[176:177], v227 offset:0
    ds_read_b64_tr_b16 v[178:179], v227 offset:5120
    s_waitcnt lgkmcnt(8)
    v_mfma_f32_16x16x32_bf16 v[244:247], v[184:187], v[96:99], v[244:247]
    ds_read_b64_tr_b16 v[180:181], v230 offset:0
    ds_read_b64_tr_b16 v[182:183], v230 offset:5120
    s_waitcnt lgkmcnt(8)
    v_mfma_f32_16x16x32_bf16 v[248:251], v[188:191], v[96:99], v[248:251]
    ds_read_b64_tr_b16 v[184:185], v227 offset:10240
    ds_read_b64_tr_b16 v[186:187], v227 offset:15360
    s_waitcnt lgkmcnt(8)
    v_mfma_f32_16x16x32_bf16 v[244:247], v[168:171], v[100:103], v[244:247]
    ds_read_b64_tr_b16 v[188:189], v230 offset:10240
    ds_read_b64_tr_b16 v[190:191], v230 offset:15360
    s_waitcnt lgkmcnt(8)
    v_mfma_f32_16x16x32_bf16 v[248:251], v[172:175], v[100:103], v[248:251]
    ds_read_b64_tr_b16 v[168:169], v227 offset:20480
    ds_read_b64_tr_b16 v[170:171], v227 offset:25600
    s_waitcnt lgkmcnt(8)
    v_mfma_f32_16x16x32_bf16 v[244:247], v[176:179], v[104:107], v[244:247]
    ds_read_b64_tr_b16 v[172:173], v230 offset:20480
    ds_read_b64_tr_b16 v[174:175], v230 offset:25600
    s_waitcnt lgkmcnt(8)
    v_mfma_f32_16x16x32_bf16 v[248:251], v[180:183], v[104:107], v[248:251]
    ds_read_b64_tr_b16 v[176:177], v227 offset:30720
    ds_read_b64_tr_b16 v[178:179], v227 offset:35840
    s_waitcnt lgkmcnt(8)
    v_mfma_f32_16x16x32_bf16 v[244:247], v[184:187], v[108:111], v[244:247]
    ds_read_b64_tr_b16 v[180:181], v230 offset:30720
    ds_read_b64_tr_b16 v[182:183], v230 offset:35840
    s_waitcnt lgkmcnt(8)
    v_mfma_f32_16x16x32_bf16 v[248:251], v[188:191], v[108:111], v[248:251]
    s_waitcnt lgkmcnt(6)
    v_mfma_f32_16x16x32_bf16 v[244:247], v[168:171], v[112:115], v[244:247]
    s_waitcnt lgkmcnt(4)
    v_mfma_f32_16x16x32_bf16 v[248:251], v[172:175], v[112:115], v[248:251]
    s_waitcnt lgkmcnt(2)
    v_mfma_f32_16x16x32_bf16 v[244:247], v[176:179], v[116:119], v[244:247]
    s_waitcnt lgkmcnt(0)
    v_mfma_f32_16x16x32_bf16 v[248:251], v[180:183], v[116:119], v[248:251]
    s_waitcnt vmcnt(0)
    s_waitcnt lgkmcnt(0)
    s_barrier
    s_add_u32 s51, s37, 12
    s_mul_i32 s46, s51, 41472
    s_add_u32 m0, s45, 81920
    s_nop 0
    buffer_load_dwordx4 v4, s[28:31], s46 offen offset:0  lds
    buffer_load_dwordx4 v5, s[28:31], s46 offen offset:1024  lds
    buffer_load_dwordx4 v6, s[28:31], s46 offen offset:2048  lds
    buffer_load_dwordx4 v7, s[28:31], s46 offen offset:3072  lds
    s_add_u32 m0, s45, 86016
    s_nop 0
    buffer_load_dwordx4 v8, s[28:31], s46 offen offset:0  lds
    s_add_u32 s46, s46, 18432
    s_add_u32 m0, s45, 87040
    s_nop 0
    buffer_load_dwordx4 v4, s[28:31], s46 offen offset:0  lds
    buffer_load_dwordx4 v5, s[28:31], s46 offen offset:1024  lds
    buffer_load_dwordx4 v6, s[28:31], s46 offen offset:2048  lds
    buffer_load_dwordx4 v7, s[28:31], s46 offen offset:3072  lds
    s_add_u32 m0, s45, 91136
    s_nop 0
    buffer_load_dwordx4 v8, s[28:31], s46 offen offset:0  lds
    s_cmp_lt_u32 s37, 2
    s_cbranch_scc0 Lw4_84
    s_mul_i32 s46, s37, 331776
    s_add_u32 m0, s45, 122880
    s_nop 0
    buffer_load_dwordx4 v28, s[28:31], s46 offen offset:0  lds
    buffer_load_dwordx4 v29, s[28:31], s46 offen offset:1024  lds
    buffer_load_dwordx4 v30, s[28:31], s46 offen offset:2048  lds
    buffer_load_dwordx4 v31, s[28:31], s46 offen offset:3072  lds
    s_add_u32 m0, s45, 126976
    s_nop 0
    buffer_load_dwordx4 v32, s[28:31], s46 offen offset:0  lds
    s_add_u32 s46, s46, 165888
    s_add_u32 m0, s45, 128000
    s_nop 0
    buffer_load_dwordx4 v28, s[28:31], s46 offen offset:0  lds
    buffer_load_dwordx4 v29, s[28:31], s46 offen offset:1024  lds
    buffer_load_dwordx4 v30, s[28:31], s46 offen offset:2048  lds
    buffer_load_dwordx4 v31, s[28:31], s46 offen offset:3072  lds
    s_add_u32 m0, s45, 132096
    s_nop 0
    buffer_load_dwordx4 v32, s[28:31], s46 offen offset:0  lds
Lw4_84:
    ds_read_b64_tr_b16 v[168:169], v228 offset:0
    ds_read_b64_tr_b16 v[170:171], v228 offset:5120
    ds_read_b64_tr_b16 v[172:173], v231 offset:0
    ds_read_b64_tr_b16 v[174:175], v231 offset:5120
    ds_read_b64_tr_b16 v[176:177], v228 offset:10240
    ds_read_b64_tr_b16 v[178:179], v228 offset:15360
    ds_read_b64_tr_b16 v[180:181], v231 offset:10240
    ds_read_b64_tr_b16 v[182:183], v231 offset:15360
    ds_read_b64_tr_b16 v[184:185], v228 offset:20480
    ds_read_b64_tr_b16 v[186:187], v228 offset:25600
    s_waitcnt lgkmcnt(8)
    v_mfma_f32_16x16x32_bf16 v[244:247], v[168:171], v[120:123], v[244:247]
    ds_read_b64_tr_b16 v[188:189], v231 offset:20480
    ds_read_b64_tr_b16 v[190:191], v231 offset:25600
    s_waitcnt lgkmcnt(8)
    v_mfma_f32_16x16x32_bf16 v[248:251], v[172:175], v[120:123], v[248:251]
    ds_read_b64_tr_b16 v[168:169], v228 offset:30720
    ds_read_b64_tr_b16 v[170:171], v228 offset:35840
    s_waitcnt lgkmcnt(8)
    v_mfma_f32_16x16x32_bf16 v[244:247], v[176:179], v[124:127], v[244:247]
    ds_read_b64_tr_b16 v[172:173], v231 offset:30720
    ds_read_b64_tr_b16 v[174:175], v231 offset:35840
    s_waitcnt lgkmcnt(8)
    v_mfma_f32_16x16x32_bf16 v[248:251], v[180:183], v[124:127], v[248:251]
    s_waitcnt lgkmcnt(6)
    v_mfma_f32_16x16x32_bf16 v[244:247], v[184:187], v[128:131], v[244:247]
    s_waitcnt lgkmcnt(4)
    v_mfma_f32_16x16x32_bf16 v[248:251], v[188:191], v[128:131], v[248:251]
    s_waitcnt lgkmcnt(2)
    v_mfma_f32_16x16x32_bf16 v[244:247], v[168:171], v[132:135], v[244:247]
    s_waitcnt lgkmcnt(0)
    v_mfma_f32_16x16x32_bf16 v[248:251], v[172:175], v[132:135], v[248:251]
    s_waitcnt vmcnt(0)
    s_lshl_b32 s55, s39, 11
    s_mul_i32 s59, s42, 512
    s_add_u32 s55, s55, s59
    s_mul_i32 s59, s43, 128
    s_add_u32 s55, s55, s59
    s_add_u32 s55, s55, 50528256
    s_lshl_b32 s51, 1, s43
    s_andn2_b32 s56, 15, s51
    s_mov_b32 s57, 0
    v_lshlrev_b32 v78, 3, v0
    s_mov_b64 s[60:61], exec
    s_mov_b64 exec, s[56:57]
    s_mov_b32 s58, 400000
Lpoll_85:
    buffer_load_dwordx2 v[76:77], v78, s[24:27], s55 offen sc1
    s_waitcnt vmcnt(0)
    v_cmp_eq_u32 vcc, s84, v76
    v_cmp_eq_u32 s[62:63], s85, v77
    s_nop 3
    s_and_b64 vcc, vcc, s[62:63]
    s_cmp_eq_u64 vcc, exec
    s_cbranch_scc1 Lpd_86
    s_sub_u32 s58, s58, 1
    s_cmp_eq_u32 s58, 0
    s_cbranch_scc1 Lpd_86
    s_branch Lpoll_85
Lpd_86:
    s_mov_b64 exec, s[60:61]
    s_add_u32 s51, s43, 1
    s_and_b32 s51, s51, 3
    s_mul_i32 s46, s51, 40960
    buffer_load_dwordx4 v[48:51], v241, s[8:11], s46 offen sc1
    buffer_load_dwordx2 v[52:53], v242, s[8:11], s46 offen sc1
    s_add_u32 s51, s43, 2
    s_and_b32 s51, s51, 3
    s_mul_i32 s46, s51, 40960
    buffer_load_dwordx4 v[56:59], v241, s[8:11], s46 offen sc1
    buffer_load_dwordx2 v[60:61], v242, s[8:11], s46 offen sc1
    s_add_u32 s51, s43, 3
    s_and_b32 s51, s51, 3
    s_mul_i32 s46, s51, 40960
    buffer_load_dwordx4 v[64:67], v241, s[8:11], s46 offen sc1
    buffer_load_dwordx2 v[68:69], v242, s[8:11], s46 offen sc1
    s_waitcnt lgkmcnt(0)
    s_barrier
    ds_read_b64_tr_b16 v[168:169], v226 offset:0
    ds_read_b64_tr_b16 v[170:171], v226 offset:5120
    ds_read_b64_tr_b16 v[172:173], v229 offset:0
    ds_read_b64_tr_b16 v[174:175], v229 offset:5120
    ds_read_b64_tr_b16 v[176:177], v226 offset:10240
    ds_read_b64_tr_b16 v[178:179], v226 offset:15360
    ds_read_b64_tr_b16 v[180:181], v229 offset:10240
    ds_read_b64_tr_b16 v[182:183], v229 offset:15360
    ds_read_b64_tr_b16 v[184:185], v226 offset:20480
    ds_read_b64_tr_b16 v[186:187], v226 offset:25600
    s_waitcnt lgkmcnt(8)
    v_mfma_f32_16x16x32_bf16 v[244:247], v[168:171], v[136:139], v[244:247]
    ds_read_b64_tr_b16 v[188:189], v229 offset:20480
    ds_read_b64_tr_b16 v[190:191], v229 offset:25600
    s_waitcnt lgkmcnt(8)
    v_mfma_f32_16x16x32_bf16 v[248:251], v[172:175], v[136:139], v[248:251]
    ds_read_b64_tr_b16 v[168:169], v226 offset:30720
    ds_read_b64_tr_b16 v[170:171], v226 offset:35840
    s_waitcnt lgkmcnt(8)
    v_mfma_f32_16x16x32_bf16 v[244:247], v[176:179], v[140:143], v[244:247]
    ds_read_b64_tr_b16 v[172:173], v229 offset:30720
    ds_read_b64_tr_b16 v[174:175], v229 offset:35840
    s_waitcnt lgkmcnt(8)
    v_mfma_f32_16x16x32_bf16 v[248:251], v[180:183], v[140:143], v[248:251]
    ds_read_b64_tr_b16 v[176:177], v227 offset:0
    ds_read_b64_tr_b16 v[178:179], v227 offset:5120
    s_waitcnt lgkmcnt(8)
    v_mfma_f32_16x16x32_bf16 v[244:247], v[184:187], v[144:147], v[244:247]
    ds_read_b64_tr_b16 v[180:181], v230 offset:0
    ds_read_b64_tr_b16 v[182:183], v230 offset:5120
    s_waitcnt lgkmcnt(8)
    v_mfma_f32_16x16x32_bf16 v[248:251], v[188:191], v[144:147], v[248:251]
    ds_read_b64_tr_b16 v[184:185], v227 offset:10240
    ds_read_b64_tr_b16 v[186:187], v227 offset:15360
    s_waitcnt lgkmcnt(8)
    v_mfma_f32_16x16x32_bf16 v[244:247], v[168:171], v[148:151], v[244:247]
    ds_read_b64_tr_b16 v[188:189], v230 offset:10240
    ds_read_b64_tr_b16 v[190:191], v230 offset:15360
    s_waitcnt lgkmcnt(8)
    v_mfma_f32_16x16x32_bf16 v[248:251], v[172:175], v[148:151], v[248:251]
    s_waitcnt lgkmcnt(6)
    v_mfma_f32_16x16x32_bf16 v[244:247], v[176:179], v[152:155], v[244:247]
    s_waitcnt lgkmcnt(4)
    v_mfma_f32_16x16x32_bf16 v[248:251], v[180:183], v[152:155], v[248:251]
    s_waitcnt lgkmcnt(2)
    v_mfma_f32_16x16x32_bf16 v[244:247], v[184:187], v[156:159], v[244:247]
    s_waitcnt lgkmcnt(0)
    v_mfma_f32_16x16x32_bf16 v[248:251], v[188:191], v[156:159], v[248:251]
    ds_read_b128 v[40:43], v241 offset:0
    ds_read_b64 v[44:45], v242 offset:0
    s_waitcnt lgkmcnt(0)
    v_mul_f32 v243, v243, v243
    v_lshlrev_b32 v16, 16, v40
    v_and_b32 v17, 0xffff0000, v40
    v_lshlrev_b32 v18, 16, v41
    v_and_b32 v19, 0xffff0000, v41
    v_lshlrev_b32 v20, 16, v42
    v_and_b32 v21, 0xffff0000, v42
    v_lshlrev_b32 v22, 16, v43
    v_and_b32 v23, 0xffff0000, v43
    v_lshlrev_b32 v24, 16, v44
    v_and_b32 v25, 0xffff0000, v44
    v_lshlrev_b32 v26, 16, v45
    v_and_b32 v27, 0xffff0000, v45
    v_lshlrev_b32 v92, 16, v232
    v_and_b32 v93, 0xffff0000, v232
    v_lshlrev_b32 v94, 16, v233
    v_and_b32 v95, 0xffff0000, v233
    v_lshlrev_b32 v96, 16, v234
    v_and_b32 v97, 0xffff0000, v234
    v_lshlrev_b32 v98, 16, v235
    v_and_b32 v99, 0xffff0000, v235
    v_lshlrev_b32 v100, 16, v236
    v_and_b32 v101, 0xffff0000, v236
    v_lshlrev_b32 v102, 16, v237
    v_and_b32 v103, 0xffff0000, v237
    s_waitcnt vmcnt(4)
    v_lshlrev_b32 v76, 16, v48
    v_and_b32 v77, 0xffff0000, v48
    v_lshlrev_b32 v78, 16, v49
    v_and_b32 v79, 0xffff0000, v49
    v_lshlrev_b32 v80, 16, v50
    v_and_b32 v81, 0xffff0000, v50
    v_lshlrev_b32 v82, 16, v51
    v_and_b32 v83, 0xffff0000, v51
    v_lshlrev_b32 v84, 16, v52
    v_and_b32 v85, 0xffff0000, v52
    v_lshlrev_b32 v86, 16, v53
    v_and_b32 v87, 0xffff0000, v53
    v_add_f32 v16, v16, v76
    v_add_f32 v17, v17, v77
    v_add_f32 v18, v18, v78
    v_add_f32 v19, v19, v79
    v_add_f32 v20, v20, v80
    v_add_f32 v21, v21, v81
    v_add_f32 v22, v22, v82
    v_add_f32 v23, v23, v83
    v_add_f32 v24, v24, v84
    v_add_f32 v25, v25, v85
    v_add_f32 v26, v26, v86
    v_add_f32 v27, v27, v87
    s_waitcnt vmcnt(2)
    v_lshlrev_b32 v76, 16, v56
    v_and_b32 v77, 0xffff0000, v56
    v_lshlrev_b32 v78, 16, v57
    v_and_b32 v79, 0xffff0000, v57
    v_lshlrev_b32 v80, 16, v58
    v_and_b32 v81, 0xffff0000, v58
    v_lshlrev_b32 v82, 16, v59
    v_and_b32 v83, 0xffff0000, v59
    v_lshlrev_b32 v84, 16, v60
    v_and_b32 v85, 0xffff0000, v60
    v_lshlrev_b32 v86, 16, v61
    v_and_b32 v87, 0xffff0000, v61
    v_add_f32 v16, v16, v76
    v_add_f32 v17, v17, v77
    v_add_f32 v18, v18, v78
    v_add_f32 v19, v19, v79
    v_add_f32 v20, v20, v80
    v_add_f32 v21, v21, v81
    v_add_f32 v22, v22, v82
    v_add_f32 v23, v23, v83
    v_add_f32 v24, v24, v84
    v_add_f32 v25, v25, v85
    v_add_f32 v26, v26, v86
    v_add_f32 v27, v27, v87
    s_waitcnt vmcnt(0)
    v_lshlrev_b32 v76, 16, v64
    v_and_b32 v77, 0xffff0000, v64
    v_lshlrev_b32 v78, 16, v65
    v_and_b32 v79, 0xffff0000, v65
    v_lshlrev_b32 v80, 16, v66
    v_and_b32 v81, 0xffff0000, v66
    v_lshlrev_b32 v82, 16, v67
    v_and_b32 v83, 0xffff0000, v67
    v_lshlrev_b32 v84, 16, v68
    v_and_b32 v85, 0xffff0000, v68
    v_lshlrev_b32 v86, 16, v69
    v_and_b32 v87, 0xffff0000, v69
    v_add_f32 v16, v16, v76
    v_add_f32 v17, v17, v77
    v_add_f32 v18, v18, v78
    v_add_f32 v19, v19, v79
    v_add_f32 v20, v20, v80
    v_add_f32 v21, v21, v81
    v_add_f32 v22, v22, v82
    v_add_f32 v23, v23, v83
    v_add_f32 v24, v24, v84
    v_add_f32 v25, v25, v85
    v_add_f32 v26, v26, v86
    v_add_f32 v27, v27, v87
    v_mul_f32 v16, v243, v16
    v_mul_f32 v17, v243, v17
    v_mul_f32 v18, v243, v18
    v_mul_f32 v19, v243, v19
    v_mul_f32 v20, v243, v20
    v_mul_f32 v21, v243, v21
    v_mul_f32 v22, v243, v22
    v_mul_f32 v23, v243, v23
    v_mul_f32 v24, v243, v24
    v_mul_f32 v25, v243, v25
    v_mul_f32 v26, v243, v26
    v_mul_f32 v27, v243, v27
    s_mov_b32 s51, 0xbfb8aa3b
    v_mul_f32 v76, s51, v16
    v_mul_f32 v77, s51, v17
    v_mul_f32 v78, s51, v18
    v_mul_f32 v79, s51, v19
    v_mul_f32 v80, s51, v20
    v_mul_f32 v81, s51, v21
    v_mul_f32 v82, s51, v22
    v_mul_f32 v83, s51, v23
    v_mul_f32 v84, s51, v24
    v_mul_f32 v85, s51, v25
    v_mul_f32 v86, s51, v26
    v_mul_f32 v87, s51, v27
    v_exp_f32 v76, v76
    v_exp_f32 v77, v77
    v_exp_f32 v78, v78
    v_exp_f32 v79, v79
    v_exp_f32 v80, v80
    v_exp_f32 v81, v81
    v_exp_f32 v82, v82
    v_exp_f32 v83, v83
    v_exp_f32 v84, v84
    v_exp_f32 v85, v85
    v_exp_f32 v86, v86
    v_exp_f32 v87, v87
    s_nop 0
    v_add_f32 v76, 1.0, v76
    v_add_f32 v77, 1.0, v77
    v_add_f32 v78, 1.0, v78
    v_add_f32 v79, 1.0, v79
    v_add_f32 v80, 1.0, v80
    v_add_f32 v81, 1.0, v81
    v_add_f32 v82, 1.0, v82
    v_add_f32 v83, 1.0, v83
    v_add_f32 v84, 1.0, v84
    v_add_f32 v85, 1.0, v85
    v_add_f32 v86, 1.0, v86
    v_add_f32 v87, 1.0, v87
    v_rcp_f32 v76, v76
    v_rcp_f32 v77, v77
    v_rcp_f32 v78, v78
    v_rcp_f32 v79, v79
    v_rcp_f32 v80, v80
    v_rcp_f32 v81, v81
    v_rcp_f32 v82, v82
    v_rcp_f32 v83, v83
    v_rcp_f32 v84, v84
    v_rcp_f32 v85, v85
    v_rcp_f32 v86, v86
    v_rcp_f32 v87, v87
    s_nop 0
    v_mul_f32 v16, v16, v76
    v_mul_f32 v17, v17, v77
    v_mul_f32 v18, v18, v78
    v_mul_f32 v19, v19, v79
    v_mul_f32 v20, v20, v80
    v_mul_f32 v21, v21, v81
    v_mul_f32 v22, v22, v82
    v_mul_f32 v23, v23, v83
    v_mul_f32 v24, v24, v84
    v_mul_f32 v25, v25, v85
    v_mul_f32 v26, v26, v86
    v_mul_f32 v27, v27, v87
    v_fma_f32 v16, v244, v16, v92
    v_fma_f32 v17, v245, v17, v93
    v_fma_f32 v18, v246, v18, v94
    v_fma_f32 v19, v247, v19, v95
    v_fma_f32 v20, v248, v20, v96
    v_fma_f32 v21, v249, v21, v97
    v_fma_f32 v22, v250, v22, v98
    v_fma_f32 v23, v251, v23, v99
    v_fma_f32 v24, v252, v24, v100
    v_fma_f32 v25, v253, v25, v101
    v_fma_f32 v26, v254, v26, v102
    v_fma_f32 v27, v255, v27, v103
    v_cvt_pk_bf16_f32 v232, v16, v17
    v_cvt_pk_bf16_f32 v233, v18, v19
    v_cvt_pk_bf16_f32 v234, v20, v21
    v_cvt_pk_bf16_f32 v235, v22, v23
    v_cvt_pk_bf16_f32 v236, v24, v25
    v_cvt_pk_bf16_f32 v237, v26, v27
    buffer_store_dwordx2 v[232:233], v238, s[12:15], 0 offen
    buffer_store_dwordx2 v[234:235], v239, s[12:15], 0 offen
    buffer_store_dwordx2 v[236:237], v240, s[12:15], 0 offen
L_exit:
    s_endpgm
.p2align 8
L_tab:
    .long 0, 16, 32, 48, 64, 80, 96, 112, 1152, 1168, 1184, 1200, 1216, 1232, 1248, 1264
    .long 2304, 2320, 2336, 2352, 2368, 2384, 2400, 2416, 3456, 3472, 3488, 3504, 3520, 3536, 3552, 3568
    .long 4608, 4624, 4640, 4656, 4672, 4688, 4704, 4720, 5760, 5776, 5792, 5808, 5824, 5840, 5856, 5872
    .long 6944, 6960, 6912, 6928, 7008, 7024, 6976, 6992, 8096, 8112, 8064, 8080, 8160, 8176, 8128, 8144
    .long 8224, 8240, 8192, 8208, 8288, 8304, 8256, 8272, 9376, 9392, 9344, 9360, 9440, 9456, 9408, 9424
    .long 10528, 10544, 10496, 10512, 10592, 10608, 10560, 10576, 11680, 11696, 11648, 11664, 11744, 11760, 11712, 11728
    .long 12864, 12880, 12896, 12912, 12800, 12816, 12832, 12848, 14016, 14032, 14048, 14064, 13952, 13968, 13984, 14000
    .long 15168, 15184, 15200, 15216, 15104, 15120, 15136, 15152, 16320, 16336, 16352, 16368, 16256, 16272, 16288, 16304
    .long 16448, 16464, 16480, 16496, 16384, 16400, 16416, 16432, 17600, 17616, 17632, 17648, 17536, 17552, 17568, 17584
    .long 18784, 18800, 18752, 18768, 18720, 18736, 18688, 18704, 19936, 19952, 19904, 19920, 19872, 19888, 19840, 19856
    .long 21088, 21104, 21056, 21072, 21024, 21040, 20992, 21008, 22240, 22256, 22208, 22224, 22176, 22192, 22144, 22160
    .long 23392, 23408, 23360, 23376, 23328, 23344, 23296, 23312, 24544, 24560, 24512, 24528, 24480, 24496, 24448, 24464
    .long 27648, 27664, 27680, 27696, 27712, 27728, 27744, 27760, 28800, 28816, 28832, 28848, 28864, 28880, 28896, 28912
    .long 29952, 29968, 29984, 30000, 30016, 30032, 30048, 30064, 31104, 31120, 31136, 31152, 31168, 31184, 31200, 31216
    .long 32256, 32272, 32288, 32304, 32320, 32336, 32352, 32368, 33408, 33424, 33440, 33456, 33472, 33488, 33504, 33520
    .long 34592, 34608, 34560, 34576, 34656, 34672, 34624, 34640, 35744, 35760, 35712, 35728, 35808, 35824, 35776, 35792
    .long 35872, 35888, 35840, 35856, 35936, 35952, 35904, 35920, 37024, 37040, 36992, 37008, 37088, 37104, 37056, 37072
    .long 38176, 38192, 38144, 38160, 38240, 38256, 38208, 38224, 39328, 39344, 39296, 39312, 39392, 39408, 39360, 39376
    .long 40512, 40528, 40544, 40560, 40448, 40464, 40480, 40496, 41664, 41680, 41696, 41712, 41600, 41616, 41632, 41648
    .long 42816, 42832, 42848, 42864, 42752, 42768, 42784, 42800, 43968, 43984, 44000, 44016, 43904, 43920, 43936, 43952
    .long 44096, 44112, 44128, 44144, 44032, 44048, 44064, 44080, 45248, 45264, 45280, 45296, 45184, 45200, 45216, 45232
    .long 46432, 46448, 46400, 46416, 46368, 46384, 46336, 46352, 47584, 47600, 47552, 47568, 47520, 47536, 47488, 47504
    .long 48736, 48752, 48704, 48720, 48672, 48688, 48640, 48656, 49888, 49904, 49856, 49872, 49824, 49840, 49792, 49808
    .long 51040, 51056, 51008, 51024, 50976, 50992, 50944, 50960, 52192, 52208, 52160, 52176, 52128, 52144, 52096, 52112
    .long 110592, 110608, 110624, 110640, 110656, 110672, 110688, 110704, 111744, 111760, 111776, 111792, 111808, 111824, 111840, 111856
    .long 112896, 112912, 112928, 112944, 112960, 112976, 112992, 113008, 114048, 114064, 114080, 114096, 114112, 114128, 114144, 114160
    .long 115200, 115216, 115232, 115248, 115264, 115280, 115296, 115312, 116352, 116368, 116384, 116400, 116416, 116432, 116448, 116464
    .long 117536, 117552, 117504, 117520, 117600, 117616, 117568, 117584, 118688, 118704, 118656, 118672, 118752, 118768, 118720, 118736
    .long 118816, 118832, 118784, 118800, 118880, 118896, 118848, 118864, 119968, 119984, 119936, 119952, 120032, 120048, 120000, 120016
    .long 121120, 121136, 121088, 121104, 121184, 121200, 121152, 121168, 122272, 122288, 122240, 122256, 122336, 122352, 122304, 122320
    .long 123456, 123472, 123488, 123504, 123392, 123408, 123424, 123440, 124608, 124624, 124640, 124656, 124544, 124560, 124576, 124592
    .long 125760, 125776, 125792, 125808, 125696, 125712, 125728, 125744, 126912, 126928, 126944, 126960, 126848, 126864, 126880, 126896
    .long 127040, 127056, 127072, 127088, 126976, 126992, 127008, 127024, 128192, 128208, 128224, 128240, 128128, 128144, 128160, 128176
    .long 129376, 129392, 129344, 129360, 129312, 129328, 129280, 129296, 130528, 130544, 130496, 130512, 130464, 130480, 130432, 130448
    .long 131680, 131696, 131648, 131664, 131616, 131632, 131584, 131600, 132832, 132848, 132800, 132816, 132768, 132784, 132736, 132752
    .long 133984, 134000, 133952, 133968, 133920, 133936, 133888, 133904, 135136, 135152, 135104, 135120, 135072, 135088, 135040, 135056
    .long 138240, 138256, 138272, 138288, 138304, 138320, 138336, 138352, 139392, 139408, 139424, 139440, 139456, 139472, 139488, 139504
    .long 140544, 140560, 140576, 140592, 140608, 140624, 140640, 140656, 141696, 141712, 141728, 141744, 141760, 141776, 141792, 141808
    .long 142848, 142864, 142880, 142896, 142912, 142928, 142944, 142960, 144000, 144016, 144032, 144048, 144064, 144080, 144096, 144112
    .long 145184, 145200, 145152, 145168, 145248, 145264, 145216, 145232, 146336, 146352, 146304, 146320, 146400, 146416, 146368, 146384
    .long 146464, 146480, 146432, 146448, 146528, 146544, 146496, 146512, 147616, 147632, 147584, 147600, 147680, 147696, 147648, 147664
    .long 148768, 148784, 148736, 148752, 148832, 148848, 148800, 148816, 149920, 149936, 149888, 149904, 149984, 150000, 149952, 149968
    .long 151104, 151120, 151136, 151152, 151040, 151056, 151072, 151088, 152256, 152272, 152288, 152304, 152192, 152208, 152224, 152240
    .long 153408, 153424, 153440, 153456, 153344, 153360, 153376, 153392, 154560, 154576, 154592, 154608, 154496, 154512, 154528, 154544
    .long 154688, 154704, 154720, 154736, 154624, 154640, 154656, 154672, 155840, 155856, 155872, 155888, 155776, 155792, 155808, 155824
    .long 157024, 157040, 156992, 157008, 156960, 156976, 156928, 156944, 158176, 158192, 158144, 158160, 158112, 158128, 158080, 158096
    .long 159328, 159344, 159296, 159312, 159264, 159280, 159232, 159248, 160480, 160496, 160448, 160464, 160416, 160432, 160384, 160400
    .long 161632, 161648, 161600, 161616, 161568, 161584, 161536, 161552, 162784, 162800, 162752, 162768, 162720, 162736, 162688, 162704
    .long 0, 8, 16, 24, 384, 392, 400, 408, 800, 808, 816, 824, 1184, 1192, 1200, 1208
    .long 1600, 1608, 1616, 1624, 1984, 1992, 2000, 2008, 2400, 2408, 2416, 2424, 2784, 2792, 2800, 2808
    .long 3072, 3080, 3088, 3096, 3456, 3464, 3472, 3480, 3872, 3880, 3888, 3896, 4256, 4264, 4272, 4280
    .long 4672, 4680, 4688, 4696, 5056, 5064, 5072, 5080, 5472, 5480, 5488, 5496, 5856, 5864, 5872, 5880
    .long 32, 40, 48, 56, 416, 424, 432, 440, 768, 776, 784, 792, 1152, 1160, 1168, 1176
    .long 1632, 1640, 1648, 1656, 2016, 2024, 2032, 2040, 2368, 2376, 2384, 2392, 2752, 2760, 2768, 2776
    .long 3104, 3112, 3120, 3128, 3488, 3496, 3504, 3512, 3840, 3848, 3856, 3864, 4224, 4232, 4240, 4248
    .long 4704, 4712, 4720, 4728, 5088, 5096, 5104, 5112, 5440, 5448, 5456, 5464, 5824, 5832, 5840, 5848
    .long 64, 128, 136, 144, 448, 512, 520, 528, 864, 928, 936, 944, 1248, 1312, 1320, 1328
    .long 1536, 1728, 1736, 1744, 1920, 2112, 2120, 2128, 2336, 2528, 2536, 2544, 2720, 2912, 2920, 2928
    .long 3136, 3200, 3208, 3216, 3520, 3584, 3592, 3600, 3936, 4000, 4008, 4016, 4320, 4384, 4392, 4400
    .long 4608, 4800, 4808, 4816, 4992, 5184, 5192, 5200, 5408, 5600, 5608, 5616, 5792, 5984, 5992, 6000
    .long 152, 160, 168, 176, 536, 544, 552, 560, 952, 896, 904, 912, 1336, 1280, 1288, 1296
    .long 1752, 1760, 1768, 1776, 2136, 2144, 2152, 2160, 2552, 2496, 2504, 2512, 2936, 2880, 2888, 2896
    .long 3224, 3232, 3240, 3248, 3608, 3616, 3624, 3632, 4024, 3968, 3976, 3984, 4408, 4352, 4360, 4368
    .long 4824, 4832, 4840, 4848, 5208, 5216, 5224, 5232, 5624, 5568, 5576, 5584, 6008, 5952, 5960, 5968
    .long 184, 192, 256, 264, 568, 576, 640, 648, 920, 992, 1056, 1064, 1304, 1376, 1440, 1448
    .long 1784, 1664, 1856, 1864, 2168, 2048, 2240, 2248, 2520, 2464, 2656, 2664, 2904, 2848, 3040, 3048
    .long 3256, 3264, 3328, 3336, 3640, 3648, 3712, 3720, 3992, 4064, 4128, 4136, 4376, 4448, 4512, 4520
    .long 4856, 4736, 4928, 4936, 5240, 5120, 5312, 5320, 5592, 5536, 5728, 5736, 5976, 5920, 6112, 6120
    .long 272, 280, 288, 296, 656, 664, 672, 680, 1072, 1080, 1024, 1032, 1456, 1464, 1408, 1416
    .long 1872, 1880, 1888, 1896, 2256, 2264, 2272, 2280, 2672, 2680, 2624, 2632, 3056, 3064, 3008, 3016
    .long 3344, 3352, 3360, 3368, 3728, 3736, 3744, 3752, 4144, 4152, 4096, 4104, 4528, 4536, 4480, 4488
    .long 4944, 4952, 4960, 4968, 5328, 5336, 5344, 5352, 5744, 5752, 5696, 5704, 6128, 6136, 6080, 6088
    .long 304, 312, 320, 320, 688, 696, 704, 704, 1040, 1048, 1120, 1120, 1424, 1432, 1504, 1504
    .long 1904, 1912, 1792, 1792, 2288, 2296, 2176, 2176, 2640, 2648, 2592, 2592, 3024, 3032, 2976, 2976
    .long 3376, 3384, 3392, 3392, 3760, 3768, 3776, 3776, 4112, 4120, 4192, 4192, 4496, 4504, 4576, 4576
    .long 4976, 4984, 4864, 4864, 5360, 5368, 5248, 5248, 5712, 5720, 5664, 5664, 6096, 6104, 6048, 6048
    .long 8, 16, 24, 32, 392, 400, 408, 416, 808, 816, 824, 768, 1192, 1200, 1208, 1152
    .long 1608, 1616, 1624, 1632, 1992, 2000, 2008, 2016, 2408, 2416, 2424, 2368, 2792, 2800, 2808, 2752
    .long 3080, 3088, 3096, 3104, 3464, 3472, 3480, 3488, 3880, 3888, 3896, 3840, 4264, 4272, 4280, 4224
    .long 4680, 4688, 4696, 4704, 5064, 5072, 5080, 5088, 5480, 5488, 5496, 5440, 5864, 5872, 5880, 5824
    .long 40, 48, 56, 64, 424, 432, 440, 448, 776, 784, 792, 864, 1160, 1168, 1176, 1248
    .long 1640, 1648, 1656, 1536, 2024, 2032, 2040, 1920, 2376, 2384, 2392, 2336, 2760, 2768, 2776, 2720
    .long 3112, 3120, 3128, 3136, 3496, 3504, 3512, 3520, 3848, 3856, 3864, 3936, 4232, 4240, 4248, 4320
    .long 4712, 4720, 4728, 4608, 5096, 5104, 5112, 4992, 5448, 5456, 5464, 5408, 5832, 5840, 5848, 5792
    .long 72, 136, 144, 152, 456, 520, 528, 536, 872, 936, 944, 952, 1256, 1320, 1328, 1336
    .long 1544, 1736, 1744, 1752, 1928, 2120, 2128, 2136, 2344, 2536, 2544, 2552, 2728, 2920, 2928, 2936
    .long 3144, 3208, 3216, 3224, 3528, 3592, 3600, 3608, 3944, 4008, 4016, 4024, 4328, 4392, 4400, 4408
    .long 4616, 4808, 4816, 4824, 5000, 5192, 5200, 5208, 5416, 5608, 5616, 5624, 5800, 5992, 6000, 6008
    .long 160, 168, 176, 184, 544, 552, 560, 568, 896, 904, 912, 920, 1280, 1288, 1296, 1304
    .long 1760, 1768, 1776, 1784, 2144, 2152, 2160, 2168, 2496, 2504, 2512, 2520, 2880, 2888, 2896, 2904
    .long 3232, 3240, 3248, 3256, 3616, 3624, 3632, 3640, 3968, 3976, 3984, 3992, 4352, 4360, 4368, 4376
    .long 4832, 4840, 4848, 4856, 5216, 5224, 5232, 5240, 5568, 5576, 5584, 5592, 5952, 5960, 5968, 5976
    .long 192, 200, 264, 272, 576, 584, 648, 656, 992, 1000, 1064, 1072, 1376, 1384, 1448, 1456
    .long 1664, 1672, 1864, 1872, 2048, 2056, 2248, 2256, 2464, 2472, 2664, 2672, 2848, 2856, 3048, 3056
    .long 3264, 3272, 3336, 3344, 3648, 3656, 3720, 3728, 4064, 4072, 4136, 4144, 4448, 4456, 4520, 4528
    .long 4736, 4744, 4936, 4944, 5120, 5128, 5320, 5328, 5536, 5544, 5736, 5744, 5920, 5928, 6120, 6128
    .long 280, 288, 296, 304, 664, 672, 680, 688, 1080, 1024, 1032, 1040, 1464, 1408, 1416, 1424
    .long 1880, 1888, 1896, 1904, 2264, 2272, 2280, 2288, 2680, 2624, 2632, 2640, 3064, 3008, 3016, 3024
    .long 3352, 3360, 3368, 3376, 3736, 3744, 3752, 3760, 4152, 4096, 4104, 4112, 4536, 4480, 4488, 4496
    .long 4952, 4960, 4968, 4976, 5336, 5344, 5352, 5360, 5752, 5696, 5704, 5712, 6136, 6080, 6088, 6096
    .long 312, 320, 328, 328, 696, 704, 712, 712, 1048, 1120, 1128, 1128, 1432, 1504, 1512, 1512
    .long 1912, 1792, 1800, 1800, 2296, 2176, 2184, 2184, 2648, 2592, 2600, 2600, 3032, 2976, 2984, 2984
    .long 3384, 3392, 3400, 3400, 3768, 3776, 3784, 3784, 4120, 4192, 4200, 4200, 4504, 4576, 4584, 4584
    .long 4984, 4864, 4872, 4872, 5368, 5248, 5256, 5256, 5720, 5664, 5672, 5672, 6104, 6048, 6056, 6056
    .long 16, 24, 32, 40, 400, 408, 416, 424, 816, 824, 768, 776, 1200, 1208, 1152, 1160
    .long 1616, 1624, 1632, 1640, 2000, 2008, 2016, 2024, 2416, 2424, 2368, 2376, 2800, 2808, 2752, 2760
    .long 3088, 3096, 3104, 3112, 3472, 3480, 3488, 3496, 3888, 3896, 3840, 3848, 4272, 4280, 4224, 4232
    .long 4688, 4696, 4704, 4712, 5072, 5080, 5088, 5096, 5488, 5496, 5440, 5448, 5872, 5880, 5824, 5832
    .long 48, 56, 64, 72, 432, 440, 448, 456, 784, 792, 864, 872, 1168, 1176, 1248, 1256
    .long 1648, 1656, 1536, 1544, 2032, 2040, 1920, 1928, 2384, 2392, 2336, 2344, 2768, 2776, 2720, 2728
    .long 3120, 3128, 3136, 3144, 3504, 3512, 3520, 3528, 3856, 3864, 3936, 3944, 4240, 4248, 4320, 4328
    .long 4720, 4728, 4608, 4616, 5104, 5112, 4992, 5000, 5456, 5464, 5408, 5416, 5840, 5848, 5792, 5800
    .long 80, 144, 152, 160, 464, 528, 536, 544, 880, 944, 952, 896, 1264, 1328, 1336, 1280
    .long 1552, 1744, 1752, 1760, 1936, 2128, 2136, 2144, 2352, 2544, 2552, 2496, 2736, 2928, 2936, 2880
    .long 3152, 3216, 3224, 3232, 3536, 3600, 3608, 3616, 3952, 4016, 4024, 3968, 4336, 4400, 4408, 4352
    .long 4624, 4816, 4824, 4832, 5008, 5200, 5208, 5216, 5424, 5616, 5624, 5568, 5808, 6000, 6008, 5952
    .long 168, 176, 184, 192, 552, 560, 568, 576, 904, 912, 920, 992, 1288, 1296, 1304, 1376
    .long 1768, 1776, 1784, 1664, 2152, 2160, 2168, 2048, 2504, 2512, 2520, 2464, 2888, 2896, 2904, 2848
    .long 3240, 3248, 3256, 3264, 3624, 3632, 3640, 3648, 3976, 3984, 3992, 4064, 4360, 4368, 4376, 4448
    .long 4840, 4848, 4856, 4736, 5224, 5232, 5240, 5120, 5576, 5584, 5592, 5536, 5960, 5968, 5976, 5920
    .long 200, 208, 272, 280, 584, 592, 656, 664, 1000, 1008, 1072, 1080, 1384, 1392, 1456, 1464
    .long 1672, 1680, 1872, 1880, 2056, 2064, 2256, 2264, 2472, 2480, 2672, 2680, 2856, 2864, 3056, 3064
    .long 3272, 3280, 3344, 3352, 3656, 3664, 3728, 3736, 4072, 4080, 4144, 4152, 4456, 4464, 4528, 4536
    .long 4744, 4752, 4944, 4952, 5128, 5136, 5328, 5336, 5544, 5552, 5744, 5752, 5928, 5936, 6128, 6136
    .long 288, 296, 304, 312, 672, 680, 688, 696, 1024, 1032, 1040, 1048, 1408, 1416, 1424, 1432
    .long 1888, 1896, 1904, 1912, 2272, 2280, 2288, 2296, 2624, 2632, 2640, 2648, 3008, 3016, 3024, 3032
    .long 3360, 3368, 3376, 3384, 3744, 3752, 3760, 3768, 4096, 4104, 4112, 4120, 4480, 4488, 4496, 4504
    .long 4960, 4968, 4976, 4984, 5344, 5352, 5360, 5368, 5696, 5704, 5712, 5720, 6080, 6088, 6096, 6104
    .long 320, 328, 336, 336, 704, 712, 720, 720, 1120, 1128, 1136, 1136, 1504, 1512, 1520, 1520
    .long 1792, 1800, 1808, 1808, 2176, 2184, 2192, 2192, 2592, 2600, 2608, 2608, 2976, 2984, 2992, 2992
    .long 3392, 3400, 3408, 3408, 3776, 3784, 3792, 3792, 4192, 4200, 4208, 4208, 4576, 4584, 4592, 4592
    .long 4864, 4872, 4880, 4880, 5248, 5256, 5264, 5264, 5664, 5672, 5680, 5680, 6048, 6056, 6064, 6064
    .long 24, 32, 40, 48, 408, 416, 424, 432, 824, 768, 776, 784, 1208, 1152, 1160, 1168
    .long 1624, 1632, 1640, 1648, 2008, 2016, 2024, 2032, 2424, 2368, 2376, 2384, 2808, 2752, 2760, 2768
    .long 3096, 3104, 3112, 3120, 3480, 3488, 3496, 3504, 3896, 3840, 3848, 3856, 4280, 4224, 4232, 4240
    .long 4696, 4704, 4712, 4720, 5080, 5088, 5096, 5104, 5496, 5440, 5448, 5456, 5880, 5824, 5832, 5840
    .long 56, 64, 72, 80, 440, 448, 456, 464, 792, 864, 872, 880, 1176, 1248, 1256, 1264
    .long 1656, 1536, 1544, 1552, 2040, 1920, 1928, 1936, 2392, 2336, 2344, 2352, 2776, 2720, 2728, 2736
    .long 3128, 3136, 3144, 3152, 3512, 3520, 3528, 3536, 3864, 3936, 3944, 3952, 4248, 4320, 4328, 4336
    .long 4728, 4608, 4616, 4624, 5112, 4992, 5000, 5008, 5464, 5408, 5416, 5424, 5848, 5792, 5800, 5808
    .long 88, 152, 160, 168, 472, 536, 544, 552, 888, 952, 896, 904, 1272, 1336, 1280, 1288
    .long 1560, 1752, 1760, 1768, 1944, 2136, 2144, 2152, 2360, 2552, 2496, 2504, 2744, 2936, 2880, 2888
    .long 3160, 3224, 3232, 3240, 3544, 3608, 3616, 3624, 3960, 4024, 3968, 3976, 4344, 4408, 4352, 4360
    .long 4632, 4824, 4832, 4840, 5016, 5208, 5216, 5224, 5432, 5624, 5568, 5576, 5816, 6008, 5952, 5960
    .long 176, 184, 192, 200, 560, 568, 576, 584, 912, 920, 992, 1000, 1296, 1304, 1376, 1384
    .long 1776, 1784, 1664, 1672, 2160, 2168, 2048, 2056, 2512, 2520, 2464, 2472, 2896, 2904, 2848, 2856
    .long 3248, 3256, 3264, 3272, 3632, 3640, 3648, 3656, 3984, 3992, 4064, 4072, 4368, 4376, 4448, 4456
    .long 4848, 4856, 4736, 4744, 5232, 5240, 5120, 5128, 5584, 5592, 5536, 5544, 5968, 5976, 5920, 5928
    .long 208, 216, 280, 288, 592, 600, 664, 672, 1008, 1016, 1080, 1024, 1392, 1400, 1464, 1408
    .long 1680, 1688, 1880, 1888, 2064, 2072, 2264, 2272, 2480, 2488, 2680, 2624, 2864, 2872, 3064, 3008
    .long 3280, 3288, 3352, 3360, 3664, 3672, 3736, 3744, 4080, 4088, 4152, 4096, 4464, 4472, 4536, 4480
    .long 4752, 4760, 4952, 4960, 5136, 5144, 5336, 5344, 5552, 5560, 5752, 5696, 5936, 5944, 6136, 6080
    .long 296, 304, 312, 320, 680, 688, 696, 704, 1032, 1040, 1048, 1120, 1416, 1424, 1432, 1504
    .long 1896, 1904, 1912, 1792, 2280, 2288, 2296, 2176, 2632, 2640, 2648, 2592, 3016, 3024, 3032, 2976
    .long 3368, 3376, 3384, 3392, 3752, 3760, 3768, 3776, 4104, 4112, 4120, 4192, 4488, 4496, 4504, 4576
    .long 4968, 4976, 4984, 4864, 5352, 5360, 5368, 5248, 5704, 5712, 5720, 5664, 6088, 6096, 6104, 6048
    .long 328, 336, 344, 344, 712, 720, 728, 728, 1128, 1136, 1144, 1144, 1512, 1520, 1528, 1528
    .long 1800, 1808, 1816, 1816, 2184, 2192, 2200, 2200, 2600, 2608, 2616, 2616, 2984, 2992, 3000, 3000
    .long 3400, 3408, 3416, 3416, 3784, 3792, 3800, 3800, 4200, 4208, 4216, 4216, 4584, 4592, 4600, 4600
    .long 4872, 4880, 4888, 4888, 5256, 5264, 5272, 5272, 5672, 5680, 5688, 5688, 6056, 6064, 6072, 6072
    .long 32, 40, 48, 56, 416, 424, 432, 440, 768, 776, 784, 792, 1152, 1160, 1168, 1176
    .long 1632, 1640, 1648, 1656, 2016, 2024, 2032, 2040, 2368, 2376, 2384, 2392, 2752, 2760, 2768, 2776
    .long 3104, 3112, 3120, 3128, 3488, 3496, 3504, 3512, 3840, 3848, 3856, 3864, 4224, 4232, 4240, 4248
    .long 4704, 4712, 4720, 4728, 5088, 5096, 5104, 5112, 5440, 5448, 5456, 5464, 5824, 5832, 5840, 5848
    .long 64, 72, 80, 88, 448, 456, 464, 472, 864, 872, 880, 888, 1248, 1256, 1264, 1272
    .long 1536, 1544, 1552, 1560, 1920, 1928, 1936, 1944, 2336, 2344, 2352, 2360, 2720, 2728, 2736, 2744
    .long 3136, 3144, 3152, 3160, 3520, 3528, 3536, 3544, 3936, 3944, 3952, 3960, 4320, 4328, 4336, 4344
    .long 4608, 4616, 4624, 4632, 4992, 5000, 5008, 5016, 5408, 5416, 5424, 5432, 5792, 5800, 5808, 5816
    .long 96, 160, 168, 176, 480, 544, 552, 560, 832, 896, 904, 912, 1216, 1280, 1288, 1296
    .long 1568, 1760, 1768, 1776, 1952, 2144, 2152, 2160, 2304, 2496, 2504, 2512, 2688, 2880, 2888, 2896
    .long 3168, 3232, 3240, 3248, 3552, 3616, 3624, 3632, 3904, 3968, 3976, 3984, 4288, 4352, 4360, 4368
    .long 4640, 4832, 4840, 4848, 5024, 5216, 5224, 5232, 5376, 5568, 5576, 5584, 5760, 5952, 5960, 5968
    .long 184, 192, 200, 208, 568, 576, 584, 592, 920, 992, 1000, 1008, 1304, 1376, 1384, 1392
    .long 1784, 1664, 1672, 1680, 2168, 2048, 2056, 2064, 2520, 2464, 2472, 2480, 2904, 2848, 2856, 2864
    .long 3256, 3264, 3272, 3280, 3640, 3648, 3656, 3664, 3992, 4064, 4072, 4080, 4376, 4448, 4456, 4464
    .long 4856, 4736, 4744, 4752, 5240, 5120, 5128, 5136, 5592, 5536, 5544, 5552, 5976, 5920, 5928, 5936
    .long 216, 224, 288, 296, 600, 608, 672, 680, 1016, 960, 1024, 1032, 1400, 1344, 1408, 1416
    .long 1688, 1696, 1888, 1896, 2072, 2080, 2272, 2280, 2488, 2432, 2624, 2632, 2872, 2816, 3008, 3016
    .long 3288, 3296, 3360, 3368, 3672, 3680, 3744, 3752, 4088, 4032, 4096, 4104, 4472, 4416, 4480, 4488
    .long 4760, 4768, 4960, 4968, 5144, 5152, 5344, 5352, 5560, 5504, 5696, 5704, 5944, 5888, 6080, 6088
    .long 304, 312, 320, 328, 688, 696, 704, 712, 1040, 1048, 1120, 1128, 1424, 1432, 1504, 1512
    .long 1904, 1912, 1792, 1800, 2288, 2296, 2176, 2184, 2640, 2648, 2592, 2600, 3024, 3032, 2976, 2984
    .long 3376, 3384, 3392, 3400, 3760, 3768, 3776, 3784, 4112, 4120, 4192, 4200, 4496, 4504, 4576, 4584
    .long 4976, 4984, 4864, 4872, 5360, 5368, 5248, 5256, 5712, 5720, 5664, 5672, 6096, 6104, 6048, 6056
    .long 336, 344, 352, 352, 720, 728, 736, 736, 1136, 1144, 1088, 1088, 1520, 1528, 1472, 1472
    .long 1808, 1816, 1824, 1824, 2192, 2200, 2208, 2208, 2608, 2616, 2560, 2560, 2992, 3000, 2944, 2944
    .long 3408, 3416, 3424, 3424, 3792, 3800, 3808, 3808, 4208, 4216, 4160, 4160, 4592, 4600, 4544, 4544
    .long 4880, 4888, 4896, 4896, 5264, 5272, 5280, 5280, 5680, 5688, 5632, 5632, 6064, 6072, 6016, 6016
    .long 40, 48, 56, 64, 424, 432, 440, 448, 776, 784, 792, 864, 1160, 1168, 1176, 1248
    .long 1640, 1648, 1656, 1536, 2024, 2032, 2040, 1920, 2376, 2384, 2392, 2336, 2760, 2768, 2776, 2720
    .long 3112, 3120, 3128, 3136, 3496, 3504, 3512, 3520, 3848, 3856, 3864, 3936, 4232, 4240, 4248, 4320
    .long 4712, 4720, 4728, 4608, 5096, 5104, 5112, 4992, 5448, 5456, 5464, 5408, 5832, 5840, 5848, 5792
    .long 72, 80, 88, 96, 456, 464, 472, 480, 872, 880, 888, 832, 1256, 1264, 1272, 1216
    .long 1544, 1552, 1560, 1568, 1928, 1936, 1944, 1952, 2344, 2352, 2360, 2304, 2728, 2736, 2744, 2688
    .long 3144, 3152, 3160, 3168, 3528, 3536, 3544, 3552, 3944, 3952, 3960, 3904, 4328, 4336, 4344, 4288
    .long 4616, 4624, 4632, 4640, 5000, 5008, 5016, 5024, 5416, 5424, 5432, 5376, 5800, 5808, 5816, 5760
    .long 104, 168, 176, 184, 488, 552, 560, 568, 840, 904, 912, 920, 1224, 1288, 1296, 1304
    .long 1576, 1768, 1776, 1784, 1960, 2152, 2160, 2168, 2312, 2504, 2512, 2520, 2696, 2888, 2896, 2904
    .long 3176, 3240, 3248, 3256, 3560, 3624, 3632, 3640, 3912, 3976, 3984, 3992, 4296, 4360, 4368, 4376
    .long 4648, 4840, 4848, 4856, 5032, 5224, 5232, 5240, 5384, 5576, 5584, 5592, 5768, 5960, 5968, 5976
    .long 192, 200, 208, 216, 576, 584, 592, 600, 992, 1000, 1008, 1016, 1376, 1384, 1392, 1400
    .long 1664, 1672, 1680, 1688, 2048, 2056, 2064, 2072, 2464, 2472, 2480, 2488, 2848, 2856, 2864, 2872
    .long 3264, 3272, 3280, 3288, 3648, 3656, 3664, 3672, 4064, 4072, 4080, 4088, 4448, 4456, 4464, 4472
    .long 4736, 4744, 4752, 4760, 5120, 5128, 5136, 5144, 5536, 5544, 5552, 5560, 5920, 5928, 5936, 5944
    .long 224, 232, 296, 304, 608, 616, 680, 688, 960, 968, 1032, 1040, 1344, 1352, 1416, 1424
    .long 1696, 1704, 1896, 1904, 2080, 2088, 2280, 2288, 2432, 2440, 2632, 2640, 2816, 2824, 3016, 3024
    .long 3296, 3304, 3368, 3376, 3680, 3688, 3752, 3760, 4032, 4040, 4104, 4112, 4416, 4424, 4488, 4496
    .long 4768, 4776, 4968, 4976, 5152, 5160, 5352, 5360, 5504, 5512, 5704, 5712, 5888, 5896, 6088, 6096
    .long 312, 320, 328, 336, 696, 704, 712, 720, 1048, 1120, 1128, 1136, 1432, 1504, 1512, 1520
    .long 1912, 1792, 1800, 1808, 2296, 2176, 2184, 2192, 2648, 2592, 2600, 2608, 3032, 2976, 2984, 2992
    .long 3384, 3392, 3400, 3408, 3768, 3776, 3784, 3792, 4120, 4192, 4200, 4208, 4504, 4576, 4584, 4592
    .long 4984, 4864, 4872, 4880, 5368, 5248, 5256, 5264, 5720, 5664, 5672, 5680, 6104, 6048, 6056, 6064
    .long 344, 352, 360, 360, 728, 736, 744, 744, 1144, 1088, 1096, 1096, 1528, 1472, 1480, 1480
    .long 1816, 1824, 1832, 1832, 2200, 2208, 2216, 2216, 2616, 2560, 2568, 2568, 3000, 2944, 2952, 2952
    .long 3416, 3424, 3432, 3432, 3800, 3808, 3816, 3816, 4216, 4160, 4168, 4168, 4600, 4544, 4552, 4552
    .long 4888, 4896, 4904, 4904, 5272, 5280, 5288, 5288, 5688, 5632, 5640, 5640, 6072, 6016, 6024, 6024
    .long 48, 56, 64, 72, 432, 440, 448, 456, 784, 792, 864, 872, 1168, 1176, 1248, 1256
    .long 1648, 1656, 1536, 1544, 2032, 2040, 1920, 1928, 2384, 2392, 2336, 2344, 2768, 2776, 2720, 2728
    .long 3120, 3128, 3136, 3144, 3504, 3512, 3520, 3528, 3856, 3864, 3936, 3944, 4240, 4248, 4320, 4328
    .long 4720, 4728, 4608, 4616, 5104, 5112, 4992, 5000, 5456, 5464, 5408, 5416, 5840, 5848, 5792, 5800
    .long 80, 88, 96, 104, 464, 472, 480, 488, 880, 888, 832, 840, 1264, 1272, 1216, 1224
    .long 1552, 1560, 1568, 1576, 1936, 1944, 1952, 1960, 2352, 2360, 2304, 2312, 2736, 2744, 2688, 2696
    .long 3152, 3160, 3168, 3176, 3536, 3544, 3552, 3560, 3952, 3960, 3904, 3912, 4336, 4344, 4288, 4296
    .long 4624, 4632, 4640, 4648, 5008, 5016, 5024, 5032, 5424, 5432, 5376, 5384, 5808, 5816, 5760, 5768
    .long 112, 176, 184, 192, 496, 560, 568, 576, 848, 912, 920, 992, 1232, 1296, 1304, 1376
    .long 1584, 1776, 1784, 1664, 1968, 2160, 2168, 2048, 2320, 2512, 2520, 2464, 2704, 2896, 2904, 2848
    .long 3184, 3248, 3256, 3264, 3568, 3632, 3640, 3648, 3920, 3984, 3992, 4064, 4304, 4368, 4376, 4448
    .long 4656, 4848, 4856, 4736, 5040, 5232, 5240, 5120, 5392, 5584, 5592, 5536, 5776, 5968, 5976, 5920
    .long 200, 208, 216, 224, 584, 592, 600, 608, 1000, 1008, 1016, 960, 1384, 1392, 1400, 1344
    .long 1672, 1680, 1688, 1696, 2056, 2064, 2072, 2080, 2472, 2480, 2488, 2432, 2856, 2864, 2872, 2816
    .long 3272, 3280, 3288, 3296, 3656, 3664, 3672, 3680, 4072, 4080, 4088, 4032, 4456, 4464, 4472, 4416
    .long 4744, 4752, 4760, 4768, 5128, 5136, 5144, 5152, 5544, 5552, 5560, 5504, 5928, 5936, 5944, 5888
    .long 232, 240, 304, 312, 616, 624, 688, 696, 968, 976, 1040, 1048, 1352, 1360, 1424, 1432
    .long 1704, 1712, 1904, 1912, 2088, 2096, 2288, 2296, 2440, 2448, 2640, 2648, 2824, 2832, 3024, 3032
    .long 3304, 3312, 3376, 3384, 3688, 3696, 3760, 3768, 4040, 4048, 4112, 4120, 4424, 4432, 4496, 4504
    .long 4776, 4784, 4976, 4984, 5160, 5168, 5360, 5368, 5512, 5520, 5712, 5720, 5896, 5904, 6096, 6104
    .long 320, 328, 336, 344, 704, 712, 720, 728, 1120, 1128, 1136, 1144, 1504, 1512, 1520, 1528
    .long 1792, 1800, 1808, 1816, 2176, 2184, 2192, 2200, 2592, 2600, 2608, 2616, 2976, 2984, 2992, 3000
    .long 3392, 3400, 3408, 3416, 3776, 3784, 3792, 3800, 4192, 4200, 4208, 4216, 4576, 4584, 4592, 4600
    .long 4864, 4872, 4880, 4888, 5248, 5256, 5264, 5272, 5664, 5672, 5680, 5688, 6048, 6056, 6064, 6072
    .long 352, 360, 368, 368, 736, 744, 752, 752, 1088, 1096, 1104, 1104, 1472, 1480, 1488, 1488
    .long 1824, 1832, 1840, 1840, 2208, 2216, 2224, 2224, 2560, 2568, 2576, 2576, 2944, 2952, 2960, 2960
    .long 3424, 3432, 3440, 3440, 3808, 3816, 3824, 3824, 4160, 4168, 4176, 4176, 4544, 4552, 4560, 4560
    .long 4896, 4904, 4912, 4912, 5280, 5288, 5296, 5296, 5632, 5640, 5648, 5648, 6016, 6024, 6032, 6032
    .long 56, 64, 72, 80, 440, 448, 456, 464, 792, 864, 872, 880, 1176, 1248, 1256, 1264
    .long 1656, 1536, 1544, 1552, 2040, 1920, 1928, 1936, 2392, 2336, 2344, 2352, 2776, 2720, 2728, 2736
    .long 3128, 3136, 3144, 3152, 3512, 3520, 3528, 3536, 3864, 3936, 3944, 3952, 4248, 4320, 4328, 4336
    .long 4728, 4608, 4616, 4624, 5112, 4992, 5000, 5008, 5464, 5408, 5416, 5424, 5848, 5792, 5800, 5808
    .long 88, 96, 104, 112, 472, 480, 488, 496, 888, 832, 840, 848, 1272, 1216, 1224, 1232
    .long 1560, 1568, 1576, 1584, 1944, 1952, 1960, 1968, 2360, 2304, 2312, 2320, 2744, 2688, 2696, 2704
    .long 3160, 3168, 3176, 3184, 3544, 3552, 3560, 3568, 3960, 3904, 3912, 3920, 4344, 4288, 4296, 4304
    .long 4632, 4640, 4648, 4656, 5016, 5024, 5032, 5040, 5432, 5376, 5384, 5392, 5816, 5760, 5768, 5776
    .long 120, 184, 192, 200, 504, 568, 576, 584, 856, 920, 992, 1000, 1240, 1304, 1376, 1384
    .long 1592, 1784, 1664, 1672, 1976, 2168, 2048, 2056, 2328, 2520, 2464, 2472, 2712, 2904, 2848, 2856
    .long 3192, 3256, 3264, 3272, 3576, 3640, 3648, 3656, 3928, 3992, 4064, 4072, 4312, 4376, 4448, 4456
    .long 4664, 4856, 4736, 4744, 5048, 5240, 5120, 5128, 5400, 5592, 5536, 5544, 5784, 5976, 5920, 5928
    .long 208, 216, 224, 232, 592, 600, 608, 616, 1008, 1016, 960, 968, 1392, 1400, 1344, 1352
    .long 1680, 1688, 1696, 1704, 2064, 2072, 2080, 2088, 2480, 2488, 2432, 2440, 2864, 2872, 2816, 2824
    .long 3280, 3288, 3296, 3304, 3664, 3672, 3680, 3688, 4080, 4088, 4032, 4040, 4464, 4472, 4416, 4424
    .long 4752, 4760, 4768, 4776, 5136, 5144, 5152, 5160, 5552, 5560, 5504, 5512, 5936, 5944, 5888, 5896
    .long 240, 248, 312, 320, 624, 632, 696, 704, 976, 984, 1048, 1120, 1360, 1368, 1432, 1504
    .long 1712, 1720, 1912, 1792, 2096, 2104, 2296, 2176, 2448, 2456, 2648, 2592, 2832, 2840, 3032, 2976
    .long 3312, 3320, 3384, 3392, 3696, 3704, 3768, 3776, 4048, 4056, 4120, 4192, 4432, 4440, 4504, 4576
    .long 4784, 4792, 4984, 4864, 5168, 5176, 5368, 5248, 5520, 5528, 5720, 5664, 5904, 5912, 6104, 6048
    .long 328, 336, 344, 352, 712, 720, 728, 736, 1128, 1136, 1144, 1088, 1512, 1520, 1528, 1472
    .long 1800, 1808, 1816, 1824, 2184, 2192, 2200, 2208, 2600, 2608, 2616, 2560, 2984, 2992, 3000, 2944
    .long 3400, 3408, 3416, 3424, 3784, 3792, 3800, 3808, 4200, 4208, 4216, 4160, 4584, 4592, 4600, 4544
    .long 4872, 4880, 4888, 4896, 5256, 5264, 5272, 5280, 5672, 5680, 5688, 5632, 6056, 6064, 6072, 6016
    .long 360, 368, 376, 376, 744, 752, 760, 760, 1096, 1104, 1112, 1112, 1480, 1488, 1496, 1496
    .long 1832, 1840, 1848, 1848, 2216, 2224, 2232, 2232, 2568, 2576, 2584, 2584, 2952, 2960, 2968, 2968
    .long 3432, 3440, 3448, 3448, 3816, 3824, 3832, 3832, 4168, 4176, 4184, 4184, 4552, 4560, 4568, 4568
    .long 4904, 4912, 4920, 4920, 5288, 5296, 5304, 5304, 5640, 5648, 5656, 5656, 6024, 6032, 6040, 6040
    .long 0, 0, 0, 0, 0, 0, 0, 0, 0, 0, 0, 0, 0, 0, 0, 0
    .long 8, 8, 8, 8, 8, 8, 8, 8, 8, 8, 8, 8, 8, 8, 8, 8
    .long 16, 16, 16, 16, 16, 16, 16, 16, 16, 16, 16, 16, 16, 16, 16, 16
    .long 24, 24, 24, 24, 24, 24, 24, 24, 24, 24, 24, 24, 24, 24, 24, 24
    .long 4, 4, 4, 4, 4, 4, 4, 4, 4, 4, 4, 4, 4, 4, 4, 4
    .long 12, 12, 12, 12, 12, 12, 12, 12, 12, 12, 12, 12, 12, 12, 12, 12
    .long 20, 20, 20, 20, 20, 20, 20, 20, 20, 20, 20, 20, 20, 20, 20, 20
    .long 28, 28, 28, 28, 28, 28, 28, 28, 28, 28, 28, 28, 28, 28, 28, 28
    .long 32, 32, 32, 32, 32, 32, 32, 32, 32, 32, 32, 32, 32, 32, 32, 32
    .long 6820, 6820, 6820, 6820, 6820, 6820, 6820, 6820, 6820, 6820, 6820, 6820, 6820, 6820, 6820, 6820
    .long 6828, 6828, 6828, 6828, 6828, 6828, 6828, 6828, 6828, 6828, 6828, 6828, 6828, 6828, 6828, 6828
    .long 6836, 6836, 6836, 6836, 6836, 6836, 6836, 6836, 6836, 6836, 6836, 6836, 6836, 6836, 6836, 6836
    .long 6816, 6816, 6816, 6816, 6816, 6816, 6816, 6816, 6816, 6816, 6816, 6816, 6816, 6816, 6816, 6816
    .long 6824, 6824, 6824, 6824, 6824, 6824, 6824, 6824, 6824, 6824, 6824, 6824, 6824, 6824, 6824, 6824
    .long 6832, 6832, 6832, 6832, 6832, 6832, 6832, 6832, 6832, 6832, 6832, 6832, 6832, 6832, 6832, 6832
    .long 6840, 6840, 6840, 6840, 6840, 6840, 6840, 6840, 6840, 6840, 6840, 6840, 6840, 6840, 6840, 6840
    .long 6844, 6844, 6844, 6844, 6844, 6844, 6844, 6844, 6844, 6844, 6844, 6844, 6844, 6844, 6844, 6844
    .long 13632, 13632, 13632, 13632, 13632, 13632, 13632, 13632, 13632, 13632, 13632, 13632, 13632, 13632, 13632, 13632
    .long 13640, 13640, 13640, 13640, 13640, 13640, 13640, 13640, 13640, 13640, 13640, 13640, 13640, 13640, 13640, 13640
    .long 13648, 13648, 13648, 13648, 13648, 13648, 13648, 13648, 13648, 13648, 13648, 13648, 13648, 13648, 13648, 13648
    .long 6848, 6848, 6848, 6848, 6848, 6848, 6848, 6848, 6848, 6848, 6848, 6848, 6848, 6848, 6848, 6848
    .long 13636, 13636, 13636, 13636, 13636, 13636, 13636, 13636, 13636, 13636, 13636, 13636, 13636, 13636, 13636, 13636
    .long 13644, 13644, 13644, 13644, 13644, 13644, 13644, 13644, 13644, 13644, 13644, 13644, 13644, 13644, 13644, 13644
    .long 13652, 13652, 13652, 13652, 13652, 13652, 13652, 13652, 13652, 13652, 13652, 13652, 13652, 13652, 13652, 13652
    .long 13656, 13656, 13656, 13656, 13656, 13656, 13656, 13656, 13656, 13656, 13656, 13656, 13656, 13656, 13656, 13656
    .long 13664, 13664, 13664, 13664, 13664, 13664, 13664, 13664, 13664, 13664, 13664, 13664, 13664, 13664, 13664, 13664
    .long 20452, 20452, 20452, 20452, 20452, 20452, 20452, 20452, 20452, 20452, 20452, 20452, 20452, 20452, 20452, 20452
    .long 20460, 20460, 20460, 20460, 20460, 20460, 20460, 20460, 20460, 20460, 20460, 20460, 20460, 20460, 20460, 20460
    .long 13660, 13660, 13660, 13660, 13660, 13660, 13660, 13660, 13660, 13660, 13660, 13660, 13660, 13660, 13660, 13660
    .long 20448, 20448, 20448, 20448, 20448, 20448, 20448, 20448, 20448, 20448, 20448, 20448, 20448, 20448, 20448, 20448
    .long 20456, 20456, 20456, 20456, 20456, 20456, 20456, 20456, 20456, 20456, 20456, 20456, 20456, 20456, 20456, 20456
    .long 20464, 20464, 20464, 20464, 20464, 20464, 20464, 20464, 20464, 20464, 20464, 20464, 20464, 20464, 20464, 20464
    .long 20468, 20468, 20468, 20468, 20468, 20468, 20468, 20468, 20468, 20468, 20468, 20468, 20468, 20468, 20468, 20468
    .long 20476, 20476, 20476, 20476, 20476, 20476, 20476, 20476, 20476, 20476, 20476, 20476, 20476, 20476, 20476, 20476
    .long 27264, 27264, 27264, 27264, 27264, 27264, 27264, 27264, 27264, 27264, 27264, 27264, 27264, 27264, 27264, 27264
    .long 27272, 27272, 27272, 27272, 27272, 27272, 27272, 27272, 27272, 27272, 27272, 27272, 27272, 27272, 27272, 27272
    .long 20472, 20472, 20472, 20472, 20472, 20472, 20472, 20472, 20472, 20472, 20472, 20472, 20472, 20472, 20472, 20472
    .long 20480, 20480, 20480, 20480, 20480, 20480, 20480, 20480, 20480, 20480, 20480, 20480, 20480, 20480, 20480, 20480
    .long 27268, 27268, 27268, 27268, 27268, 27268, 27268, 27268, 27268, 27268, 27268, 27268, 27268, 27268, 27268, 27268
    .long 27276, 27276, 27276, 27276, 27276, 27276, 27276, 27276, 27276, 27276, 27276, 27276, 27276, 27276, 27276, 27276
    .long 27280, 27280, 27280, 27280, 27280, 27280, 27280, 27280, 27280, 27280, 27280, 27280, 27280, 27280, 27280, 27280
    .long 27288, 27288, 27288, 27288, 27288, 27288, 27288, 27288, 27288, 27288, 27288, 27288, 27288, 27288, 27288, 27288
    .long 27296, 27296, 27296, 27296, 27296, 27296, 27296, 27296, 27296, 27296, 27296, 27296, 27296, 27296, 27296, 27296
    .long 34084, 34084, 34084, 34084, 34084, 34084, 34084, 34084, 34084, 34084, 34084, 34084, 34084, 34084, 34084, 34084
    .long 27284, 27284, 27284, 27284, 27284, 27284, 27284, 27284, 27284, 27284, 27284, 27284, 27284, 27284, 27284, 27284
    .long 27292, 27292, 27292, 27292, 27292, 27292, 27292, 27292, 27292, 27292, 27292, 27292, 27292, 27292, 27292, 27292
    .long 34080, 34080, 34080, 34080, 34080, 34080, 34080, 34080, 34080, 34080, 34080, 34080, 34080, 34080, 34080, 34080
    .long 34088, 34088, 34088, 34088, 34088, 34088, 34088, 34088, 34088, 34088, 34088, 34088, 34088, 34088, 34088, 34088
    .long 34092, 34092, 34092, 34092, 34092, 34092, 34092, 34092, 34092, 34092, 34092, 34092, 34092, 34092, 34092, 34092
    .long 34100, 34100, 34100, 34100, 34100, 34100, 34100, 34100, 34100, 34100, 34100, 34100, 34100, 34100, 34100, 34100
    .long 34108, 34108, 34108, 34108, 34108, 34108, 34108, 34108, 34108, 34108, 34108, 34108, 34108, 34108, 34108, 34108
    .long 40, 40, 40, 40, 40, 40, 40, 40, 40, 40, 40, 40, 40, 40, 40, 40
    .long 34096, 34096, 34096, 34096, 34096, 34096, 34096, 34096, 34096, 34096, 34096, 34096, 34096, 34096, 34096, 34096
    .long 34104, 34104, 34104, 34104, 34104, 34104, 34104, 34104, 34104, 34104, 34104, 34104, 34104, 34104, 34104, 34104
    .long 34112, 34112, 34112, 34112, 34112, 34112, 34112, 34112, 34112, 34112, 34112, 34112, 34112, 34112, 34112, 34112
    .long 40, 40, 40, 40, 40, 40, 40, 40, 40, 40, 40, 40, 40, 40, 40, 40
    .long 672, 720, 768, 816, 864, 912, 960, 1008, 1056, 1104, 1152, 1200, 1248, 1296, 1344, 1392
    .long 672, 720, 768, 816, 864, 912, 960, 1008, 1056, 1104, 1152, 1200, 1248, 1296, 1344, 1392
    .long 672, 720, 768, 816, 864, 912, 960, 1008, 1056, 1104, 1152, 1200, 1248, 1296, 1344, 1392
    .long 672, 720, 768, 816, 864, 912, 960, 1008, 1056, 1104, 1152, 1200, 1248, 1296, 1344, 1392
    .long 1440, 1488, 1536, 1584, 1632, 1680, 1728, 1776, 1824, 1872, 1920, 1968, 2016, 2064, 2112, 2160
    .long 1440, 1488, 1536, 1584, 1632, 1680, 1728, 1776, 1824, 1872, 1920, 1968, 2016, 2064, 2112, 2160
    .long 1440, 1488, 1536, 1584, 1632, 1680, 1728, 1776, 1824, 1872, 1920, 1968, 2016, 2064, 2112, 2160
    .long 1440, 1488, 1536, 1584, 1632, 1680, 1728, 1776, 1824, 1872, 1920, 1968, 2016, 2064, 2112, 2160
    .long 2208, 2256, 2304, 2352, 2400, 2448, 2496, 2544, 2592, 2640, 2688, 2736, 2784, 2832, 2880, 2928
    .long 2208, 2256, 2304, 2352, 2400, 2448, 2496, 2544, 2592, 2640, 2688, 2736, 2784, 2832, 2880, 2928
    .long 2208, 2256, 2304, 2352, 2400, 2448, 2496, 2544, 2592, 2640, 2688, 2736, 2784, 2832, 2880, 2928
    .long 2208, 2256, 2304, 2352, 2400, 2448, 2496, 2544, 2592, 2640, 2688, 2736, 2784, 2832, 2880, 2928
    .long 2976, 3024, 3072, 3120, 3168, 3216, 3264, 3312, 3360, 3408, 3456, 3504, 3552, 3600, 3648, 3696
    .long 2976, 3024, 3072, 3120, 3168, 3216, 3264, 3312, 3360, 3408, 3456, 3504, 3552, 3600, 3648, 3696
    .long 2976, 3024, 3072, 3120, 3168, 3216, 3264, 3312, 3360, 3408, 3456, 3504, 3552, 3600, 3648, 3696
    .long 2976, 3024, 3072, 3120, 3168, 3216, 3264, 3312, 3360, 3408, 3456, 3504, 3552, 3600, 3648, 3696
    .long 3744, 3792, 3840, 3888, 3936, 3984, 4032, 4080, 4128, 4176, 4224, 4272, 4320, 4368, 4416, 4464
    .long 3744, 3792, 3840, 3888, 3936, 3984, 4032, 4080, 4128, 4176, 4224, 4272, 4320, 4368, 4416, 4464
    .long 3744, 3792, 3840, 3888, 3936, 3984, 4032, 4080, 4128, 4176, 4224, 4272, 4320, 4368, 4416, 4464
    .long 3744, 3792, 3840, 3888, 3936, 3984, 4032, 4080, 4128, 4176, 4224, 4272, 4320, 4368, 4416, 4464
    .long 4512, 4560, 4608, 4656, 4704, 4752, 4800, 4848, 4896, 4944, 4992, 5040, 5088, 5136, 5184, 5232
    .long 4512, 4560, 4608, 4656, 4704, 4752, 4800, 4848, 4896, 4944, 4992, 5040, 5088, 5136, 5184, 5232
    .long 4512, 4560, 4608, 4656, 4704, 4752, 4800, 4848, 4896, 4944, 4992, 5040, 5088, 5136, 5184, 5232
    .long 4512, 4560, 4608, 4656, 4704, 4752, 4800, 4848, 4896, 4944, 4992, 5040, 5088, 5136, 5184, 5232
    .long 5280, 5328, 5376, 5424, 5472, 5520, 5568, 5616, 5664, 5712, 5760, 5808, 5856, 5904, 5952, 6000
    .long 5280, 5328, 5376, 5424, 5472, 5520, 5568, 5616, 5664, 5712, 5760, 5808, 5856, 5904, 5952, 6000
    .long 5280, 5328, 5376, 5424, 5472, 5520, 5568, 5616, 5664, 5712, 5760, 5808, 5856, 5904, 5952, 6000
    .long 5280, 5328, 5376, 5424, 5472, 5520, 5568, 5616, 5664, 5712, 5760, 5808, 5856, 5904, 5952, 6000
    .long 6048, 6096, 6144, 6192, 6240, 6288, 6336, 6384, 6432, 6480, 6528, 6576, 6624, 6672, 6720, 6768
    .long 6048, 6096, 6144, 6192, 6240, 6288, 6336, 6384, 6432, 6480, 6528, 6576, 6624, 6672, 6720, 6768
    .long 6048, 6096, 6144, 6192, 6240, 6288, 6336, 6384, 6432, 6480, 6528, 6576, 6624, 6672, 6720, 6768
    .long 6048, 6096, 6144, 6192, 6240, 6288, 6336, 6384, 6432, 6480, 6528, 6576, 6624, 6672, 6720, 6768
    .long 0, 16, 32, 48, 64, 80, 96, 112, 128, 144, 160, 176, 192, 208, 224, 240
    .long 256, 272, 288, 304, 1152, 1168, 1184, 1200, 1216, 1232, 1248, 1264, 1280, 1296, 1312, 1328
    .long 1344, 1360, 1376, 1392, 1408, 1424, 1440, 1456, 2304, 2320, 2336, 2352, 2368, 2384, 2400, 2416
    .long 2432, 2448, 2464, 2480, 2496, 2512, 2528, 2544, 2560, 2576, 2592, 2608, 3456, 3472, 3488, 3504
    .long 2496, 2512, 2528, 2544, 2560, 2576, 2592, 2608, 2624, 2640, 2656, 2672, 2688, 2704, 2720, 2736
    .long 3616, 3632, 3584, 3600, 3680, 3696, 3648, 3664, 3744, 3760, 3712, 3728, 3808, 3824, 3776, 3792
    .long 3872, 3888, 3840, 3856, 4768, 4784, 4736, 4752, 4832, 4848, 4800, 4816, 4896, 4912, 4864, 4880
    .long 4960, 4976, 4928, 4944, 5024, 5040, 4992, 5008, 5920, 5936, 5888, 5904, 5984, 6000, 5952, 5968
    .long 5024, 5040, 4992, 5008, 5088, 5104, 5056, 5072, 5152, 5168, 5120, 5136, 6048, 6064, 6016, 6032
    .long 6112, 6128, 6080, 6096, 6176, 6192, 6144, 6160, 6240, 6256, 6208, 6224, 6304, 6320, 6272, 6288
    .long 7168, 7184, 7200, 7216, 7232, 7248, 7264, 7280, 7296, 7312, 7328, 7344, 7360, 7376, 7392, 7408
    .long 7424, 7440, 7456, 7472, 8320, 8336, 8352, 8368, 8384, 8400, 8416, 8432, 8448, 8464, 8480, 8496
    .long 7488, 7504, 7520, 7536, 7552, 7568, 7584, 7600, 8448, 8464, 8480, 8496, 8512, 8528, 8544, 8560
    .long 8576, 8592, 8608, 8624, 8640, 8656, 8672, 8688, 8704, 8720, 8736, 8752, 9600, 9616, 9632, 9648
    .long 9664, 9680, 9696, 9712, 9728, 9744, 9760, 9776, 9792, 9808, 9824, 9840, 9856, 9872, 9888, 9904
    .long 10784, 10800, 10752, 10768, 10848, 10864, 10816, 10832, 10912, 10928, 10880, 10896, 10976, 10992, 10944, 10960
    .long 14112, 14128, 14080, 14096, 15008, 15024, 14976, 14992, 15072, 15088, 15040, 15056, 15136, 15152, 15104, 15120
    .long 15200, 15216, 15168, 15184, 15264, 15280, 15232, 15248, 16160, 16176, 16128, 16144, 16224, 16240, 16192, 16208
    .long 16288, 16304, 16256, 16272, 16352, 16368, 16320, 16336, 16416, 16432, 16384, 16400, 17312, 17328, 17280, 17296
    .long 17376, 17392, 17344, 17360, 17440, 17456, 17408, 17424, 17504, 17520, 17472, 17488, 17568, 17584, 17536, 17552
    .long 36864, 36880, 36896, 36912, 36928, 36944, 36960, 36976, 36992, 37008, 37024, 37040, 37056, 37072, 37088, 37104
    .long 37120, 37136, 37152, 37168, 38016, 38032, 38048, 38064, 38080, 38096, 38112, 38128, 38144, 38160, 38176, 38192
    .long 38208, 38224, 38240, 38256, 38272, 38288, 38304, 38320, 39168, 39184, 39200, 39216, 39232, 39248, 39264, 39280
    .long 39296, 39312, 39328, 39344, 39360, 39376, 39392, 39408, 39424, 39440, 39456, 39472, 40320, 40336, 40352, 40368
    .long 39360, 39376, 39392, 39408, 39424, 39440, 39456, 39472, 39488, 39504, 39520, 39536, 39552, 39568, 39584, 39600
    .long 77344, 77360, 77312, 77328, 77408, 77424, 77376, 77392, 77472, 77488, 77440, 77456, 77536, 77552, 77504, 77520
    .long 77600, 77616, 77568, 77584, 78496, 78512, 78464, 78480, 78560, 78576, 78528, 78544, 78624, 78640, 78592, 78608
    .long 78688, 78704, 78656, 78672, 78752, 78768, 78720, 78736, 79648, 79664, 79616, 79632, 79712, 79728, 79680, 79696
    .long 78752, 78768, 78720, 78736, 78816, 78832, 78784, 78800, 78880, 78896, 78848, 78864, 79776, 79792, 79744, 79760
    .long 79840, 79856, 79808, 79824, 79904, 79920, 79872, 79888, 79968, 79984, 79936, 79952, 80032, 80048, 80000, 80016
    .long 117760, 117776, 117792, 117808, 117824, 117840, 117856, 117872, 117888, 117904, 117920, 117936, 117952, 117968, 117984, 118000
    .long 118016, 118032, 118048, 118064, 118912, 118928, 118944, 118960, 118976, 118992, 119008, 119024, 119040, 119056, 119072, 119088
    .long 118080, 118096, 118112, 118128, 118144, 118160, 118176, 118192, 119040, 119056, 119072, 119088, 119104, 119120, 119136, 119152
    .long 119168, 119184, 119200, 119216, 119232, 119248, 119264, 119280, 119296, 119312, 119328, 119344, 120192, 120208, 120224, 120240
    .long 120256, 120272, 120288, 120304, 120320, 120336, 120352, 120368, 120384, 120400, 120416, 120432, 120448, 120464, 120480, 120496
    .long 158240, 158256, 158208, 158224, 158304, 158320, 158272, 158288, 158368, 158384, 158336, 158352, 158432, 158448, 158400, 158416
    .long 161568, 161584, 161536, 161552, 162464, 162480, 162432, 162448, 162528, 162544, 162496, 162512, 162592, 162608, 162560, 162576
    .long 162656, 162672, 162624, 162640, 162720, 162736, 162688, 162704, 163616, 163632, 163584, 163600, 163680, 163696, 163648, 163664
    .long 163744, 163760, 163712, 163728, 163808, 163824, 163776, 163792, 163872, 163888, 163840, 163856, 164768, 164784, 164736, 164752
    .long 164832, 164848, 164800, 164816, 164896, 164912, 164864, 164880, 164960, 164976, 164928, 164944, 165024, 165040, 164992, 165008
    .long 0, 8, 16, 24, 320, 328, 336, 344, 640, 648, 656, 664, 960, 968, 976, 984
    .long 1312, 1320, 1328, 1336, 1632, 1640, 1648, 1656, 1952, 1960, 1968, 1976, 2272, 2280, 2288, 2296
    .long 2560, 2568, 2576, 2584, 2880, 2888, 2896, 2904, 3200, 3208, 3216, 3224, 3520, 3528, 3536, 3544
    .long 3872, 3880, 3888, 3896, 4192, 4200, 4208, 4216, 4512, 4520, 4528, 4536, 4832, 4840, 4848, 4856
    .long 32, 40, 48, 56, 352, 360, 368, 376, 672, 680, 688, 696, 992, 1000, 1008, 1016
    .long 1280, 1288, 1296, 1304, 1600, 1608, 1616, 1624, 1920, 1928, 1936, 1944, 2240, 2248, 2256, 2264
    .long 2592, 2600, 2608, 2616, 2912, 2920, 2928, 2936, 3232, 3240, 3248, 3256, 3552, 3560, 3568, 3576
    .long 3840, 3848, 3856, 3864, 4160, 4168, 4176, 4184, 4480, 4488, 4496, 4504, 4800, 4808, 4816, 4824
    .long 64, 72, 80, 88, 384, 392, 400, 408, 704, 712, 720, 728, 1024, 1032, 1040, 1048
    .long 1376, 1384, 1392, 1400, 1696, 1704, 1712, 1720, 2016, 2024, 2032, 2040, 2336, 2344, 2352, 2360
    .long 2624, 2632, 2640, 2648, 2944, 2952, 2960, 2968, 3264, 3272, 3280, 3288, 3584, 3592, 3600, 3608
    .long 3936, 3944, 3952, 3960, 4256, 4264, 4272, 4280, 4576, 4584, 4592, 4600, 4896, 4904, 4912, 4920
    .long 96, 104, 112, 120, 416, 424, 432, 440, 736, 744, 752, 760, 1056, 1064, 1072, 1080
    .long 1344, 1352, 1360, 1368, 1664, 1672, 1680, 1688, 1984, 1992, 2000, 2008, 2304, 2312, 2320, 2328
    .long 2656, 2664, 2672, 2680, 2976, 2984, 2992, 3000, 3296, 3304, 3312, 3320, 3616, 3624, 3632, 3640
    .long 3904, 3912, 3920, 3928, 4224, 4232, 4240, 4248, 4544, 4552, 4560, 4568, 4864, 4872, 4880, 4888
    .long 128, 136, 144, 152, 448, 456, 464, 472, 768, 776, 784, 792, 1088, 1096, 1104, 1112
    .long 1440, 1448, 1456, 1464, 1760, 1768, 1776, 1784, 2080, 2088, 2096, 2104, 2400, 2408, 2416, 2424
    .long 2688, 2696, 2704, 2712, 3008, 3016, 3024, 3032, 3328, 3336, 3344, 3352, 3648, 3656, 3664, 3672
    .long 4000, 4008, 4016, 4024, 4320, 4328, 4336, 4344, 4640, 4648, 4656, 4664, 4960, 4968, 4976, 4984
    .long 160, 168, 176, 184, 480, 488, 496, 504, 800, 808, 816, 824, 1120, 1128, 1136, 1144
    .long 1408, 1416, 1424, 1432, 1728, 1736, 1744, 1752, 2048, 2056, 2064, 2072, 2368, 2376, 2384, 2392
    .long 2720, 2728, 2736, 2744, 3040, 3048, 3056, 3064, 3360, 3368, 3376, 3384, 3680, 3688, 3696, 3704
    .long 3968, 3976, 3984, 3992, 4288, 4296, 4304, 4312, 4608, 4616, 4624, 4632, 4928, 4936, 4944, 4952
    .long 192, 200, 208, 216, 512, 520, 528, 536, 832, 840, 848, 856, 1152, 1160, 1168, 1176
    .long 1504, 1512, 1520, 1528, 1824, 1832, 1840, 1848, 2144, 2152, 2160, 2168, 2464, 2472, 2480, 2488
    .long 2752, 2760, 2768, 2776, 3072, 3080, 3088, 3096, 3392, 3400, 3408, 3416, 3712, 3720, 3728, 3736
    .long 4064, 4072, 4080, 4088, 4384, 4392, 4400, 4408, 4704, 4712, 4720, 4728, 5024, 5032, 5040, 5048
    .long 224, 232, 240, 248, 544, 552, 560, 568, 864, 872, 880, 888, 1184, 1192, 1200, 1208
    .long 1472, 1480, 1488, 1496, 1792, 1800, 1808, 1816, 2112, 2120, 2128, 2136, 2432, 2440, 2448, 2456
    .long 2784, 2792, 2800, 2808, 3104, 3112, 3120, 3128, 3424, 3432, 3440, 3448, 3744, 3752, 3760, 3768
    .long 4032, 4040, 4048, 4056, 4352, 4360, 4368, 4376, 4672, 4680, 4688, 4696, 4992, 5000, 5008, 5016
    .long 256, 264, 272, 280, 576, 584, 592, 600, 896, 904, 912, 920, 1216, 1224, 1232, 1240
    .long 1568, 1576, 1584, 1592, 1888, 1896, 1904, 1912, 2208, 2216, 2224, 2232, 2528, 2536, 2544, 2552
    .long 2816, 2824, 2832, 2840, 3136, 3144, 3152, 3160, 3456, 3464, 3472, 3480, 3776, 3784, 3792, 3800
    .long 4128, 4136, 4144, 4152, 4448, 4456, 4464, 4472, 4768, 4776, 4784, 4792, 5088, 5096, 5104, 5112
    .long 288, 296, 304, 312, 608, 616, 624, 632, 928, 936, 944, 952, 1248, 1256, 1264, 1272
    .long 1536, 1544, 1552, 1560, 1856, 1864, 1872, 1880, 2176, 2184, 2192, 2200, 2496, 2504, 2512, 2520
    .long 2848, 2856, 2864, 2872, 3168, 3176, 3184, 3192, 3488, 3496, 3504, 3512, 3808, 3816, 3824, 3832
    .long 4096, 4104, 4112, 4120, 4416, 4424, 4432, 4440, 4736, 4744, 4752, 4760, 5056, 5064, 5072, 5080
    .long 0, 16, 32, 48, 64, 80, 96, 112, 128, 144, 160, 176, 192, 208, 224, 240
    .long 256, 272, 288, 304, 320, 336, 352, 368, 384, 400, 416, 432, 448, 464, 480, 496
    .long 512, 528, 544, 560, 576, 592, 608, 624, 640, 656, 672, 688, 704, 720, 736, 752
    .long 768, 784, 800, 816, 832, 848, 864, 880, 896, 912, 928, 944, 960, 976, 992, 1008
    .long 1024, 1040, 1056, 1072, 1088, 1104, 1120, 1136, 1152, 1168, 1184, 1200, 1216, 1232, 1248, 1264
    .long 1280, 1296, 1312, 1328, 1344, 1360, 1376, 1392, 1408, 1424, 1440, 1456, 1472, 1488, 1504, 1520
    .long 1536, 1552, 1568, 1584, 1600, 1616, 1632, 1648, 1664, 1680, 1696, 1712, 1728, 1744, 1760, 1776
    .long 1792, 1808, 1824, 1840, 1856, 1872, 1888, 1904, 1920, 1936, 1952, 1968, 1984, 2000, 2016, 2032
    .long 2048, 2064, 2080, 2096, 2112, 2128, 2144, 2160, 2176, 2192, 2208, 2224, 2240, 2256, 2272, 2288
    .long 2304, 2320, 2336, 2352, 2368, 2384, 2400, 2416, 2432, 2448, 2464, 2480, 2496, 2512, 2528, 2544
    .long 2560, 2576, 2592, 2608, 2624, 2640, 2656, 2672, 2672, 2672, 2672, 2672, 2672, 2672, 2672, 2672
    .long 2672, 2672, 2672, 2672, 2672, 2672, 2672, 2672, 2672, 2672, 2672, 2672, 2672, 2672, 2672, 2672
    .long 0, 16, 32, 48, 64, 80, 96, 112, 128, 144, 160, 176, 192, 208, 224, 240
    .long 256, 272, 288, 304, 320, 336, 352, 368, 384, 400, 416, 432, 448, 464, 480, 496
    .long 512, 528, 544, 560, 576, 592, 608, 624, 640, 656, 6816, 6832, 6848, 6864, 6880, 6896
    .long 6912, 6928, 6944, 6960, 6976, 6992, 7008, 7024, 7040, 7056, 7072, 7088, 7104, 7120, 7136, 7152
    .long 7168, 7184, 7200, 7216, 7232, 7248, 7264, 7280, 7296, 7312, 7328, 7344, 7360, 7376, 7392, 7408
    .long 7424, 7440, 7456, 7472, 13632, 13648, 13664, 13680, 13696, 13712, 13728, 13744, 13760, 13776, 13792, 13808
    .long 13824, 13840, 13856, 13872, 13888, 13904, 13920, 13936, 13952, 13968, 13984, 14000, 14016, 14032, 14048, 14064
    .long 14080, 14096, 14112, 14128, 14144, 14160, 14176, 14192, 14208, 14224, 14240, 14256, 14272, 14288, 20448, 20464
    .long 20480, 20496, 20512, 20528, 20544, 20560, 20576, 20592, 20608, 20624, 20640, 20656, 20672, 20688, 20704, 20720
    .long 20736, 20752, 20768, 20784, 20800, 20816, 20832, 20848, 20864, 20880, 20896, 20912, 20928, 20944, 20960, 20976
    .long 20992, 21008, 21024, 21040, 21056, 21072, 21088, 21104, 21104, 21104, 21104, 21104, 21104, 21104, 21104, 21104
    .long 21104, 21104, 21104, 21104, 21104, 21104, 21104, 21104, 21104, 21104, 21104, 21104, 21104, 21104, 21104, 21104
    .long 0, 80, 160, 240, 320, 400, 480, 560, 640, 720, 800, 880, 960, 1040, 1120, 1200
    .long 8, 88, 168, 248, 328, 408, 488, 568, 648, 728, 808, 888, 968, 1048, 1128, 1208
    .long 16, 96, 176, 256, 336, 416, 496, 576, 656, 736, 816, 896, 976, 1056, 1136, 1216
    .long 24, 104, 184, 264, 344, 424, 504, 584, 664, 744, 824, 904, 984, 1064, 1144, 1224
    .long 64, 144, 224, 304, 384, 464, 544, 624, 704, 784, 864, 944, 1024, 1104, 1184, 1264
    .long 1344, 1424, 1504, 1584, 1664, 1744, 1824, 1904, 1984, 2064, 2144, 2224, 2304, 2384, 2464, 2544
    .long 64, 144, 224, 304, 384, 464, 544, 624, 704, 784, 864, 944, 1024, 1104, 1184, 1264
    .long 1344, 1424, 1504, 1584, 1664, 1744, 1824, 1904, 1984, 2064, 2144, 2224, 2304, 2384, 2464, 2544
    .long 2560, 2640, 2720, 2800, 2880, 2960, 3040, 3120, 3200, 3280, 3360, 3440, 3520, 3600, 3680, 3760
    .long 2568, 2648, 2728, 2808, 2888, 2968, 3048, 3128, 3208, 3288, 3368, 3448, 3528, 3608, 3688, 3768
    .long 2576, 2656, 2736, 2816, 2896, 2976, 3056, 3136, 3216, 3296, 3376, 3456, 3536, 3616, 3696, 3776
    .long 2584, 2664, 2744, 2824, 2904, 2984, 3064, 3144, 3224, 3304, 3384, 3464, 3544, 3624, 3704, 3784
    .long 2624, 2704, 2784, 2864, 2944, 3024, 3104, 3184, 3264, 3344, 3424, 3504, 3584, 3664, 3744, 3824
    .long 3904, 3984, 4064, 4144, 4224, 4304, 4384, 4464, 4544, 4624, 4704, 4784, 4864, 4944, 5024, 5104
    .long 2624, 2704, 2784, 2864, 2944, 3024, 3104, 3184, 3264, 3344, 3424, 3504, 3584, 3664, 3744, 3824
    .long 3904, 3984, 4064, 4144, 4224, 4304, 4384, 4464, 4544, 4624, 4704, 4784, 4864, 4944, 5024, 5104
    .long 5120, 5200, 5280, 5360, 5440, 5520, 5600, 5680, 5760, 5840, 5920, 6000, 6080, 6160, 6240, 6320
    .long 5128, 5208, 5288, 5368, 5448, 5528, 5608, 5688, 5768, 5848, 5928, 6008, 6088, 6168, 6248, 6328
    .long 5136, 5216, 5296, 5376, 5456, 5536, 5616, 5696, 5776, 5856, 5936, 6016, 6096, 6176, 6256, 6336
    .long 5144, 5224, 5304, 5384, 5464, 5544, 5624, 5704, 5784, 5864, 5944, 6024, 6104, 6184, 6264, 6344
    .long 5184, 5264, 5344, 5424, 5504, 5584, 5664, 5744, 5824, 5904, 5984, 6064, 6144, 6224, 6304, 6384
    .long 6464, 6544, 6624, 6704, 6784, 6864, 6944, 7024, 7104, 7184, 7264, 7344, 7424, 7504, 7584, 7664
    .long 5184, 5264, 5344, 5424, 5504, 5584, 5664, 5744, 5824, 5904, 5984, 6064, 6144, 6224, 6304, 6384
    .long 6464, 6544, 6624, 6704, 6784, 6864, 6944, 7024, 7104, 7184, 7264, 7344, 7424, 7504, 7584, 7664
    .long 7680, 7760, 7840, 7920, 8000, 8080, 8160, 8240, 8320, 8400, 8480, 8560, 8640, 8720, 8800, 8880
    .long 7688, 7768, 7848, 7928, 8008, 8088, 8168, 8248, 8328, 8408, 8488, 8568, 8648, 8728, 8808, 8888
    .long 7696, 7776, 7856, 7936, 8016, 8096, 8176, 8256, 8336, 8416, 8496, 8576, 8656, 8736, 8816, 8896
    .long 7704, 7784, 7864, 7944, 8024, 8104, 8184, 8264, 8344, 8424, 8504, 8584, 8664, 8744, 8824, 8904
    .long 7744, 7824, 7904, 7984, 8064, 8144, 8224, 8304, 8384, 8464, 8544, 8624, 8704, 8784, 8864, 8944
    .long 9024, 9104, 9184, 9264, 9344, 9424, 9504, 9584, 9664, 9744, 9824, 9904, 9984, 10064, 10144, 10224
    .long 7744, 7824, 7904, 7984, 8064, 8144, 8224, 8304, 8384, 8464, 8544, 8624, 8704, 8784, 8864, 8944
    .long 9024, 9104, 9184, 9264, 9344, 9424, 9504, 9584, 9664, 9744, 9824, 9904, 9984, 10064, 10144, 10224
    .long 0, 16, 32, 48, 64, 80, 96, 112, 128, 144, 160, 176, 192, 208, 224, 240
    .long 1024, 1040, 1056, 1072, 1088, 1104, 1120, 1136, 1152, 1168, 1184, 1200, 1216, 1232, 1248, 1264
    .long 0, 16, 32, 48, 64, 80, 96, 112, 128, 144, 160, 176, 192, 208, 224, 240
    .long 1024, 1040, 1056, 1072, 1088, 1104, 1120, 1136, 1152, 1168, 1184, 1200, 1216, 1232, 1248, 1264
    .long 0, 1152, 2304, 3456, 4608, 5760, 6912, 8064, 9216, 10368, 11520, 12672, 13824, 14976, 16128, 17280
    .long 8, 1160, 2312, 3464, 4616, 5768, 6920, 8072, 9224, 10376, 11528, 12680, 13832, 14984, 16136, 17288
    .long 16, 1168, 2320, 3472, 4624, 5776, 6928, 8080, 9232, 10384, 11536, 12688, 13840, 14992, 16144, 17296
    .long 24, 1176, 2328, 3480, 4632, 5784, 6936, 8088, 9240, 10392, 11544, 12696, 13848, 15000, 16152, 17304
    .long 0, 48, 96, 144, 192, 240, 288, 336, 384, 432, 480, 528, 576, 624, 672, 720
    .long 0, 48, 96, 144, 192, 240, 288, 336, 384, 432, 480, 528, 576, 624, 672, 720
    .long 0, 48, 96, 144, 192, 240, 288, 336, 384, 432, 480, 528, 576, 624, 672, 720
    .long 0, 48, 96, 144, 192, 240, 288, 336, 384, 432, 480, 528, 576, 624, 672, 720
    .long 16256, 0, 0, 0, 1065353216, 0, 0, 0, 0, 16256, 0, 0, 0, 1065353216, 0, 0
    .long 0, 0, 16256, 0, 0, 0, 1065353216, 0, 0, 0, 0, 16256, 0, 0, 0, 1065353216
    .long 0, 0, 0, 0, 0, 0, 0, 0, 0, 0, 0, 0, 0, 0, 0, 0
    .long 0, 0, 0, 0, 0, 0, 0, 0, 0, 0, 0, 0, 0, 0, 0, 0
    .long 0, 0, 0, 0, 0, 0, 0, 0, 0, 0, 0, 0, 0, 0, 0, 0
    .long 0, 0, 0, 0, 0, 0, 0, 0, 0, 0, 0, 0, 0, 0, 0, 0
    .long 16256, 0, 0, 0, 1065353216, 0, 0, 0, 0, 16256, 0, 0, 0, 1065353216, 0, 0
    .long 0, 0, 16256, 0, 0, 0, 1065353216, 0, 0, 0, 0, 16256, 0, 0, 0, 1065353216
    .long 0, 0, 0, 0, 0, 0, 0, 0, 0, 0, 0, 0, 0, 0, 0, 0
    .long 0, 0, 0, 0, 0, 0, 0, 0, 0, 0, 0, 0, 0, 0, 0, 0
    .long 0, 0, 0, 0, 0, 0, 0, 0, 0, 0, 0, 0, 0, 0, 0, 0
    .long 0, 0, 0, 0, 0, 0, 0, 0, 0, 0, 0, 0, 0, 0, 0, 0
    .long 0, 0, 0, 0, 0, 0, 0, 0, 0, 0, 0, 0, 0, 0, 0, 0
    .long 0, 0, 0, 0, 0, 0, 0, 0, 0, 0, 0, 0, 0, 0, 0, 0
    .long 0, 0, 0, 0, 0, 0, 0, 0, 0, 0, 0, 0, 0, 0, 0, 0
    .long 0, 0, 0, 0, 0, 0, 0, 0, 0, 0, 0, 0, 0, 0, 0, 0
    .long 0, 0, 0, 0, 0, 0, 0, 0, 0, 0, 0, 0, 0, 0, 0, 0
    .long 0, 0, 0, 0, 0, 0, 0, 0, 0, 0, 0, 0, 0, 0, 0, 0
    .long 0, 0, 0, 0, 0, 0, 0, 0, 0, 0, 0, 0, 0, 0, 0, 0
    .long 0, 0, 0, 0, 0, 0, 0, 0, 0, 0, 0, 0, 0, 0, 0, 0
    .long 0, 0, 0, 0, 0, 0, 0, 0, 0, 0, 0, 0, 0, 0, 0, 0
    .long 0, 0, 0, 0, 0, 0, 0, 0, 0, 0, 0, 0, 0, 0, 0, 0
    .long 0, 0, 0, 0, 0, 0, 0, 0, 0, 0, 0, 0, 0, 0, 0, 0
    .long 0, 0, 0, 0, 0, 0, 0, 0, 0, 0, 0, 0, 0, 0, 0, 0
    .long 16256, 0, 0, 0, 1065353216, 0, 0, 0, 0, 16256, 0, 0, 0, 1065353216, 0, 0
    .long 0, 0, 16256, 0, 0, 0, 1065353216, 0, 0, 0, 0, 16256, 0, 0, 0, 1065353216
    .long 0, 0, 0, 0, 0, 0, 0, 0, 0, 0, 0, 0, 0, 0, 0, 0
    .long 0, 0, 0, 0, 0, 0, 0, 0, 0, 0, 0, 0, 0, 0, 0, 0
    .long 0, 0, 0, 0, 0, 0, 0, 0, 0, 0, 0, 0, 0, 0, 0, 0
    .long 0, 0, 0, 0, 0, 0, 0, 0, 0, 0, 0, 0, 0, 0, 0, 0
    .long 16256, 0, 0, 0, 1065353216, 0, 0, 0, 0, 16256, 0, 0, 0, 1065353216, 0, 0
    .long 0, 0, 16256, 0, 0, 0, 1065353216, 0, 0, 0, 0, 16256, 0, 0, 0, 1065353216
    .long 0, 4, 32, 6816, 0, 4, 32, 6816, 0, 4, 32, 6816, 0, 4, 32, 6816
    .long 0, 4, 32, 6816, 0, 4, 32, 6816, 0, 4, 32, 6816, 0, 4, 32, 6816
    .long 0, 4, 32, 6816, 0, 4, 32, 6816, 0, 4, 32, 6816, 0, 4, 32, 6816
    .long 0, 4, 32, 6816, 0, 4, 32, 6816, 0, 4, 32, 6816, 0, 4, 32, 6816
    .long 8, 12, 6820, 6824, 8, 12, 6820, 6824, 8, 12, 6820, 6824, 8, 12, 6820, 6824
    .long 8, 12, 6820, 6824, 8, 12, 6820, 6824, 8, 12, 6820, 6824, 8, 12, 6820, 6824
    .long 8, 12, 6820, 6824, 8, 12, 6820, 6824, 8, 12, 6820, 6824, 8, 12, 6820, 6824
    .long 8, 12, 6820, 6824, 8, 12, 6820, 6824, 8, 12, 6820, 6824, 8, 12, 6820, 6824
    .long 16, 20, 6828, 6832, 16, 20, 6828, 6832, 16, 20, 6828, 6832, 16, 20, 6828, 6832
    .long 16, 20, 6828, 6832, 16, 20, 6828, 6832, 16, 20, 6828, 6832, 16, 20, 6828, 6832
    .long 16, 20, 6828, 6832, 16, 20, 6828, 6832, 16, 20, 6828, 6832, 16, 20, 6828, 6832
    .long 16, 20, 6828, 6832, 16, 20, 6828, 6832, 16, 20, 6828, 6832, 16, 20, 6828, 6832
    .long 24, 28, 6836, 6840, 24, 28, 6836, 6840, 24, 28, 6836, 6840, 24, 28, 6836, 6840
    .long 24, 28, 6836, 6840, 24, 28, 6836, 6840, 24, 28, 6836, 6840, 24, 28, 6836, 6840
    .long 24, 28, 6836, 6840, 24, 28, 6836, 6840, 24, 28, 6836, 6840, 24, 28, 6836, 6840
    .long 24, 28, 6836, 6840, 24, 28, 6836, 6840, 24, 28, 6836, 6840, 24, 28, 6836, 6840
    .long 6844, 6848, 13656, 13660, 6844, 6848, 13656, 13660, 6844, 6848, 13656, 13660, 6844, 6848, 13656, 13660
    .long 6844, 6848, 13656, 13660, 6844, 6848, 13656, 13660, 6844, 6848, 13656, 13660, 6844, 6848, 13656, 13660
    .long 6844, 6848, 13656, 13660, 6844, 6848, 13656, 13660, 6844, 6848, 13656, 13660, 6844, 6848, 13656, 13660
    .long 6844, 6848, 13656, 13660, 6844, 6848, 13656, 13660, 6844, 6848, 13656, 13660, 6844, 6848, 13656, 13660
    .long 13632, 13636, 13664, 20448, 13632, 13636, 13664, 20448, 13632, 13636, 13664, 20448, 13632, 13636, 13664, 20448
    .long 13632, 13636, 13664, 20448, 13632, 13636, 13664, 20448, 13632, 13636, 13664, 20448, 13632, 13636, 13664, 20448
    .long 13632, 13636, 13664, 20448, 13632, 13636, 13664, 20448, 13632, 13636, 13664, 20448, 13632, 13636, 13664, 20448
    .long 13632, 13636, 13664, 20448, 13632, 13636, 13664, 20448, 13632, 13636, 13664, 20448, 13632, 13636, 13664, 20448
    .long 13640, 13644, 20452, 20456, 13640, 13644, 20452, 20456, 13640, 13644, 20452, 20456, 13640, 13644, 20452, 20456
    .long 13640, 13644, 20452, 20456, 13640, 13644, 20452, 20456, 13640, 13644, 20452, 20456, 13640, 13644, 20452, 20456
    .long 13640, 13644, 20452, 20456, 13640, 13644, 20452, 20456, 13640, 13644, 20452, 20456, 13640, 13644, 20452, 20456
    .long 13640, 13644, 20452, 20456, 13640, 13644, 20452, 20456, 13640, 13644, 20452, 20456, 13640, 13644, 20452, 20456
    .long 13648, 13652, 20460, 20464, 13648, 13652, 20460, 20464, 13648, 13652, 20460, 20464, 13648, 13652, 20460, 20464
    .long 13648, 13652, 20460, 20464, 13648, 13652, 20460, 20464, 13648, 13652, 20460, 20464, 13648, 13652, 20460, 20464
    .long 13648, 13652, 20460, 20464, 13648, 13652, 20460, 20464, 13648, 13652, 20460, 20464, 13648, 13652, 20460, 20464
    .long 13648, 13652, 20460, 20464, 13648, 13652, 20460, 20464, 13648, 13652, 20460, 20464, 13648, 13652, 20460, 20464
    .long 20468, 20472, 27280, 27284, 20468, 20472, 27280, 27284, 20468, 20472, 27280, 27284, 20468, 20472, 27280, 27284
    .long 20468, 20472, 27280, 27284, 20468, 20472, 27280, 27284, 20468, 20472, 27280, 27284, 20468, 20472, 27280, 27284
    .long 20468, 20472, 27280, 27284, 20468, 20472, 27280, 27284, 20468, 20472, 27280, 27284, 20468, 20472, 27280, 27284
    .long 20468, 20472, 27280, 27284, 20468, 20472, 27280, 27284, 20468, 20472, 27280, 27284, 20468, 20472, 27280, 27284
    .long 20476, 20480, 27288, 27292, 20476, 20480, 27288, 27292, 20476, 20480, 27288, 27292, 20476, 20480, 27288, 27292
    .long 20476, 20480, 27288, 27292, 20476, 20480, 27288, 27292, 20476, 20480, 27288, 27292, 20476, 20480, 27288, 27292
    .long 20476, 20480, 27288, 27292, 20476, 20480, 27288, 27292, 20476, 20480, 27288, 27292, 20476, 20480, 27288, 27292
    .long 20476, 20480, 27288, 27292, 20476, 20480, 27288, 27292, 20476, 20480, 27288, 27292, 20476, 20480, 27288, 27292
    .long 27264, 27268, 27296, 34080, 27264, 27268, 27296, 34080, 27264, 27268, 27296, 34080, 27264, 27268, 27296, 34080
    .long 27264, 27268, 27296, 34080, 27264, 27268, 27296, 34080, 27264, 27268, 27296, 34080, 27264, 27268, 27296, 34080
    .long 27264, 27268, 27296, 34080, 27264, 27268, 27296, 34080, 27264, 27268, 27296, 34080, 27264, 27268, 27296, 34080
    .long 27264, 27268, 27296, 34080, 27264, 27268, 27296, 34080, 27264, 27268, 27296, 34080, 27264, 27268, 27296, 34080
    .long 27272, 27276, 34084, 34088, 27272, 27276, 34084, 34088, 27272, 27276, 34084, 34088, 27272, 27276, 34084, 34088
    .long 27272, 27276, 34084, 34088, 27272, 27276, 34084, 34088, 27272, 27276, 34084, 34088, 27272, 27276, 34084, 34088
    .long 27272, 27276, 34084, 34088, 27272, 27276, 34084, 34088, 27272, 27276, 34084, 34088, 27272, 27276, 34084, 34088
    .long 27272, 27276, 34084, 34088, 27272, 27276, 34084, 34088, 27272, 27276, 34084, 34088, 27272, 27276, 34084, 34088
    .long 34092, 34096, 0, 0, 34092, 34096, 0, 0, 34092, 34096, 0, 0, 34092, 34096, 0, 0
    .long 34092, 34096, 0, 0, 34092, 34096, 0, 0, 34092, 34096, 0, 0, 34092, 34096, 0, 0
    .long 34092, 34096, 0, 0, 34092, 34096, 0, 0, 34092, 34096, 0, 0, 34092, 34096, 0, 0
    .long 34092, 34096, 0, 0, 34092, 34096, 0, 0, 34092, 34096, 0, 0, 34092, 34096, 0, 0
    .long 34100, 34104, 0, 0, 34100, 34104, 0, 0, 34100, 34104, 0, 0, 34100, 34104, 0, 0
    .long 34100, 34104, 0, 0, 34100, 34104, 0, 0, 34100, 34104, 0, 0, 34100, 34104, 0, 0
    .long 34100, 34104, 0, 0, 34100, 34104, 0, 0, 34100, 34104, 0, 0, 34100, 34104, 0, 0
    .long 34100, 34104, 0, 0, 34100, 34104, 0, 0, 34100, 34104, 0, 0, 34100, 34104, 0, 0
    .long 34108, 34112, 0, 0, 34108, 34112, 0, 0, 34108, 34112, 0, 0, 34108, 34112, 0, 0
    .long 34108, 34112, 0, 0, 34108, 34112, 0, 0, 34108, 34112, 0, 0, 34108, 34112, 0, 0
    .long 34108, 34112, 0, 0, 34108, 34112, 0, 0, 34108, 34112, 0, 0, 34108, 34112, 0, 0
    .long 34108, 34112, 0, 0, 34108, 34112, 0, 0, 34108, 34112, 0, 0, 34108, 34112, 0, 0
    .long 40, 40, 0, 0, 40, 40, 0, 0, 40, 40, 0, 0, 40, 40, 0, 0
    .long 40, 40, 0, 0, 40, 40, 0, 0, 40, 40, 0, 0, 40, 40, 0, 0
    .long 40, 40, 0, 0, 40, 40, 0, 0, 40, 40, 0, 0, 40, 40, 0, 0
    .long 40, 40, 0, 0, 40, 40, 0, 0, 40, 40, 0, 0, 40, 40, 0, 0
    .long 672, 1440, 0, 0, 720, 1488, 0, 0, 768, 1536, 0, 0, 816, 1584, 0, 0
    .long 864, 1632, 0, 0, 912, 1680, 0, 0, 960, 1728, 0, 0, 1008, 1776, 0, 0
    .long 1056, 1824, 0, 0, 1104, 1872, 0, 0, 1152, 1920, 0, 0, 1200, 1968, 0, 0
    .long 1248, 2016, 0, 0, 1296, 2064, 0, 0, 1344, 2112, 0, 0, 1392, 2160, 0, 0
    .long 672, 1440, 0, 0, 720, 1488, 0, 0, 768, 1536, 0, 0, 816, 1584, 0, 0
    .long 864, 1632, 0, 0, 912, 1680, 0, 0, 960, 1728, 0, 0, 1008, 1776, 0, 0
    .long 1056, 1824, 0, 0, 1104, 1872, 0, 0, 1152, 1920, 0, 0, 1200, 1968, 0, 0
    .long 1248, 2016, 0, 0, 1296, 2064, 0, 0, 1344, 2112, 0, 0, 1392, 2160, 0, 0
    .long 672, 1440, 0, 0, 720, 1488, 0, 0, 768, 1536, 0, 0, 816, 1584, 0, 0
    .long 864, 1632, 0, 0, 912, 1680, 0, 0, 960, 1728, 0, 0, 1008, 1776, 0, 0
    .long 1056, 1824, 0, 0, 1104, 1872, 0, 0, 1152, 1920, 0, 0, 1200, 1968, 0, 0
    .long 1248, 2016, 0, 0, 1296, 2064, 0, 0, 1344, 2112, 0, 0, 1392, 2160, 0, 0
    .long 672, 1440, 0, 0, 720, 1488, 0, 0, 768, 1536, 0, 0, 816, 1584, 0, 0
    .long 864, 1632, 0, 0, 912, 1680, 0, 0, 960, 1728, 0, 0, 1008, 1776, 0, 0
    .long 1056, 1824, 0, 0, 1104, 1872, 0, 0, 1152, 1920, 0, 0, 1200, 1968, 0, 0
    .long 1248, 2016, 0, 0, 1296, 2064, 0, 0, 1344, 2112, 0, 0, 1392, 2160, 0, 0
    .long 1440, 672, 0, 0, 1488, 720, 0, 0, 1536, 768, 0, 0, 1584, 816, 0, 0
    .long 1632, 864, 0, 0, 1680, 912, 0, 0, 1728, 960, 0, 0, 1776, 1008, 0, 0
    .long 1824, 1056, 0, 0, 1872, 1104, 0, 0, 1920, 1152, 0, 0, 1968, 1200, 0, 0
    .long 2016, 1248, 0, 0, 2064, 1296, 0, 0, 2112, 1344, 0, 0, 2160, 1392, 0, 0
    .long 1440, 672, 0, 0, 1488, 720, 0, 0, 1536, 768, 0, 0, 1584, 816, 0, 0
    .long 1632, 864, 0, 0, 1680, 912, 0, 0, 1728, 960, 0, 0, 1776, 1008, 0, 0
    .long 1824, 1056, 0, 0, 1872, 1104, 0, 0, 1920, 1152, 0, 0, 1968, 1200, 0, 0
    .long 2016, 1248, 0, 0, 2064, 1296, 0, 0, 2112, 1344, 0, 0, 2160, 1392, 0, 0
    .long 1440, 672, 0, 0, 1488, 720, 0, 0, 1536, 768, 0, 0, 1584, 816, 0, 0
    .long 1632, 864, 0, 0, 1680, 912, 0, 0, 1728, 960, 0, 0, 1776, 1008, 0, 0
    .long 1824, 1056, 0, 0, 1872, 1104, 0, 0, 1920, 1152, 0, 0, 1968, 1200, 0, 0
    .long 2016, 1248, 0, 0, 2064, 1296, 0, 0, 2112, 1344, 0, 0, 2160, 1392, 0, 0
    .long 1440, 672, 0, 0, 1488, 720, 0, 0, 1536, 768, 0, 0, 1584, 816, 0, 0
    .long 1632, 864, 0, 0, 1680, 912, 0, 0, 1728, 960, 0, 0, 1776, 1008, 0, 0
    .long 1824, 1056, 0, 0, 1872, 1104, 0, 0, 1920, 1152, 0, 0, 1968, 1200, 0, 0
    .long 2016, 1248, 0, 0, 2064, 1296, 0, 0, 2112, 1344, 0, 0, 2160, 1392, 0, 0
    .long 2208, 2976, 0, 0, 2256, 3024, 0, 0, 2304, 3072, 0, 0, 2352, 3120, 0, 0
    .long 2400, 3168, 0, 0, 2448, 3216, 0, 0, 2496, 3264, 0, 0, 2544, 3312, 0, 0
    .long 2592, 3360, 0, 0, 2640, 3408, 0, 0, 2688, 3456, 0, 0, 2736, 3504, 0, 0
    .long 2784, 3552, 0, 0, 2832, 3600, 0, 0, 2880, 3648, 0, 0, 2928, 3696, 0, 0
    .long 2208, 2976, 0, 0, 2256, 3024, 0, 0, 2304, 3072, 0, 0, 2352, 3120, 0, 0
    .long 2400, 3168, 0, 0, 2448, 3216, 0, 0, 2496, 3264, 0, 0, 2544, 3312, 0, 0
    .long 2592, 3360, 0, 0, 2640, 3408, 0, 0, 2688, 3456, 0, 0, 2736, 3504, 0, 0
    .long 2784, 3552, 0, 0, 2832, 3600, 0, 0, 2880, 3648, 0, 0, 2928, 3696, 0, 0
    .long 2208, 2976, 0, 0, 2256, 3024, 0, 0, 2304, 3072, 0, 0, 2352, 3120, 0, 0
    .long 2400, 3168, 0, 0, 2448, 3216, 0, 0, 2496, 3264, 0, 0, 2544, 3312, 0, 0
    .long 2592, 3360, 0, 0, 2640, 3408, 0, 0, 2688, 3456, 0, 0, 2736, 3504, 0, 0
    .long 2784, 3552, 0, 0, 2832, 3600, 0, 0, 2880, 3648, 0, 0, 2928, 3696, 0, 0
    .long 2208, 2976, 0, 0, 2256, 3024, 0, 0, 2304, 3072, 0, 0, 2352, 3120, 0, 0
    .long 2400, 3168, 0, 0, 2448, 3216, 0, 0, 2496, 3264, 0, 0, 2544, 3312, 0, 0
    .long 2592, 3360, 0, 0, 2640, 3408, 0, 0, 2688, 3456, 0, 0, 2736, 3504, 0, 0
    .long 2784, 3552, 0, 0, 2832, 3600, 0, 0, 2880, 3648, 0, 0, 2928, 3696, 0, 0
    .long 2976, 2208, 0, 0, 3024, 2256, 0, 0, 3072, 2304, 0, 0, 3120, 2352, 0, 0
    .long 3168, 2400, 0, 0, 3216, 2448, 0, 0, 3264, 2496, 0, 0, 3312, 2544, 0, 0
    .long 3360, 2592, 0, 0, 3408, 2640, 0, 0, 3456, 2688, 0, 0, 3504, 2736, 0, 0
    .long 3552, 2784, 0, 0, 3600, 2832, 0, 0, 3648, 2880, 0, 0, 3696, 2928, 0, 0
    .long 2976, 2208, 0, 0, 3024, 2256, 0, 0, 3072, 2304, 0, 0, 3120, 2352, 0, 0
    .long 3168, 2400, 0, 0, 3216, 2448, 0, 0, 3264, 2496, 0, 0, 3312, 2544, 0, 0
    .long 3360, 2592, 0, 0, 3408, 2640, 0, 0, 3456, 2688, 0, 0, 3504, 2736, 0, 0
    .long 3552, 2784, 0, 0, 3600, 2832, 0, 0, 3648, 2880, 0, 0, 3696, 2928, 0, 0
    .long 2976, 2208, 0, 0, 3024, 2256, 0, 0, 3072, 2304, 0, 0, 3120, 2352, 0, 0
    .long 3168, 2400, 0, 0, 3216, 2448, 0, 0, 3264, 2496, 0, 0, 3312, 2544, 0, 0
    .long 3360, 2592, 0, 0, 3408, 2640, 0, 0, 3456, 2688, 0, 0, 3504, 2736, 0, 0
    .long 3552, 2784, 0, 0, 3600, 2832, 0, 0, 3648, 2880, 0, 0, 3696, 2928, 0, 0
    .long 2976, 2208, 0, 0, 3024, 2256, 0, 0, 3072, 2304, 0, 0, 3120, 2352, 0, 0
    .long 3168, 2400, 0, 0, 3216, 2448, 0, 0, 3264, 2496, 0, 0, 3312, 2544, 0, 0
    .long 3360, 2592, 0, 0, 3408, 2640, 0, 0, 3456, 2688, 0, 0, 3504, 2736, 0, 0
    .long 3552, 2784, 0, 0, 3600, 2832, 0, 0, 3648, 2880, 0, 0, 3696, 2928, 0, 0
    .long 3744, 4512, 0, 0, 3792, 4560, 0, 0, 3840, 4608, 0, 0, 3888, 4656, 0, 0
    .long 3936, 4704, 0, 0, 3984, 4752, 0, 0, 4032, 4800, 0, 0, 4080, 4848, 0, 0
    .long 4128, 4896, 0, 0, 4176, 4944, 0, 0, 4224, 4992, 0, 0, 4272, 5040, 0, 0
    .long 4320, 5088, 0, 0, 4368, 5136, 0, 0, 4416, 5184, 0, 0, 4464, 5232, 0, 0
    .long 3744, 4512, 0, 0, 3792, 4560, 0, 0, 3840, 4608, 0, 0, 3888, 4656, 0, 0
    .long 3936, 4704, 0, 0, 3984, 4752, 0, 0, 4032, 4800, 0, 0, 4080, 4848, 0, 0
    .long 4128, 4896, 0, 0, 4176, 4944, 0, 0, 4224, 4992, 0, 0, 4272, 5040, 0, 0
    .long 4320, 5088, 0, 0, 4368, 5136, 0, 0, 4416, 5184, 0, 0, 4464, 5232, 0, 0
    .long 3744, 4512, 0, 0, 3792, 4560, 0, 0, 3840, 4608, 0, 0, 3888, 4656, 0, 0
    .long 3936, 4704, 0, 0, 3984, 4752, 0, 0, 4032, 4800, 0, 0, 4080, 4848, 0, 0
    .long 4128, 4896, 0, 0, 4176, 4944, 0, 0, 4224, 4992, 0, 0, 4272, 5040, 0, 0
    .long 4320, 5088, 0, 0, 4368, 5136, 0, 0, 4416, 5184, 0, 0, 4464, 5232, 0, 0
    .long 3744, 4512, 0, 0, 3792, 4560, 0, 0, 3840, 4608, 0, 0, 3888, 4656, 0, 0
    .long 3936, 4704, 0, 0, 3984, 4752, 0, 0, 4032, 4800, 0, 0, 4080, 4848, 0, 0
    .long 4128, 4896, 0, 0, 4176, 4944, 0, 0, 4224, 4992, 0, 0, 4272, 5040, 0, 0
    .long 4320, 5088, 0, 0, 4368, 5136, 0, 0, 4416, 5184, 0, 0, 4464, 5232, 0, 0
    .long 4512, 3744, 0, 0, 4560, 3792, 0, 0, 4608, 3840, 0, 0, 4656, 3888, 0, 0
    .long 4704, 3936, 0, 0, 4752, 3984, 0, 0, 4800, 4032, 0, 0, 4848, 4080, 0, 0
    .long 4896, 4128, 0, 0, 4944, 4176, 0, 0, 4992, 4224, 0, 0, 5040, 4272, 0, 0
    .long 5088, 4320, 0, 0, 5136, 4368, 0, 0, 5184, 4416, 0, 0, 5232, 4464, 0, 0
    .long 4512, 3744, 0, 0, 4560, 3792, 0, 0, 4608, 3840, 0, 0, 4656, 3888, 0, 0
    .long 4704, 3936, 0, 0, 4752, 3984, 0, 0, 4800, 4032, 0, 0, 4848, 4080, 0, 0
    .long 4896, 4128, 0, 0, 4944, 4176, 0, 0, 4992, 4224, 0, 0, 5040, 4272, 0, 0
    .long 5088, 4320, 0, 0, 5136, 4368, 0, 0, 5184, 4416, 0, 0, 5232, 4464, 0, 0
    .long 4512, 3744, 0, 0, 4560, 3792, 0, 0, 4608, 3840, 0, 0, 4656, 3888, 0, 0
    .long 4704, 3936, 0, 0, 4752, 3984, 0, 0, 4800, 4032, 0, 0, 4848, 4080, 0, 0
    .long 4896, 4128, 0, 0, 4944, 4176, 0, 0, 4992, 4224, 0, 0, 5040, 4272, 0, 0
    .long 5088, 4320, 0, 0, 5136, 4368, 0, 0, 5184, 4416, 0, 0, 5232, 4464, 0, 0
    .long 4512, 3744, 0, 0, 4560, 3792, 0, 0, 4608, 3840, 0, 0, 4656, 3888, 0, 0
    .long 4704, 3936, 0, 0, 4752, 3984, 0, 0, 4800, 4032, 0, 0, 4848, 4080, 0, 0
    .long 4896, 4128, 0, 0, 4944, 4176, 0, 0, 4992, 4224, 0, 0, 5040, 4272, 0, 0
    .long 5088, 4320, 0, 0, 5136, 4368, 0, 0, 5184, 4416, 0, 0, 5232, 4464, 0, 0
    .long 5280, 6048, 0, 0, 5328, 6096, 0, 0, 5376, 6144, 0, 0, 5424, 6192, 0, 0
    .long 5472, 6240, 0, 0, 5520, 6288, 0, 0, 5568, 6336, 0, 0, 5616, 6384, 0, 0
    .long 5664, 6432, 0, 0, 5712, 6480, 0, 0, 5760, 6528, 0, 0, 5808, 6576, 0, 0
    .long 5856, 6624, 0, 0, 5904, 6672, 0, 0, 5952, 6720, 0, 0, 6000, 6768, 0, 0
    .long 5280, 6048, 0, 0, 5328, 6096, 0, 0, 5376, 6144, 0, 0, 5424, 6192, 0, 0
    .long 5472, 6240, 0, 0, 5520, 6288, 0, 0, 5568, 6336, 0, 0, 5616, 6384, 0, 0
    .long 5664, 6432, 0, 0, 5712, 6480, 0, 0, 5760, 6528, 0, 0, 5808, 6576, 0, 0
    .long 5856, 6624, 0, 0, 5904, 6672, 0, 0, 5952, 6720, 0, 0, 6000, 6768, 0, 0
    .long 5280, 6048, 0, 0, 5328, 6096, 0, 0, 5376, 6144, 0, 0, 5424, 6192, 0, 0
    .long 5472, 6240, 0, 0, 5520, 6288, 0, 0, 5568, 6336, 0, 0, 5616, 6384, 0, 0
    .long 5664, 6432, 0, 0, 5712, 6480, 0, 0, 5760, 6528, 0, 0, 5808, 6576, 0, 0
    .long 5856, 6624, 0, 0, 5904, 6672, 0, 0, 5952, 6720, 0, 0, 6000, 6768, 0, 0
    .long 5280, 6048, 0, 0, 5328, 6096, 0, 0, 5376, 6144, 0, 0, 5424, 6192, 0, 0
    .long 5472, 6240, 0, 0, 5520, 6288, 0, 0, 5568, 6336, 0, 0, 5616, 6384, 0, 0
    .long 5664, 6432, 0, 0, 5712, 6480, 0, 0, 5760, 6528, 0, 0, 5808, 6576, 0, 0
    .long 5856, 6624, 0, 0, 5904, 6672, 0, 0, 5952, 6720, 0, 0, 6000, 6768, 0, 0
    .long 6048, 5280, 0, 0, 6096, 5328, 0, 0, 6144, 5376, 0, 0, 6192, 5424, 0, 0
    .long 6240, 5472, 0, 0, 6288, 5520, 0, 0, 6336, 5568, 0, 0, 6384, 5616, 0, 0
    .long 6432, 5664, 0, 0, 6480, 5712, 0, 0, 6528, 5760, 0, 0, 6576, 5808, 0, 0
    .long 6624, 5856, 0, 0, 6672, 5904, 0, 0, 6720, 5952, 0, 0, 6768, 6000, 0, 0
    .long 6048, 5280, 0, 0, 6096, 5328, 0, 0, 6144, 5376, 0, 0, 6192, 5424, 0, 0
    .long 6240, 5472, 0, 0, 6288, 5520, 0, 0, 6336, 5568, 0, 0, 6384, 5616, 0, 0
    .long 6432, 5664, 0, 0, 6480, 5712, 0, 0, 6528, 5760, 0, 0, 6576, 5808, 0, 0
    .long 6624, 5856, 0, 0, 6672, 5904, 0, 0, 6720, 5952, 0, 0, 6768, 6000, 0, 0
    .long 6048, 5280, 0, 0, 6096, 5328, 0, 0, 6144, 5376, 0, 0, 6192, 5424, 0, 0
    .long 6240, 5472, 0, 0, 6288, 5520, 0, 0, 6336, 5568, 0, 0, 6384, 5616, 0, 0
    .long 6432, 5664, 0, 0, 6480, 5712, 0, 0, 6528, 5760, 0, 0, 6576, 5808, 0, 0
    .long 6624, 5856, 0, 0, 6672, 5904, 0, 0, 6720, 5952, 0, 0, 6768, 6000, 0, 0
    .long 6048, 5280, 0, 0, 6096, 5328, 0, 0, 6144, 5376, 0, 0, 6192, 5424, 0, 0
    .long 6240, 5472, 0, 0, 6288, 5520, 0, 0, 6336, 5568, 0, 0, 6384, 5616, 0, 0
    .long 6432, 5664, 0, 0, 6480, 5712, 0, 0, 6528, 5760, 0, 0, 6576, 5808, 0, 0
    .long 6624, 5856, 0, 0, 6672, 5904, 0, 0, 6720, 5952, 0, 0, 6768, 6000, 0, 0
    .long 0, 2496, 5024, 7488, 16, 2512, 5040, 7504, 32, 2528, 4992, 7520, 48, 2544, 5008, 7536
    .long 64, 2560, 5088, 7552, 80, 2576, 5104, 7568, 96, 2592, 5056, 7584, 112, 2608, 5072, 7600
    .long 128, 2624, 5152, 8448, 144, 2640, 5168, 8464, 160, 2656, 5120, 8480, 176, 2672, 5136, 8496
    .long 192, 2688, 6048, 8512, 208, 2704, 6064, 8528, 224, 2720, 6016, 8544, 240, 2736, 6032, 8560
    .long 256, 3616, 6112, 8576, 272, 3632, 6128, 8592, 288, 3584, 6080, 8608, 304, 3600, 6096, 8624
    .long 1152, 3680, 6176, 8640, 1168, 3696, 6192, 8656, 1184, 3648, 6144, 8672, 1200, 3664, 6160, 8688
    .long 1216, 3744, 6240, 8704, 1232, 3760, 6256, 8720, 1248, 3712, 6208, 8736, 1264, 3728, 6224, 8752
    .long 1280, 3808, 6304, 9600, 1296, 3824, 6320, 9616, 1312, 3776, 6272, 9632, 1328, 3792, 6288, 9648
    .long 1344, 3872, 7168, 9664, 1360, 3888, 7184, 9680, 1376, 3840, 7200, 9696, 1392, 3856, 7216, 9712
    .long 1408, 4768, 7232, 9728, 1424, 4784, 7248, 9744, 1440, 4736, 7264, 9760, 1456, 4752, 7280, 9776
    .long 2304, 4832, 7296, 9792, 2320, 4848, 7312, 9808, 2336, 4800, 7328, 9824, 2352, 4816, 7344, 9840
    .long 2368, 4896, 7360, 9856, 2384, 4912, 7376, 9872, 2400, 4864, 7392, 9888, 2416, 4880, 7408, 9904
    .long 2432, 4960, 7424, 10784, 2448, 4976, 7440, 10800, 2464, 4928, 7456, 10752, 2480, 4944, 7472, 10768
    .long 2496, 5024, 8320, 10848, 2512, 5040, 8336, 10864, 2528, 4992, 8352, 10816, 2544, 5008, 8368, 10832
    .long 2560, 5920, 8384, 10912, 2576, 5936, 8400, 10928, 2592, 5888, 8416, 10880, 2608, 5904, 8432, 10896
    .long 3456, 5984, 8448, 10976, 3472, 6000, 8464, 10992, 3488, 5952, 8480, 10944, 3504, 5968, 8496, 10960
    .long 14112, 0, 0, 0, 14128, 0, 0, 0, 14080, 0, 0, 0, 14096, 0, 0, 0
    .long 15008, 0, 0, 0, 15024, 0, 0, 0, 14976, 0, 0, 0, 14992, 0, 0, 0
    .long 15072, 0, 0, 0, 15088, 0, 0, 0, 15040, 0, 0, 0, 15056, 0, 0, 0
    .long 15136, 0, 0, 0, 15152, 0, 0, 0, 15104, 0, 0, 0, 15120, 0, 0, 0
    .long 15200, 0, 0, 0, 15216, 0, 0, 0, 15168, 0, 0, 0, 15184, 0, 0, 0
    .long 15264, 0, 0, 0, 15280, 0, 0, 0, 15232, 0, 0, 0, 15248, 0, 0, 0
    .long 16160, 0, 0, 0, 16176, 0, 0, 0, 16128, 0, 0, 0, 16144, 0, 0, 0
    .long 16224, 0, 0, 0, 16240, 0, 0, 0, 16192, 0, 0, 0, 16208, 0, 0, 0
    .long 16288, 0, 0, 0, 16304, 0, 0, 0, 16256, 0, 0, 0, 16272, 0, 0, 0
    .long 16352, 0, 0, 0, 16368, 0, 0, 0, 16320, 0, 0, 0, 16336, 0, 0, 0
    .long 16416, 0, 0, 0, 16432, 0, 0, 0, 16384, 0, 0, 0, 16400, 0, 0, 0
    .long 17312, 0, 0, 0, 17328, 0, 0, 0, 17280, 0, 0, 0, 17296, 0, 0, 0
    .long 17376, 0, 0, 0, 17392, 0, 0, 0, 17344, 0, 0, 0, 17360, 0, 0, 0
    .long 17440, 0, 0, 0, 17456, 0, 0, 0, 17408, 0, 0, 0, 17424, 0, 0, 0
    .long 17504, 0, 0, 0, 17520, 0, 0, 0, 17472, 0, 0, 0, 17488, 0, 0, 0
    .long 17568, 0, 0, 0, 17584, 0, 0, 0, 17536, 0, 0, 0, 17552, 0, 0, 0
    .long 36864, 39360, 78752, 118080, 36880, 39376, 78768, 118096, 36896, 39392, 78720, 118112, 36912, 39408, 78736, 118128
    .long 36928, 39424, 78816, 118144, 36944, 39440, 78832, 118160, 36960, 39456, 78784, 118176, 36976, 39472, 78800, 118192
    .long 36992, 39488, 78880, 119040, 37008, 39504, 78896, 119056, 37024, 39520, 78848, 119072, 37040, 39536, 78864, 119088
    .long 37056, 39552, 79776, 119104, 37072, 39568, 79792, 119120, 37088, 39584, 79744, 119136, 37104, 39600, 79760, 119152
    .long 37120, 77344, 79840, 119168, 37136, 77360, 79856, 119184, 37152, 77312, 79808, 119200, 37168, 77328, 79824, 119216
    .long 38016, 77408, 79904, 119232, 38032, 77424, 79920, 119248, 38048, 77376, 79872, 119264, 38064, 77392, 79888, 119280
    .long 38080, 77472, 79968, 119296, 38096, 77488, 79984, 119312, 38112, 77440, 79936, 119328, 38128, 77456, 79952, 119344
    .long 38144, 77536, 80032, 120192, 38160, 77552, 80048, 120208, 38176, 77504, 80000, 120224, 38192, 77520, 80016, 120240
    .long 38208, 77600, 117760, 120256, 38224, 77616, 117776, 120272, 38240, 77568, 117792, 120288, 38256, 77584, 117808, 120304
    .long 38272, 78496, 117824, 120320, 38288, 78512, 117840, 120336, 38304, 78464, 117856, 120352, 38320, 78480, 117872, 120368
    .long 39168, 78560, 117888, 120384, 39184, 78576, 117904, 120400, 39200, 78528, 117920, 120416, 39216, 78544, 117936, 120432
    .long 39232, 78624, 117952, 120448, 39248, 78640, 117968, 120464, 39264, 78592, 117984, 120480, 39280, 78608, 118000, 120496
    .long 39296, 78688, 118016, 158240, 39312, 78704, 118032, 158256, 39328, 78656, 118048, 158208, 39344, 78672, 118064, 158224
    .long 39360, 78752, 118912, 158304, 39376, 78768, 118928, 158320, 39392, 78720, 118944, 158272, 39408, 78736, 118960, 158288
    .long 39424, 79648, 118976, 158368, 39440, 79664, 118992, 158384, 39456, 79616, 119008, 158336, 39472, 79632, 119024, 158352
    .long 40320, 79712, 119040, 158432, 40336, 79728, 119056, 158448, 40352, 79680, 119072, 158400, 40368, 79696, 119088, 158416
    .long 161568, 0, 0, 0, 161584, 0, 0, 0, 161536, 0, 0, 0, 161552, 0, 0, 0
    .long 162464, 0, 0, 0, 162480, 0, 0, 0, 162432, 0, 0, 0, 162448, 0, 0, 0
    .long 162528, 0, 0, 0, 162544, 0, 0, 0, 162496, 0, 0, 0, 162512, 0, 0, 0
    .long 162592, 0, 0, 0, 162608, 0, 0, 0, 162560, 0, 0, 0, 162576, 0, 0, 0
    .long 162656, 0, 0, 0, 162672, 0, 0, 0, 162624, 0, 0, 0, 162640, 0, 0, 0
    .long 162720, 0, 0, 0, 162736, 0, 0, 0, 162688, 0, 0, 0, 162704, 0, 0, 0
    .long 163616, 0, 0, 0, 163632, 0, 0, 0, 163584, 0, 0, 0, 163600, 0, 0, 0
    .long 163680, 0, 0, 0, 163696, 0, 0, 0, 163648, 0, 0, 0, 163664, 0, 0, 0
    .long 163744, 0, 0, 0, 163760, 0, 0, 0, 163712, 0, 0, 0, 163728, 0, 0, 0
    .long 163808, 0, 0, 0, 163824, 0, 0, 0, 163776, 0, 0, 0, 163792, 0, 0, 0
    .long 163872, 0, 0, 0, 163888, 0, 0, 0, 163840, 0, 0, 0, 163856, 0, 0, 0
    .long 164768, 0, 0, 0, 164784, 0, 0, 0, 164736, 0, 0, 0, 164752, 0, 0, 0
    .long 164832, 0, 0, 0, 164848, 0, 0, 0, 164800, 0, 0, 0, 164816, 0, 0, 0
    .long 164896, 0, 0, 0, 164912, 0, 0, 0, 164864, 0, 0, 0, 164880, 0, 0, 0
    .long 164960, 0, 0, 0, 164976, 0, 0, 0, 164928, 0, 0, 0, 164944, 0, 0, 0
    .long 165024, 0, 0, 0, 165040, 0, 0, 0, 164992, 0, 0, 0, 165008, 0, 0, 0
    .long 0, 1024, 2048, 0, 16, 1040, 2064, 16, 32, 1056, 2080, 32, 48, 1072, 2096, 48
    .long 64, 1088, 2112, 64, 80, 1104, 2128, 80, 96, 1120, 2144, 96, 112, 1136, 2160, 112
    .long 128, 1152, 2176, 128, 144, 1168, 2192, 144, 160, 1184, 2208, 160, 176, 1200, 2224, 176
    .long 192, 1216, 2240, 192, 208, 1232, 2256, 208, 224, 1248, 2272, 224, 240, 1264, 2288, 240
    .long 256, 1280, 2304, 256, 272, 1296, 2320, 272, 288, 1312, 2336, 288, 304, 1328, 2352, 304
    .long 320, 1344, 2368, 320, 336, 1360, 2384, 336, 352, 1376, 2400, 352, 368, 1392, 2416, 368
    .long 384, 1408, 2432, 384, 400, 1424, 2448, 400, 416, 1440, 2464, 416, 432, 1456, 2480, 432
    .long 448, 1472, 2496, 448, 464, 1488, 2512, 464, 480, 1504, 2528, 480, 496, 1520, 2544, 496
    .long 512, 1536, 2560, 512, 528, 1552, 2576, 528, 544, 1568, 2592, 544, 560, 1584, 2608, 560
    .long 576, 1600, 2624, 576, 592, 1616, 2640, 592, 608, 1632, 2656, 608, 624, 1648, 2672, 624
    .long 640, 1664, 2672, 640, 656, 1680, 2672, 656, 672, 1696, 2672, 6816, 688, 1712, 2672, 6832
    .long 704, 1728, 2672, 6848, 720, 1744, 2672, 6864, 736, 1760, 2672, 6880, 752, 1776, 2672, 6896
    .long 768, 1792, 2672, 6912, 784, 1808, 2672, 6928, 800, 1824, 2672, 6944, 816, 1840, 2672, 6960
    .long 832, 1856, 2672, 6976, 848, 1872, 2672, 6992, 864, 1888, 2672, 7008, 880, 1904, 2672, 7024
    .long 896, 1920, 2672, 7040, 912, 1936, 2672, 7056, 928, 1952, 2672, 7072, 944, 1968, 2672, 7088
    .long 960, 1984, 2672, 7104, 976, 2000, 2672, 7120, 992, 2016, 2672, 7136, 1008, 2032, 2672, 7152
    .long 7168, 20480, 0, 0, 7184, 20496, 0, 0, 7200, 20512, 0, 0, 7216, 20528, 0, 0
    .long 7232, 20544, 0, 0, 7248, 20560, 0, 0, 7264, 20576, 0, 0, 7280, 20592, 0, 0
    .long 7296, 20608, 0, 0, 7312, 20624, 0, 0, 7328, 20640, 0, 0, 7344, 20656, 0, 0
    .long 7360, 20672, 0, 0, 7376, 20688, 0, 0, 7392, 20704, 0, 0, 7408, 20720, 0, 0
    .long 7424, 20736, 0, 0, 7440, 20752, 0, 0, 7456, 20768, 0, 0, 7472, 20784, 0, 0
    .long 13632, 20800, 0, 0, 13648, 20816, 0, 0, 13664, 20832, 0, 0, 13680, 20848, 0, 0
    .long 13696, 20864, 0, 0, 13712, 20880, 0, 0, 13728, 20896, 0, 0, 13744, 20912, 0, 0
    .long 13760, 20928, 0, 0, 13776, 20944, 0, 0, 13792, 20960, 0, 0, 13808, 20976, 0, 0
    .long 13824, 20992, 0, 0, 13840, 21008, 0, 0, 13856, 21024, 0, 0, 13872, 21040, 0, 0
    .long 13888, 21056, 0, 0, 13904, 21072, 0, 0, 13920, 21088, 0, 0, 13936, 21104, 0, 0
    .long 13952, 21104, 0, 0, 13968, 21104, 0, 0, 13984, 21104, 0, 0, 14000, 21104, 0, 0
    .long 14016, 21104, 0, 0, 14032, 21104, 0, 0, 14048, 21104, 0, 0, 14064, 21104, 0, 0
    .long 14080, 21104, 0, 0, 14096, 21104, 0, 0, 14112, 21104, 0, 0, 14128, 21104, 0, 0
    .long 14144, 21104, 0, 0, 14160, 21104, 0, 0, 14176, 21104, 0, 0, 14192, 21104, 0, 0
    .long 14208, 21104, 0, 0, 14224, 21104, 0, 0, 14240, 21104, 0, 0, 14256, 21104, 0, 0
    .long 14272, 21104, 0, 0, 14288, 21104, 0, 0, 20448, 21104, 0, 0, 20464, 21104, 0, 0
L_tab_end:
L_code_end:

.section .rodata,"a"
.p2align 6
.amdhsa_kernel recurrent_scan__sliding_local_dilated__glu_gated_reglu__prompt_kernel
  .amdhsa_next_free_vgpr 256
  .amdhsa_next_free_sgpr 102
  .amdhsa_accum_offset 256
  .amdhsa_group_segment_fixed_size 0
  .amdhsa_kernarg_size 80
  .amdhsa_user_sgpr_count 2
  .amdhsa_user_sgpr_kernarg_segment_ptr 1
  .amdhsa_system_sgpr_workgroup_id_x 1
  .amdhsa_float_denorm_mode_32 3
.end_amdhsa_kernel
```
